```python
import torch

def _softmax(x, axis=-1):
    return torch.softmax(x, dim=axis)
def _gelu(x):
    return torch.nn.functional.gelu(x, approximate="tanh")
def _silu(x):
    return torch.nn.functional.silu(x)
def _sigmoid(x):
    return torch.sigmoid(x)
def _layernorm(x, axis=-1, eps=1e-5):
    m = x.mean(dim=axis, keepdim=True)
    v = x.var(dim=axis, keepdim=True, unbiased=False)
    return (x - m) / torch.sqrt(v + eps)
def _scatter_add(tgt, idx, src, axis=0):
    return tgt.clone().index_add_(axis, idx, src)
def _segment_sum(src, seg, n):
    out = torch.zeros((n,) + src.shape[1:], dtype=src.dtype)
    return out.index_add_(0, seg, src)
def _pad(x, pw):
    flat = tuple(v for pair in reversed(pw) for v in pair)
    return torch.nn.functional.pad(x, flat)

kernel_name = 'standalone__gqa_block_cached__near_ridge'

def setup_inputs():

    _w = (lambda a: (lambda t: t.to(torch.bfloat16) if t.is_floating_point() else t)(torch.as_tensor(a)))
    B, Sq, D = 32, 48, 448
    Hq, Hkv, Sk, Dh = 16, 8, 512, 256
    assert Hq % Hkv == 0, (Hq, Hkv)
    return {
        "x": _w((lambda *s: torch.randn(*s, dtype=torch.bfloat16) * 0.8)(B, Sq, D)),
        "k_cache": _w((lambda *s: torch.randn(*s, dtype=torch.bfloat16) * 0.8)(B, Hkv, Sk, Dh)),
        "v_cache": _w((lambda *s: torch.randn(*s, dtype=torch.bfloat16) * 0.05)(B, Hkv, Sk, Dh)),
        "wq": _w((lambda *s: torch.randn(*s, dtype=torch.bfloat16) * 0.8)(D, Hq * Dh) * (D ** -0.5)),
        "wo": _w((lambda *s: torch.randn(*s, dtype=torch.bfloat16) * 0.05)(Hq * Dh, D) * ((Hq * Dh) ** -0.5)),
    }

def reference(x, k_cache, v_cache, wq, wo):
    B, Sq, D = x.shape
    Hq, Dh = 16, 256
    Hkv = k_cache.shape[1]
    rep = Hq // Hkv
    q = (lambda x, *d: x.permute(*d))((x @ wq).reshape(B, Sq, Hq, Dh), 0, 2, 1, 3)
    k = (lambda x, n, axis: torch.repeat_interleave(x, n, dim=axis))(k_cache, rep, axis=1)
    v = (lambda x, n, axis: torch.repeat_interleave(x, n, dim=axis))(v_cache, rep, axis=1)
    scores = torch.einsum("bhqd,bhkd->bhqk", q, k) * (Dh ** -0.5)
    p = _softmax(scores, axis=-1)
    o = torch.einsum("bhqk,bhkd->bhqd", p, v)
    return (lambda x, *d: x.permute(*d))(o, 0, 2, 1, 3).reshape(B, Sq, Hq * Dh) @ wo
```

```asm
; @launch grid=(256,1,1) block=(512,1,1) lds=163840
.amdgcn_target "amdgcn-amd-amdhsa--gfx950"
.text
.globl standalone__gqa_block_cached__near_ridge_kernel
.p2align 8
.type standalone__gqa_block_cached__near_ridge_kernel,@function
standalone__gqa_block_cached__near_ridge_kernel:
s_cmp_ge_u32 s2, 256
s_cbranch_scc1 L_exit
s_load_dwordx8 s[64:71], s[0:1], 0
s_load_dwordx8 s[72:79], s[0:1], 32
v_lshrrev_b32 v12, 6, v0
v_and_b32 v1, 63, v0
v_readfirstlane_b32 s58, v12
v_and_b32 v12, 3, v12
s_lshr_b32 s48, s2, 3
s_and_b32 s49, s2, 7
s_bfe_u32 s57, s48, 0x10000
s_and_b32 s41, s58, 3
s_cmp_ge_u32 s58, 4
s_cbranch_scc1 L_att
v_lshrrev_b32 v2, 3, v1
v_and_b32 v3, 7, v1
v_and_b32 v4, 1, v12
s_lshl_b32 s42, s41, 12
v_lshrrev_b32 v5, 1, v2
v_lshl_or_b32 v5, v4, 2, v5
v_xor_b32 v5, v5, v3
v_lshl_add_u32 v6, v4, 3, v2
v_lshrrev_b32 v7, 1, v12
v_mul_u32_u24 v233, 896, v6
v_lshl_add_u32 v233, v7, 9, v233
v_lshl_add_u32 v233, v5, 4, v233
s_mov_b32 s6, 43008
s_mov_b32 s7, 0x20000
s_mul_i32 s44, s48, 43008
s_and_b32 s59, s41, 2
s_lshl_b32 s59, s59, 16
s_waitcnt lgkmcnt(0)
s_add_u32 s4, s64, s44
s_addc_u32 s5, s65, 0
s_add_u32 m0, s42, 0
s_nop 0
buffer_load_dwordx4 v233, s[4:7], 0 offen lds
s_add_u32 m0, s42, 896
s_nop 0
buffer_load_dwordx4 v233, s[4:7], 0 offen offset:128 lds
s_add_u32 m0, s42, 1792
s_nop 0
buffer_load_dwordx4 v233, s[4:7], 0 offen offset:256 lds
s_add_u32 m0, s42, 2688
s_nop 0
buffer_load_dwordx4 v233, s[4:7], s59 offen offset:384 lds
v_lshl_add_u32 v232, v12, 5, v2
v_lshlrev_b32 v244, 9, v232
v_lshl_add_u32 v232, v5, 4, v244
v_and_b32 v5, 2, v2
v_lshl_or_b32 v5, v4, 2, v5
v_xor_b32 v5, v5, v3
v_lshlrev_b32 v245, 13, v6
v_lshl_add_u32 v245, v7, 9, v245
v_lshl_add_u32 v245, v5, 4, v245
v_and_b32 v5, 6, v2
v_xor_b32 v5, v5, v3
v_lshl_add_u32 v244, v5, 4, v244
v_lshl_add_u32 v6, v4, 5, v2
v_lshl_add_u32 v6, v7, 8, v6
v_mul_u32_u24 v246, 896, v6
v_lshl_add_u32 v246, v5, 4, v246
s_mov_b32 s32, 3072
s_mov_b32 s35, 130048
s_mov_b32 s38, 6144
s_mov_b32 s33, 6144
s_mov_b32 s36, 260096
s_mov_b32 s39, 12288
s_mov_b32 s34, 9216
s_mov_b32 s37, 390144
s_mov_b32 s40, 18432
s_mov_b32 s11, 0x20000
s_mov_b32 s15, 0x20000
s_mov_b32 s19, 0x20000
s_mov_b32 s23, 0x20000
s_mov_b32 s27, 0x20000
s_mov_b32 s31, 0x20000
s_mov_b32 s63, 0x20000
s_mov_b32 s10, 262144
s_mov_b32 s14, 262144
s_mov_b32 s18, 3662848
s_mov_b32 s22, 458752
s_mov_b32 s26, 43008
s_mov_b32 s30, 43008
s_mov_b32 s62, 256
s_lshl_b32 s45, s2, 18
s_lshl_b32 s46, s49, 10
s_mul_i32 s47, s49, 458752
s_add_u32 s16, s70, s46
s_addc_u32 s17, s71, 0
s_add_u32 s8, s66, s45
s_addc_u32 s9, s67, 0
s_add_u32 s12, s68, s45
s_addc_u32 s13, s69, 0
s_add_u32 s20, s72, s47
s_addc_u32 s21, s73, 0
s_add_u32 s28, s74, s44
s_addc_u32 s29, s75, 0
s_add_u32 m0, s42, 16384
v_add_u32 v233, 0x3800, v233
buffer_load_dwordx4 v233, s[4:7], 0 offen lds
s_add_u32 m0, s42, 17280
s_nop 0
buffer_load_dwordx4 v233, s[4:7], 0 offen offset:128 lds
s_add_u32 m0, s42, 18176
s_nop 0
buffer_load_dwordx4 v233, s[4:7], 0 offen offset:256 lds
s_add_u32 m0, s42, 19072
s_nop 0
buffer_load_dwordx4 v233, s[4:7], s59 offen offset:384 lds
s_add_u32 m0, s42, 32768
v_add_u32 v233, 0x3800, v233
buffer_load_dwordx4 v233, s[4:7], 0 offen lds
s_add_u32 m0, s42, 33664
s_nop 0
buffer_load_dwordx4 v233, s[4:7], 0 offen offset:128 lds
v_lshrrev_b32 v8, 4, v1
v_and_b32 v13, 15, v1
v_bfe_u32 v9, v1, 2, 2
v_and_b32 v10, 3, v1
v_lshrrev_b32 v5, 1, v13
v_xor_b32 v5, v5, v8
v_lshlrev_b32 v5, 4, v5
v_and_b32 v6, 7, v13
v_lshl_add_u32 v5, v6, 7, v5
v_lshrrev_b32 v6, 3, v13
v_lshl_add_u32 v234, v6, 12, v5
v_xor_b32 v235, 64, v234
v_and_b32 v6, 1, v8
v_lshrrev_b32 v11, 1, v9
v_lshl_or_b32 v11, v6, 1, v11
v_lshrrev_b32 v8, 1, v8
v_lshlrev_b32 v5, 1, v4
v_xor_b32 v5, v5, v11
v_lshlrev_b32 v5, 5, v5
v_lshl_add_u32 v5, v10, 3, v5
v_lshl_add_u32 v5, v9, 7, v5
v_lshl_add_u32 v236, v8, 10, v5
v_lshl_add_u32 v236, v6, 12, v236
v_lshl_add_u32 v236, v7, 13, v236
v_xor_b32 v237, 32, v236
v_xor_b32 v5, v12, v11
v_lshlrev_b32 v5, 5, v5
v_lshl_add_u32 v5, v10, 3, v5
v_lshl_add_u32 v5, v9, 7, v5
v_lshl_add_u32 v5, v6, 9, v5
v_lshl_add_u32 v247, v8, 10, v5
v_lshlrev_b32 v5, 4, v1
v_add_u32 v248, 131072, v5
v_mul_u32_u24 v238, 3072, v12
v_lshl_add_u32 v238, v8, 8, v238
v_lshl_add_u32 v238, v13, 4, v238
v_lshl_add_u32 v238, v6, 3, v238
v_add_u32 v238, 131072, v238
v_mul_u32_u24 v250, 1536, v12
v_add_u32 v249, v250, v5
v_lshl_add_u32 v250, v1, 3, v250
s_mul_i32 s44, s2, 43008
s_add_u32 s24, s78, s44
s_addc_u32 s25, s79, 0
s_mov_b32 s60, s76
s_mov_b32 s61, s77
s_lshl_b32 s44, s49, 7
s_add_u32 s50, s44, 128
s_sub_u32 s45, s50, 896
s_cselect_b32 s50, s50, s45
s_add_u32 s51, s50, 128
s_sub_u32 s45, s51, 896
s_cselect_b32 s51, s51, s45
s_add_u32 s52, s51, 128
s_sub_u32 s45, s52, 896
s_cselect_b32 s52, s52, s45
s_add_u32 s53, s52, 128
s_sub_u32 s45, s53, 896
s_cselect_b32 s53, s53, s45
s_add_u32 s54, s53, 128
s_sub_u32 s45, s54, 896
s_cselect_b32 s54, s54, s45
s_add_u32 s55, s54, 128
s_sub_u32 s45, s55, 896
s_cselect_b32 s55, s55, s45
s_add_u32 s56, s55, 128
s_sub_u32 s45, s56, 896
s_cselect_b32 s56, s56, s45
s_cmp_eq_u32 s57, 1
s_cbranch_scc1 L_p_c1
s_branch L_p_c0
L_att:
s_setprio 1
s_getpc_b64 s[46:47]
L_pc:
s_mov_b32 s44, L_p_c0-L_pc
s_cmp_eq_u32 s57, 1
s_cselect_b32 s44, L_p_c1-L_pc, s44
s_add_u32 s46, s46, s44
s_addc_u32 s47, s47, 0
s_lshr_b32 s44, s48, 1
s_lshl_b32 s44, s44, 0
s_and_b32 s45, s48, 0
s_or_b32 s44, s44, s45
s_lshl_b32 s44, s44, 2
s_add_u32 s44, s44, s41
s_mul_i32 s44, s44, 1024
v_min_u32 v14, 7, v1
v_lshl_add_u32 v14, v14, 7, s44
v_min_u32 v14, L_last_c1-L_p_c1, v14
v_mov_b32 v15, s47
v_add_co_u32 v14, vcc, s46, v14
s_nop 1
v_addc_co_u32 v15, vcc, 0, v15, vcc
global_load_dword v16, v[14:15], off
v_mbcnt_lo_u32_b32 v17, -1, 0
v_min_u32 v17, 6, v17
s_lshl_b32 s45, s48, 2
s_add_u32 s44, s41, s45
s_mul_i32 s44, s44, 7
v_add_u32 v17, s44, v17
v_lshlrev_b32 v17, 2, v17
v_lshrrev_b32 v18, 3, v17
v_and_b32 v17, 7, v17
v_lshlrev_b32 v17, 7, v17
v_lshl_add_u32 v17, v18, 13, v17
s_lshl_b32 s46, s49, 10
s_mov_b32 s18, 3662848
s_mov_b32 s19, 0x20000
s_waitcnt lgkmcnt(0)
s_add_u32 s16, s70, s46
s_addc_u32 s17, s71, 0
buffer_load_dword v18, v17, s[16:19], 0 offen
v_and_b32 v4, 1, v12
v_lshrrev_b32 v7, 1, v12
v_lshrrev_b32 v8, 4, v1
v_and_b32 v13, 15, v1
v_bfe_u32 v9, v1, 2, 2
v_and_b32 v10, 3, v1
v_lshrrev_b32 v5, 1, v13
v_xor_b32 v5, v5, v8
v_lshlrev_b32 v5, 4, v5
v_and_b32 v6, 7, v13
v_lshl_add_u32 v5, v6, 7, v5
v_lshrrev_b32 v6, 3, v13
v_lshl_add_u32 v5, v6, 12, v5
v_lshl_add_u32 v240, v4, 13, v5
v_xor_b32 v241, 64, v240
v_and_b32 v6, 1, v8
v_lshrrev_b32 v11, 1, v9
v_lshl_or_b32 v11, v6, 1, v11
v_lshrrev_b32 v8, 1, v8
v_lshlrev_b32 v5, 1, v4
v_xor_b32 v5, v5, v11
v_lshlrev_b32 v5, 5, v5
v_lshl_add_u32 v5, v10, 3, v5
v_lshl_add_u32 v5, v9, 7, v5
v_lshl_add_u32 v5, v6, 9, v5
v_lshl_add_u32 v244, v8, 12, v5
v_lshl_add_u32 v244, v4, 13, v244
v_lshlrev_b32 v5, 4, v1
v_add_u32 v5, 131072, v5
v_mul_u32_u24 v242, 6144, v7
v_add_u32 v242, v242, v5
v_mul_u32_u24 v243, 7168, v12
v_add_u32 v243, v243, v5
v_xor_b32 v248, 1, v12
v_mul_u32_u24 v248, 7168, v248
v_add_u32 v248, v248, v5
s_mov_b32 s43, 0x3db8aa3b
v_lshrrev_b32 v2, 3, v1
v_and_b32 v3, 7, v1
v_lshrrev_b32 v5, 1, v2
v_lshl_or_b32 v5, v4, 2, v5
v_xor_b32 v5, v5, v3
v_lshl_add_u32 v6, v12, 5, v2
v_lshlrev_b32 v6, 9, v6
v_lshl_add_u32 v245, v5, 4, v6
v_and_b32 v5, 2, v2
v_lshl_or_b32 v5, v4, 2, v5
v_xor_b32 v5, v5, v3
v_lshl_add_u32 v6, v4, 3, v2
v_lshlrev_b32 v6, 13, v6
v_lshl_add_u32 v6, v7, 9, v6
v_lshl_add_u32 v246, v5, 4, v6
s_lshl_b32 s42, s41, 12
s_mov_b32 s32, 3072
s_mov_b32 s35, 130048
s_mov_b32 s38, 6144
s_mov_b32 s33, 6144
s_mov_b32 s36, 260096
s_mov_b32 s39, 12288
s_mov_b32 s34, 9216
s_mov_b32 s37, 390144
s_mov_b32 s40, 18432
s_lshl_b32 s45, s2, 18
s_lshl_b32 s46, s49, 10
s_mul_i32 s47, s49, 458752
s_add_u32 s16, s70, s46
s_addc_u32 s17, s71, 0
s_mov_b32 s18, 3662848
s_mov_b32 s19, 0x20000
s_add_u32 s8, s66, s45
s_addc_u32 s9, s67, 0
s_mov_b32 s10, 262144
s_mov_b32 s11, 0x20000
s_add_u32 s12, s68, s45
s_addc_u32 s13, s69, 0
s_mov_b32 s14, 262144
s_mov_b32 s15, 0x20000
s_add_u32 s20, s72, s47
s_addc_u32 s21, s73, 0
s_mov_b32 s22, 458752
s_mov_b32 s23, 0x20000
s_lshl_b32 s44, s49, 7
s_add_u32 s50, s44, 128
s_sub_u32 s45, s50, 896
s_cselect_b32 s50, s50, s45
s_add_u32 s51, s50, 128
s_sub_u32 s45, s51, 896
s_cselect_b32 s51, s51, s45
s_add_u32 s52, s51, 128
s_sub_u32 s45, s52, 896
s_cselect_b32 s52, s52, s45
s_add_u32 s53, s52, 128
s_sub_u32 s45, s53, 896
s_cselect_b32 s53, s53, s45
s_add_u32 s54, s53, 128
s_sub_u32 s45, s54, 896
s_cselect_b32 s54, s54, s45
s_add_u32 s55, s54, 128
s_sub_u32 s45, s55, 896
s_cselect_b32 s55, s55, s45
s_add_u32 s56, s55, 128
s_sub_u32 s45, s56, 896
s_cselect_b32 s56, s56, s45
s_lshl_b32 s44, s48, 12
s_add_u32 s44, s44, 16777216
s_add_u32 s24, s78, s44
s_addc_u32 s25, s79, 0
s_mov_b32 s26, 4096
s_mov_b32 s27, 0x20000
s_mov_b32 s60, s76
s_mov_b32 s61, s77
s_mov_b32 s62, 256
s_mov_b32 s63, 0x20000
v_mov_b32 v252, 0
v_mov_b32 v253, 1
s_lshl_b32 s46, s48, 3
s_and_b32 s47, s48, 7
s_xor_b32 s47, s47, s49
s_cbranch_scc1 L_noclr
v_lshlrev_b32 v20, 4, v1
v_mov_b32 v32, 0
v_mov_b32 v33, 0
v_mov_b32 v34, 0
v_mov_b32 v35, 0
s_lshl_b32 s44, s41, 10
buffer_store_dwordx4 v[32:35], v20, s[24:27], s44 offen offset:0 sc1
s_waitcnt vmcnt(0)
L_noclr:
s_cmp_eq_u32 s57, 1
s_cbranch_scc1 L_a_c1
s_branch L_a_c0
L_exit:
s_endpgm
.p2align 6
L_p_c0:
s_add_u32 m0, s42, 34560
s_nop 0
buffer_load_dwordx4 v233, s[4:7], 0 offen offset:256 lds
s_add_u32 m0, s42, 35456
s_nop 0
buffer_load_dwordx4 v233, s[4:7], s59 offen offset:384 lds
s_add_u32 m0, s42, 49152
s_nop 0
buffer_load_dwordx4 v245, s[16:19], 0 offen lds
buffer_load_dwordx4 v245, s[16:19], s35 offen offset:1024 lds
buffer_load_dwordx4 v245, s[16:19], s36 offen offset:2048 lds
s_waitcnt vmcnt(11)
s_barrier
ds_read_b128 v[0:3], v234
buffer_load_dwordx4 v245, s[16:19], s37 offen offset:3072 lds
ds_read_b128 v[12:15], v235
ds_read_b128 v[24:27], v234 offset:1024
ds_read_b128 v[36:39], v235 offset:1024
ds_read_b128 v[48:51], v234 offset:2048
ds_read_b128 v[60:63], v235 offset:2048
ds_read_b128 v[72:75], v234 offset:3072
ds_read_b128 v[84:87], v235 offset:3072
ds_read_b128 v[96:99], v234 offset:8192
ds_read_b128 v[108:111], v235 offset:8192
ds_read_b128 v[120:123], v234 offset:9216
ds_read_b128 v[132:135], v235 offset:9216
s_add_u32 m0, s42, 65536
v_add_u32 v245, 0x80000, v245
buffer_load_dwordx4 v245, s[16:19], 0 offen lds
ds_read_b128 v[144:147], v234 offset:10240
ds_read_b128 v[156:159], v235 offset:10240
buffer_load_dwordx4 v245, s[16:19], s35 offen offset:1024 lds
buffer_load_dwordx4 v245, s[16:19], s36 offen offset:2048 lds
buffer_load_dwordx4 v245, s[16:19], s37 offen offset:3072 lds
s_add_u32 m0, s42, 81920
v_add_u32 v245, 0x80000, v245
buffer_load_dwordx4 v245, s[16:19], 0 offen lds
buffer_load_dwordx4 v245, s[16:19], s35 offen offset:1024 lds
buffer_load_dwordx4 v245, s[16:19], s36 offen offset:2048 lds
buffer_load_dwordx4 v245, s[16:19], s37 offen offset:3072 lds
s_add_u32 m0, s42, 98304
v_add_u32 v245, 0x80000, v245
buffer_load_dwordx4 v245, s[16:19], 0 offen lds
buffer_load_dwordx4 v245, s[16:19], s35 offen offset:1024 lds
buffer_load_dwordx4 v245, s[16:19], s36 offen offset:2048 lds
s_waitcnt vmcnt(15) lgkmcnt(0)
s_barrier
ds_read_b128 v[4:7], v234 offset:16384
ds_read_b128 v[8:11], v234 offset:32768
ds_read_b128 v[16:19], v235 offset:16384
ds_read_b128 v[20:23], v235 offset:32768
buffer_load_dwordx4 v245, s[16:19], s37 offen offset:3072 lds
ds_read_b128 v[28:31], v234 offset:17408
ds_read_b128 v[32:35], v234 offset:33792
ds_read_b128 v[40:43], v235 offset:17408
ds_read_b128 v[44:47], v235 offset:33792
ds_read_b128 v[52:55], v234 offset:18432
ds_read_b128 v[56:59], v234 offset:34816
ds_read_b128 v[64:67], v235 offset:18432
ds_read_b128 v[68:71], v235 offset:34816
ds_read_b128 v[76:79], v234 offset:19456
ds_read_b128 v[80:83], v234 offset:35840
ds_read_b128 v[88:91], v235 offset:19456
ds_read_b128 v[92:95], v235 offset:35840
s_add_u32 m0, s42, 114688
v_add_u32 v245, 0x80000, v245
buffer_load_dwordx4 v245, s[16:19], 0 offen lds
ds_read_b128 v[100:103], v234 offset:24576
ds_read_b128 v[104:107], v234 offset:40960
ds_read_b128 v[112:115], v235 offset:24576
ds_read_b128 v[116:119], v235 offset:40960
ds_read_b128 v[124:127], v234 offset:25600
ds_read_b128 v[128:131], v234 offset:41984
ds_read_b128 v[136:139], v235 offset:25600
ds_read_b128 v[140:143], v235 offset:41984
buffer_load_dwordx4 v245, s[16:19], s35 offen offset:1024 lds
ds_read_b128 v[148:151], v234 offset:26624
ds_read_b128 v[152:155], v234 offset:43008
ds_read_b128 v[160:163], v235 offset:26624
ds_read_b128 v[164:167], v235 offset:43008
buffer_load_dwordx4 v245, s[16:19], s36 offen offset:2048 lds
s_waitcnt vmcnt(11) lgkmcnt(0)
s_barrier
ds_read_b64_tr_b16 v[192:193], v236 offset:49152
buffer_load_dwordx4 v245, s[16:19], s37 offen offset:3072 lds
ds_read_b64_tr_b16 v[194:195], v236 offset:49664
ds_read_b64_tr_b16 v[196:197], v236 offset:51200
ds_read_b64_tr_b16 v[198:199], v236 offset:51712
ds_read_b64_tr_b16 v[200:201], v237 offset:51200
ds_read_b64_tr_b16 v[202:203], v237 offset:51712
ds_read_b64_tr_b16 v[204:205], v237 offset:49152
ds_read_b64_tr_b16 v[206:207], v237 offset:49664
v_xor_b32 v236, 0x10000, v236
ds_read_b64_tr_b16 v[208:209], v236
ds_read_b64_tr_b16 v[210:211], v236 offset:512
ds_read_b64_tr_b16 v[212:213], v236 offset:2048
s_add_u32 m0, s42, 0
v_add_u32 v245, 0x80000, v245
buffer_load_dwordx4 v245, s[16:19], 0 offen lds
ds_read_b64_tr_b16 v[214:215], v236 offset:2560
v_xor_b32 v237, 0x10000, v237
ds_read_b64_tr_b16 v[216:217], v237 offset:2048
ds_read_b64_tr_b16 v[218:219], v237 offset:2560
s_waitcnt lgkmcnt(12)
v_mfma_f32_16x16x32_bf16 v[168:171], v[192:195], v[0:3], 0
ds_read_b64_tr_b16 v[220:221], v237
ds_read_b64_tr_b16 v[222:223], v237 offset:512
s_waitcnt lgkmcnt(12)
v_mfma_f32_16x16x32_bf16 v[168:171], v[196:199], v[12:15], v[168:171]
buffer_load_dwordx4 v245, s[16:19], s35 offen offset:1024 lds
v_mfma_f32_16x16x32_bf16 v[172:175], v[196:199], v[16:19], 0
v_mfma_f32_16x16x32_bf16 v[172:175], v[192:195], v[4:7], v[172:175]
v_mfma_f32_16x16x32_bf16 v[176:179], v[192:195], v[8:11], 0
v_mfma_f32_16x16x32_bf16 v[176:179], v[196:199], v[20:23], v[176:179]
buffer_load_dwordx4 v245, s[16:19], s36 offen offset:2048 lds
s_waitcnt lgkmcnt(10)
v_mfma_f32_16x16x32_bf16 v[188:191], v[200:203], v[20:23], 0
s_waitcnt lgkmcnt(8)
v_mfma_f32_16x16x32_bf16 v[188:191], v[204:207], v[8:11], v[188:191]
v_mfma_f32_16x16x32_bf16 v[184:187], v[204:207], v[4:7], 0
buffer_load_dwordx4 v245, s[16:19], s37 offen offset:3072 lds
v_mfma_f32_16x16x32_bf16 v[184:187], v[200:203], v[16:19], v[184:187]
v_mfma_f32_16x16x32_bf16 v[180:183], v[200:203], v[12:15], 0
v_mfma_f32_16x16x32_bf16 v[180:183], v[204:207], v[0:3], v[180:183]
s_waitcnt lgkmcnt(6)
v_mfma_f32_16x16x32_bf16 v[168:171], v[208:211], v[24:27], v[168:171]
s_add_u32 m0, s42, 16384
v_add_u32 v245, 0x80000, v245
buffer_load_dwordx4 v245, s[16:19], 0 offen lds
s_waitcnt lgkmcnt(4)
v_mfma_f32_16x16x32_bf16 v[168:171], v[212:215], v[36:39], v[168:171]
v_mfma_f32_16x16x32_bf16 v[172:175], v[212:215], v[40:43], v[172:175]
v_mfma_f32_16x16x32_bf16 v[172:175], v[208:211], v[28:31], v[172:175]
buffer_load_dwordx4 v245, s[16:19], s35 offen offset:1024 lds
v_mfma_f32_16x16x32_bf16 v[176:179], v[208:211], v[32:35], v[176:179]
v_mfma_f32_16x16x32_bf16 v[176:179], v[212:215], v[44:47], v[176:179]
s_waitcnt lgkmcnt(2)
v_mfma_f32_16x16x32_bf16 v[188:191], v[216:219], v[44:47], v[188:191]
s_waitcnt lgkmcnt(0)
v_mfma_f32_16x16x32_bf16 v[188:191], v[220:223], v[32:35], v[188:191]
buffer_load_dwordx4 v245, s[16:19], s36 offen offset:2048 lds
v_mfma_f32_16x16x32_bf16 v[184:187], v[220:223], v[28:31], v[184:187]
v_mfma_f32_16x16x32_bf16 v[184:187], v[216:219], v[40:43], v[184:187]
s_waitcnt vmcnt(11)
s_barrier
ds_read_b64_tr_b16 v[192:193], v236 offset:16384
buffer_load_dwordx4 v245, s[16:19], s37 offen offset:3072 lds
ds_read_b64_tr_b16 v[194:195], v236 offset:16896
v_mfma_f32_16x16x32_bf16 v[180:183], v[216:219], v[36:39], v[180:183]
ds_read_b64_tr_b16 v[196:197], v236 offset:18432
ds_read_b64_tr_b16 v[198:199], v236 offset:18944
v_mfma_f32_16x16x32_bf16 v[180:183], v[220:223], v[24:27], v[180:183]
ds_read_b64_tr_b16 v[200:201], v237 offset:18432
ds_read_b64_tr_b16 v[202:203], v237 offset:18944
ds_read_b64_tr_b16 v[204:205], v237 offset:16384
ds_read_b64_tr_b16 v[206:207], v237 offset:16896
v_mbcnt_lo_u32_b32 v251, -1, 0
v_min_u32 v251, 20, v251
s_lshl_b32 s45, s48, 2
s_add_u32 s44, s41, s45
s_mul_i32 s44, s44, 21
v_add_u32 v251, s44, v251
v_mul_u32_u24 v252, 21846, v251
v_lshrrev_b32 v252, 16, v252
v_add3_u32 v251, v251, v252, 1
v_lshrrev_b32 v252, 3, v251
v_and_b32 v251, 7, v251
v_lshlrev_b32 v251, 7, v251
v_lshl_add_u32 v251, v252, 13, v251
buffer_load_dword v252, v251, s[16:19], 0 offen
s_waitcnt lgkmcnt(6)
v_mfma_f32_16x16x32_bf16 v[168:171], v[192:195], v[48:51], v[168:171]
ds_read_b64_tr_b16 v[208:209], v236 offset:32768
ds_read_b64_tr_b16 v[210:211], v236 offset:33280
s_waitcnt lgkmcnt(6)
v_mfma_f32_16x16x32_bf16 v[168:171], v[196:199], v[60:63], v[168:171]
ds_read_b64_tr_b16 v[212:213], v236 offset:34816
ds_read_b64_tr_b16 v[214:215], v236 offset:35328
v_mfma_f32_16x16x32_bf16 v[172:175], v[196:199], v[64:67], v[172:175]
s_add_u32 m0, s42, 32768
s_nop 0
buffer_load_dwordx4 v232, s[8:11], 0 offen nt lds
v_mfma_f32_16x16x32_bf16 v[172:175], v[192:195], v[52:55], v[172:175]
ds_read_b64_tr_b16 v[216:217], v237 offset:34816
ds_read_b64_tr_b16 v[218:219], v237 offset:35328
v_mfma_f32_16x16x32_bf16 v[176:179], v[192:195], v[56:59], v[176:179]
ds_read_b64_tr_b16 v[220:221], v237 offset:32768
ds_read_b64_tr_b16 v[222:223], v237 offset:33280
v_mfma_f32_16x16x32_bf16 v[176:179], v[196:199], v[68:71], v[176:179]
s_waitcnt lgkmcnt(10)
v_mfma_f32_16x16x32_bf16 v[188:191], v[200:203], v[68:71], v[188:191]
buffer_load_dwordx4 v232, s[8:11], s32 offen offset:1024 nt lds
s_waitcnt lgkmcnt(8)
v_mfma_f32_16x16x32_bf16 v[188:191], v[204:207], v[56:59], v[188:191]
v_mfma_f32_16x16x32_bf16 v[184:187], v[204:207], v[52:55], v[184:187]
v_mfma_f32_16x16x32_bf16 v[184:187], v[200:203], v[64:67], v[184:187]
buffer_load_dwordx4 v232, s[8:11], s33 offen offset:2048 nt lds
v_mfma_f32_16x16x32_bf16 v[180:183], v[200:203], v[60:63], v[180:183]
v_mfma_f32_16x16x32_bf16 v[180:183], v[204:207], v[48:51], v[180:183]
s_waitcnt lgkmcnt(6)
v_mfma_f32_16x16x32_bf16 v[168:171], v[208:211], v[72:75], v[168:171]
s_waitcnt lgkmcnt(4)
v_mfma_f32_16x16x32_bf16 v[168:171], v[212:215], v[84:87], v[168:171]
buffer_load_dwordx4 v232, s[8:11], s34 offen offset:3072 nt lds
v_mfma_f32_16x16x32_bf16 v[172:175], v[212:215], v[88:91], v[172:175]
v_mfma_f32_16x16x32_bf16 v[172:175], v[208:211], v[76:79], v[172:175]
v_mfma_f32_16x16x32_bf16 v[176:179], v[208:211], v[80:83], v[176:179]
v_mfma_f32_16x16x32_bf16 v[176:179], v[212:215], v[92:95], v[176:179]
s_waitcnt lgkmcnt(2)
v_mfma_f32_16x16x32_bf16 v[188:191], v[216:219], v[92:95], v[188:191]
s_waitcnt lgkmcnt(0)
v_mfma_f32_16x16x32_bf16 v[188:191], v[220:223], v[80:83], v[188:191]
v_mfma_f32_16x16x32_bf16 v[184:187], v[220:223], v[76:79], v[184:187]
v_mfma_f32_16x16x32_bf16 v[184:187], v[216:219], v[88:91], v[184:187]
s_waitcnt vmcnt(9)
s_barrier
ds_read_b64_tr_b16 v[192:193], v236 offset:49152
ds_read_b64_tr_b16 v[194:195], v236 offset:49664
v_mfma_f32_16x16x32_bf16 v[180:183], v[216:219], v[84:87], v[180:183]
ds_read_b64_tr_b16 v[196:197], v236 offset:51200
ds_read_b64_tr_b16 v[198:199], v236 offset:51712
v_mfma_f32_16x16x32_bf16 v[180:183], v[220:223], v[72:75], v[180:183]
ds_read_b64_tr_b16 v[200:201], v237 offset:51200
ds_read_b64_tr_b16 v[202:203], v237 offset:51712
ds_read_b64_tr_b16 v[204:205], v237 offset:49152
ds_read_b64_tr_b16 v[206:207], v237 offset:49664
v_xor_b32 v236, 0x10000, v236
ds_read_b64_tr_b16 v[208:209], v236
ds_read_b64_tr_b16 v[210:211], v236 offset:512
ds_read_b64_tr_b16 v[212:213], v236 offset:2048
ds_read_b64_tr_b16 v[214:215], v236 offset:2560
v_xor_b32 v237, 0x10000, v237
ds_read_b64_tr_b16 v[216:217], v237 offset:2048
ds_read_b64_tr_b16 v[218:219], v237 offset:2560
ds_read_b64_tr_b16 v[220:221], v237
ds_read_b64_tr_b16 v[222:223], v237 offset:512
s_waitcnt lgkmcnt(14)
v_mfma_f32_16x16x32_bf16 v[168:171], v[192:195], v[96:99], v[168:171]
s_waitcnt lgkmcnt(12)
v_mfma_f32_16x16x32_bf16 v[168:171], v[196:199], v[108:111], v[168:171]
v_mfma_f32_16x16x32_bf16 v[172:175], v[196:199], v[112:115], v[172:175]
v_mfma_f32_16x16x32_bf16 v[172:175], v[192:195], v[100:103], v[172:175]
v_mfma_f32_16x16x32_bf16 v[176:179], v[192:195], v[104:107], v[176:179]
v_mfma_f32_16x16x32_bf16 v[176:179], v[196:199], v[116:119], v[176:179]
s_waitcnt lgkmcnt(10)
v_mfma_f32_16x16x32_bf16 v[188:191], v[200:203], v[116:119], v[188:191]
s_waitcnt lgkmcnt(8)
v_mfma_f32_16x16x32_bf16 v[188:191], v[204:207], v[104:107], v[188:191]
v_mfma_f32_16x16x32_bf16 v[184:187], v[204:207], v[100:103], v[184:187]
v_mfma_f32_16x16x32_bf16 v[184:187], v[200:203], v[112:115], v[184:187]
v_mfma_f32_16x16x32_bf16 v[180:183], v[200:203], v[108:111], v[180:183]
v_mfma_f32_16x16x32_bf16 v[180:183], v[204:207], v[96:99], v[180:183]
s_waitcnt lgkmcnt(6)
v_mfma_f32_16x16x32_bf16 v[168:171], v[208:211], v[120:123], v[168:171]
s_waitcnt lgkmcnt(4)
v_mfma_f32_16x16x32_bf16 v[168:171], v[212:215], v[132:135], v[168:171]
v_mfma_f32_16x16x32_bf16 v[172:175], v[212:215], v[136:139], v[172:175]
v_mfma_f32_16x16x32_bf16 v[172:175], v[208:211], v[124:127], v[172:175]
v_mfma_f32_16x16x32_bf16 v[176:179], v[208:211], v[128:131], v[176:179]
v_mfma_f32_16x16x32_bf16 v[176:179], v[212:215], v[140:143], v[176:179]
s_waitcnt lgkmcnt(2)
v_mfma_f32_16x16x32_bf16 v[188:191], v[216:219], v[140:143], v[188:191]
s_waitcnt lgkmcnt(0)
v_mfma_f32_16x16x32_bf16 v[188:191], v[220:223], v[128:131], v[188:191]
v_mfma_f32_16x16x32_bf16 v[184:187], v[220:223], v[124:127], v[184:187]
v_mfma_f32_16x16x32_bf16 v[184:187], v[216:219], v[136:139], v[184:187]
s_waitcnt vmcnt(5)
s_barrier
ds_read_b64_tr_b16 v[192:193], v236 offset:16384
ds_read_b64_tr_b16 v[194:195], v236 offset:16896
v_mfma_f32_16x16x32_bf16 v[180:183], v[216:219], v[132:135], v[180:183]
ds_read_b64_tr_b16 v[196:197], v236 offset:18432
ds_read_b64_tr_b16 v[198:199], v236 offset:18944
v_mfma_f32_16x16x32_bf16 v[180:183], v[220:223], v[120:123], v[180:183]
ds_read_b64_tr_b16 v[200:201], v237 offset:18432
ds_read_b64_tr_b16 v[202:203], v237 offset:18944
ds_read_b64_tr_b16 v[204:205], v237 offset:16384
ds_read_b64_tr_b16 v[206:207], v237 offset:16896
s_waitcnt lgkmcnt(6)
v_mfma_f32_16x16x32_bf16 v[168:171], v[192:195], v[144:147], v[168:171]
s_waitcnt lgkmcnt(4)
v_mfma_f32_16x16x32_bf16 v[168:171], v[196:199], v[156:159], v[168:171]
v_mfma_f32_16x16x32_bf16 v[172:175], v[196:199], v[160:163], v[172:175]
v_mfma_f32_16x16x32_bf16 v[172:175], v[192:195], v[148:151], v[172:175]
v_mfma_f32_16x16x32_bf16 v[176:179], v[192:195], v[152:155], v[176:179]
v_mfma_f32_16x16x32_bf16 v[176:179], v[196:199], v[164:167], v[176:179]
s_waitcnt lgkmcnt(2)
v_mfma_f32_16x16x32_bf16 v[188:191], v[200:203], v[164:167], v[188:191]
s_waitcnt lgkmcnt(0)
v_mfma_f32_16x16x32_bf16 v[188:191], v[204:207], v[152:155], v[188:191]
v_mfma_f32_16x16x32_bf16 v[184:187], v[204:207], v[148:151], v[184:187]
v_mfma_f32_16x16x32_bf16 v[184:187], v[200:203], v[160:163], v[184:187]
v_mfma_f32_16x16x32_bf16 v[180:183], v[200:203], v[156:159], v[180:183]
v_mfma_f32_16x16x32_bf16 v[180:183], v[204:207], v[144:147], v[180:183]
v_cvt_pk_bf16_f32 v224, v168, v169
v_cvt_pk_bf16_f32 v225, v170, v171
v_cvt_pk_bf16_f32 v226, v172, v173
v_cvt_pk_bf16_f32 v227, v174, v175
v_cvt_pk_bf16_f32 v228, v176, v177
v_cvt_pk_bf16_f32 v229, v178, v179
s_nop 1
v_cvt_pk_bf16_f32 v230, v180, v181
v_cvt_pk_bf16_f32 v231, v182, v183
v_cvt_pk_bf16_f32 v240, v184, v185
v_cvt_pk_bf16_f32 v241, v186, v187
v_cvt_pk_bf16_f32 v242, v188, v189
v_cvt_pk_bf16_f32 v243, v190, v191
ds_write_b64 v238, v[224:225]
ds_write_b64 v238, v[226:227] offset:1024
ds_write_b64 v238, v[228:229] offset:2048
ds_write_b64 v238, v[230:231] offset:512
ds_write_b64 v238, v[240:241] offset:1536
ds_write_b64 v238, v[242:243] offset:2560
s_waitcnt vmcnt(0) lgkmcnt(0)
s_barrier
s_add_u32 m0, s42, 114688
v_add_u32 v245, 0xffe00080, v245
buffer_load_dwordx4 v245, s[16:19], s35 offen offset:1024 lds
buffer_load_dwordx4 v245, s[16:19], s36 offen offset:2048 lds
s_barrier
buffer_load_dwordx4 v245, s[16:19], s37 offen offset:3072 lds
s_add_u32 m0, s42, 0
v_add_u32 v245, 0x80000, v245
buffer_load_dwordx4 v245, s[16:19], 0 offen lds
buffer_load_dwordx4 v245, s[16:19], s35 offen offset:1024 lds
buffer_load_dwordx4 v245, s[16:19], s36 offen offset:2048 lds
buffer_load_dwordx4 v245, s[16:19], s37 offen offset:3072 lds
s_add_u32 m0, s42, 16384
v_add_u32 v245, 0x80000, v245
buffer_load_dwordx4 v245, s[16:19], 0 offen lds
buffer_load_dwordx4 v245, s[16:19], s35 offen offset:1024 lds
buffer_load_dwordx4 v245, s[16:19], s36 offen offset:2048 lds
buffer_load_dwordx4 v245, s[16:19], s37 offen offset:3072 lds
s_barrier
v_xor_b32 v236, 0x10000, v236
ds_read_b64_tr_b16 v[208:209], v236 offset:16384
ds_read_b64_tr_b16 v[210:211], v236 offset:16896
ds_read_b64_tr_b16 v[212:213], v236 offset:18432
s_add_u32 m0, s42, 32768
v_add_u32 v245, 0x80000, v245
buffer_load_dwordx4 v245, s[16:19], 0 offen lds
ds_read_b64_tr_b16 v[214:215], v236 offset:18944
v_xor_b32 v237, 0x10000, v237
ds_read_b64_tr_b16 v[216:217], v237 offset:18432
ds_read_b64_tr_b16 v[218:219], v237 offset:18944
ds_read_b64_tr_b16 v[220:221], v237 offset:16384
ds_read_b64_tr_b16 v[222:223], v237 offset:16896
s_waitcnt lgkmcnt(6)
v_mfma_f32_16x16x32_bf16 v[168:171], v[208:211], v[0:3], 0
buffer_load_dwordx4 v245, s[16:19], s35 offen offset:1024 lds
s_waitcnt lgkmcnt(4)
v_mfma_f32_16x16x32_bf16 v[168:171], v[212:215], v[12:15], v[168:171]
v_mfma_f32_16x16x32_bf16 v[172:175], v[212:215], v[16:19], 0
v_mfma_f32_16x16x32_bf16 v[172:175], v[208:211], v[4:7], v[172:175]
buffer_load_dwordx4 v245, s[16:19], s36 offen offset:2048 lds
v_mfma_f32_16x16x32_bf16 v[176:179], v[208:211], v[8:11], 0
v_mfma_f32_16x16x32_bf16 v[176:179], v[212:215], v[20:23], v[176:179]
s_waitcnt lgkmcnt(2)
v_mfma_f32_16x16x32_bf16 v[188:191], v[216:219], v[20:23], 0
s_waitcnt lgkmcnt(0)
v_mfma_f32_16x16x32_bf16 v[188:191], v[220:223], v[8:11], v[188:191]
buffer_load_dwordx4 v245, s[16:19], s37 offen offset:3072 lds
v_mfma_f32_16x16x32_bf16 v[184:187], v[220:223], v[4:7], 0
v_mfma_f32_16x16x32_bf16 v[184:187], v[216:219], v[16:19], v[184:187]
s_add_u32 m0, s42, 49152
v_add_u32 v245, 0x80000, v245
buffer_load_dwordx4 v245, s[16:19], 0 offen lds
buffer_load_dwordx4 v245, s[16:19], s35 offen offset:1024 lds
buffer_load_dwordx4 v245, s[16:19], s36 offen offset:2048 lds
buffer_load_dwordx4 v245, s[16:19], s37 offen offset:3072 lds
s_waitcnt vmcnt(12)
s_barrier
ds_read_b64_tr_b16 v[192:193], v236 offset:32768
ds_read_b64_tr_b16 v[194:195], v236 offset:33280
v_mfma_f32_16x16x32_bf16 v[180:183], v[216:219], v[12:15], 0
s_add_u32 m0, s42, 65536
v_add_u32 v232, 0x20000, v232
buffer_load_dwordx4 v232, s[8:11], s32 offen offset:1024 nt lds
v_mfma_f32_16x16x32_bf16 v[180:183], v[220:223], v[0:3], v[180:183]
ds_read_b64_tr_b16 v[196:197], v236 offset:34816
ds_read_b64_tr_b16 v[198:199], v236 offset:35328
ds_read_b64_tr_b16 v[200:201], v237 offset:34816
ds_read_b64_tr_b16 v[202:203], v237 offset:35328
ds_read_b64_tr_b16 v[204:205], v237 offset:32768
ds_read_b64_tr_b16 v[206:207], v237 offset:33280
ds_read_b64_tr_b16 v[208:209], v236 offset:49152
ds_read_b64_tr_b16 v[210:211], v236 offset:49664
ds_read_b64_tr_b16 v[212:213], v236 offset:51200
buffer_load_dwordx4 v232, s[8:11], s33 offen offset:2048 nt lds
s_waitcnt lgkmcnt(9)
v_mfma_f32_16x16x32_bf16 v[168:171], v[192:195], v[24:27], v[168:171]
ds_read_b64_tr_b16 v[214:215], v236 offset:51712
ds_read_b64_tr_b16 v[216:217], v237 offset:51200
ds_read_b64_tr_b16 v[218:219], v237 offset:51712
ds_read_b64_tr_b16 v[220:221], v237 offset:49152
ds_read_b64_tr_b16 v[222:223], v237 offset:49664
v_xor_b32 v236, 0x10000, v236
s_waitcnt lgkmcnt(12)
v_mfma_f32_16x16x32_bf16 v[168:171], v[196:199], v[36:39], v[168:171]
buffer_load_dwordx4 v232, s[8:11], s34 offen offset:3072 nt lds
v_mfma_f32_16x16x32_bf16 v[172:175], v[196:199], v[40:43], v[172:175]
v_mfma_f32_16x16x32_bf16 v[172:175], v[192:195], v[28:31], v[172:175]
v_mfma_f32_16x16x32_bf16 v[176:179], v[192:195], v[32:35], v[176:179]
ds_read_b64_tr_b16 v[192:193], v236
v_mbcnt_lo_u32_b32 v251, -1, 0
v_min_u32 v251, 27, v251
s_lshl_b32 s45, s48, 2
s_add_u32 s44, s41, s45
s_mul_i32 s44, s44, 28
v_add_u32 v251, s44, v251
v_lshlrev_b32 v251, 7, v251
buffer_load_dword v252, v251, s[20:23], 0 offen
v_mfma_f32_16x16x32_bf16 v[176:179], v[196:199], v[44:47], v[176:179]
ds_read_b64_tr_b16 v[194:195], v236 offset:512
ds_read_b64_tr_b16 v[196:197], v236 offset:2048
s_waitcnt lgkmcnt(13)
v_mfma_f32_16x16x32_bf16 v[188:191], v[200:203], v[44:47], v[188:191]
ds_read_b64_tr_b16 v[198:199], v236 offset:2560
v_xor_b32 v237, 0x10000, v237
s_waitcnt lgkmcnt(12)
v_mfma_f32_16x16x32_bf16 v[188:191], v[204:207], v[32:35], v[188:191]
s_add_u32 m0, s42, 81920
v_add_u32 v232, 0x10000, v232
buffer_load_dwordx4 v232, s[8:11], 0 offen nt lds
v_mfma_f32_16x16x32_bf16 v[184:187], v[204:207], v[28:31], v[184:187]
v_mfma_f32_16x16x32_bf16 v[184:187], v[200:203], v[40:43], v[184:187]
v_mfma_f32_16x16x32_bf16 v[180:183], v[200:203], v[36:39], v[180:183]
ds_read_b64_tr_b16 v[200:201], v237 offset:2048
buffer_load_dwordx4 v232, s[8:11], s32 offen offset:1024 nt lds
v_mfma_f32_16x16x32_bf16 v[180:183], v[204:207], v[24:27], v[180:183]
ds_read_b64_tr_b16 v[202:203], v237 offset:2560
ds_read_b64_tr_b16 v[204:205], v237
s_waitcnt lgkmcnt(13)
v_mfma_f32_16x16x32_bf16 v[168:171], v[208:211], v[48:51], v[168:171]
ds_read_b64_tr_b16 v[206:207], v237 offset:512
s_waitcnt lgkmcnt(12)
v_mfma_f32_16x16x32_bf16 v[168:171], v[212:215], v[60:63], v[168:171]
buffer_load_dwordx4 v232, s[8:11], s33 offen offset:2048 nt lds
v_mfma_f32_16x16x32_bf16 v[172:175], v[212:215], v[64:67], v[172:175]
v_mfma_f32_16x16x32_bf16 v[172:175], v[208:211], v[52:55], v[172:175]
v_mfma_f32_16x16x32_bf16 v[176:179], v[208:211], v[56:59], v[176:179]
v_mfma_f32_16x16x32_bf16 v[176:179], v[212:215], v[68:71], v[176:179]
buffer_load_dwordx4 v232, s[8:11], s34 offen offset:3072 nt lds
s_waitcnt lgkmcnt(10)
v_mfma_f32_16x16x32_bf16 v[188:191], v[216:219], v[68:71], v[188:191]
s_waitcnt lgkmcnt(8)
v_mfma_f32_16x16x32_bf16 v[188:191], v[220:223], v[56:59], v[188:191]
v_mfma_f32_16x16x32_bf16 v[184:187], v[220:223], v[52:55], v[184:187]
v_mfma_f32_16x16x32_bf16 v[184:187], v[216:219], v[64:67], v[184:187]
v_mfma_f32_16x16x32_bf16 v[180:183], v[216:219], v[60:63], v[180:183]
v_mfma_f32_16x16x32_bf16 v[180:183], v[220:223], v[48:51], v[180:183]
s_waitcnt lgkmcnt(6)
v_mfma_f32_16x16x32_bf16 v[168:171], v[192:195], v[72:75], v[168:171]
s_waitcnt lgkmcnt(4)
v_mfma_f32_16x16x32_bf16 v[168:171], v[196:199], v[84:87], v[168:171]
v_mfma_f32_16x16x32_bf16 v[172:175], v[196:199], v[88:91], v[172:175]
v_mfma_f32_16x16x32_bf16 v[172:175], v[192:195], v[76:79], v[172:175]
v_mfma_f32_16x16x32_bf16 v[176:179], v[192:195], v[80:83], v[176:179]
v_mfma_f32_16x16x32_bf16 v[176:179], v[196:199], v[92:95], v[176:179]
s_waitcnt lgkmcnt(2)
v_mfma_f32_16x16x32_bf16 v[188:191], v[200:203], v[92:95], v[188:191]
s_waitcnt lgkmcnt(0)
v_mfma_f32_16x16x32_bf16 v[188:191], v[204:207], v[80:83], v[188:191]
v_mfma_f32_16x16x32_bf16 v[184:187], v[204:207], v[76:79], v[184:187]
v_mfma_f32_16x16x32_bf16 v[184:187], v[200:203], v[88:91], v[184:187]
s_waitcnt vmcnt(12)
s_barrier
ds_read_b64_tr_b16 v[208:209], v236 offset:16384
ds_read_b64_tr_b16 v[210:211], v236 offset:16896
v_mfma_f32_16x16x32_bf16 v[180:183], v[200:203], v[84:87], v[180:183]
ds_read_b64_tr_b16 v[212:213], v236 offset:18432
ds_read_b64_tr_b16 v[214:215], v236 offset:18944
v_mfma_f32_16x16x32_bf16 v[180:183], v[204:207], v[72:75], v[180:183]
ds_read_b64_tr_b16 v[216:217], v237 offset:18432
ds_read_b64_tr_b16 v[218:219], v237 offset:18944
ds_read_b64_tr_b16 v[220:221], v237 offset:16384
ds_read_b64_tr_b16 v[222:223], v237 offset:16896
ds_read_b64_tr_b16 v[192:193], v236 offset:32768
ds_read_b64_tr_b16 v[194:195], v236 offset:33280
ds_read_b64_tr_b16 v[196:197], v236 offset:34816
ds_read_b64_tr_b16 v[198:199], v236 offset:35328
ds_read_b64_tr_b16 v[200:201], v237 offset:34816
ds_read_b64_tr_b16 v[202:203], v237 offset:35328
ds_read_b64_tr_b16 v[204:205], v237 offset:32768
ds_read_b64_tr_b16 v[206:207], v237 offset:33280
s_waitcnt lgkmcnt(14)
v_mfma_f32_16x16x32_bf16 v[168:171], v[208:211], v[96:99], v[168:171]
s_waitcnt lgkmcnt(12)
v_mfma_f32_16x16x32_bf16 v[168:171], v[212:215], v[108:111], v[168:171]
v_mfma_f32_16x16x32_bf16 v[172:175], v[212:215], v[112:115], v[172:175]
v_mfma_f32_16x16x32_bf16 v[172:175], v[208:211], v[100:103], v[172:175]
v_mfma_f32_16x16x32_bf16 v[176:179], v[208:211], v[104:107], v[176:179]
v_mfma_f32_16x16x32_bf16 v[176:179], v[212:215], v[116:119], v[176:179]
s_waitcnt lgkmcnt(10)
v_mfma_f32_16x16x32_bf16 v[188:191], v[216:219], v[116:119], v[188:191]
s_waitcnt lgkmcnt(8)
v_mfma_f32_16x16x32_bf16 v[188:191], v[220:223], v[104:107], v[188:191]
v_mfma_f32_16x16x32_bf16 v[184:187], v[220:223], v[100:103], v[184:187]
v_mfma_f32_16x16x32_bf16 v[184:187], v[216:219], v[112:115], v[184:187]
v_mfma_f32_16x16x32_bf16 v[180:183], v[216:219], v[108:111], v[180:183]
v_mfma_f32_16x16x32_bf16 v[180:183], v[220:223], v[96:99], v[180:183]
s_waitcnt lgkmcnt(6)
v_mfma_f32_16x16x32_bf16 v[168:171], v[192:195], v[120:123], v[168:171]
s_waitcnt lgkmcnt(4)
v_mfma_f32_16x16x32_bf16 v[168:171], v[196:199], v[132:135], v[168:171]
v_mfma_f32_16x16x32_bf16 v[172:175], v[196:199], v[136:139], v[172:175]
v_mfma_f32_16x16x32_bf16 v[172:175], v[192:195], v[124:127], v[172:175]
v_mfma_f32_16x16x32_bf16 v[176:179], v[192:195], v[128:131], v[176:179]
v_mfma_f32_16x16x32_bf16 v[176:179], v[196:199], v[140:143], v[176:179]
s_waitcnt lgkmcnt(2)
v_mfma_f32_16x16x32_bf16 v[188:191], v[200:203], v[140:143], v[188:191]
s_waitcnt lgkmcnt(0)
v_mfma_f32_16x16x32_bf16 v[188:191], v[204:207], v[128:131], v[188:191]
v_mfma_f32_16x16x32_bf16 v[184:187], v[204:207], v[124:127], v[184:187]
v_mfma_f32_16x16x32_bf16 v[184:187], v[200:203], v[136:139], v[184:187]
s_waitcnt vmcnt(8)
s_barrier
ds_read_b64_tr_b16 v[208:209], v236 offset:49152
ds_read_b64_tr_b16 v[210:211], v236 offset:49664
v_mfma_f32_16x16x32_bf16 v[180:183], v[200:203], v[132:135], v[180:183]
ds_read_b64_tr_b16 v[212:213], v236 offset:51200
ds_read_b64_tr_b16 v[214:215], v236 offset:51712
v_mfma_f32_16x16x32_bf16 v[180:183], v[204:207], v[120:123], v[180:183]
ds_read_b64_tr_b16 v[216:217], v237 offset:51200
ds_read_b64_tr_b16 v[218:219], v237 offset:51712
ds_read_b64_tr_b16 v[220:221], v237 offset:49152
ds_read_b64_tr_b16 v[222:223], v237 offset:49664
s_waitcnt lgkmcnt(6)
v_mfma_f32_16x16x32_bf16 v[168:171], v[208:211], v[144:147], v[168:171]
s_waitcnt lgkmcnt(4)
v_mfma_f32_16x16x32_bf16 v[168:171], v[212:215], v[156:159], v[168:171]
v_mfma_f32_16x16x32_bf16 v[172:175], v[212:215], v[160:163], v[172:175]
v_mfma_f32_16x16x32_bf16 v[172:175], v[208:211], v[148:151], v[172:175]
v_mfma_f32_16x16x32_bf16 v[176:179], v[208:211], v[152:155], v[176:179]
v_mfma_f32_16x16x32_bf16 v[176:179], v[212:215], v[164:167], v[176:179]
s_waitcnt lgkmcnt(2)
v_mfma_f32_16x16x32_bf16 v[188:191], v[216:219], v[164:167], v[188:191]
s_waitcnt lgkmcnt(0)
v_mfma_f32_16x16x32_bf16 v[188:191], v[220:223], v[152:155], v[188:191]
v_mfma_f32_16x16x32_bf16 v[184:187], v[220:223], v[148:151], v[184:187]
v_mfma_f32_16x16x32_bf16 v[184:187], v[216:219], v[160:163], v[184:187]
v_mfma_f32_16x16x32_bf16 v[180:183], v[216:219], v[156:159], v[180:183]
v_mfma_f32_16x16x32_bf16 v[180:183], v[220:223], v[144:147], v[180:183]
v_cvt_pk_bf16_f32 v224, v168, v169
v_cvt_pk_bf16_f32 v225, v170, v171
v_cvt_pk_bf16_f32 v226, v172, v173
v_cvt_pk_bf16_f32 v227, v174, v175
v_cvt_pk_bf16_f32 v228, v176, v177
v_cvt_pk_bf16_f32 v229, v178, v179
s_nop 1
v_cvt_pk_bf16_f32 v230, v180, v181
v_cvt_pk_bf16_f32 v231, v182, v183
v_cvt_pk_bf16_f32 v240, v184, v185
v_cvt_pk_bf16_f32 v241, v186, v187
v_cvt_pk_bf16_f32 v242, v188, v189
v_cvt_pk_bf16_f32 v243, v190, v191
s_waitcnt vmcnt(5)
s_barrier
s_add_u32 m0, s42, 114688
v_add_u32 v232, 0xfffe0080, v232
buffer_load_dwordx4 v232, s[8:11], s33 offen offset:2048 nt lds
buffer_load_dwordx4 v232, s[8:11], s34 offen offset:3072 nt lds
s_add_u32 m0, s42, 0
v_add_u32 v232, 0x10000, v232
buffer_load_dwordx4 v232, s[8:11], 0 offen nt lds
s_add_u32 m0, s42, 16384
v_add_u32 v245, 0xffd00080, v245
buffer_load_dwordx4 v245, s[16:19], 0 offen lds
buffer_load_dwordx4 v245, s[16:19], s35 offen offset:1024 lds
buffer_load_dwordx4 v245, s[16:19], s36 offen offset:2048 lds
buffer_load_dwordx4 v245, s[16:19], s37 offen offset:3072 lds
s_waitcnt vmcnt(7)
s_barrier
ds_write_b64 v238, v[224:225] offset:12288
ds_write_b64 v238, v[226:227] offset:13312
ds_write_b64 v238, v[228:229] offset:14336
ds_write_b64 v238, v[230:231] offset:12800
ds_write_b64 v238, v[240:241] offset:13824
ds_write_b64 v238, v[242:243] offset:14848
s_add_u32 m0, s42, 32768
v_add_u32 v245, 0x80000, v245
buffer_load_dwordx4 v245, s[16:19], 0 offen lds
buffer_load_dwordx4 v245, s[16:19], s35 offen offset:1024 lds
buffer_load_dwordx4 v245, s[16:19], s36 offen offset:2048 lds
buffer_load_dwordx4 v245, s[16:19], s37 offen offset:3072 lds
s_waitcnt lgkmcnt(0)
s_barrier
s_add_u32 m0, s42, 49152
v_add_u32 v245, 0x80000, v245
buffer_load_dwordx4 v245, s[16:19], 0 offen lds
buffer_load_dwordx4 v245, s[16:19], s35 offen offset:1024 lds
s_waitcnt vmcnt(11)
s_barrier
buffer_load_dwordx4 v245, s[16:19], s36 offen offset:2048 lds
buffer_load_dwordx4 v245, s[16:19], s37 offen offset:3072 lds
s_add_u32 m0, s42, 65536
v_add_u32 v245, 0x80000, v245
buffer_load_dwordx4 v245, s[16:19], 0 offen lds
buffer_load_dwordx4 v245, s[16:19], s35 offen offset:1024 lds
buffer_load_dwordx4 v245, s[16:19], s36 offen offset:2048 lds
buffer_load_dwordx4 v245, s[16:19], s37 offen offset:3072 lds
s_add_u32 m0, s42, 81920
v_add_u32 v245, 0x80000, v245
buffer_load_dwordx4 v245, s[16:19], 0 offen lds
buffer_load_dwordx4 v245, s[16:19], s35 offen offset:1024 lds
buffer_load_dwordx4 v245, s[16:19], s36 offen offset:2048 lds
s_waitcnt vmcnt(11)
s_barrier
ds_read_b64_tr_b16 v[192:193], v236 offset:16384
ds_read_b64_tr_b16 v[194:195], v236 offset:16896
ds_read_b64_tr_b16 v[196:197], v236 offset:18432
ds_read_b64_tr_b16 v[198:199], v236 offset:18944
ds_read_b64_tr_b16 v[200:201], v237 offset:18432
ds_read_b64_tr_b16 v[202:203], v237 offset:18944
ds_read_b64_tr_b16 v[204:205], v237 offset:16384
ds_read_b64_tr_b16 v[206:207], v237 offset:16896
ds_read_b64_tr_b16 v[208:209], v236 offset:32768
ds_read_b64_tr_b16 v[210:211], v236 offset:33280
ds_read_b64_tr_b16 v[212:213], v236 offset:34816
ds_read_b64_tr_b16 v[214:215], v236 offset:35328
ds_read_b64_tr_b16 v[216:217], v237 offset:34816
ds_read_b64_tr_b16 v[218:219], v237 offset:35328
ds_read_b64_tr_b16 v[220:221], v237 offset:32768
ds_read_b64_tr_b16 v[222:223], v237 offset:33280
s_waitcnt lgkmcnt(14)
v_mfma_f32_16x16x32_bf16 v[168:171], v[192:195], v[0:3], 0
s_waitcnt lgkmcnt(12)
v_mfma_f32_16x16x32_bf16 v[168:171], v[196:199], v[12:15], v[168:171]
v_mfma_f32_16x16x32_bf16 v[172:175], v[196:199], v[16:19], 0
v_mfma_f32_16x16x32_bf16 v[172:175], v[192:195], v[4:7], v[172:175]
v_mfma_f32_16x16x32_bf16 v[176:179], v[192:195], v[8:11], 0
v_mfma_f32_16x16x32_bf16 v[176:179], v[196:199], v[20:23], v[176:179]
s_waitcnt lgkmcnt(10)
v_mfma_f32_16x16x32_bf16 v[188:191], v[200:203], v[20:23], 0
s_waitcnt lgkmcnt(8)
v_mfma_f32_16x16x32_bf16 v[188:191], v[204:207], v[8:11], v[188:191]
v_mfma_f32_16x16x32_bf16 v[184:187], v[204:207], v[4:7], 0
v_mfma_f32_16x16x32_bf16 v[184:187], v[200:203], v[16:19], v[184:187]
v_mfma_f32_16x16x32_bf16 v[180:183], v[200:203], v[12:15], 0
v_mfma_f32_16x16x32_bf16 v[180:183], v[204:207], v[0:3], v[180:183]
s_waitcnt lgkmcnt(6)
v_mfma_f32_16x16x32_bf16 v[168:171], v[208:211], v[24:27], v[168:171]
s_waitcnt lgkmcnt(4)
v_mfma_f32_16x16x32_bf16 v[168:171], v[212:215], v[36:39], v[168:171]
v_mfma_f32_16x16x32_bf16 v[172:175], v[212:215], v[40:43], v[172:175]
v_mfma_f32_16x16x32_bf16 v[172:175], v[208:211], v[28:31], v[172:175]
v_mfma_f32_16x16x32_bf16 v[176:179], v[208:211], v[32:35], v[176:179]
v_mfma_f32_16x16x32_bf16 v[176:179], v[212:215], v[44:47], v[176:179]
s_waitcnt lgkmcnt(2)
v_mfma_f32_16x16x32_bf16 v[188:191], v[216:219], v[44:47], v[188:191]
s_waitcnt lgkmcnt(0)
v_mfma_f32_16x16x32_bf16 v[188:191], v[220:223], v[32:35], v[188:191]
v_mfma_f32_16x16x32_bf16 v[184:187], v[220:223], v[28:31], v[184:187]
v_mfma_f32_16x16x32_bf16 v[184:187], v[216:219], v[40:43], v[184:187]
s_waitcnt vmcnt(3)
s_barrier
ds_read_b64_tr_b16 v[192:193], v236 offset:49152
ds_read_b64_tr_b16 v[194:195], v236 offset:49664
v_mfma_f32_16x16x32_bf16 v[180:183], v[216:219], v[36:39], v[180:183]
ds_read_b64_tr_b16 v[196:197], v236 offset:51200
ds_read_b64_tr_b16 v[198:199], v236 offset:51712
v_mfma_f32_16x16x32_bf16 v[180:183], v[220:223], v[24:27], v[180:183]
ds_read_b64_tr_b16 v[200:201], v237 offset:51200
ds_read_b64_tr_b16 v[202:203], v237 offset:51712
ds_read_b64_tr_b16 v[204:205], v237 offset:49152
ds_read_b64_tr_b16 v[206:207], v237 offset:49664
v_xor_b32 v236, 0x10000, v236
ds_read_b64_tr_b16 v[208:209], v236
ds_read_b64_tr_b16 v[210:211], v236 offset:512
ds_read_b64_tr_b16 v[212:213], v236 offset:2048
ds_read_b64_tr_b16 v[214:215], v236 offset:2560
v_xor_b32 v237, 0x10000, v237
ds_read_b64_tr_b16 v[216:217], v237 offset:2048
ds_read_b64_tr_b16 v[218:219], v237 offset:2560
ds_read_b64_tr_b16 v[220:221], v237
ds_read_b64_tr_b16 v[222:223], v237 offset:512
s_waitcnt lgkmcnt(14)
v_mfma_f32_16x16x32_bf16 v[168:171], v[192:195], v[48:51], v[168:171]
s_waitcnt lgkmcnt(12)
v_mfma_f32_16x16x32_bf16 v[168:171], v[196:199], v[60:63], v[168:171]
v_mfma_f32_16x16x32_bf16 v[172:175], v[196:199], v[64:67], v[172:175]
v_mfma_f32_16x16x32_bf16 v[172:175], v[192:195], v[52:55], v[172:175]
v_mfma_f32_16x16x32_bf16 v[176:179], v[192:195], v[56:59], v[176:179]
v_mfma_f32_16x16x32_bf16 v[176:179], v[196:199], v[68:71], v[176:179]
s_waitcnt lgkmcnt(10)
v_mfma_f32_16x16x32_bf16 v[188:191], v[200:203], v[68:71], v[188:191]
s_waitcnt lgkmcnt(8)
v_mfma_f32_16x16x32_bf16 v[188:191], v[204:207], v[56:59], v[188:191]
v_mfma_f32_16x16x32_bf16 v[184:187], v[204:207], v[52:55], v[184:187]
v_mfma_f32_16x16x32_bf16 v[184:187], v[200:203], v[64:67], v[184:187]
v_mfma_f32_16x16x32_bf16 v[180:183], v[200:203], v[60:63], v[180:183]
v_mfma_f32_16x16x32_bf16 v[180:183], v[204:207], v[48:51], v[180:183]
s_waitcnt lgkmcnt(6)
v_mfma_f32_16x16x32_bf16 v[168:171], v[208:211], v[72:75], v[168:171]
s_waitcnt lgkmcnt(4)
v_mfma_f32_16x16x32_bf16 v[168:171], v[212:215], v[84:87], v[168:171]
v_mfma_f32_16x16x32_bf16 v[172:175], v[212:215], v[88:91], v[172:175]
v_mfma_f32_16x16x32_bf16 v[172:175], v[208:211], v[76:79], v[172:175]
v_mfma_f32_16x16x32_bf16 v[176:179], v[208:211], v[80:83], v[176:179]
v_mfma_f32_16x16x32_bf16 v[176:179], v[212:215], v[92:95], v[176:179]
s_waitcnt lgkmcnt(2)
v_mfma_f32_16x16x32_bf16 v[188:191], v[216:219], v[92:95], v[188:191]
s_waitcnt lgkmcnt(0)
v_mfma_f32_16x16x32_bf16 v[188:191], v[220:223], v[80:83], v[188:191]
v_mfma_f32_16x16x32_bf16 v[184:187], v[220:223], v[76:79], v[184:187]
v_mfma_f32_16x16x32_bf16 v[184:187], v[216:219], v[88:91], v[184:187]
s_barrier
v_mfma_f32_16x16x32_bf16 v[180:183], v[216:219], v[84:87], v[180:183]
v_mfma_f32_16x16x32_bf16 v[180:183], v[220:223], v[72:75], v[180:183]
s_waitcnt vmcnt(0)
s_barrier
ds_read_b64_tr_b16 v[192:193], v236 offset:16384
ds_read_b64_tr_b16 v[194:195], v236 offset:16896
ds_read_b64_tr_b16 v[196:197], v236 offset:18432
ds_read_b64_tr_b16 v[198:199], v236 offset:18944
ds_read_b64_tr_b16 v[200:201], v237 offset:18432
ds_read_b64_tr_b16 v[202:203], v237 offset:18944
ds_read_b64_tr_b16 v[204:205], v237 offset:16384
ds_read_b64_tr_b16 v[206:207], v237 offset:16896
ds_read_b64_tr_b16 v[208:209], v236 offset:32768
ds_read_b64_tr_b16 v[210:211], v236 offset:33280
ds_read_b64_tr_b16 v[212:213], v236 offset:34816
ds_read_b64_tr_b16 v[214:215], v236 offset:35328
ds_read_b64_tr_b16 v[216:217], v237 offset:34816
ds_read_b64_tr_b16 v[218:219], v237 offset:35328
ds_read_b64_tr_b16 v[220:221], v237 offset:32768
ds_read_b64_tr_b16 v[222:223], v237 offset:33280
s_waitcnt lgkmcnt(14)
v_mfma_f32_16x16x32_bf16 v[168:171], v[192:195], v[96:99], v[168:171]
s_waitcnt lgkmcnt(12)
v_mfma_f32_16x16x32_bf16 v[168:171], v[196:199], v[108:111], v[168:171]
v_mfma_f32_16x16x32_bf16 v[172:175], v[196:199], v[112:115], v[172:175]
v_mfma_f32_16x16x32_bf16 v[172:175], v[192:195], v[100:103], v[172:175]
v_mfma_f32_16x16x32_bf16 v[176:179], v[192:195], v[104:107], v[176:179]
v_mfma_f32_16x16x32_bf16 v[176:179], v[196:199], v[116:119], v[176:179]
s_waitcnt lgkmcnt(10)
v_mfma_f32_16x16x32_bf16 v[188:191], v[200:203], v[116:119], v[188:191]
s_waitcnt lgkmcnt(8)
v_mfma_f32_16x16x32_bf16 v[188:191], v[204:207], v[104:107], v[188:191]
v_mfma_f32_16x16x32_bf16 v[184:187], v[204:207], v[100:103], v[184:187]
v_mfma_f32_16x16x32_bf16 v[184:187], v[200:203], v[112:115], v[184:187]
v_mfma_f32_16x16x32_bf16 v[180:183], v[200:203], v[108:111], v[180:183]
v_mfma_f32_16x16x32_bf16 v[180:183], v[204:207], v[96:99], v[180:183]
s_waitcnt lgkmcnt(6)
v_mfma_f32_16x16x32_bf16 v[168:171], v[208:211], v[120:123], v[168:171]
s_waitcnt lgkmcnt(4)
v_mfma_f32_16x16x32_bf16 v[168:171], v[212:215], v[132:135], v[168:171]
v_mfma_f32_16x16x32_bf16 v[172:175], v[212:215], v[136:139], v[172:175]
v_mfma_f32_16x16x32_bf16 v[172:175], v[208:211], v[124:127], v[172:175]
v_mfma_f32_16x16x32_bf16 v[176:179], v[208:211], v[128:131], v[176:179]
v_mfma_f32_16x16x32_bf16 v[176:179], v[212:215], v[140:143], v[176:179]
s_waitcnt lgkmcnt(2)
v_mfma_f32_16x16x32_bf16 v[188:191], v[216:219], v[140:143], v[188:191]
s_waitcnt lgkmcnt(0)
v_mfma_f32_16x16x32_bf16 v[188:191], v[220:223], v[128:131], v[188:191]
v_mfma_f32_16x16x32_bf16 v[184:187], v[220:223], v[124:127], v[184:187]
v_mfma_f32_16x16x32_bf16 v[184:187], v[216:219], v[136:139], v[184:187]
s_add_u32 m0, s42, 32768
v_add_u32 v232, 0xfffe0080, v232
buffer_load_dwordx4 v232, s[8:11], s34 offen offset:3072 nt lds
s_add_u32 m0, s42, 49152
v_add_u32 v232, 0x10000, v232
buffer_load_dwordx4 v232, s[8:11], 0 offen nt lds
s_barrier
ds_read_b64_tr_b16 v[192:193], v236 offset:49152
ds_read_b64_tr_b16 v[194:195], v236 offset:49664
v_mfma_f32_16x16x32_bf16 v[180:183], v[216:219], v[132:135], v[180:183]
ds_read_b64_tr_b16 v[196:197], v236 offset:51200
ds_read_b64_tr_b16 v[198:199], v236 offset:51712
v_mfma_f32_16x16x32_bf16 v[180:183], v[220:223], v[120:123], v[180:183]
ds_read_b64_tr_b16 v[200:201], v237 offset:51200
ds_read_b64_tr_b16 v[202:203], v237 offset:51712
ds_read_b64_tr_b16 v[204:205], v237 offset:49152
ds_read_b64_tr_b16 v[206:207], v237 offset:49664
s_waitcnt lgkmcnt(6)
v_mfma_f32_16x16x32_bf16 v[168:171], v[192:195], v[144:147], v[168:171]
s_waitcnt lgkmcnt(4)
v_mfma_f32_16x16x32_bf16 v[168:171], v[196:199], v[156:159], v[168:171]
v_mfma_f32_16x16x32_bf16 v[172:175], v[196:199], v[160:163], v[172:175]
v_mfma_f32_16x16x32_bf16 v[172:175], v[192:195], v[148:151], v[172:175]
v_mfma_f32_16x16x32_bf16 v[176:179], v[192:195], v[152:155], v[176:179]
v_mfma_f32_16x16x32_bf16 v[176:179], v[196:199], v[164:167], v[176:179]
s_waitcnt lgkmcnt(2)
v_mfma_f32_16x16x32_bf16 v[188:191], v[200:203], v[164:167], v[188:191]
s_waitcnt lgkmcnt(0)
v_mfma_f32_16x16x32_bf16 v[188:191], v[204:207], v[152:155], v[188:191]
v_mfma_f32_16x16x32_bf16 v[184:187], v[204:207], v[148:151], v[184:187]
v_mfma_f32_16x16x32_bf16 v[184:187], v[200:203], v[160:163], v[184:187]
v_mfma_f32_16x16x32_bf16 v[180:183], v[200:203], v[156:159], v[180:183]
v_mfma_f32_16x16x32_bf16 v[180:183], v[204:207], v[144:147], v[180:183]
v_cvt_pk_bf16_f32 v224, v168, v169
v_cvt_pk_bf16_f32 v225, v170, v171
v_cvt_pk_bf16_f32 v226, v172, v173
v_cvt_pk_bf16_f32 v227, v174, v175
v_cvt_pk_bf16_f32 v228, v176, v177
v_cvt_pk_bf16_f32 v229, v178, v179
s_nop 1
v_cvt_pk_bf16_f32 v230, v180, v181
v_cvt_pk_bf16_f32 v231, v182, v183
v_cvt_pk_bf16_f32 v240, v184, v185
v_cvt_pk_bf16_f32 v241, v186, v187
v_cvt_pk_bf16_f32 v242, v188, v189
v_cvt_pk_bf16_f32 v243, v190, v191
s_barrier
buffer_load_dwordx4 v232, s[8:11], s34 offen offset:3072 nt lds
s_add_u32 m0, s42, 65536
v_add_u32 v245, 0xffe00080, v245
buffer_load_dwordx4 v245, s[16:19], 0 offen lds
buffer_load_dwordx4 v245, s[16:19], s35 offen offset:1024 lds
buffer_load_dwordx4 v245, s[16:19], s36 offen offset:2048 lds
buffer_load_dwordx4 v245, s[16:19], s37 offen offset:3072 lds
s_barrier
ds_write_b64 v238, v[224:225]
ds_write_b64 v238, v[226:227] offset:1024
ds_write_b64 v238, v[228:229] offset:2048
ds_write_b64 v238, v[230:231] offset:512
ds_write_b64 v238, v[240:241] offset:1536
ds_write_b64 v238, v[242:243] offset:2560
s_waitcnt vmcnt(6) lgkmcnt(0)
s_barrier
s_add_u32 m0, s42, 81920
v_add_u32 v245, 0x80000, v245
buffer_load_dwordx4 v245, s[16:19], 0 offen lds
buffer_load_dwordx4 v245, s[16:19], s35 offen offset:1024 lds
buffer_load_dwordx4 v245, s[16:19], s36 offen offset:2048 lds
buffer_load_dwordx4 v245, s[16:19], s37 offen offset:3072 lds
s_add_u32 m0, s42, 98304
v_add_u32 v245, 0x80000, v245
buffer_load_dwordx4 v245, s[16:19], 0 offen lds
buffer_load_dwordx4 v245, s[16:19], s35 offen offset:1024 lds
buffer_load_dwordx4 v245, s[16:19], s36 offen offset:2048 lds
buffer_load_dwordx4 v245, s[16:19], s37 offen offset:3072 lds
s_add_u32 m0, s42, 114688
v_add_u32 v245, 0x80000, v245
buffer_load_dwordx4 v245, s[16:19], 0 offen lds
buffer_load_dwordx4 v245, s[16:19], s35 offen offset:1024 lds
buffer_load_dwordx4 v245, s[16:19], s36 offen offset:2048 lds
buffer_load_dwordx4 v245, s[16:19], s37 offen offset:3072 lds
s_add_u32 m0, s42, 0
v_add_u32 v245, 0x80000, v245
buffer_load_dwordx4 v245, s[16:19], 0 offen lds
buffer_load_dwordx4 v245, s[16:19], s35 offen offset:1024 lds
s_waitcnt vmcnt(10)
s_barrier
ds_read_b64_tr_b16 v[208:209], v236
ds_read_b64_tr_b16 v[210:211], v236 offset:512
ds_read_b64_tr_b16 v[212:213], v236 offset:2048
ds_read_b64_tr_b16 v[214:215], v236 offset:2560
ds_read_b64_tr_b16 v[216:217], v237 offset:2048
ds_read_b64_tr_b16 v[218:219], v237 offset:2560
ds_read_b64_tr_b16 v[220:221], v237
ds_read_b64_tr_b16 v[222:223], v237 offset:512
ds_read_b64_tr_b16 v[192:193], v236 offset:16384
ds_read_b64_tr_b16 v[194:195], v236 offset:16896
ds_read_b64_tr_b16 v[196:197], v236 offset:18432
ds_read_b64_tr_b16 v[198:199], v236 offset:18944
ds_read_b64_tr_b16 v[200:201], v237 offset:18432
ds_read_b64_tr_b16 v[202:203], v237 offset:18944
ds_read_b64_tr_b16 v[204:205], v237 offset:16384
ds_read_b64_tr_b16 v[206:207], v237 offset:16896
s_waitcnt lgkmcnt(14)
v_mfma_f32_16x16x32_bf16 v[168:171], v[208:211], v[0:3], 0
s_waitcnt lgkmcnt(12)
v_mfma_f32_16x16x32_bf16 v[168:171], v[212:215], v[12:15], v[168:171]
v_mfma_f32_16x16x32_bf16 v[172:175], v[212:215], v[16:19], 0
v_mfma_f32_16x16x32_bf16 v[172:175], v[208:211], v[4:7], v[172:175]
v_mfma_f32_16x16x32_bf16 v[176:179], v[208:211], v[8:11], 0
v_mfma_f32_16x16x32_bf16 v[176:179], v[212:215], v[20:23], v[176:179]
s_waitcnt lgkmcnt(10)
v_mfma_f32_16x16x32_bf16 v[188:191], v[216:219], v[20:23], 0
s_waitcnt lgkmcnt(8)
v_mfma_f32_16x16x32_bf16 v[188:191], v[220:223], v[8:11], v[188:191]
v_mfma_f32_16x16x32_bf16 v[184:187], v[220:223], v[4:7], 0
v_mfma_f32_16x16x32_bf16 v[184:187], v[216:219], v[16:19], v[184:187]
v_mfma_f32_16x16x32_bf16 v[180:183], v[216:219], v[12:15], 0
v_mfma_f32_16x16x32_bf16 v[180:183], v[220:223], v[0:3], v[180:183]
s_waitcnt lgkmcnt(6)
v_mfma_f32_16x16x32_bf16 v[168:171], v[192:195], v[24:27], v[168:171]
s_waitcnt lgkmcnt(4)
v_mfma_f32_16x16x32_bf16 v[168:171], v[196:199], v[36:39], v[168:171]
v_mfma_f32_16x16x32_bf16 v[172:175], v[196:199], v[40:43], v[172:175]
v_mfma_f32_16x16x32_bf16 v[172:175], v[192:195], v[28:31], v[172:175]
v_mfma_f32_16x16x32_bf16 v[176:179], v[192:195], v[32:35], v[176:179]
v_mfma_f32_16x16x32_bf16 v[176:179], v[196:199], v[44:47], v[176:179]
s_waitcnt lgkmcnt(2)
v_mfma_f32_16x16x32_bf16 v[188:191], v[200:203], v[44:47], v[188:191]
s_waitcnt lgkmcnt(0)
v_mfma_f32_16x16x32_bf16 v[188:191], v[204:207], v[32:35], v[188:191]
v_mfma_f32_16x16x32_bf16 v[184:187], v[204:207], v[28:31], v[184:187]
v_mfma_f32_16x16x32_bf16 v[184:187], v[200:203], v[40:43], v[184:187]
s_waitcnt vmcnt(2)
s_barrier
ds_read_b64_tr_b16 v[208:209], v236 offset:32768
ds_read_b64_tr_b16 v[210:211], v236 offset:33280
v_mfma_f32_16x16x32_bf16 v[180:183], v[200:203], v[36:39], v[180:183]
ds_read_b64_tr_b16 v[212:213], v236 offset:34816
ds_read_b64_tr_b16 v[214:215], v236 offset:35328
v_mfma_f32_16x16x32_bf16 v[180:183], v[204:207], v[24:27], v[180:183]
ds_read_b64_tr_b16 v[216:217], v237 offset:34816
ds_read_b64_tr_b16 v[218:219], v237 offset:35328
ds_read_b64_tr_b16 v[220:221], v237 offset:32768
ds_read_b64_tr_b16 v[222:223], v237 offset:33280
ds_read_b64_tr_b16 v[192:193], v236 offset:49152
ds_read_b64_tr_b16 v[194:195], v236 offset:49664
ds_read_b64_tr_b16 v[196:197], v236 offset:51200
ds_read_b64_tr_b16 v[198:199], v236 offset:51712
ds_read_b64_tr_b16 v[200:201], v237 offset:51200
ds_read_b64_tr_b16 v[202:203], v237 offset:51712
ds_read_b64_tr_b16 v[204:205], v237 offset:49152
ds_read_b64_tr_b16 v[206:207], v237 offset:49664
s_waitcnt lgkmcnt(14)
v_mfma_f32_16x16x32_bf16 v[168:171], v[208:211], v[48:51], v[168:171]
s_waitcnt lgkmcnt(12)
v_mfma_f32_16x16x32_bf16 v[168:171], v[212:215], v[60:63], v[168:171]
v_mfma_f32_16x16x32_bf16 v[172:175], v[212:215], v[64:67], v[172:175]
v_mfma_f32_16x16x32_bf16 v[172:175], v[208:211], v[52:55], v[172:175]
v_mfma_f32_16x16x32_bf16 v[176:179], v[208:211], v[56:59], v[176:179]
v_mfma_f32_16x16x32_bf16 v[176:179], v[212:215], v[68:71], v[176:179]
s_waitcnt lgkmcnt(10)
v_mfma_f32_16x16x32_bf16 v[188:191], v[216:219], v[68:71], v[188:191]
s_waitcnt lgkmcnt(8)
v_mfma_f32_16x16x32_bf16 v[188:191], v[220:223], v[56:59], v[188:191]
v_mfma_f32_16x16x32_bf16 v[184:187], v[220:223], v[52:55], v[184:187]
v_mfma_f32_16x16x32_bf16 v[184:187], v[216:219], v[64:67], v[184:187]
v_mfma_f32_16x16x32_bf16 v[180:183], v[216:219], v[60:63], v[180:183]
v_mfma_f32_16x16x32_bf16 v[180:183], v[220:223], v[48:51], v[180:183]
s_waitcnt lgkmcnt(6)
v_mfma_f32_16x16x32_bf16 v[168:171], v[192:195], v[72:75], v[168:171]
s_waitcnt lgkmcnt(4)
v_mfma_f32_16x16x32_bf16 v[168:171], v[196:199], v[84:87], v[168:171]
v_mfma_f32_16x16x32_bf16 v[172:175], v[196:199], v[88:91], v[172:175]
v_mfma_f32_16x16x32_bf16 v[172:175], v[192:195], v[76:79], v[172:175]
v_mfma_f32_16x16x32_bf16 v[176:179], v[192:195], v[80:83], v[176:179]
v_mfma_f32_16x16x32_bf16 v[176:179], v[196:199], v[92:95], v[176:179]
s_waitcnt lgkmcnt(2)
v_mfma_f32_16x16x32_bf16 v[188:191], v[200:203], v[92:95], v[188:191]
s_waitcnt lgkmcnt(0)
v_mfma_f32_16x16x32_bf16 v[188:191], v[204:207], v[80:83], v[188:191]
v_mfma_f32_16x16x32_bf16 v[184:187], v[204:207], v[76:79], v[184:187]
v_mfma_f32_16x16x32_bf16 v[184:187], v[200:203], v[88:91], v[184:187]
s_waitcnt vmcnt(0)
s_barrier
v_xor_b32 v236, 0x10000, v236
ds_read_b64_tr_b16 v[208:209], v236
v_mfma_f32_16x16x32_bf16 v[180:183], v[200:203], v[84:87], v[180:183]
ds_read_b64_tr_b16 v[210:211], v236 offset:512
ds_read_b64_tr_b16 v[212:213], v236 offset:2048
v_mfma_f32_16x16x32_bf16 v[180:183], v[204:207], v[72:75], v[180:183]
ds_read_b64_tr_b16 v[214:215], v236 offset:2560
v_xor_b32 v237, 0x10000, v237
ds_read_b64_tr_b16 v[216:217], v237 offset:2048
ds_read_b64_tr_b16 v[218:219], v237 offset:2560
ds_read_b64_tr_b16 v[220:221], v237
ds_read_b64_tr_b16 v[222:223], v237 offset:512
ds_read_b64_tr_b16 v[192:193], v236 offset:16384
ds_read_b64_tr_b16 v[194:195], v236 offset:16896
ds_read_b64_tr_b16 v[196:197], v236 offset:18432
ds_read_b64_tr_b16 v[198:199], v236 offset:18944
ds_read_b64_tr_b16 v[200:201], v237 offset:18432
ds_read_b64_tr_b16 v[202:203], v237 offset:18944
ds_read_b64_tr_b16 v[204:205], v237 offset:16384
ds_read_b64_tr_b16 v[206:207], v237 offset:16896
s_waitcnt lgkmcnt(14)
v_mfma_f32_16x16x32_bf16 v[168:171], v[208:211], v[96:99], v[168:171]
s_waitcnt lgkmcnt(12)
v_mfma_f32_16x16x32_bf16 v[168:171], v[212:215], v[108:111], v[168:171]
v_mfma_f32_16x16x32_bf16 v[172:175], v[212:215], v[112:115], v[172:175]
v_mfma_f32_16x16x32_bf16 v[172:175], v[208:211], v[100:103], v[172:175]
v_mfma_f32_16x16x32_bf16 v[176:179], v[208:211], v[104:107], v[176:179]
v_mfma_f32_16x16x32_bf16 v[176:179], v[212:215], v[116:119], v[176:179]
s_waitcnt lgkmcnt(10)
v_mfma_f32_16x16x32_bf16 v[188:191], v[216:219], v[116:119], v[188:191]
s_waitcnt lgkmcnt(8)
v_mfma_f32_16x16x32_bf16 v[188:191], v[220:223], v[104:107], v[188:191]
v_mfma_f32_16x16x32_bf16 v[184:187], v[220:223], v[100:103], v[184:187]
v_mfma_f32_16x16x32_bf16 v[184:187], v[216:219], v[112:115], v[184:187]
v_mfma_f32_16x16x32_bf16 v[180:183], v[216:219], v[108:111], v[180:183]
v_mfma_f32_16x16x32_bf16 v[180:183], v[220:223], v[96:99], v[180:183]
s_waitcnt lgkmcnt(6)
v_mfma_f32_16x16x32_bf16 v[168:171], v[192:195], v[120:123], v[168:171]
s_waitcnt lgkmcnt(4)
v_mfma_f32_16x16x32_bf16 v[168:171], v[196:199], v[132:135], v[168:171]
v_mfma_f32_16x16x32_bf16 v[172:175], v[196:199], v[136:139], v[172:175]
v_mfma_f32_16x16x32_bf16 v[172:175], v[192:195], v[124:127], v[172:175]
v_mfma_f32_16x16x32_bf16 v[176:179], v[192:195], v[128:131], v[176:179]
v_mfma_f32_16x16x32_bf16 v[176:179], v[196:199], v[140:143], v[176:179]
s_waitcnt lgkmcnt(2)
v_mfma_f32_16x16x32_bf16 v[188:191], v[200:203], v[140:143], v[188:191]
s_waitcnt lgkmcnt(0)
v_mfma_f32_16x16x32_bf16 v[188:191], v[204:207], v[128:131], v[188:191]
v_mfma_f32_16x16x32_bf16 v[184:187], v[204:207], v[124:127], v[184:187]
v_mfma_f32_16x16x32_bf16 v[184:187], v[200:203], v[136:139], v[184:187]
s_barrier
v_mfma_f32_16x16x32_bf16 v[180:183], v[200:203], v[132:135], v[180:183]
v_mfma_f32_16x16x32_bf16 v[180:183], v[204:207], v[120:123], v[180:183]
s_barrier
ds_read_b64_tr_b16 v[208:209], v236 offset:32768
s_add_u32 m0, s42, 98304
v_add_u32 v232, 0xffff0080, v232
buffer_load_dwordx4 v232, s[8:11], s33 offen offset:2048 nt lds
ds_read_b64_tr_b16 v[210:211], v236 offset:33280
ds_read_b64_tr_b16 v[212:213], v236 offset:34816
ds_read_b64_tr_b16 v[214:215], v236 offset:35328
ds_read_b64_tr_b16 v[216:217], v237 offset:34816
ds_read_b64_tr_b16 v[218:219], v237 offset:35328
ds_read_b64_tr_b16 v[220:221], v237 offset:32768
ds_read_b64_tr_b16 v[222:223], v237 offset:33280
s_waitcnt lgkmcnt(6)
v_mfma_f32_16x16x32_bf16 v[168:171], v[208:211], v[144:147], v[168:171]
buffer_load_dwordx4 v232, s[8:11], s34 offen offset:3072 nt lds
s_waitcnt lgkmcnt(4)
v_mfma_f32_16x16x32_bf16 v[168:171], v[212:215], v[156:159], v[168:171]
v_mfma_f32_16x16x32_bf16 v[172:175], v[212:215], v[160:163], v[172:175]
v_mfma_f32_16x16x32_bf16 v[172:175], v[208:211], v[148:151], v[172:175]
v_mfma_f32_16x16x32_bf16 v[176:179], v[208:211], v[152:155], v[176:179]
v_mfma_f32_16x16x32_bf16 v[176:179], v[212:215], v[164:167], v[176:179]
s_waitcnt lgkmcnt(2)
v_mfma_f32_16x16x32_bf16 v[188:191], v[216:219], v[164:167], v[188:191]
s_waitcnt lgkmcnt(0)
v_mfma_f32_16x16x32_bf16 v[188:191], v[220:223], v[152:155], v[188:191]
v_mfma_f32_16x16x32_bf16 v[184:187], v[220:223], v[148:151], v[184:187]
v_mfma_f32_16x16x32_bf16 v[184:187], v[216:219], v[160:163], v[184:187]
v_mfma_f32_16x16x32_bf16 v[180:183], v[216:219], v[156:159], v[180:183]
v_mfma_f32_16x16x32_bf16 v[180:183], v[220:223], v[144:147], v[180:183]
v_cvt_pk_bf16_f32 v224, v168, v169
v_cvt_pk_bf16_f32 v225, v170, v171
v_cvt_pk_bf16_f32 v226, v172, v173
v_cvt_pk_bf16_f32 v227, v174, v175
v_cvt_pk_bf16_f32 v228, v176, v177
v_cvt_pk_bf16_f32 v229, v178, v179
s_nop 1
v_cvt_pk_bf16_f32 v230, v180, v181
v_cvt_pk_bf16_f32 v231, v182, v183
v_cvt_pk_bf16_f32 v240, v184, v185
v_cvt_pk_bf16_f32 v241, v186, v187
v_cvt_pk_bf16_f32 v242, v188, v189
v_cvt_pk_bf16_f32 v243, v190, v191
s_add_u32 m0, s42, 114688
v_add_u32 v232, 0x10000, v232
buffer_load_dwordx4 v232, s[8:11], 0 offen nt lds
s_barrier
buffer_load_dwordx4 v232, s[8:11], s32 offen offset:1024 nt lds
buffer_load_dwordx4 v232, s[8:11], s33 offen offset:2048 nt lds
buffer_load_dwordx4 v232, s[8:11], s34 offen offset:3072 nt lds
s_add_u32 m0, s42, 0
v_add_u32 v232, 0x10000, v232
buffer_load_dwordx4 v232, s[8:11], 0 offen nt lds
s_barrier
ds_write_b64 v238, v[224:225] offset:12288
ds_write_b64 v238, v[226:227] offset:13312
ds_write_b64 v238, v[228:229] offset:14336
ds_write_b64 v238, v[230:231] offset:12800
ds_write_b64 v238, v[240:241] offset:13824
ds_write_b64 v238, v[242:243] offset:14848
buffer_load_dwordx4 v232, s[8:11], s32 offen offset:1024 nt lds
s_waitcnt lgkmcnt(0)
s_barrier
buffer_load_dwordx4 v232, s[8:11], s33 offen offset:2048 nt lds
buffer_load_dwordx4 v232, s[8:11], s34 offen offset:3072 nt lds
s_add_u32 m0, s42, 16384
v_add_u32 v245, s50, v246
buffer_load_dwordx4 v245, s[20:23], 0 offen lds
s_waitcnt vmcnt(9)
s_barrier
buffer_load_dwordx4 v245, s[20:23], s38 offen offset:1024 lds
buffer_load_dwordx4 v245, s[20:23], s39 offen offset:2048 lds
buffer_load_dwordx4 v245, s[20:23], s40 offen offset:3072 lds
s_add_u32 m0, s42, 32768
v_add_u32 v245, s51, v246
buffer_load_dwordx4 v245, s[20:23], 0 offen lds
buffer_load_dwordx4 v245, s[20:23], s38 offen offset:1024 lds
buffer_load_dwordx4 v245, s[20:23], s39 offen offset:2048 lds
buffer_load_dwordx4 v245, s[20:23], s40 offen offset:3072 lds
s_add_u32 m0, s42, 49152
v_add_u32 v245, s52, v246
buffer_load_dwordx4 v245, s[20:23], 0 offen lds
buffer_load_dwordx4 v245, s[20:23], s38 offen offset:1024 lds
buffer_load_dwordx4 v245, s[20:23], s39 offen offset:2048 lds
buffer_load_dwordx4 v245, s[20:23], s40 offen offset:3072 lds
s_add_u32 m0, s42, 65536
v_add_u32 v245, s53, v246
buffer_load_dwordx4 v245, s[20:23], 0 offen lds
s_waitcnt vmcnt(17)
s_barrier
buffer_load_dwordx4 v245, s[20:23], s38 offen offset:1024 lds
buffer_load_dwordx4 v245, s[20:23], s39 offen offset:2048 lds
buffer_load_dwordx4 v245, s[20:23], s40 offen offset:3072 lds
s_add_u32 m0, s42, 81920
v_add_u32 v232, 0x10000, v232
buffer_load_dwordx4 v232, s[8:11], 0 offen nt lds
buffer_load_dwordx4 v232, s[8:11], s32 offen offset:1024 nt lds
buffer_load_dwordx4 v232, s[8:11], s33 offen offset:2048 nt lds
buffer_load_dwordx4 v232, s[8:11], s34 offen offset:3072 nt lds
s_add_u32 m0, s42, 98304
v_add_u32 v245, s54, v246
buffer_load_dwordx4 v245, s[20:23], 0 offen lds
buffer_load_dwordx4 v245, s[20:23], s38 offen offset:1024 lds
buffer_load_dwordx4 v245, s[20:23], s39 offen offset:2048 lds
buffer_load_dwordx4 v245, s[20:23], s40 offen offset:3072 lds
s_waitcnt vmcnt(8)
s_barrier
ds_read_b64_tr_b16 v[0:1], v247 offset:16384
s_add_u32 m0, s42, 114688
v_add_u32 v245, s55, v246
buffer_load_dwordx4 v245, s[20:23], 0 offen lds
ds_read_b64_tr_b16 v[2:3], v247 offset:18432
ds_read_b64_tr_b16 v[4:5], v247 offset:20480
ds_read_b64_tr_b16 v[6:7], v247 offset:22528
ds_read_b64_tr_b16 v[8:9], v247 offset:24576
ds_read_b64_tr_b16 v[10:11], v247 offset:26624
ds_read_b64_tr_b16 v[12:13], v247 offset:28672
ds_read_b64_tr_b16 v[14:15], v247 offset:30720
ds_read_b64_tr_b16 v[28:29], v247 offset:45056
ds_read_b64_tr_b16 v[30:31], v247 offset:47104
ds_read_b64_tr_b16 v[24:25], v247 offset:40960
ds_read_b64_tr_b16 v[26:27], v247 offset:43008
buffer_load_dwordx4 v245, s[20:23], s38 offen offset:1024 lds
ds_read_b64_tr_b16 v[20:21], v247 offset:36864
ds_read_b64_tr_b16 v[22:23], v247 offset:38912
ds_read_b64_tr_b16 v[16:17], v247 offset:32768
ds_read_b64_tr_b16 v[18:19], v247 offset:34816
ds_read_b64_tr_b16 v[32:33], v247 offset:49152
ds_read_b64_tr_b16 v[34:35], v247 offset:51200
ds_read_b64_tr_b16 v[36:37], v247 offset:53248
ds_read_b64_tr_b16 v[38:39], v247 offset:55296
ds_read_b64_tr_b16 v[40:41], v247 offset:57344
ds_read_b64_tr_b16 v[42:43], v247 offset:59392
ds_read_b64_tr_b16 v[44:45], v247 offset:61440
buffer_load_dwordx4 v245, s[20:23], s39 offen offset:2048 lds
ds_read_b64_tr_b16 v[46:47], v247 offset:63488
v_xor_b32 v247, 0x10000, v247
ds_read_b64_tr_b16 v[60:61], v247 offset:12288
ds_read_b64_tr_b16 v[62:63], v247 offset:14336
ds_read_b64_tr_b16 v[56:57], v247 offset:8192
ds_read_b64_tr_b16 v[58:59], v247 offset:10240
ds_read_b64_tr_b16 v[52:53], v247 offset:4096
ds_read_b64_tr_b16 v[54:55], v247 offset:6144
ds_read_b64_tr_b16 v[48:49], v247
ds_read_b64_tr_b16 v[50:51], v247 offset:2048
buffer_load_dwordx4 v245, s[20:23], s40 offen offset:3072 lds
s_waitcnt lgkmcnt(0)
s_barrier
s_add_u32 m0, s42, 0
v_add_u32 v245, s56, v246
buffer_load_dwordx4 v245, s[20:23], 0 offen lds
buffer_load_dwordx4 v245, s[20:23], s38 offen offset:1024 lds
buffer_load_dwordx4 v245, s[20:23], s39 offen offset:2048 lds
s_waitcnt vmcnt(11)
s_barrier
buffer_load_dwordx4 v245, s[20:23], s40 offen offset:3072 lds
s_add_u32 m0, s42, 16384
s_nop 0
buffer_load_dwordx4 v244, s[12:15], 0 offen nt lds
buffer_load_dwordx4 v244, s[12:15], s32 offen offset:1024 nt lds
buffer_load_dwordx4 v244, s[12:15], s33 offen offset:2048 nt lds
buffer_load_dwordx4 v244, s[12:15], s34 offen offset:3072 nt lds
s_add_u32 m0, s42, 32768
v_add_u32 v244, 0x10000, v244
buffer_load_dwordx4 v244, s[12:15], 0 offen nt lds
buffer_load_dwordx4 v244, s[12:15], s32 offen offset:1024 nt lds
buffer_load_dwordx4 v244, s[12:15], s33 offen offset:2048 nt lds
buffer_load_dwordx4 v244, s[12:15], s34 offen offset:3072 nt lds
s_add_u32 m0, s42, 49152
v_add_u32 v244, 0x10000, v244
buffer_load_dwordx4 v244, s[12:15], 0 offen nt lds
buffer_load_dwordx4 v244, s[12:15], s32 offen offset:1024 nt lds
buffer_load_dwordx4 v244, s[12:15], s33 offen offset:2048 nt lds
s_waitcnt vmcnt(11)
s_barrier
ds_read_b64_tr_b16 v[64:65], v247 offset:32768
buffer_load_dwordx4 v244, s[12:15], s34 offen offset:3072 nt lds
ds_read_b64_tr_b16 v[66:67], v247 offset:34816
ds_read_b64_tr_b16 v[68:69], v247 offset:36864
ds_read_b64_tr_b16 v[70:71], v247 offset:38912
ds_read_b64_tr_b16 v[72:73], v247 offset:40960
ds_read_b64_tr_b16 v[74:75], v247 offset:43008
ds_read_b64_tr_b16 v[76:77], v247 offset:45056
ds_read_b64_tr_b16 v[78:79], v247 offset:47104
ds_read_b64_tr_b16 v[92:93], v247 offset:61440
ds_read_b64_tr_b16 v[94:95], v247 offset:63488
ds_read_b64_tr_b16 v[88:89], v247 offset:57344
ds_read_b64_tr_b16 v[90:91], v247 offset:59392
ds_read_b64_tr_b16 v[84:85], v247 offset:53248
ds_read_b64_tr_b16 v[86:87], v247 offset:55296
ds_read_b64_tr_b16 v[80:81], v247 offset:49152
ds_read_b64_tr_b16 v[82:83], v247 offset:51200
v_xor_b32 v247, 0x10000, v247
ds_read_b64_tr_b16 v[96:97], v247
ds_read_b64_tr_b16 v[98:99], v247 offset:2048
ds_read_b64_tr_b16 v[100:101], v247 offset:4096
ds_read_b64_tr_b16 v[102:103], v247 offset:6144
ds_read_b64_tr_b16 v[104:105], v247 offset:8192
ds_read_b64_tr_b16 v[106:107], v247 offset:10240
ds_read_b64_tr_b16 v[108:109], v247 offset:12288
ds_read_b64_tr_b16 v[110:111], v247 offset:14336
s_add_u32 m0, s42, 65536
v_add_u32 v244, 0x10000, v244
buffer_load_dwordx4 v244, s[12:15], 0 offen nt lds
buffer_load_dwordx4 v244, s[12:15], s32 offen offset:1024 nt lds
buffer_load_dwordx4 v244, s[12:15], s33 offen offset:2048 nt lds
s_waitcnt vmcnt(11) lgkmcnt(0)
s_barrier
s_lshr_b32 s44, s41, 1
s_mul_i32 s44, s44, 14336
s_mul_i32 s45, s41, 7168
v_add_u32 v160, s44, v248
v_add_u32 v161, s45, v248
v_mbcnt_lo_u32_b32 v162, -1, 0
v_mbcnt_hi_u32_b32 v162, -1, v162
s_add_u32 s45, s45, 137216
v_lshl_add_u32 v162, v162, 2, s45
v_and_b32 v164, 0x1ff, v236
v_bfe_u32 v163, v236, 12, 1
v_lshl_or_b32 v164, v163, 9, v164
v_bfe_u32 v163, v236, 10, 1
v_lshl_or_b32 v164, v163, 12, v164
v_xor_b32 v165, 32, v164
v_mov_b32 v168, 0x3f803f80
v_mov_b32 v169, 0x3f803f80
v_mov_b32 v170, 0x3f803f80
v_mov_b32 v171, 0x3f803f80
ds_read_b128 v[112:115], v160
buffer_load_dwordx4 v244, s[12:15], s34 offen offset:3072 nt lds
ds_read_b128 v[124:127], v160 offset:7168
ds_read_b128 v[128:131], v160 offset:8192
ds_read_b128 v[116:119], v160 offset:1024
ds_read_b128 v[120:123], v160 offset:2048
ds_read_b128 v[132:135], v160 offset:9216
ds_read_b64_tr_b16 v[140:141], v164 offset:24576
ds_read_b64_tr_b16 v[142:143], v164 offset:25600
ds_read_b64_tr_b16 v[136:137], v164 offset:16384
ds_read_b64_tr_b16 v[138:139], v164 offset:17408
ds_read_b64_tr_b16 v[144:145], v165 offset:16384
ds_read_b64_tr_b16 v[146:147], v165 offset:17408
s_add_u32 m0, s42, 81920
v_add_u32 v244, 0xfffd0080, v244
buffer_load_dwordx4 v244, s[12:15], 0 offen nt lds
s_waitcnt lgkmcnt(11)
v_mfma_f32_16x16x32_bf16 v[172:175], v[168:171], v[112:115], 0
ds_read_b64_tr_b16 v[148:149], v165 offset:24576
ds_read_b64_tr_b16 v[150:151], v165 offset:25600
s_waitcnt lgkmcnt(12)
v_mfma_f32_16x16x32_bf16 v[172:175], v[168:171], v[124:127], v[172:175]
s_waitcnt lgkmcnt(11)
v_mfma_f32_16x16x32_bf16 v[176:179], v[168:171], v[128:131], 0
buffer_load_dwordx4 v244, s[12:15], s32 offen offset:1024 nt lds
s_waitcnt lgkmcnt(10)
v_mfma_f32_16x16x32_bf16 v[176:179], v[168:171], v[116:119], v[176:179]
s_waitcnt lgkmcnt(9)
v_mfma_f32_16x16x32_bf16 v[180:183], v[168:171], v[120:123], 0
s_waitcnt lgkmcnt(8)
v_mfma_f32_16x16x32_bf16 v[180:183], v[168:171], v[132:135], v[180:183]
buffer_load_dwordx4 v244, s[12:15], s33 offen offset:2048 nt lds
s_waitcnt lgkmcnt(6)
v_mfma_f32_16x16x32_bf16 v[192:195], v[140:143], v[132:135], 0
s_waitcnt lgkmcnt(4)
v_mfma_f32_16x16x32_bf16 v[192:195], v[136:139], v[120:123], v[192:195]
v_mfma_f32_16x16x32_bf16 v[188:191], v[136:139], v[116:119], 0
v_mfma_f32_16x16x32_bf16 v[188:191], v[140:143], v[128:131], v[188:191]
v_mfma_f32_16x16x32_bf16 v[184:187], v[140:143], v[124:127], 0
v_mfma_f32_16x16x32_bf16 v[184:187], v[136:139], v[112:115], v[184:187]
s_waitcnt lgkmcnt(0)
s_barrier
v_mfma_f32_16x16x32_bf16 v[196:199], v[144:147], v[112:115], 0
ds_read_b128 v[112:115], v160 offset:3072
v_mfma_f32_16x16x32_bf16 v[196:199], v[148:151], v[124:127], v[196:199]
ds_read_b128 v[124:127], v160 offset:10240
v_mfma_f32_16x16x32_bf16 v[200:203], v[148:151], v[128:131], 0
ds_read_b128 v[128:131], v160 offset:11264
v_mfma_f32_16x16x32_bf16 v[200:203], v[144:147], v[116:119], v[200:203]
ds_read_b128 v[116:119], v160 offset:4096
v_mfma_f32_16x16x32_bf16 v[204:207], v[144:147], v[120:123], 0
ds_read_b128 v[120:123], v160 offset:5120
v_mfma_f32_16x16x32_bf16 v[204:207], v[148:151], v[132:135], v[204:207]
ds_read_b128 v[132:135], v160 offset:12288
ds_read_b64_tr_b16 v[156:157], v164 offset:26624
s_waitcnt lgkmcnt(6)
v_mfma_f32_16x16x32_bf16 v[172:175], v[168:171], v[112:115], v[172:175]
ds_read_b64_tr_b16 v[158:159], v164 offset:27648
ds_read_b64_tr_b16 v[152:153], v164 offset:18432
s_waitcnt lgkmcnt(7)
v_mfma_f32_16x16x32_bf16 v[172:175], v[168:171], v[124:127], v[172:175]
ds_read_b64_tr_b16 v[154:155], v164 offset:19456
ds_read_b64_tr_b16 v[208:209], v165 offset:18432
s_waitcnt lgkmcnt(8)
v_mfma_f32_16x16x32_bf16 v[176:179], v[168:171], v[128:131], v[176:179]
ds_read_b64_tr_b16 v[210:211], v165 offset:19456
ds_read_b64_tr_b16 v[212:213], v165 offset:26624
s_waitcnt lgkmcnt(9)
v_mfma_f32_16x16x32_bf16 v[176:179], v[168:171], v[116:119], v[176:179]
ds_read_b64_tr_b16 v[214:215], v165 offset:27648
s_waitcnt lgkmcnt(9)
v_mfma_f32_16x16x32_bf16 v[180:183], v[168:171], v[120:123], v[180:183]
s_waitcnt lgkmcnt(8)
v_mfma_f32_16x16x32_bf16 v[180:183], v[168:171], v[132:135], v[180:183]
s_waitcnt lgkmcnt(6)
v_mfma_f32_16x16x32_bf16 v[192:195], v[156:159], v[132:135], v[192:195]
s_waitcnt lgkmcnt(4)
v_mfma_f32_16x16x32_bf16 v[192:195], v[152:155], v[120:123], v[192:195]
v_mfma_f32_16x16x32_bf16 v[188:191], v[152:155], v[116:119], v[188:191]
v_mfma_f32_16x16x32_bf16 v[188:191], v[156:159], v[128:131], v[188:191]
v_mfma_f32_16x16x32_bf16 v[184:187], v[156:159], v[124:127], v[184:187]
v_mfma_f32_16x16x32_bf16 v[184:187], v[152:155], v[112:115], v[184:187]
buffer_load_dwordx4 v244, s[12:15], s34 offen offset:3072 nt lds
s_add_u32 m0, s42, 98304
v_add_u32 v244, 0x10000, v244
buffer_load_dwordx4 v244, s[12:15], 0 offen nt lds
buffer_load_dwordx4 v244, s[12:15], s32 offen offset:1024 nt lds
s_waitcnt vmcnt(14) lgkmcnt(0)
s_barrier
v_mfma_f32_16x16x32_bf16 v[196:199], v[208:211], v[112:115], v[196:199]
ds_read_b128 v[112:115], v160
buffer_load_dwordx4 v244, s[12:15], s33 offen offset:2048 nt lds
v_mfma_f32_16x16x32_bf16 v[196:199], v[212:215], v[124:127], v[196:199]
ds_read_b128 v[124:127], v160 offset:7168
v_mfma_f32_16x16x32_bf16 v[200:203], v[212:215], v[128:131], v[200:203]
ds_read_b128 v[128:131], v160 offset:8192
v_mfma_f32_16x16x32_bf16 v[200:203], v[208:211], v[116:119], v[200:203]
ds_read_b128 v[116:119], v160 offset:1024
buffer_load_dwordx4 v244, s[12:15], s34 offen offset:3072 nt lds
v_mfma_f32_16x16x32_bf16 v[204:207], v[208:211], v[120:123], v[204:207]
ds_read_b128 v[120:123], v160 offset:2048
v_mfma_f32_16x16x32_bf16 v[204:207], v[212:215], v[132:135], v[204:207]
ds_read_b128 v[132:135], v160 offset:9216
ds_read_b64_tr_b16 v[140:141], v164 offset:40960
s_waitcnt lgkmcnt(6)
v_mfma_f32_16x16x32_bf16 v[172:175], v[168:171], v[112:115], v[172:175]
s_add_u32 m0, s42, 114688
v_add_u32 v244, 0x10000, v244
buffer_load_dwordx4 v244, s[12:15], 0 offen nt lds
s_waitcnt lgkmcnt(5)
v_mfma_f32_16x16x32_bf16 v[172:175], v[168:171], v[124:127], v[172:175]
ds_read_b64_tr_b16 v[142:143], v164 offset:41984
ds_read_b64_tr_b16 v[136:137], v164 offset:32768
s_waitcnt lgkmcnt(6)
v_mfma_f32_16x16x32_bf16 v[176:179], v[168:171], v[128:131], v[176:179]
ds_read_b64_tr_b16 v[138:139], v164 offset:33792
ds_read_b64_tr_b16 v[144:145], v165 offset:32768
s_waitcnt lgkmcnt(7)
v_mfma_f32_16x16x32_bf16 v[176:179], v[168:171], v[116:119], v[176:179]
buffer_load_dwordx4 v244, s[12:15], s32 offen offset:1024 nt lds
ds_read_b64_tr_b16 v[146:147], v165 offset:33792
s_waitcnt lgkmcnt(7)
v_mfma_f32_16x16x32_bf16 v[180:183], v[168:171], v[120:123], v[180:183]
ds_read_b64_tr_b16 v[148:149], v165 offset:40960
ds_read_b64_tr_b16 v[150:151], v165 offset:41984
s_waitcnt lgkmcnt(8)
v_mfma_f32_16x16x32_bf16 v[180:183], v[168:171], v[132:135], v[180:183]
s_waitcnt lgkmcnt(6)
v_mfma_f32_16x16x32_bf16 v[192:195], v[140:143], v[132:135], v[192:195]
buffer_load_dwordx4 v244, s[12:15], s33 offen offset:2048 nt lds
s_waitcnt lgkmcnt(4)
v_mfma_f32_16x16x32_bf16 v[192:195], v[136:139], v[120:123], v[192:195]
v_mfma_f32_16x16x32_bf16 v[188:191], v[136:139], v[116:119], v[188:191]
v_mfma_f32_16x16x32_bf16 v[188:191], v[140:143], v[128:131], v[188:191]
buffer_load_dwordx4 v244, s[12:15], s34 offen offset:3072 nt lds
v_mfma_f32_16x16x32_bf16 v[184:187], v[140:143], v[124:127], v[184:187]
v_mfma_f32_16x16x32_bf16 v[184:187], v[136:139], v[112:115], v[184:187]
s_waitcnt lgkmcnt(0)
s_barrier
v_mfma_f32_16x16x32_bf16 v[196:199], v[144:147], v[112:115], v[196:199]
s_add_u32 m0, s42, 0
v_add_u32 v244, 0x10000, v244
buffer_load_dwordx4 v244, s[12:15], 0 offen nt lds
v_mfma_f32_16x16x32_bf16 v[196:199], v[148:151], v[124:127], v[196:199]
ds_read_b128 v[112:115], v160 offset:3072
ds_read_b128 v[124:127], v160 offset:10240
v_mfma_f32_16x16x32_bf16 v[200:203], v[148:151], v[128:131], v[200:203]
ds_read_b128 v[128:131], v160 offset:11264
v_mfma_f32_16x16x32_bf16 v[200:203], v[144:147], v[116:119], v[200:203]
ds_read_b128 v[116:119], v160 offset:4096
v_mfma_f32_16x16x32_bf16 v[204:207], v[144:147], v[120:123], v[204:207]
ds_read_b128 v[120:123], v160 offset:5120
v_mfma_f32_16x16x32_bf16 v[204:207], v[148:151], v[132:135], v[204:207]
ds_read_b128 v[132:135], v160 offset:12288
ds_read_b64_tr_b16 v[156:157], v164 offset:43008
ds_read_b64_tr_b16 v[158:159], v164 offset:44032
ds_read_b64_tr_b16 v[152:153], v164 offset:34816
ds_read_b64_tr_b16 v[154:155], v164 offset:35840
ds_read_b64_tr_b16 v[208:209], v165 offset:34816
s_waitcnt lgkmcnt(10)
v_mfma_f32_16x16x32_bf16 v[172:175], v[168:171], v[112:115], v[172:175]
ds_read_b64_tr_b16 v[210:211], v165 offset:35840
ds_read_b64_tr_b16 v[212:213], v165 offset:43008
s_waitcnt lgkmcnt(11)
v_mfma_f32_16x16x32_bf16 v[172:175], v[168:171], v[124:127], v[172:175]
ds_read_b64_tr_b16 v[214:215], v165 offset:44032
s_waitcnt lgkmcnt(11)
v_mfma_f32_16x16x32_bf16 v[176:179], v[168:171], v[128:131], v[176:179]
s_waitcnt lgkmcnt(10)
v_mfma_f32_16x16x32_bf16 v[176:179], v[168:171], v[116:119], v[176:179]
s_waitcnt lgkmcnt(9)
v_mfma_f32_16x16x32_bf16 v[180:183], v[168:171], v[120:123], v[180:183]
s_waitcnt lgkmcnt(8)
v_mfma_f32_16x16x32_bf16 v[180:183], v[168:171], v[132:135], v[180:183]
s_waitcnt lgkmcnt(6)
v_mfma_f32_16x16x32_bf16 v[192:195], v[156:159], v[132:135], v[192:195]
s_waitcnt lgkmcnt(4)
v_mfma_f32_16x16x32_bf16 v[192:195], v[152:155], v[120:123], v[192:195]
v_mfma_f32_16x16x32_bf16 v[188:191], v[152:155], v[116:119], v[188:191]
v_mfma_f32_16x16x32_bf16 v[188:191], v[156:159], v[128:131], v[188:191]
v_mfma_f32_16x16x32_bf16 v[184:187], v[156:159], v[124:127], v[184:187]
v_mfma_f32_16x16x32_bf16 v[184:187], v[152:155], v[112:115], v[184:187]
s_waitcnt vmcnt(17) lgkmcnt(0)
s_barrier
v_mfma_f32_16x16x32_bf16 v[196:199], v[208:211], v[112:115], v[196:199]
ds_read_b128 v[112:115], v160
v_mfma_f32_16x16x32_bf16 v[196:199], v[212:215], v[124:127], v[196:199]
ds_read_b128 v[124:127], v160 offset:7168
v_mfma_f32_16x16x32_bf16 v[200:203], v[212:215], v[128:131], v[200:203]
ds_read_b128 v[128:131], v160 offset:8192
v_mfma_f32_16x16x32_bf16 v[200:203], v[208:211], v[116:119], v[200:203]
ds_read_b128 v[116:119], v160 offset:1024
v_mfma_f32_16x16x32_bf16 v[204:207], v[208:211], v[120:123], v[204:207]
ds_read_b128 v[120:123], v160 offset:2048
v_mfma_f32_16x16x32_bf16 v[204:207], v[212:215], v[132:135], v[204:207]
ds_read_b128 v[132:135], v160 offset:9216
ds_read_b64_tr_b16 v[140:141], v164 offset:57344
s_waitcnt lgkmcnt(6)
v_mfma_f32_16x16x32_bf16 v[172:175], v[168:171], v[112:115], v[172:175]
ds_read_b64_tr_b16 v[142:143], v164 offset:58368
ds_read_b64_tr_b16 v[136:137], v164 offset:49152
s_waitcnt lgkmcnt(7)
v_mfma_f32_16x16x32_bf16 v[172:175], v[168:171], v[124:127], v[172:175]
ds_read_b64_tr_b16 v[138:139], v164 offset:50176
ds_read_b64_tr_b16 v[144:145], v165 offset:49152
s_waitcnt lgkmcnt(8)
v_mfma_f32_16x16x32_bf16 v[176:179], v[168:171], v[128:131], v[176:179]
ds_read_b64_tr_b16 v[146:147], v165 offset:50176
ds_read_b64_tr_b16 v[148:149], v165 offset:57344
s_waitcnt lgkmcnt(9)
v_mfma_f32_16x16x32_bf16 v[176:179], v[168:171], v[116:119], v[176:179]
ds_read_b64_tr_b16 v[150:151], v165 offset:58368
s_waitcnt lgkmcnt(9)
v_mfma_f32_16x16x32_bf16 v[180:183], v[168:171], v[120:123], v[180:183]
s_waitcnt lgkmcnt(8)
v_mfma_f32_16x16x32_bf16 v[180:183], v[168:171], v[132:135], v[180:183]
s_waitcnt lgkmcnt(6)
v_mfma_f32_16x16x32_bf16 v[192:195], v[140:143], v[132:135], v[192:195]
s_waitcnt lgkmcnt(4)
v_mfma_f32_16x16x32_bf16 v[192:195], v[136:139], v[120:123], v[192:195]
v_mfma_f32_16x16x32_bf16 v[188:191], v[136:139], v[116:119], v[188:191]
v_mfma_f32_16x16x32_bf16 v[188:191], v[140:143], v[128:131], v[188:191]
v_mfma_f32_16x16x32_bf16 v[184:187], v[140:143], v[124:127], v[184:187]
v_mfma_f32_16x16x32_bf16 v[184:187], v[136:139], v[112:115], v[184:187]
s_waitcnt lgkmcnt(0)
s_barrier
v_mfma_f32_16x16x32_bf16 v[196:199], v[144:147], v[112:115], v[196:199]
buffer_load_dwordx4 v244, s[12:15], s32 offen offset:1024 nt lds
ds_read_b128 v[112:115], v160 offset:3072
v_mfma_f32_16x16x32_bf16 v[196:199], v[148:151], v[124:127], v[196:199]
ds_read_b128 v[124:127], v160 offset:10240
v_mfma_f32_16x16x32_bf16 v[200:203], v[148:151], v[128:131], v[200:203]
ds_read_b128 v[128:131], v160 offset:11264
v_mfma_f32_16x16x32_bf16 v[200:203], v[144:147], v[116:119], v[200:203]
s_add_u32 m0, s42, 16384
v_add_u32 v246, 0xe000, v246
v_add_u32 v245, s50, v246
buffer_load_dwordx4 v245, s[20:23], 0 offen lds
v_mfma_f32_16x16x32_bf16 v[204:207], v[144:147], v[120:123], v[204:207]
ds_read_b128 v[116:119], v160 offset:4096
ds_read_b128 v[120:123], v160 offset:5120
v_mfma_f32_16x16x32_bf16 v[204:207], v[148:151], v[132:135], v[204:207]
ds_read_b128 v[132:135], v160 offset:12288
ds_read_b64_tr_b16 v[156:157], v164 offset:59392
s_waitcnt lgkmcnt(6)
v_mfma_f32_16x16x32_bf16 v[172:175], v[168:171], v[112:115], v[172:175]
buffer_load_dwordx4 v245, s[20:23], s38 offen offset:1024 lds
ds_read_b64_tr_b16 v[158:159], v164 offset:60416
s_waitcnt lgkmcnt(6)
v_mfma_f32_16x16x32_bf16 v[172:175], v[168:171], v[124:127], v[172:175]
ds_read_b64_tr_b16 v[152:153], v164 offset:51200
ds_read_b64_tr_b16 v[154:155], v164 offset:52224
s_waitcnt lgkmcnt(7)
v_mfma_f32_16x16x32_bf16 v[176:179], v[168:171], v[128:131], v[176:179]
ds_read_b64_tr_b16 v[208:209], v165 offset:51200
ds_read_b64_tr_b16 v[210:211], v165 offset:52224
s_waitcnt lgkmcnt(8)
v_mfma_f32_16x16x32_bf16 v[176:179], v[168:171], v[116:119], v[176:179]
ds_read_b64_tr_b16 v[212:213], v165 offset:59392
ds_read_b64_tr_b16 v[214:215], v165 offset:60416
s_waitcnt lgkmcnt(9)
v_mfma_f32_16x16x32_bf16 v[180:183], v[168:171], v[120:123], v[180:183]
s_waitcnt lgkmcnt(8)
v_mfma_f32_16x16x32_bf16 v[180:183], v[168:171], v[132:135], v[180:183]
s_waitcnt lgkmcnt(6)
v_mfma_f32_16x16x32_bf16 v[192:195], v[156:159], v[132:135], v[192:195]
s_waitcnt lgkmcnt(4)
v_mfma_f32_16x16x32_bf16 v[192:195], v[152:155], v[120:123], v[192:195]
v_mfma_f32_16x16x32_bf16 v[188:191], v[152:155], v[116:119], v[188:191]
v_mfma_f32_16x16x32_bf16 v[188:191], v[156:159], v[128:131], v[188:191]
v_mfma_f32_16x16x32_bf16 v[184:187], v[156:159], v[124:127], v[184:187]
v_mfma_f32_16x16x32_bf16 v[184:187], v[152:155], v[112:115], v[184:187]
s_waitcnt vmcnt(16) lgkmcnt(0)
s_barrier
v_mfma_f32_16x16x32_bf16 v[196:199], v[208:211], v[112:115], v[196:199]
ds_read_b128 v[112:115], v160
v_mfma_f32_16x16x32_bf16 v[196:199], v[212:215], v[124:127], v[196:199]
ds_read_b128 v[124:127], v160 offset:7168
v_mfma_f32_16x16x32_bf16 v[200:203], v[212:215], v[128:131], v[200:203]
ds_read_b128 v[128:131], v160 offset:8192
v_mfma_f32_16x16x32_bf16 v[200:203], v[208:211], v[116:119], v[200:203]
ds_read_b128 v[116:119], v160 offset:1024
v_mfma_f32_16x16x32_bf16 v[204:207], v[208:211], v[120:123], v[204:207]
ds_read_b128 v[120:123], v160 offset:2048
v_mfma_f32_16x16x32_bf16 v[204:207], v[212:215], v[132:135], v[204:207]
ds_read_b128 v[132:135], v160 offset:9216
v_xor_b32 v164, 0x10000, v164
s_waitcnt lgkmcnt(5)
v_mfma_f32_16x16x32_bf16 v[172:175], v[168:171], v[112:115], v[172:175]
ds_read_b64_tr_b16 v[140:141], v164 offset:8192
ds_read_b64_tr_b16 v[142:143], v164 offset:9216
s_waitcnt lgkmcnt(6)
v_mfma_f32_16x16x32_bf16 v[172:175], v[168:171], v[124:127], v[172:175]
ds_read_b64_tr_b16 v[136:137], v164
ds_read_b64_tr_b16 v[138:139], v164 offset:1024
s_waitcnt lgkmcnt(7)
v_mfma_f32_16x16x32_bf16 v[176:179], v[168:171], v[128:131], v[176:179]
v_xor_b32 v165, 0x10000, v165
ds_read_b64_tr_b16 v[144:145], v165
s_waitcnt lgkmcnt(7)
v_mfma_f32_16x16x32_bf16 v[176:179], v[168:171], v[116:119], v[176:179]
ds_read_b64_tr_b16 v[146:147], v165 offset:1024
ds_read_b64_tr_b16 v[148:149], v165 offset:8192
s_waitcnt lgkmcnt(8)
v_mfma_f32_16x16x32_bf16 v[180:183], v[168:171], v[120:123], v[180:183]
ds_read_b64_tr_b16 v[150:151], v165 offset:9216
s_waitcnt lgkmcnt(8)
v_mfma_f32_16x16x32_bf16 v[180:183], v[168:171], v[132:135], v[180:183]
s_waitcnt lgkmcnt(6)
v_mfma_f32_16x16x32_bf16 v[192:195], v[140:143], v[132:135], v[192:195]
s_waitcnt lgkmcnt(4)
v_mfma_f32_16x16x32_bf16 v[192:195], v[136:139], v[120:123], v[192:195]
v_mfma_f32_16x16x32_bf16 v[188:191], v[136:139], v[116:119], v[188:191]
v_mfma_f32_16x16x32_bf16 v[188:191], v[140:143], v[128:131], v[188:191]
v_mfma_f32_16x16x32_bf16 v[184:187], v[140:143], v[124:127], v[184:187]
v_mfma_f32_16x16x32_bf16 v[184:187], v[136:139], v[112:115], v[184:187]
s_waitcnt vmcnt(12) lgkmcnt(0)
s_barrier
v_mfma_f32_16x16x32_bf16 v[196:199], v[144:147], v[112:115], v[196:199]
ds_read_b128 v[112:115], v160 offset:3072
v_mfma_f32_16x16x32_bf16 v[196:199], v[148:151], v[124:127], v[196:199]
ds_read_b128 v[124:127], v160 offset:10240
v_mfma_f32_16x16x32_bf16 v[200:203], v[148:151], v[128:131], v[200:203]
ds_read_b128 v[128:131], v160 offset:11264
v_mfma_f32_16x16x32_bf16 v[200:203], v[144:147], v[116:119], v[200:203]
ds_read_b128 v[116:119], v160 offset:4096
v_mfma_f32_16x16x32_bf16 v[204:207], v[144:147], v[120:123], v[204:207]
ds_read_b128 v[120:123], v160 offset:5120
v_mfma_f32_16x16x32_bf16 v[204:207], v[148:151], v[132:135], v[204:207]
ds_read_b128 v[132:135], v160 offset:12288
ds_read_b64_tr_b16 v[156:157], v164 offset:10240
s_waitcnt lgkmcnt(6)
v_mfma_f32_16x16x32_bf16 v[172:175], v[168:171], v[112:115], v[172:175]
ds_read_b64_tr_b16 v[158:159], v164 offset:11264
ds_read_b64_tr_b16 v[152:153], v164 offset:2048
s_waitcnt lgkmcnt(7)
v_mfma_f32_16x16x32_bf16 v[172:175], v[168:171], v[124:127], v[172:175]
ds_read_b64_tr_b16 v[154:155], v164 offset:3072
ds_read_b64_tr_b16 v[208:209], v165 offset:2048
s_waitcnt lgkmcnt(8)
v_mfma_f32_16x16x32_bf16 v[176:179], v[168:171], v[128:131], v[176:179]
ds_read_b64_tr_b16 v[210:211], v165 offset:3072
ds_read_b64_tr_b16 v[212:213], v165 offset:10240
s_waitcnt lgkmcnt(9)
v_mfma_f32_16x16x32_bf16 v[176:179], v[168:171], v[116:119], v[176:179]
ds_read_b64_tr_b16 v[214:215], v165 offset:11264
s_waitcnt lgkmcnt(9)
v_mfma_f32_16x16x32_bf16 v[180:183], v[168:171], v[120:123], v[180:183]
s_waitcnt lgkmcnt(8)
v_mfma_f32_16x16x32_bf16 v[180:183], v[168:171], v[132:135], v[180:183]
s_waitcnt lgkmcnt(6)
v_mfma_f32_16x16x32_bf16 v[192:195], v[156:159], v[132:135], v[192:195]
s_waitcnt lgkmcnt(4)
v_mfma_f32_16x16x32_bf16 v[192:195], v[152:155], v[120:123], v[192:195]
v_mfma_f32_16x16x32_bf16 v[188:191], v[152:155], v[116:119], v[188:191]
v_rcp_f32 v172, v172
v_mfma_f32_16x16x32_bf16 v[188:191], v[156:159], v[128:131], v[188:191]
v_rcp_f32 v176, v176
v_mfma_f32_16x16x32_bf16 v[184:187], v[156:159], v[124:127], v[184:187]
v_rcp_f32 v180, v180
v_mfma_f32_16x16x32_bf16 v[184:187], v[152:155], v[112:115], v[184:187]
s_nop 0
v_mul_f32 v192, v192, v180
v_mul_f32 v193, v193, v180
s_waitcnt lgkmcnt(2)
v_mfma_f32_16x16x32_bf16 v[196:199], v[208:211], v[112:115], v[196:199]
v_mul_f32 v194, v194, v180
v_mul_f32 v195, v195, v180
s_waitcnt lgkmcnt(0)
v_mfma_f32_16x16x32_bf16 v[196:199], v[212:215], v[124:127], v[196:199]
v_cvt_pk_bf16_f32 v192, v192, v193
v_cvt_pk_bf16_f32 v193, v194, v195
v_mfma_f32_16x16x32_bf16 v[200:203], v[212:215], v[128:131], v[200:203]
v_mul_f32 v188, v188, v176
v_mul_f32 v189, v189, v176
v_mfma_f32_16x16x32_bf16 v[200:203], v[208:211], v[116:119], v[200:203]
v_mul_f32 v190, v190, v176
v_mul_f32 v191, v191, v176
v_mfma_f32_16x16x32_bf16 v[204:207], v[208:211], v[120:123], v[204:207]
v_cvt_pk_bf16_f32 v188, v188, v189
v_cvt_pk_bf16_f32 v189, v190, v191
v_mfma_f32_16x16x32_bf16 v[204:207], v[212:215], v[132:135], v[204:207]
v_mul_f32 v184, v184, v172
v_mul_f32 v185, v185, v172
v_mul_f32 v186, v186, v172
buffer_load_dwordx4 v245, s[20:23], s39 offen offset:2048 lds
v_mul_f32 v187, v187, v172
v_cvt_pk_bf16_f32 v184, v184, v185
v_cvt_pk_bf16_f32 v185, v186, v187
v_mul_f32 v196, v196, v172
v_mul_f32 v197, v197, v172
v_mul_f32 v198, v198, v172
v_mul_f32 v199, v199, v172
v_cvt_pk_bf16_f32 v186, v196, v197
v_cvt_pk_bf16_f32 v187, v198, v199
ds_write_b128 v161, v[184:187]
buffer_load_dwordx4 v245, s[20:23], s40 offen offset:3072 lds
v_mul_f32 v200, v200, v176
v_mul_f32 v201, v201, v176
v_mul_f32 v202, v202, v176
v_mul_f32 v203, v203, v176
v_cvt_pk_bf16_f32 v190, v200, v201
v_cvt_pk_bf16_f32 v191, v202, v203
ds_write_b128 v161, v[188:191] offset:1024
s_add_u32 m0, s42, 32768
v_add_u32 v245, s51, v246
buffer_load_dwordx4 v245, s[20:23], 0 offen lds
v_mul_f32 v204, v204, v180
v_mul_f32 v205, v205, v180
v_mul_f32 v206, v206, v180
v_mul_f32 v207, v207, v180
v_cvt_pk_bf16_f32 v194, v204, v205
v_cvt_pk_bf16_f32 v195, v206, v207
ds_write_b128 v161, v[192:195] offset:2048
ds_write_b32 v162, v172
ds_write_b32 v162, v176 offset:256
ds_write_b32 v162, v180 offset:512
buffer_load_dwordx4 v245, s[20:23], s38 offen offset:1024 lds
buffer_load_dwordx4 v245, s[20:23], s39 offen offset:2048 lds
s_waitcnt vmcnt(13) lgkmcnt(0)
s_barrier
ds_read_b128 v[112:115], v248
buffer_load_dwordx4 v245, s[20:23], s40 offen offset:3072 lds
ds_read_b128 v[124:127], v248 offset:7168
ds_read_b128 v[136:139], v248 offset:14336
ds_read_b128 v[148:151], v248 offset:21504
ds_read_b128 v[152:155], v248 offset:22528
ds_read_b128 v[140:143], v248 offset:15360
ds_read_b128 v[128:131], v248 offset:8192
ds_read_b128 v[116:119], v248 offset:1024
ds_read_b128 v[120:123], v248 offset:2048
ds_read_b128 v[132:135], v248 offset:9216
ds_read_b128 v[144:147], v248 offset:16384
ds_read_b128 v[156:159], v248 offset:23552
s_add_u32 m0, s42, 49152
v_add_u32 v245, s52, v246
buffer_load_dwordx4 v245, s[20:23], 0 offen lds
s_waitcnt lgkmcnt(11)
v_mfma_f32_16x16x32_bf16 v[160:163], v[0:3], v[112:115], 0
s_waitcnt lgkmcnt(10)
v_mfma_f32_16x16x32_bf16 v[160:163], v[4:7], v[124:127], v[160:163]
s_waitcnt lgkmcnt(9)
v_mfma_f32_16x16x32_bf16 v[160:163], v[8:11], v[136:139], v[160:163]
s_waitcnt lgkmcnt(8)
v_mfma_f32_16x16x32_bf16 v[160:163], v[12:15], v[148:151], v[160:163]
s_waitcnt lgkmcnt(7)
v_mfma_f32_16x16x32_bf16 v[164:167], v[12:15], v[152:155], 0
s_waitcnt lgkmcnt(6)
v_mfma_f32_16x16x32_bf16 v[164:167], v[8:11], v[140:143], v[164:167]
s_waitcnt lgkmcnt(5)
v_mfma_f32_16x16x32_bf16 v[164:167], v[4:7], v[128:131], v[164:167]
s_waitcnt lgkmcnt(4)
v_mfma_f32_16x16x32_bf16 v[164:167], v[0:3], v[116:119], v[164:167]
s_waitcnt lgkmcnt(3)
v_mfma_f32_16x16x32_bf16 v[168:171], v[0:3], v[120:123], 0
s_waitcnt lgkmcnt(2)
v_mfma_f32_16x16x32_bf16 v[168:171], v[4:7], v[132:135], v[168:171]
buffer_load_dwordx4 v245, s[20:23], s38 offen offset:1024 lds
buffer_load_dwordx4 v245, s[20:23], s39 offen offset:2048 lds
buffer_load_dwordx4 v245, s[20:23], s40 offen offset:3072 lds
s_waitcnt vmcnt(14) lgkmcnt(0)
s_barrier
v_mfma_f32_16x16x32_bf16 v[168:171], v[8:11], v[144:147], v[168:171]
v_mfma_f32_16x16x32_bf16 v[168:171], v[12:15], v[156:159], v[168:171]
s_add_u32 m0, s42, 81920
v_add_u32 v245, s53, v246
buffer_load_dwordx4 v245, s[20:23], 0 offen lds
buffer_load_dwordx4 v245, s[20:23], s38 offen offset:1024 lds
buffer_load_dwordx4 v245, s[20:23], s39 offen offset:2048 lds
buffer_load_dwordx4 v245, s[20:23], s40 offen offset:3072 lds
s_add_u32 m0, s42, 0
s_nop 0
buffer_load_dwordx4 v244, s[12:15], s33 offen offset:2048 nt lds
s_add_u32 m0, s42, 65536
v_add_u32 v245, s54, v246
buffer_load_dwordx4 v245, s[20:23], 0 offen lds
buffer_load_dwordx4 v245, s[20:23], s38 offen offset:1024 lds
buffer_load_dwordx4 v245, s[20:23], s39 offen offset:2048 lds
s_waitcnt vmcnt(12)
s_barrier
v_mfma_f32_16x16x32_bf16 v[180:183], v[28:31], v[156:159], 0
buffer_load_dwordx4 v245, s[20:23], s40 offen offset:3072 lds
ds_read_b64_tr_b16 v[0:1], v247 offset:16384
v_mfma_f32_16x16x32_bf16 v[180:183], v[24:27], v[144:147], v[180:183]
ds_read_b64_tr_b16 v[2:3], v247 offset:18432
ds_read_b64_tr_b16 v[4:5], v247 offset:20480
v_mfma_f32_16x16x32_bf16 v[180:183], v[20:23], v[132:135], v[180:183]
ds_read_b64_tr_b16 v[6:7], v247 offset:22528
ds_read_b64_tr_b16 v[8:9], v247 offset:24576
v_mfma_f32_16x16x32_bf16 v[180:183], v[16:19], v[120:123], v[180:183]
s_add_u32 m0, s42, 0
s_nop 0
buffer_load_dwordx4 v244, s[12:15], s34 offen offset:3072 nt lds
v_mfma_f32_16x16x32_bf16 v[176:179], v[16:19], v[116:119], 0
ds_read_b64_tr_b16 v[10:11], v247 offset:26624
ds_read_b64_tr_b16 v[12:13], v247 offset:28672
v_mfma_f32_16x16x32_bf16 v[176:179], v[20:23], v[128:131], v[176:179]
ds_read_b64_tr_b16 v[14:15], v247 offset:30720
v_mfma_f32_16x16x32_bf16 v[176:179], v[24:27], v[140:143], v[176:179]
v_mfma_f32_16x16x32_bf16 v[176:179], v[28:31], v[152:155], v[176:179]
s_add_u32 m0, s42, 98304
v_add_u32 v245, s55, v246
buffer_load_dwordx4 v245, s[20:23], 0 offen lds
v_mfma_f32_16x16x32_bf16 v[172:175], v[28:31], v[148:151], 0
ds_read_b64_tr_b16 v[28:29], v247 offset:45056
ds_read_b64_tr_b16 v[30:31], v247 offset:47104
v_mfma_f32_16x16x32_bf16 v[172:175], v[24:27], v[136:139], v[172:175]
ds_read_b64_tr_b16 v[24:25], v247 offset:40960
ds_read_b64_tr_b16 v[26:27], v247 offset:43008
v_mfma_f32_16x16x32_bf16 v[172:175], v[20:23], v[124:127], v[172:175]
ds_read_b64_tr_b16 v[20:21], v247 offset:36864
buffer_load_dwordx4 v245, s[20:23], s38 offen offset:1024 lds
v_mfma_f32_16x16x32_bf16 v[172:175], v[16:19], v[112:115], v[172:175]
ds_read_b64_tr_b16 v[22:23], v247 offset:38912
ds_read_b64_tr_b16 v[16:17], v247 offset:32768
v_mfma_f32_16x16x32_bf16 v[184:187], v[32:35], v[112:115], 0
ds_read_b64_tr_b16 v[18:19], v247 offset:34816
v_mfma_f32_16x16x32_bf16 v[184:187], v[36:39], v[124:127], v[184:187]
v_mfma_f32_16x16x32_bf16 v[184:187], v[40:43], v[136:139], v[184:187]
buffer_load_dwordx4 v245, s[20:23], s39 offen offset:2048 lds
v_mfma_f32_16x16x32_bf16 v[184:187], v[44:47], v[148:151], v[184:187]
v_mfma_f32_16x16x32_bf16 v[188:191], v[44:47], v[152:155], 0
v_mfma_f32_16x16x32_bf16 v[188:191], v[40:43], v[140:143], v[188:191]
v_mfma_f32_16x16x32_bf16 v[188:191], v[36:39], v[128:131], v[188:191]
buffer_load_dwordx4 v245, s[20:23], s40 offen offset:3072 lds
v_mfma_f32_16x16x32_bf16 v[188:191], v[32:35], v[116:119], v[188:191]
v_mfma_f32_16x16x32_bf16 v[192:195], v[32:35], v[120:123], 0
v_mfma_f32_16x16x32_bf16 v[192:195], v[36:39], v[132:135], v[192:195]
v_mfma_f32_16x16x32_bf16 v[192:195], v[40:43], v[144:147], v[192:195]
s_add_u32 m0, s42, 114688
v_add_u32 v245, s56, v246
buffer_load_dwordx4 v245, s[20:23], 0 offen lds
v_mfma_f32_16x16x32_bf16 v[192:195], v[44:47], v[156:159], v[192:195]
v_mfma_f32_16x16x32_bf16 v[204:207], v[60:63], v[156:159], 0
v_mfma_f32_16x16x32_bf16 v[204:207], v[56:59], v[144:147], v[204:207]
v_mfma_f32_16x16x32_bf16 v[204:207], v[52:55], v[132:135], v[204:207]
buffer_load_dwordx4 v245, s[20:23], s38 offen offset:1024 lds
v_mfma_f32_16x16x32_bf16 v[204:207], v[48:51], v[120:123], v[204:207]
v_mfma_f32_16x16x32_bf16 v[200:203], v[48:51], v[116:119], 0
v_mfma_f32_16x16x32_bf16 v[200:203], v[52:55], v[128:131], v[200:203]
v_mfma_f32_16x16x32_bf16 v[200:203], v[56:59], v[140:143], v[200:203]
buffer_load_dwordx4 v245, s[20:23], s39 offen offset:2048 lds
v_mfma_f32_16x16x32_bf16 v[200:203], v[60:63], v[152:155], v[200:203]
v_mfma_f32_16x16x32_bf16 v[196:199], v[60:63], v[148:151], 0
v_mfma_f32_16x16x32_bf16 v[196:199], v[56:59], v[136:139], v[196:199]
buffer_load_dwordx4 v245, s[20:23], s40 offen offset:3072 lds
s_waitcnt vmcnt(9) lgkmcnt(0)
s_barrier
v_mfma_f32_16x16x32_bf16 v[196:199], v[52:55], v[124:127], v[196:199]
s_add_u32 m0, s42, 16384
v_add_u32 v244, 0xfffd0080, v244
buffer_load_dwordx4 v244, s[12:15], 0 offen nt lds
v_mfma_f32_16x16x32_bf16 v[196:199], v[48:51], v[112:115], v[196:199]
ds_read_b64_tr_b16 v[32:33], v247 offset:49152
ds_read_b64_tr_b16 v[34:35], v247 offset:51200
v_mfma_f32_16x16x32_bf16 v[208:211], v[64:67], v[112:115], 0
ds_read_b64_tr_b16 v[36:37], v247 offset:53248
ds_read_b64_tr_b16 v[38:39], v247 offset:55296
v_mfma_f32_16x16x32_bf16 v[208:211], v[68:71], v[124:127], v[208:211]
ds_read_b64_tr_b16 v[40:41], v247 offset:57344
buffer_load_dwordx4 v244, s[12:15], s32 offen offset:1024 nt lds
v_mfma_f32_16x16x32_bf16 v[208:211], v[72:75], v[136:139], v[208:211]
ds_read_b64_tr_b16 v[42:43], v247 offset:59392
ds_read_b64_tr_b16 v[44:45], v247 offset:61440
v_mfma_f32_16x16x32_bf16 v[208:211], v[76:79], v[148:151], v[208:211]
ds_read_b64_tr_b16 v[46:47], v247 offset:63488
v_xor_b32 v247, 0x10000, v247
v_mfma_f32_16x16x32_bf16 v[212:215], v[76:79], v[152:155], 0
ds_read_b64_tr_b16 v[60:61], v247 offset:28672
buffer_load_dwordx4 v244, s[12:15], s33 offen offset:2048 nt lds
v_mfma_f32_16x16x32_bf16 v[212:215], v[72:75], v[140:143], v[212:215]
ds_read_b64_tr_b16 v[62:63], v247 offset:30720
ds_read_b64_tr_b16 v[56:57], v247 offset:24576
v_mfma_f32_16x16x32_bf16 v[212:215], v[68:71], v[128:131], v[212:215]
ds_read_b64_tr_b16 v[58:59], v247 offset:26624
ds_read_b64_tr_b16 v[52:53], v247 offset:20480
v_mfma_f32_16x16x32_bf16 v[212:215], v[64:67], v[116:119], v[212:215]
ds_read_b64_tr_b16 v[54:55], v247 offset:22528
buffer_load_dwordx4 v244, s[12:15], s34 offen offset:3072 nt lds
v_mfma_f32_16x16x32_bf16 v[216:219], v[64:67], v[120:123], 0
ds_read_b64_tr_b16 v[48:49], v247 offset:16384
ds_read_b64_tr_b16 v[50:51], v247 offset:18432
v_mfma_f32_16x16x32_bf16 v[216:219], v[68:71], v[132:135], v[216:219]
ds_read_b64_tr_b16 v[64:65], v247
ds_read_b64_tr_b16 v[66:67], v247 offset:2048
v_mfma_f32_16x16x32_bf16 v[216:219], v[72:75], v[144:147], v[216:219]
ds_read_b64_tr_b16 v[68:69], v247 offset:4096
s_add_u32 m0, s42, 32768
v_add_u32 v244, 0x10000, v244
buffer_load_dwordx4 v244, s[12:15], 0 offen nt lds
v_mfma_f32_16x16x32_bf16 v[216:219], v[76:79], v[156:159], v[216:219]
ds_read_b64_tr_b16 v[70:71], v247 offset:6144
ds_read_b64_tr_b16 v[72:73], v247 offset:8192
v_mfma_f32_16x16x32_bf16 v[228:231], v[92:95], v[156:159], 0
ds_read_b64_tr_b16 v[74:75], v247 offset:10240
ds_read_b64_tr_b16 v[76:77], v247 offset:12288
v_mfma_f32_16x16x32_bf16 v[228:231], v[88:91], v[144:147], v[228:231]
ds_read_b64_tr_b16 v[78:79], v247 offset:14336
buffer_load_dwordx4 v244, s[12:15], s32 offen offset:1024 nt lds
v_mfma_f32_16x16x32_bf16 v[228:231], v[84:87], v[132:135], v[228:231]
v_mfma_f32_16x16x32_bf16 v[228:231], v[80:83], v[120:123], v[228:231]
v_mfma_f32_16x16x32_bf16 v[224:227], v[80:83], v[116:119], 0
v_mfma_f32_16x16x32_bf16 v[224:227], v[84:87], v[128:131], v[224:227]
buffer_load_dwordx4 v244, s[12:15], s33 offen offset:2048 nt lds
v_mfma_f32_16x16x32_bf16 v[224:227], v[88:91], v[140:143], v[224:227]
v_mfma_f32_16x16x32_bf16 v[224:227], v[92:95], v[152:155], v[224:227]
v_mfma_f32_16x16x32_bf16 v[220:223], v[92:95], v[148:151], 0
v_mfma_f32_16x16x32_bf16 v[220:223], v[88:91], v[136:139], v[220:223]
v_mfma_f32_16x16x32_bf16 v[220:223], v[84:87], v[124:127], v[220:223]
v_mfma_f32_16x16x32_bf16 v[220:223], v[80:83], v[112:115], v[220:223]
v_mfma_f32_16x16x32_bf16 v[232:235], v[96:99], v[112:115], 0
v_mfma_f32_16x16x32_bf16 v[232:235], v[100:103], v[124:127], v[232:235]
v_mfma_f32_16x16x32_bf16 v[232:235], v[104:107], v[136:139], v[232:235]
v_mfma_f32_16x16x32_bf16 v[232:235], v[108:111], v[148:151], v[232:235]
v_mfma_f32_16x16x32_bf16 v[236:239], v[108:111], v[152:155], 0
v_mfma_f32_16x16x32_bf16 v[236:239], v[104:107], v[140:143], v[236:239]
v_mfma_f32_16x16x32_bf16 v[236:239], v[100:103], v[128:131], v[236:239]
v_mfma_f32_16x16x32_bf16 v[236:239], v[96:99], v[116:119], v[236:239]
v_mfma_f32_16x16x32_bf16 v[240:243], v[96:99], v[120:123], 0
v_mfma_f32_16x16x32_bf16 v[240:243], v[100:103], v[132:135], v[240:243]
buffer_load_dwordx4 v244, s[12:15], s34 offen offset:3072 nt lds
s_waitcnt vmcnt(8) lgkmcnt(0)
s_barrier
v_mfma_f32_16x16x32_bf16 v[240:243], v[104:107], v[144:147], v[240:243]
s_add_u32 m0, s42, 49152
v_add_u32 v244, 0x10000, v244
buffer_load_dwordx4 v244, s[12:15], 0 offen nt lds
v_mfma_f32_16x16x32_bf16 v[240:243], v[108:111], v[156:159], v[240:243]
ds_read_b64_tr_b16 v[92:93], v247 offset:45056
ds_read_b64_tr_b16 v[94:95], v247 offset:47104
ds_read_b64_tr_b16 v[88:89], v247 offset:40960
ds_read_b64_tr_b16 v[90:91], v247 offset:43008
ds_read_b64_tr_b16 v[84:85], v247 offset:36864
ds_read_b64_tr_b16 v[86:87], v247 offset:38912
ds_read_b64_tr_b16 v[80:81], v247 offset:32768
ds_read_b64_tr_b16 v[82:83], v247 offset:34816
ds_read_b64_tr_b16 v[96:97], v247 offset:49152
buffer_load_dwordx4 v244, s[12:15], s32 offen offset:1024 nt lds
ds_read_b64_tr_b16 v[98:99], v247 offset:51200
ds_read_b64_tr_b16 v[100:101], v247 offset:53248
ds_read_b64_tr_b16 v[102:103], v247 offset:55296
ds_read_b64_tr_b16 v[104:105], v247 offset:57344
ds_read_b64_tr_b16 v[106:107], v247 offset:59392
ds_read_b64_tr_b16 v[108:109], v247 offset:61440
ds_read_b64_tr_b16 v[110:111], v247 offset:63488
buffer_load_dwordx4 v244, s[12:15], s33 offen offset:2048 nt lds
s_waitcnt lgkmcnt(0)
s_barrier
buffer_load_dwordx4 v244, s[12:15], s34 offen offset:3072 nt lds
s_add_u32 m0, s42, 81920
v_add_u32 v244, 0x10000, v244
buffer_load_dwordx4 v244, s[12:15], 0 offen nt lds
buffer_load_dwordx4 v244, s[12:15], s32 offen offset:1024 nt lds
buffer_load_dwordx4 v244, s[12:15], s33 offen offset:2048 nt lds
buffer_load_dwordx4 v244, s[12:15], s34 offen offset:3072 nt lds
s_waitcnt vmcnt(12)
s_barrier
ds_read_b128 v[112:115], v248
ds_read_b128 v[124:127], v248 offset:7168
ds_read_b128 v[136:139], v248 offset:14336
ds_read_b128 v[148:151], v248 offset:21504
ds_read_b128 v[152:155], v248 offset:22528
ds_read_b128 v[140:143], v248 offset:15360
ds_read_b128 v[128:131], v248 offset:8192
ds_read_b128 v[116:119], v248 offset:1024
ds_read_b128 v[120:123], v248 offset:2048
ds_read_b128 v[132:135], v248 offset:9216
ds_read_b128 v[144:147], v248 offset:16384
ds_read_b128 v[156:159], v248 offset:23552
s_waitcnt lgkmcnt(11)
v_mfma_f32_16x16x32_bf16 v[160:163], v[0:3], v[112:115], v[160:163]
s_waitcnt lgkmcnt(10)
v_mfma_f32_16x16x32_bf16 v[160:163], v[4:7], v[124:127], v[160:163]
s_waitcnt lgkmcnt(9)
v_mfma_f32_16x16x32_bf16 v[160:163], v[8:11], v[136:139], v[160:163]
s_waitcnt lgkmcnt(8)
v_mfma_f32_16x16x32_bf16 v[160:163], v[12:15], v[148:151], v[160:163]
s_waitcnt lgkmcnt(7)
v_mfma_f32_16x16x32_bf16 v[164:167], v[12:15], v[152:155], v[164:167]
s_waitcnt lgkmcnt(6)
v_mfma_f32_16x16x32_bf16 v[164:167], v[8:11], v[140:143], v[164:167]
s_waitcnt lgkmcnt(5)
v_mfma_f32_16x16x32_bf16 v[164:167], v[4:7], v[128:131], v[164:167]
s_waitcnt lgkmcnt(4)
v_mfma_f32_16x16x32_bf16 v[164:167], v[0:3], v[116:119], v[164:167]
s_waitcnt lgkmcnt(3)
v_mfma_f32_16x16x32_bf16 v[168:171], v[0:3], v[120:123], v[168:171]
s_waitcnt lgkmcnt(2)
v_mfma_f32_16x16x32_bf16 v[168:171], v[4:7], v[132:135], v[168:171]
s_add_u32 m0, s42, 65536
v_add_u32 v244, 0xfffd0080, v244
buffer_load_dwordx4 v244, s[12:15], 0 offen nt lds
buffer_load_dwordx4 v244, s[12:15], s32 offen offset:1024 nt lds
buffer_load_dwordx4 v244, s[12:15], s33 offen offset:2048 nt lds
s_waitcnt vmcnt(11) lgkmcnt(0)
s_barrier
v_mfma_f32_16x16x32_bf16 v[168:171], v[8:11], v[144:147], v[168:171]
buffer_load_dwordx4 v244, s[12:15], s34 offen offset:3072 nt lds
v_mfma_f32_16x16x32_bf16 v[168:171], v[12:15], v[156:159], v[168:171]
v_mfma_f32_16x16x32_bf16 v[180:183], v[28:31], v[156:159], v[180:183]
v_mfma_f32_16x16x32_bf16 v[180:183], v[24:27], v[144:147], v[180:183]
v_mfma_f32_16x16x32_bf16 v[180:183], v[20:23], v[132:135], v[180:183]
s_add_u32 m0, s42, 98304
v_add_u32 v244, 0x10000, v244
buffer_load_dwordx4 v244, s[12:15], 0 offen nt lds
v_mfma_f32_16x16x32_bf16 v[180:183], v[16:19], v[120:123], v[180:183]
v_mfma_f32_16x16x32_bf16 v[176:179], v[16:19], v[116:119], v[176:179]
v_mfma_f32_16x16x32_bf16 v[176:179], v[20:23], v[128:131], v[176:179]
v_mfma_f32_16x16x32_bf16 v[176:179], v[24:27], v[140:143], v[176:179]
buffer_load_dwordx4 v244, s[12:15], s32 offen offset:1024 nt lds
v_mfma_f32_16x16x32_bf16 v[176:179], v[28:31], v[152:155], v[176:179]
v_mfma_f32_16x16x32_bf16 v[172:175], v[28:31], v[148:151], v[172:175]
v_mfma_f32_16x16x32_bf16 v[172:175], v[24:27], v[136:139], v[172:175]
v_mfma_f32_16x16x32_bf16 v[172:175], v[20:23], v[124:127], v[172:175]
v_mfma_f32_16x16x32_bf16 v[172:175], v[16:19], v[112:115], v[172:175]
v_mfma_f32_16x16x32_bf16 v[184:187], v[32:35], v[112:115], v[184:187]
v_mfma_f32_16x16x32_bf16 v[184:187], v[36:39], v[124:127], v[184:187]
v_mfma_f32_16x16x32_bf16 v[184:187], v[40:43], v[136:139], v[184:187]
v_mfma_f32_16x16x32_bf16 v[184:187], v[44:47], v[148:151], v[184:187]
v_mfma_f32_16x16x32_bf16 v[188:191], v[44:47], v[152:155], v[188:191]
v_mfma_f32_16x16x32_bf16 v[188:191], v[40:43], v[140:143], v[188:191]
v_mfma_f32_16x16x32_bf16 v[188:191], v[36:39], v[128:131], v[188:191]
v_mfma_f32_16x16x32_bf16 v[188:191], v[32:35], v[116:119], v[188:191]
v_mfma_f32_16x16x32_bf16 v[192:195], v[32:35], v[120:123], v[192:195]
v_mfma_f32_16x16x32_bf16 v[192:195], v[36:39], v[132:135], v[192:195]
buffer_load_dwordx4 v244, s[12:15], s33 offen offset:2048 nt lds
s_barrier
v_mfma_f32_16x16x32_bf16 v[192:195], v[40:43], v[144:147], v[192:195]
v_mfma_f32_16x16x32_bf16 v[192:195], v[44:47], v[156:159], v[192:195]
v_mfma_f32_16x16x32_bf16 v[204:207], v[60:63], v[156:159], v[204:207]
v_mfma_f32_16x16x32_bf16 v[204:207], v[56:59], v[144:147], v[204:207]
v_mfma_f32_16x16x32_bf16 v[204:207], v[52:55], v[132:135], v[204:207]
v_mfma_f32_16x16x32_bf16 v[204:207], v[48:51], v[120:123], v[204:207]
v_mfma_f32_16x16x32_bf16 v[200:203], v[48:51], v[116:119], v[200:203]
v_mfma_f32_16x16x32_bf16 v[200:203], v[52:55], v[128:131], v[200:203]
v_mfma_f32_16x16x32_bf16 v[200:203], v[56:59], v[140:143], v[200:203]
v_mfma_f32_16x16x32_bf16 v[200:203], v[60:63], v[152:155], v[200:203]
v_mfma_f32_16x16x32_bf16 v[196:199], v[60:63], v[148:151], v[196:199]
v_mfma_f32_16x16x32_bf16 v[196:199], v[56:59], v[136:139], v[196:199]
v_mfma_f32_16x16x32_bf16 v[196:199], v[52:55], v[124:127], v[196:199]
v_mfma_f32_16x16x32_bf16 v[196:199], v[48:51], v[112:115], v[196:199]
v_mfma_f32_16x16x32_bf16 v[208:211], v[64:67], v[112:115], v[208:211]
v_mfma_f32_16x16x32_bf16 v[208:211], v[68:71], v[124:127], v[208:211]
v_mfma_f32_16x16x32_bf16 v[208:211], v[72:75], v[136:139], v[208:211]
v_mfma_f32_16x16x32_bf16 v[208:211], v[76:79], v[148:151], v[208:211]
v_mfma_f32_16x16x32_bf16 v[212:215], v[76:79], v[152:155], v[212:215]
v_mfma_f32_16x16x32_bf16 v[212:215], v[72:75], v[140:143], v[212:215]
v_mfma_f32_16x16x32_bf16 v[212:215], v[68:71], v[128:131], v[212:215]
v_mfma_f32_16x16x32_bf16 v[212:215], v[64:67], v[116:119], v[212:215]
v_mfma_f32_16x16x32_bf16 v[216:219], v[64:67], v[120:123], v[216:219]
v_mfma_f32_16x16x32_bf16 v[216:219], v[68:71], v[132:135], v[216:219]
buffer_load_dwordx4 v244, s[12:15], s34 offen offset:3072 nt lds
s_add_u32 m0, s42, 114688
v_add_u32 v244, 0x10000, v244
buffer_load_dwordx4 v244, s[12:15], 0 offen nt lds
buffer_load_dwordx4 v244, s[12:15], s32 offen offset:1024 nt lds
s_waitcnt vmcnt(14)
s_barrier
v_mfma_f32_16x16x32_bf16 v[216:219], v[72:75], v[144:147], v[216:219]
buffer_load_dwordx4 v244, s[12:15], s33 offen offset:2048 nt lds
v_mfma_f32_16x16x32_bf16 v[216:219], v[76:79], v[156:159], v[216:219]
v_mfma_f32_16x16x32_bf16 v[228:231], v[92:95], v[156:159], v[228:231]
v_mfma_f32_16x16x32_bf16 v[228:231], v[88:91], v[144:147], v[228:231]
v_mfma_f32_16x16x32_bf16 v[228:231], v[84:87], v[132:135], v[228:231]
buffer_load_dwordx4 v244, s[12:15], s34 offen offset:3072 nt lds
v_mfma_f32_16x16x32_bf16 v[228:231], v[80:83], v[120:123], v[228:231]
v_mfma_f32_16x16x32_bf16 v[224:227], v[80:83], v[116:119], v[224:227]
v_mfma_f32_16x16x32_bf16 v[224:227], v[84:87], v[128:131], v[224:227]
v_mfma_f32_16x16x32_bf16 v[224:227], v[88:91], v[140:143], v[224:227]
s_add_u32 m0, s42, 0
v_add_u32 v244, 0x10000, v244
buffer_load_dwordx4 v244, s[12:15], 0 offen nt lds
v_mfma_f32_16x16x32_bf16 v[224:227], v[92:95], v[152:155], v[224:227]
v_mfma_f32_16x16x32_bf16 v[220:223], v[92:95], v[148:151], v[220:223]
v_mfma_f32_16x16x32_bf16 v[220:223], v[88:91], v[136:139], v[220:223]
buffer_load_dwordx4 v244, s[12:15], s32 offen offset:1024 nt lds
s_waitcnt vmcnt(14)
s_barrier
v_mfma_f32_16x16x32_bf16 v[220:223], v[84:87], v[124:127], v[220:223]
v_mfma_f32_16x16x32_bf16 v[220:223], v[80:83], v[112:115], v[220:223]
v_mfma_f32_16x16x32_bf16 v[232:235], v[96:99], v[112:115], v[232:235]
v_mfma_f32_16x16x32_bf16 v[232:235], v[100:103], v[124:127], v[232:235]
v_mfma_f32_16x16x32_bf16 v[232:235], v[104:107], v[136:139], v[232:235]
v_mfma_f32_16x16x32_bf16 v[232:235], v[108:111], v[148:151], v[232:235]
v_mfma_f32_16x16x32_bf16 v[236:239], v[108:111], v[152:155], v[236:239]
v_mfma_f32_16x16x32_bf16 v[236:239], v[104:107], v[140:143], v[236:239]
v_mfma_f32_16x16x32_bf16 v[236:239], v[100:103], v[128:131], v[236:239]
v_mfma_f32_16x16x32_bf16 v[236:239], v[96:99], v[116:119], v[236:239]
v_mfma_f32_16x16x32_bf16 v[240:243], v[96:99], v[120:123], v[240:243]
v_mfma_f32_16x16x32_bf16 v[240:243], v[100:103], v[132:135], v[240:243]
buffer_load_dwordx4 v244, s[12:15], s33 offen offset:2048 nt lds
buffer_load_dwordx4 v244, s[12:15], s34 offen offset:3072 nt lds
s_add_u32 m0, s42, 16384
v_add_u32 v246, 0xe000, v246
v_add_u32 v245, s50, v246
buffer_load_dwordx4 v245, s[20:23], 0 offen lds
buffer_load_dwordx4 v245, s[20:23], s38 offen offset:1024 lds
s_waitcnt vmcnt(14)
s_barrier
v_mfma_f32_16x16x32_bf16 v[240:243], v[104:107], v[144:147], v[240:243]
buffer_load_dwordx4 v245, s[20:23], s39 offen offset:2048 lds
v_mfma_f32_16x16x32_bf16 v[240:243], v[108:111], v[156:159], v[240:243]
buffer_load_dwordx4 v245, s[20:23], s40 offen offset:3072 lds
s_add_u32 m0, s42, 32768
v_add_u32 v245, s51, v246
buffer_load_dwordx4 v245, s[20:23], 0 offen lds
s_waitcnt vmcnt(13)
s_barrier
s_waitcnt vmcnt(9)
s_barrier
buffer_load_dwordx4 v245, s[20:23], s38 offen offset:1024 lds
buffer_load_dwordx4 v245, s[20:23], s39 offen offset:2048 lds
buffer_load_dwordx4 v245, s[20:23], s40 offen offset:3072 lds
s_add_u32 m0, s42, 49152
v_add_u32 v245, s52, v246
buffer_load_dwordx4 v245, s[20:23], 0 offen lds
buffer_load_dwordx4 v245, s[20:23], s38 offen offset:1024 lds
buffer_load_dwordx4 v245, s[20:23], s39 offen offset:2048 lds
buffer_load_dwordx4 v245, s[20:23], s40 offen offset:3072 lds
s_add_u32 m0, s42, 81920
v_add_u32 v245, s53, v246
buffer_load_dwordx4 v245, s[20:23], 0 offen lds
buffer_load_dwordx4 v245, s[20:23], s38 offen offset:1024 lds
s_waitcnt vmcnt(10)
s_barrier
ds_read_b128 v[112:115], v248
buffer_load_dwordx4 v245, s[20:23], s39 offen offset:2048 lds
ds_read_b128 v[124:127], v248 offset:7168
ds_read_b128 v[136:139], v248 offset:14336
ds_read_b128 v[148:151], v248 offset:21504
ds_read_b128 v[152:155], v248 offset:22528
ds_read_b128 v[140:143], v248 offset:15360
ds_read_b128 v[128:131], v248 offset:8192
ds_read_b128 v[116:119], v248 offset:1024
ds_read_b128 v[120:123], v248 offset:2048
ds_read_b128 v[132:135], v248 offset:9216
ds_read_b128 v[144:147], v248 offset:16384
ds_read_b128 v[156:159], v248 offset:23552
buffer_load_dwordx4 v245, s[20:23], s40 offen offset:3072 lds
v_xor_b32 v247, 0x10000, v247
ds_read_b64_tr_b16 v[0:1], v247 offset:16384
ds_read_b64_tr_b16 v[2:3], v247 offset:18432
ds_read_b64_tr_b16 v[4:5], v247 offset:20480
ds_read_b64_tr_b16 v[6:7], v247 offset:22528
ds_read_b64_tr_b16 v[8:9], v247 offset:24576
ds_read_b64_tr_b16 v[10:11], v247 offset:26624
ds_read_b64_tr_b16 v[12:13], v247 offset:28672
ds_read_b64_tr_b16 v[14:15], v247 offset:30720
v_mbcnt_lo_u32_b32 v252, -1, 0
v_and_b32 v254, 7, v252
s_add_u32 m0, s42, 65536
v_add_u32 v245, s54, v246
buffer_load_dwordx4 v245, s[20:23], 0 offen lds
v_lshlrev_b32 v254, 2, v254
v_sub_u32 v253, s49, v252
v_and_b32 v253, 7, v253
v_lshlrev_b32 v252, 9, v252
v_lshl_add_u32 v252, v253, 2, v252
s_lshl_b32 s46, s48, 12
s_add_u32 s46, s46, 16777216
s_add_u32 s4, s78, s46
s_addc_u32 s5, s79, 0
s_mov_b32 s6, 4096
s_lshl_b32 s46, s41, 7
s_lshl_b32 s47, s49, 9
buffer_load_dwordx4 v245, s[20:23], s38 offen offset:1024 lds
s_waitcnt lgkmcnt(6)
v_mfma_f32_16x16x32_bf16 v[160:163], v[0:3], v[112:115], v[160:163]
buffer_load_dwordx4 v245, s[20:23], s39 offen offset:2048 lds
s_waitcnt lgkmcnt(4)
v_mfma_f32_16x16x32_bf16 v[160:163], v[4:7], v[124:127], v[160:163]
s_waitcnt lgkmcnt(2)
v_mfma_f32_16x16x32_bf16 v[160:163], v[8:11], v[136:139], v[160:163]
s_waitcnt lgkmcnt(0)
v_mfma_f32_16x16x32_bf16 v[160:163], v[12:15], v[148:151], v[160:163]
buffer_load_dwordx4 v245, s[20:23], s40 offen offset:3072 lds
v_mfma_f32_16x16x32_bf16 v[164:167], v[12:15], v[152:155], v[164:167]
v_mfma_f32_16x16x32_bf16 v[164:167], v[8:11], v[140:143], v[164:167]
v_mfma_f32_16x16x32_bf16 v[164:167], v[4:7], v[128:131], v[164:167]
v_mfma_f32_16x16x32_bf16 v[164:167], v[0:3], v[116:119], v[164:167]
s_add_u32 m0, s42, 98304
v_add_u32 v245, s55, v246
buffer_load_dwordx4 v245, s[20:23], 0 offen lds
v_mfma_f32_16x16x32_bf16 v[168:171], v[0:3], v[120:123], v[168:171]
v_mfma_f32_16x16x32_bf16 v[168:171], v[4:7], v[132:135], v[168:171]
buffer_load_dwordx4 v245, s[20:23], s38 offen offset:1024 lds
buffer_load_dwordx4 v245, s[20:23], s39 offen offset:2048 lds
s_waitcnt vmcnt(11)
s_barrier
ds_read_b64_tr_b16 v[28:29], v247 offset:45056
ds_read_b64_tr_b16 v[30:31], v247 offset:47104
v_mfma_f32_16x16x32_bf16 v[168:171], v[8:11], v[144:147], v[168:171]
buffer_load_dwordx4 v245, s[20:23], s40 offen offset:3072 lds
ds_read_b64_tr_b16 v[24:25], v247 offset:40960
v_mfma_f32_16x16x32_bf16 v[168:171], v[12:15], v[156:159], v[168:171]
ds_read_b64_tr_b16 v[26:27], v247 offset:43008
ds_read_b64_tr_b16 v[20:21], v247 offset:36864
ds_read_b64_tr_b16 v[22:23], v247 offset:38912
ds_read_b64_tr_b16 v[16:17], v247 offset:32768
ds_read_b64_tr_b16 v[18:19], v247 offset:34816
ds_read_b64_tr_b16 v[32:33], v247 offset:49152
ds_read_b64_tr_b16 v[34:35], v247 offset:51200
ds_read_b64_tr_b16 v[36:37], v247 offset:53248
s_add_u32 m0, s42, 114688
v_add_u32 v245, s56, v246
buffer_load_dwordx4 v245, s[20:23], 0 offen lds
s_waitcnt lgkmcnt(9)
v_mfma_f32_16x16x32_bf16 v[180:183], v[28:31], v[156:159], v[180:183]
ds_read_b64_tr_b16 v[38:39], v247 offset:55296
ds_read_b64_tr_b16 v[40:41], v247 offset:57344
ds_read_b64_tr_b16 v[42:43], v247 offset:59392
ds_read_b64_tr_b16 v[44:45], v247 offset:61440
s_waitcnt lgkmcnt(11)
v_mfma_f32_16x16x32_bf16 v[180:183], v[24:27], v[144:147], v[180:183]
ds_read_b64_tr_b16 v[46:47], v247 offset:63488
buffer_load_dwordx4 v245, s[20:23], s38 offen offset:1024 lds
s_waitcnt lgkmcnt(10)
v_mfma_f32_16x16x32_bf16 v[180:183], v[20:23], v[132:135], v[180:183]
s_waitcnt lgkmcnt(8)
v_mfma_f32_16x16x32_bf16 v[180:183], v[16:19], v[120:123], v[180:183]
v_mfma_f32_16x16x32_bf16 v[176:179], v[16:19], v[116:119], v[176:179]
buffer_load_dwordx4 v245, s[20:23], s39 offen offset:2048 lds
v_mfma_f32_16x16x32_bf16 v[176:179], v[20:23], v[128:131], v[176:179]
v_mfma_f32_16x16x32_bf16 v[176:179], v[24:27], v[140:143], v[176:179]
v_mfma_f32_16x16x32_bf16 v[176:179], v[28:31], v[152:155], v[176:179]
v_mfma_f32_16x16x32_bf16 v[172:175], v[28:31], v[148:151], v[172:175]
buffer_load_dwordx4 v245, s[20:23], s40 offen offset:3072 lds
v_mfma_f32_16x16x32_bf16 v[172:175], v[24:27], v[136:139], v[172:175]
v_mfma_f32_16x16x32_bf16 v[172:175], v[20:23], v[124:127], v[172:175]
v_mfma_f32_16x16x32_bf16 v[172:175], v[16:19], v[112:115], v[172:175]
s_waitcnt lgkmcnt(6)
v_mfma_f32_16x16x32_bf16 v[184:187], v[32:35], v[112:115], v[184:187]
s_waitcnt lgkmcnt(4)
v_mfma_f32_16x16x32_bf16 v[184:187], v[36:39], v[124:127], v[184:187]
s_waitcnt lgkmcnt(2)
v_mfma_f32_16x16x32_bf16 v[184:187], v[40:43], v[136:139], v[184:187]
s_waitcnt lgkmcnt(0)
v_mfma_f32_16x16x32_bf16 v[184:187], v[44:47], v[148:151], v[184:187]
v_mfma_f32_16x16x32_bf16 v[188:191], v[44:47], v[152:155], v[188:191]
v_mfma_f32_16x16x32_bf16 v[188:191], v[40:43], v[140:143], v[188:191]
v_mfma_f32_16x16x32_bf16 v[188:191], v[36:39], v[128:131], v[188:191]
v_mfma_f32_16x16x32_bf16 v[188:191], v[32:35], v[116:119], v[188:191]
v_mfma_f32_16x16x32_bf16 v[192:195], v[32:35], v[120:123], v[192:195]
v_mfma_f32_16x16x32_bf16 v[192:195], v[36:39], v[132:135], v[192:195]
s_add_u32 m0, s42, 16384
v_add_u32 v246, 0xe000, v246
v_add_u32 v245, s50, v246
buffer_load_dwordx4 v245, s[20:23], 0 offen lds
buffer_load_dwordx4 v245, s[20:23], s38 offen offset:1024 lds
buffer_load_dwordx4 v245, s[20:23], s39 offen offset:2048 lds
buffer_load_dwordx4 v245, s[20:23], s40 offen offset:3072 lds
s_waitcnt vmcnt(8)
s_barrier
v_xor_b32 v247, 0x10000, v247
s_add_u32 m0, s42, 0
v_add_u32 v245, s51, v246
buffer_load_dwordx4 v245, s[20:23], 0 offen lds
ds_read_b64_tr_b16 v[60:61], v247 offset:28672
v_mfma_f32_16x16x32_bf16 v[192:195], v[40:43], v[144:147], v[192:195]
ds_read_b64_tr_b16 v[62:63], v247 offset:30720
ds_read_b64_tr_b16 v[56:57], v247 offset:24576
v_mfma_f32_16x16x32_bf16 v[192:195], v[44:47], v[156:159], v[192:195]
ds_read_b64_tr_b16 v[58:59], v247 offset:26624
ds_read_b64_tr_b16 v[52:53], v247 offset:20480
ds_read_b64_tr_b16 v[54:55], v247 offset:22528
ds_read_b64_tr_b16 v[48:49], v247 offset:16384
buffer_load_dwordx4 v245, s[20:23], s38 offen offset:1024 lds
ds_read_b64_tr_b16 v[50:51], v247 offset:18432
ds_read_b64_tr_b16 v[64:65], v247
ds_read_b64_tr_b16 v[66:67], v247 offset:2048
ds_read_b64_tr_b16 v[68:69], v247 offset:4096
ds_read_b64_tr_b16 v[70:71], v247 offset:6144
ds_read_b64_tr_b16 v[72:73], v247 offset:8192
ds_read_b64_tr_b16 v[74:75], v247 offset:10240
ds_read_b64_tr_b16 v[76:77], v247 offset:12288
ds_read_b64_tr_b16 v[78:79], v247 offset:14336
s_waitcnt lgkmcnt(14)
v_mfma_f32_16x16x32_bf16 v[204:207], v[60:63], v[156:159], v[204:207]
buffer_load_dwordx4 v245, s[20:23], s39 offen offset:2048 lds
ds_read_b64_tr_b16 v[92:93], v247 offset:45056
s_waitcnt lgkmcnt(13)
v_mfma_f32_16x16x32_bf16 v[204:207], v[56:59], v[144:147], v[204:207]
ds_read_b64_tr_b16 v[94:95], v247 offset:47104
ds_read_b64_tr_b16 v[88:89], v247 offset:40960
s_waitcnt lgkmcnt(13)
v_mfma_f32_16x16x32_bf16 v[204:207], v[52:55], v[132:135], v[204:207]
ds_read_b64_tr_b16 v[90:91], v247 offset:43008
ds_read_b64_tr_b16 v[84:85], v247 offset:36864
buffer_load_dwordx4 v245, s[20:23], s40 offen offset:3072 lds
s_waitcnt lgkmcnt(13)
v_mfma_f32_16x16x32_bf16 v[204:207], v[48:51], v[120:123], v[204:207]
ds_read_b64_tr_b16 v[86:87], v247 offset:38912
ds_read_b64_tr_b16 v[80:81], v247 offset:32768
v_mfma_f32_16x16x32_bf16 v[200:203], v[48:51], v[116:119], v[200:203]
ds_read_b64_tr_b16 v[82:83], v247 offset:34816
v_mfma_f32_16x16x32_bf16 v[200:203], v[52:55], v[128:131], v[200:203]
s_add_u32 m0, s42, 32768
v_add_u32 v245, s52, v246
buffer_load_dwordx4 v245, s[20:23], 0 offen lds
v_mfma_f32_16x16x32_bf16 v[200:203], v[56:59], v[140:143], v[200:203]
v_mfma_f32_16x16x32_bf16 v[200:203], v[60:63], v[152:155], v[200:203]
v_mfma_f32_16x16x32_bf16 v[196:199], v[60:63], v[148:151], v[196:199]
v_mfma_f32_16x16x32_bf16 v[196:199], v[56:59], v[136:139], v[196:199]
buffer_load_dwordx4 v245, s[20:23], s38 offen offset:1024 lds
v_mfma_f32_16x16x32_bf16 v[196:199], v[52:55], v[124:127], v[196:199]
v_mfma_f32_16x16x32_bf16 v[196:199], v[48:51], v[112:115], v[196:199]
s_waitcnt lgkmcnt(14)
v_mfma_f32_16x16x32_bf16 v[208:211], v[64:67], v[112:115], v[208:211]
s_waitcnt lgkmcnt(12)
v_mfma_f32_16x16x32_bf16 v[208:211], v[68:71], v[124:127], v[208:211]
buffer_load_dwordx4 v245, s[20:23], s39 offen offset:2048 lds
s_waitcnt lgkmcnt(10)
v_mfma_f32_16x16x32_bf16 v[208:211], v[72:75], v[136:139], v[208:211]
s_waitcnt lgkmcnt(8)
v_mfma_f32_16x16x32_bf16 v[208:211], v[76:79], v[148:151], v[208:211]
v_mfma_f32_16x16x32_bf16 v[212:215], v[76:79], v[152:155], v[212:215]
buffer_load_dwordx4 v245, s[20:23], s40 offen offset:3072 lds
v_mfma_f32_16x16x32_bf16 v[212:215], v[72:75], v[140:143], v[212:215]
v_mfma_f32_16x16x32_bf16 v[212:215], v[68:71], v[128:131], v[212:215]
v_mfma_f32_16x16x32_bf16 v[212:215], v[64:67], v[116:119], v[212:215]
v_mfma_f32_16x16x32_bf16 v[216:219], v[64:67], v[120:123], v[216:219]
s_add_u32 m0, s42, 49152
v_add_u32 v245, s53, v246
buffer_load_dwordx4 v245, s[20:23], 0 offen lds
v_mfma_f32_16x16x32_bf16 v[216:219], v[68:71], v[132:135], v[216:219]
buffer_load_dwordx4 v245, s[20:23], s38 offen offset:1024 lds
buffer_load_dwordx4 v245, s[20:23], s39 offen offset:2048 lds
s_waitcnt vmcnt(7) lgkmcnt(0)
s_barrier
ds_read_b64_tr_b16 v[96:97], v247 offset:49152
buffer_load_dwordx4 v245, s[20:23], s40 offen offset:3072 lds
ds_read_b64_tr_b16 v[98:99], v247 offset:51200
v_mfma_f32_16x16x32_bf16 v[216:219], v[72:75], v[144:147], v[216:219]
ds_read_b64_tr_b16 v[100:101], v247 offset:53248
ds_read_b64_tr_b16 v[102:103], v247 offset:55296
v_mfma_f32_16x16x32_bf16 v[216:219], v[76:79], v[156:159], v[216:219]
ds_read_b64_tr_b16 v[104:105], v247 offset:57344
ds_read_b64_tr_b16 v[106:107], v247 offset:59392
v_mfma_f32_16x16x32_bf16 v[228:231], v[92:95], v[156:159], v[228:231]
s_add_u32 m0, s42, 81920
v_add_u32 v245, s54, v246
buffer_load_dwordx4 v245, s[20:23], 0 offen lds
v_mfma_f32_16x16x32_bf16 v[228:231], v[88:91], v[144:147], v[228:231]
ds_read_b64_tr_b16 v[108:109], v247 offset:61440
ds_read_b64_tr_b16 v[110:111], v247 offset:63488
v_mfma_f32_16x16x32_bf16 v[228:231], v[84:87], v[132:135], v[228:231]
v_mfma_f32_16x16x32_bf16 v[228:231], v[80:83], v[120:123], v[228:231]
v_mfma_f32_16x16x32_bf16 v[224:227], v[80:83], v[116:119], v[224:227]
buffer_load_dwordx4 v245, s[20:23], s38 offen offset:1024 lds
v_mfma_f32_16x16x32_bf16 v[224:227], v[84:87], v[128:131], v[224:227]
v_mfma_f32_16x16x32_bf16 v[224:227], v[88:91], v[140:143], v[224:227]
v_mfma_f32_16x16x32_bf16 v[224:227], v[92:95], v[152:155], v[224:227]
v_mfma_f32_16x16x32_bf16 v[220:223], v[92:95], v[148:151], v[220:223]
buffer_load_dwordx4 v245, s[20:23], s39 offen offset:2048 lds
v_mfma_f32_16x16x32_bf16 v[220:223], v[88:91], v[136:139], v[220:223]
v_mfma_f32_16x16x32_bf16 v[220:223], v[84:87], v[124:127], v[220:223]
v_mfma_f32_16x16x32_bf16 v[220:223], v[80:83], v[112:115], v[220:223]
s_waitcnt lgkmcnt(6)
v_mfma_f32_16x16x32_bf16 v[232:235], v[96:99], v[112:115], v[232:235]
buffer_load_dwordx4 v245, s[20:23], s40 offen offset:3072 lds
ds_read_b128 v[112:115], v248
s_waitcnt lgkmcnt(5)
v_mfma_f32_16x16x32_bf16 v[232:235], v[100:103], v[124:127], v[232:235]
ds_read_b128 v[124:127], v248 offset:7168
s_waitcnt lgkmcnt(4)
v_mfma_f32_16x16x32_bf16 v[232:235], v[104:107], v[136:139], v[232:235]
ds_read_b128 v[136:139], v248 offset:14336
s_waitcnt lgkmcnt(3)
v_mfma_f32_16x16x32_bf16 v[232:235], v[108:111], v[148:151], v[232:235]
s_add_u32 m0, s42, 65536
v_add_u32 v245, s55, v246
buffer_load_dwordx4 v245, s[20:23], 0 offen lds
v_mfma_f32_16x16x32_bf16 v[236:239], v[108:111], v[152:155], v[236:239]
ds_read_b128 v[148:151], v248 offset:21504
ds_read_b128 v[152:155], v248 offset:22528
v_mfma_f32_16x16x32_bf16 v[236:239], v[104:107], v[140:143], v[236:239]
ds_read_b128 v[140:143], v248 offset:15360
v_mfma_f32_16x16x32_bf16 v[236:239], v[100:103], v[128:131], v[236:239]
ds_read_b128 v[128:131], v248 offset:8192
buffer_load_dwordx4 v245, s[20:23], s38 offen offset:1024 lds
v_mfma_f32_16x16x32_bf16 v[236:239], v[96:99], v[116:119], v[236:239]
ds_read_b128 v[116:119], v248 offset:1024
v_mfma_f32_16x16x32_bf16 v[240:243], v[96:99], v[120:123], v[240:243]
ds_read_b128 v[120:123], v248 offset:2048
v_mfma_f32_16x16x32_bf16 v[240:243], v[100:103], v[132:135], v[240:243]
ds_read_b128 v[132:135], v248 offset:9216
buffer_load_dwordx4 v245, s[20:23], s39 offen offset:2048 lds
v_mfma_f32_16x16x32_bf16 v[240:243], v[104:107], v[144:147], v[240:243]
ds_read_b128 v[144:147], v248 offset:16384
v_mfma_f32_16x16x32_bf16 v[240:243], v[108:111], v[156:159], v[240:243]
ds_read_b128 v[156:159], v248 offset:23552
v_xor_b32 v247, 0x10000, v247
ds_read_b64_tr_b16 v[0:1], v247 offset:16384
ds_read_b64_tr_b16 v[2:3], v247 offset:18432
ds_read_b64_tr_b16 v[4:5], v247 offset:20480
buffer_load_dwordx4 v245, s[20:23], s40 offen offset:3072 lds
ds_read_b64_tr_b16 v[6:7], v247 offset:22528
ds_read_b64_tr_b16 v[8:9], v247 offset:24576
ds_read_b64_tr_b16 v[10:11], v247 offset:26624
ds_read_b64_tr_b16 v[12:13], v247 offset:28672
ds_read_b64_tr_b16 v[14:15], v247 offset:30720
ds_read_b64_tr_b16 v[28:29], v247 offset:12288
ds_read_b64_tr_b16 v[30:31], v247 offset:14336
ds_read_b64_tr_b16 v[24:25], v247 offset:8192
ds_read_b64_tr_b16 v[26:27], v247 offset:10240
ds_read_b64_tr_b16 v[20:21], v247 offset:4096
ds_read_b64_tr_b16 v[22:23], v247 offset:6144
s_add_u32 m0, s42, 98304
v_add_u32 v245, s56, v246
buffer_load_dwordx4 v245, s[20:23], 0 offen lds
s_waitcnt lgkmcnt(12)
v_mfma_f32_16x16x32_bf16 v[160:163], v[0:3], v[112:115], v[160:163]
ds_read_b64_tr_b16 v[16:17], v247
ds_read_b64_tr_b16 v[18:19], v247 offset:2048
s_waitcnt lgkmcnt(12)
v_mfma_f32_16x16x32_bf16 v[160:163], v[4:7], v[124:127], v[160:163]
s_waitcnt lgkmcnt(10)
v_mfma_f32_16x16x32_bf16 v[160:163], v[8:11], v[136:139], v[160:163]
buffer_load_dwordx4 v245, s[20:23], s38 offen offset:1024 lds
s_waitcnt lgkmcnt(8)
v_mfma_f32_16x16x32_bf16 v[160:163], v[12:15], v[148:151], v[160:163]
v_mfma_f32_16x16x32_bf16 v[164:167], v[12:15], v[152:155], v[164:167]
v_mfma_f32_16x16x32_bf16 v[164:167], v[8:11], v[140:143], v[164:167]
buffer_load_dwordx4 v245, s[20:23], s39 offen offset:2048 lds
v_mfma_f32_16x16x32_bf16 v[164:167], v[4:7], v[128:131], v[164:167]
v_mfma_f32_16x16x32_bf16 v[164:167], v[0:3], v[116:119], v[164:167]
v_mfma_f32_16x16x32_bf16 v[168:171], v[0:3], v[120:123], v[168:171]
v_mfma_f32_16x16x32_bf16 v[168:171], v[4:7], v[132:135], v[168:171]
buffer_load_dwordx4 v245, s[20:23], s40 offen offset:3072 lds
s_waitcnt vmcnt(4) lgkmcnt(0)
s_barrier
ds_read_b64_tr_b16 v[32:33], v247 offset:32768
ds_read_b64_tr_b16 v[34:35], v247 offset:34816
v_mfma_f32_16x16x32_bf16 v[168:171], v[8:11], v[144:147], v[168:171]
ds_read_b64_tr_b16 v[36:37], v247 offset:36864
ds_read_b64_tr_b16 v[38:39], v247 offset:38912
v_mfma_f32_16x16x32_bf16 v[168:171], v[12:15], v[156:159], v[168:171]
ds_read_b64_tr_b16 v[40:41], v247 offset:40960
ds_read_b64_tr_b16 v[42:43], v247 offset:43008
v_mfma_f32_16x16x32_bf16 v[180:183], v[28:31], v[156:159], v[180:183]
ds_read_b64_tr_b16 v[44:45], v247 offset:45056
ds_read_b64_tr_b16 v[46:47], v247 offset:47104
v_mfma_f32_16x16x32_bf16 v[180:183], v[24:27], v[144:147], v[180:183]
ds_read_b64_tr_b16 v[60:61], v247 offset:61440
ds_read_b64_tr_b16 v[62:63], v247 offset:63488
v_mfma_f32_16x16x32_bf16 v[180:183], v[20:23], v[132:135], v[180:183]
ds_read_b64_tr_b16 v[56:57], v247 offset:57344
ds_read_b64_tr_b16 v[58:59], v247 offset:59392
v_mfma_f32_16x16x32_bf16 v[180:183], v[16:19], v[120:123], v[180:183]
ds_read_b64_tr_b16 v[52:53], v247 offset:53248
ds_read_b64_tr_b16 v[54:55], v247 offset:55296
v_mfma_f32_16x16x32_bf16 v[176:179], v[16:19], v[116:119], v[176:179]
ds_read_b64_tr_b16 v[48:49], v247 offset:49152
ds_read_b64_tr_b16 v[50:51], v247 offset:51200
v_mfma_f32_16x16x32_bf16 v[176:179], v[20:23], v[128:131], v[176:179]
v_xor_b32 v247, 0x10000, v247
ds_read_b64_tr_b16 v[64:65], v247 offset:16384
v_mfma_f32_16x16x32_bf16 v[176:179], v[24:27], v[140:143], v[176:179]
ds_read_b64_tr_b16 v[66:67], v247 offset:18432
ds_read_b64_tr_b16 v[68:69], v247 offset:20480
v_mfma_f32_16x16x32_bf16 v[176:179], v[28:31], v[152:155], v[176:179]
ds_read_b64_tr_b16 v[70:71], v247 offset:22528
ds_read_b64_tr_b16 v[72:73], v247 offset:24576
v_mfma_f32_16x16x32_bf16 v[172:175], v[28:31], v[148:151], v[172:175]
ds_read_b64_tr_b16 v[74:75], v247 offset:26624
ds_read_b64_tr_b16 v[76:77], v247 offset:28672
v_mfma_f32_16x16x32_bf16 v[172:175], v[24:27], v[136:139], v[172:175]
ds_read_b64_tr_b16 v[78:79], v247 offset:30720
ds_read_b64_tr_b16 v[92:93], v247 offset:12288
v_mfma_f32_16x16x32_bf16 v[172:175], v[20:23], v[124:127], v[172:175]
ds_read_b64_tr_b16 v[94:95], v247 offset:14336
ds_read_b64_tr_b16 v[88:89], v247 offset:8192
v_mfma_f32_16x16x32_bf16 v[172:175], v[16:19], v[112:115], v[172:175]
ds_read_b64_tr_b16 v[90:91], v247 offset:10240
ds_read_b64_tr_b16 v[84:85], v247 offset:4096
s_waitcnt lgkmcnt(14)
v_mfma_f32_16x16x32_bf16 v[184:187], v[32:35], v[112:115], v[184:187]
ds_read_b64_tr_b16 v[86:87], v247 offset:6144
ds_read_b64_tr_b16 v[80:81], v247
v_mfma_f32_16x16x32_bf16 v[184:187], v[36:39], v[124:127], v[184:187]
ds_read_b64_tr_b16 v[82:83], v247 offset:2048
v_cvt_pk_bf16_f32 v160, v160, v161
v_mfma_f32_16x16x32_bf16 v[184:187], v[40:43], v[136:139], v[184:187]
v_cvt_pk_bf16_f32 v161, v162, v163
v_cvt_pk_bf16_f32 v162, v164, v165
v_mfma_f32_16x16x32_bf16 v[184:187], v[44:47], v[148:151], v[184:187]
v_cvt_pk_bf16_f32 v163, v166, v167
v_cvt_pk_bf16_f32 v168, v168, v169
v_mfma_f32_16x16x32_bf16 v[188:191], v[44:47], v[152:155], v[188:191]
v_cvt_pk_bf16_f32 v169, v170, v171
s_mul_i32 s44, s50, 48
v_mfma_f32_16x16x32_bf16 v[188:191], v[40:43], v[140:143], v[188:191]
buffer_store_dwordx4 v[160:163], v249, s[24:27], s44 offen sc1
v_mfma_f32_16x16x32_bf16 v[188:191], v[36:39], v[128:131], v[188:191]
buffer_store_dwordx2 v[168:169], v250, s[24:27], s44 offen offset:1024 sc1
v_mfma_f32_16x16x32_bf16 v[188:191], v[32:35], v[116:119], v[188:191]
v_cvt_pk_bf16_f32 v172, v172, v173
v_cvt_pk_bf16_f32 v173, v174, v175
v_mfma_f32_16x16x32_bf16 v[192:195], v[32:35], v[120:123], v[192:195]
v_cvt_pk_bf16_f32 v174, v176, v177
v_cvt_pk_bf16_f32 v175, v178, v179
v_mfma_f32_16x16x32_bf16 v[192:195], v[36:39], v[132:135], v[192:195]
v_cvt_pk_bf16_f32 v180, v180, v181
v_cvt_pk_bf16_f32 v181, v182, v183
v_mfma_f32_16x16x32_bf16 v[192:195], v[40:43], v[144:147], v[192:195]
s_mul_i32 s44, s51, 48
buffer_store_dwordx4 v[172:175], v249, s[24:27], s44 offen sc1
v_mfma_f32_16x16x32_bf16 v[192:195], v[44:47], v[156:159], v[192:195]
buffer_store_dwordx2 v[180:181], v250, s[24:27], s44 offen offset:1024 sc1
v_mfma_f32_16x16x32_bf16 v[204:207], v[60:63], v[156:159], v[204:207]
v_mfma_f32_16x16x32_bf16 v[204:207], v[56:59], v[144:147], v[204:207]
v_mfma_f32_16x16x32_bf16 v[204:207], v[52:55], v[132:135], v[204:207]
s_waitcnt lgkmcnt(14)
v_mfma_f32_16x16x32_bf16 v[204:207], v[48:51], v[120:123], v[204:207]
v_cvt_pk_bf16_f32 v184, v184, v185
v_cvt_pk_bf16_f32 v185, v186, v187
v_mfma_f32_16x16x32_bf16 v[200:203], v[48:51], v[116:119], v[200:203]
v_cvt_pk_bf16_f32 v186, v188, v189
v_cvt_pk_bf16_f32 v187, v190, v191
v_mfma_f32_16x16x32_bf16 v[200:203], v[52:55], v[128:131], v[200:203]
v_cvt_pk_bf16_f32 v192, v192, v193
v_cvt_pk_bf16_f32 v193, v194, v195
v_mfma_f32_16x16x32_bf16 v[200:203], v[56:59], v[140:143], v[200:203]
s_mul_i32 s44, s52, 48
buffer_store_dwordx4 v[184:187], v249, s[24:27], s44 offen sc1
v_mfma_f32_16x16x32_bf16 v[200:203], v[60:63], v[152:155], v[200:203]
buffer_store_dwordx2 v[192:193], v250, s[24:27], s44 offen offset:1024 sc1
v_mfma_f32_16x16x32_bf16 v[196:199], v[60:63], v[148:151], v[196:199]
v_mfma_f32_16x16x32_bf16 v[196:199], v[56:59], v[136:139], v[196:199]
s_waitcnt vmcnt(6) lgkmcnt(0)
s_barrier
ds_read_b64_tr_b16 v[96:97], v247 offset:32768
ds_read_b64_tr_b16 v[98:99], v247 offset:34816
v_mfma_f32_16x16x32_bf16 v[196:199], v[52:55], v[124:127], v[196:199]
ds_read_b64_tr_b16 v[100:101], v247 offset:36864
ds_read_b64_tr_b16 v[102:103], v247 offset:38912
v_mfma_f32_16x16x32_bf16 v[196:199], v[48:51], v[112:115], v[196:199]
ds_read_b64_tr_b16 v[104:105], v247 offset:40960
ds_read_b64_tr_b16 v[106:107], v247 offset:43008
v_mfma_f32_16x16x32_bf16 v[208:211], v[64:67], v[112:115], v[208:211]
ds_read_b64_tr_b16 v[108:109], v247 offset:45056
ds_read_b64_tr_b16 v[110:111], v247 offset:47104
v_mfma_f32_16x16x32_bf16 v[208:211], v[68:71], v[124:127], v[208:211]
v_mfma_f32_16x16x32_bf16 v[208:211], v[72:75], v[136:139], v[208:211]
v_mfma_f32_16x16x32_bf16 v[208:211], v[76:79], v[148:151], v[208:211]
v_cvt_pk_bf16_f32 v196, v196, v197
v_cvt_pk_bf16_f32 v197, v198, v199
v_mfma_f32_16x16x32_bf16 v[212:215], v[76:79], v[152:155], v[212:215]
v_cvt_pk_bf16_f32 v198, v200, v201
v_cvt_pk_bf16_f32 v199, v202, v203
v_mfma_f32_16x16x32_bf16 v[212:215], v[72:75], v[140:143], v[212:215]
v_cvt_pk_bf16_f32 v204, v204, v205
v_cvt_pk_bf16_f32 v205, v206, v207
v_mfma_f32_16x16x32_bf16 v[212:215], v[68:71], v[128:131], v[212:215]
s_mul_i32 s44, s53, 48
buffer_store_dwordx4 v[196:199], v249, s[24:27], s44 offen sc1
v_mfma_f32_16x16x32_bf16 v[212:215], v[64:67], v[116:119], v[212:215]
buffer_store_dwordx2 v[204:205], v250, s[24:27], s44 offen offset:1024 sc1
v_mfma_f32_16x16x32_bf16 v[216:219], v[64:67], v[120:123], v[216:219]
v_mfma_f32_16x16x32_bf16 v[216:219], v[68:71], v[132:135], v[216:219]
v_mfma_f32_16x16x32_bf16 v[216:219], v[72:75], v[144:147], v[216:219]
v_mfma_f32_16x16x32_bf16 v[216:219], v[76:79], v[156:159], v[216:219]
v_mfma_f32_16x16x32_bf16 v[228:231], v[92:95], v[156:159], v[228:231]
v_mfma_f32_16x16x32_bf16 v[228:231], v[88:91], v[144:147], v[228:231]
v_mfma_f32_16x16x32_bf16 v[228:231], v[84:87], v[132:135], v[228:231]
v_mfma_f32_16x16x32_bf16 v[228:231], v[80:83], v[120:123], v[228:231]
v_cvt_pk_bf16_f32 v208, v208, v209
v_cvt_pk_bf16_f32 v209, v210, v211
v_mfma_f32_16x16x32_bf16 v[224:227], v[80:83], v[116:119], v[224:227]
v_cvt_pk_bf16_f32 v210, v212, v213
v_cvt_pk_bf16_f32 v211, v214, v215
v_mfma_f32_16x16x32_bf16 v[224:227], v[84:87], v[128:131], v[224:227]
v_cvt_pk_bf16_f32 v216, v216, v217
v_cvt_pk_bf16_f32 v217, v218, v219
v_mfma_f32_16x16x32_bf16 v[224:227], v[88:91], v[140:143], v[224:227]
s_mul_i32 s44, s54, 48
buffer_store_dwordx4 v[208:211], v249, s[24:27], s44 offen sc1
v_mfma_f32_16x16x32_bf16 v[224:227], v[92:95], v[152:155], v[224:227]
buffer_store_dwordx2 v[216:217], v250, s[24:27], s44 offen offset:1024 sc1
v_mfma_f32_16x16x32_bf16 v[220:223], v[92:95], v[148:151], v[220:223]
v_mfma_f32_16x16x32_bf16 v[220:223], v[88:91], v[136:139], v[220:223]
v_mfma_f32_16x16x32_bf16 v[220:223], v[84:87], v[124:127], v[220:223]
v_mfma_f32_16x16x32_bf16 v[220:223], v[80:83], v[112:115], v[220:223]
s_waitcnt lgkmcnt(6)
v_mfma_f32_16x16x32_bf16 v[232:235], v[96:99], v[112:115], v[232:235]
s_waitcnt lgkmcnt(4)
v_mfma_f32_16x16x32_bf16 v[232:235], v[100:103], v[124:127], v[232:235]
s_waitcnt lgkmcnt(2)
v_mfma_f32_16x16x32_bf16 v[232:235], v[104:107], v[136:139], v[232:235]
s_waitcnt lgkmcnt(0)
v_mfma_f32_16x16x32_bf16 v[232:235], v[108:111], v[148:151], v[232:235]
v_cvt_pk_bf16_f32 v220, v220, v221
v_cvt_pk_bf16_f32 v221, v222, v223
v_mfma_f32_16x16x32_bf16 v[236:239], v[108:111], v[152:155], v[236:239]
v_cvt_pk_bf16_f32 v222, v224, v225
v_cvt_pk_bf16_f32 v223, v226, v227
v_mfma_f32_16x16x32_bf16 v[236:239], v[104:107], v[140:143], v[236:239]
v_cvt_pk_bf16_f32 v228, v228, v229
v_cvt_pk_bf16_f32 v229, v230, v231
v_mfma_f32_16x16x32_bf16 v[236:239], v[100:103], v[128:131], v[236:239]
s_mul_i32 s44, s55, 48
buffer_store_dwordx4 v[220:223], v249, s[24:27], s44 offen sc1
v_mfma_f32_16x16x32_bf16 v[236:239], v[96:99], v[116:119], v[236:239]
buffer_store_dwordx2 v[228:229], v250, s[24:27], s44 offen offset:1024 sc1
v_mfma_f32_16x16x32_bf16 v[240:243], v[96:99], v[120:123], v[240:243]
v_mfma_f32_16x16x32_bf16 v[240:243], v[100:103], v[132:135], v[240:243]
v_mfma_f32_16x16x32_bf16 v[240:243], v[104:107], v[144:147], v[240:243]
v_mfma_f32_16x16x32_bf16 v[240:243], v[108:111], v[156:159], v[240:243]
s_mul_i32 s45, s41, 7168
v_add_u32 v251, s45, v248
ds_write_b128 v251, v[232:235] offset:3072
ds_write_b128 v251, v[236:239] offset:4096
s_nop 3
ds_write_b128 v251, v[240:243] offset:5120
s_cmp_lg_u32 s49, 7
s_cbranch_scc1 L_own_c0
v_cvt_pk_bf16_f32 v232, v232, v233
v_cvt_pk_bf16_f32 v233, v234, v235
v_cvt_pk_bf16_f32 v234, v236, v237
v_cvt_pk_bf16_f32 v235, v238, v239
v_cvt_pk_bf16_f32 v240, v240, v241
v_cvt_pk_bf16_f32 v241, v242, v243
s_mul_i32 s44, s56, 48
buffer_store_dwordx4 v[232:235], v249, s[24:27], s44 offen sc1
buffer_store_dwordx2 v[240:241], v250, s[24:27], s44 offen offset:1024 sc1
L_own_c0:
v_mov_b32 v112, 1
s_waitcnt lgkmcnt(0)
s_barrier
s_mov_b64 exec, 0x7f
s_waitcnt vmcnt(0)
buffer_store_dword v112, v252, s[4:7], s46 offen sc1
s_mov_b64 exec, -1
s_endpgm
.p2align 6
L_a_c0:
s_barrier
s_barrier
s_barrier
s_barrier
s_barrier
s_or_b32 s44, s41, s47
s_cbranch_scc1 L_hs_c0_0
s_mov_b64 exec, 1
buffer_store_dword v253, v252, s[60:63], s46 offen sc1
s_mov_b64 exec, -1
L_hs_c0_0:
s_add_u32 m0, s42, 49152
v_add_u32 v245, 0x10000, v245
buffer_load_dwordx4 v245, s[8:11], 0 offen nt lds
buffer_load_dwordx4 v245, s[8:11], s32 offen offset:1024 nt lds
buffer_load_dwordx4 v245, s[8:11], s33 offen offset:2048 nt lds
buffer_load_dwordx4 v245, s[8:11], s34 offen offset:3072 nt lds
s_add_u32 m0, s42, 65536
v_add_u32 v245, 0x10000, v245
buffer_load_dwordx4 v245, s[8:11], 0 offen nt lds
s_add_u32 m0, s42, 81920
v_add_u32 v246, 0x80, v246
buffer_load_dwordx4 v246, s[16:19], 0 offen lds
buffer_load_dwordx4 v246, s[16:19], s35 offen offset:1024 lds
s_barrier
buffer_load_dwordx4 v246, s[16:19], s36 offen offset:2048 lds
buffer_load_dwordx4 v246, s[16:19], s37 offen offset:3072 lds
s_add_u32 m0, s42, 98304
v_add_u32 v246, 0x80000, v246
buffer_load_dwordx4 v246, s[16:19], 0 offen lds
buffer_load_dwordx4 v246, s[16:19], s35 offen offset:1024 lds
buffer_load_dwordx4 v246, s[16:19], s36 offen offset:2048 lds
buffer_load_dwordx4 v246, s[16:19], s37 offen offset:3072 lds
s_add_u32 m0, s42, 114688
v_add_u32 v246, 0x80000, v246
buffer_load_dwordx4 v246, s[16:19], 0 offen lds
s_barrier
ds_read_b128 v[216:219], v240 offset:32768
ds_read_b128 v[192:195], v242
ds_read_b128 v[220:223], v241 offset:32768
ds_read_b128 v[204:207], v242 offset:3072
ds_read_b128 v[208:211], v242 offset:4096
ds_read_b128 v[196:199], v242 offset:1024
ds_read_b128 v[200:203], v242 offset:2048
ds_read_b128 v[212:215], v242 offset:5120
ds_read_b128 v[224:227], v241 offset:33792
ds_read_b128 v[228:231], v240 offset:33792
ds_read_b128 v[232:235], v240 offset:34816
ds_read_b128 v[236:239], v241 offset:34816
s_waitcnt lgkmcnt(10)
v_mfma_f32_16x16x32_bf16 v[0:3], v[216:219], v[192:195], 0
s_waitcnt lgkmcnt(8)
v_mfma_f32_16x16x32_bf16 v[0:3], v[220:223], v[204:207], v[0:3]
s_waitcnt lgkmcnt(7)
v_mfma_f32_16x16x32_bf16 v[8:11], v[220:223], v[208:211], 0
s_waitcnt lgkmcnt(6)
v_mfma_f32_16x16x32_bf16 v[8:11], v[216:219], v[196:199], v[8:11]
s_waitcnt vmcnt(14) lgkmcnt(5)
v_mfma_f32_16x16x32_bf16 v[16:19], v[216:219], v[200:203], 0
ds_read_b128 v[216:219], v241 offset:35840
s_waitcnt lgkmcnt(5)
v_mfma_f32_16x16x32_bf16 v[16:19], v[220:223], v[212:215], v[16:19]
ds_read_b128 v[220:223], v240 offset:35840
s_waitcnt lgkmcnt(5)
v_mfma_f32_16x16x32_bf16 v[20:23], v[224:227], v[212:215], 0
s_waitcnt lgkmcnt(4)
v_mfma_f32_16x16x32_bf16 v[20:23], v[228:231], v[200:203], v[20:23]
v_mfma_f32_16x16x32_bf16 v[12:15], v[228:231], v[196:199], 0
v_mfma_f32_16x16x32_bf16 v[12:15], v[224:227], v[208:211], v[12:15]
v_mfma_f32_16x16x32_bf16 v[4:7], v[224:227], v[204:207], 0
v_mfma_f32_16x16x32_bf16 v[4:7], v[228:231], v[192:195], v[4:7]
s_waitcnt lgkmcnt(3)
v_mfma_f32_16x16x32_bf16 v[24:27], v[232:235], v[192:195], 0
s_waitcnt lgkmcnt(2)
v_mfma_f32_16x16x32_bf16 v[24:27], v[236:239], v[204:207], v[24:27]
v_mfma_f32_16x16x32_bf16 v[32:35], v[236:239], v[208:211], 0
v_mfma_f32_16x16x32_bf16 v[32:35], v[232:235], v[196:199], v[32:35]
v_mfma_f32_16x16x32_bf16 v[40:43], v[232:235], v[200:203], 0
v_mfma_f32_16x16x32_bf16 v[40:43], v[236:239], v[212:215], v[40:43]
s_waitcnt lgkmcnt(1)
v_mfma_f32_16x16x32_bf16 v[44:47], v[216:219], v[212:215], 0
s_waitcnt lgkmcnt(0)
v_mfma_f32_16x16x32_bf16 v[44:47], v[220:223], v[200:203], v[44:47]
v_mfma_f32_16x16x32_bf16 v[36:39], v[220:223], v[196:199], 0
v_mfma_f32_16x16x32_bf16 v[36:39], v[216:219], v[208:211], v[36:39]
s_waitcnt vmcnt(10)
s_barrier
ds_read_b128 v[224:227], v240 offset:49152
ds_read_b128 v[228:231], v241 offset:49152
v_mfma_f32_16x16x32_bf16 v[28:31], v[216:219], v[204:207], 0
ds_read_b128 v[232:235], v241 offset:50176
ds_read_b128 v[236:239], v240 offset:50176
v_mfma_f32_16x16x32_bf16 v[28:31], v[220:223], v[192:195], v[28:31]
ds_read_b128 v[216:219], v240 offset:51200
ds_read_b128 v[220:223], v241 offset:51200
s_waitcnt lgkmcnt(5)
v_mfma_f32_16x16x32_bf16 v[48:51], v[224:227], v[192:195], 0
s_waitcnt lgkmcnt(4)
v_mfma_f32_16x16x32_bf16 v[48:51], v[228:231], v[204:207], v[48:51]
v_mfma_f32_16x16x32_bf16 v[56:59], v[228:231], v[208:211], 0
v_mfma_f32_16x16x32_bf16 v[56:59], v[224:227], v[196:199], v[56:59]
v_mfma_f32_16x16x32_bf16 v[64:67], v[224:227], v[200:203], 0
ds_read_b128 v[224:227], v241 offset:52224
v_mfma_f32_16x16x32_bf16 v[64:67], v[228:231], v[212:215], v[64:67]
ds_read_b128 v[228:231], v240 offset:52224
s_waitcnt lgkmcnt(5)
v_mfma_f32_16x16x32_bf16 v[68:71], v[232:235], v[212:215], 0
s_waitcnt lgkmcnt(4)
v_mfma_f32_16x16x32_bf16 v[68:71], v[236:239], v[200:203], v[68:71]
v_mfma_f32_16x16x32_bf16 v[60:63], v[236:239], v[196:199], 0
v_mfma_f32_16x16x32_bf16 v[60:63], v[232:235], v[208:211], v[60:63]
v_mfma_f32_16x16x32_bf16 v[52:55], v[232:235], v[204:207], 0
v_mfma_f32_16x16x32_bf16 v[52:55], v[236:239], v[192:195], v[52:55]
s_waitcnt lgkmcnt(3)
v_mfma_f32_16x16x32_bf16 v[72:75], v[216:219], v[192:195], 0
s_waitcnt lgkmcnt(2)
v_mfma_f32_16x16x32_bf16 v[72:75], v[220:223], v[204:207], v[72:75]
v_mfma_f32_16x16x32_bf16 v[80:83], v[220:223], v[208:211], 0
v_mfma_f32_16x16x32_bf16 v[80:83], v[216:219], v[196:199], v[80:83]
v_mfma_f32_16x16x32_bf16 v[88:91], v[216:219], v[200:203], 0
v_mfma_f32_16x16x32_bf16 v[88:91], v[220:223], v[212:215], v[88:91]
s_waitcnt lgkmcnt(1)
v_mfma_f32_16x16x32_bf16 v[92:95], v[224:227], v[212:215], 0
s_waitcnt lgkmcnt(0)
v_mfma_f32_16x16x32_bf16 v[92:95], v[228:231], v[200:203], v[92:95]
v_mfma_f32_16x16x32_bf16 v[84:87], v[228:231], v[196:199], 0
v_mfma_f32_16x16x32_bf16 v[84:87], v[224:227], v[208:211], v[84:87]
s_waitcnt vmcnt(5)
s_barrier
v_mfma_f32_16x16x32_bf16 v[76:79], v[224:227], v[204:207], 0
v_mfma_f32_16x16x32_bf16 v[76:79], v[228:231], v[192:195], v[76:79]
s_waitcnt vmcnt(0)
s_barrier
s_barrier
s_add_u32 m0, s42, 98304
v_add_u32 v245, 0xfffe0080, v245
buffer_load_dwordx4 v245, s[8:11], 0 offen nt lds
buffer_load_dwordx4 v245, s[8:11], s32 offen offset:1024 nt lds
buffer_load_dwordx4 v245, s[8:11], s33 offen offset:2048 nt lds
buffer_load_dwordx4 v245, s[8:11], s34 offen offset:3072 nt lds
s_add_u32 m0, s42, 114688
v_add_u32 v245, 0x10000, v245
buffer_load_dwordx4 v245, s[8:11], 0 offen nt lds
s_barrier
s_cmp_lg_u32 s41, 0
s_cbranch_scc1 L_hs_c0_1
buffer_load_dword v249, v252, s[60:63], s46 offen sc1
L_hs_c0_1:
buffer_load_dwordx4 v245, s[8:11], s32 offen offset:1024 nt lds
s_barrier
v_xor_b32 v240, 0x10000, v240
ds_read_b128 v[232:235], v240
v_xor_b32 v241, 0x10000, v241
ds_read_b128 v[236:239], v241
ds_read_b128 v[216:219], v241 offset:1024
ds_read_b128 v[220:223], v240 offset:1024
ds_read_b128 v[224:227], v240 offset:2048
ds_read_b128 v[228:231], v241 offset:2048
s_waitcnt lgkmcnt(5)
v_mfma_f32_16x16x32_bf16 v[96:99], v[232:235], v[192:195], 0
s_waitcnt lgkmcnt(4)
v_mfma_f32_16x16x32_bf16 v[96:99], v[236:239], v[204:207], v[96:99]
v_mfma_f32_16x16x32_bf16 v[104:107], v[236:239], v[208:211], 0
v_mfma_f32_16x16x32_bf16 v[104:107], v[232:235], v[196:199], v[104:107]
v_mfma_f32_16x16x32_bf16 v[112:115], v[232:235], v[200:203], 0
ds_read_b128 v[232:235], v241 offset:3072
v_mfma_f32_16x16x32_bf16 v[112:115], v[236:239], v[212:215], v[112:115]
ds_read_b128 v[236:239], v240 offset:3072
s_waitcnt lgkmcnt(5)
v_mfma_f32_16x16x32_bf16 v[116:119], v[216:219], v[212:215], 0
s_waitcnt lgkmcnt(4)
v_mfma_f32_16x16x32_bf16 v[116:119], v[220:223], v[200:203], v[116:119]
v_mfma_f32_16x16x32_bf16 v[108:111], v[220:223], v[196:199], 0
v_mfma_f32_16x16x32_bf16 v[108:111], v[216:219], v[208:211], v[108:111]
v_mfma_f32_16x16x32_bf16 v[100:103], v[216:219], v[204:207], 0
v_mfma_f32_16x16x32_bf16 v[100:103], v[220:223], v[192:195], v[100:103]
s_waitcnt lgkmcnt(3)
v_mfma_f32_16x16x32_bf16 v[120:123], v[224:227], v[192:195], 0
s_waitcnt lgkmcnt(2)
v_mfma_f32_16x16x32_bf16 v[120:123], v[228:231], v[204:207], v[120:123]
v_mfma_f32_16x16x32_bf16 v[128:131], v[228:231], v[208:211], 0
v_mfma_f32_16x16x32_bf16 v[128:131], v[224:227], v[196:199], v[128:131]
v_mfma_f32_16x16x32_bf16 v[136:139], v[224:227], v[200:203], 0
v_mfma_f32_16x16x32_bf16 v[136:139], v[228:231], v[212:215], v[136:139]
s_waitcnt lgkmcnt(1)
v_mfma_f32_16x16x32_bf16 v[140:143], v[232:235], v[212:215], 0
s_waitcnt lgkmcnt(0)
v_mfma_f32_16x16x32_bf16 v[140:143], v[236:239], v[200:203], v[140:143]
v_mfma_f32_16x16x32_bf16 v[132:135], v[236:239], v[196:199], 0
v_mfma_f32_16x16x32_bf16 v[132:135], v[232:235], v[208:211], v[132:135]
s_barrier
ds_read_b128 v[216:219], v240 offset:16384
ds_read_b128 v[220:223], v241 offset:16384
v_mfma_f32_16x16x32_bf16 v[124:127], v[232:235], v[204:207], 0
ds_read_b128 v[224:227], v241 offset:17408
ds_read_b128 v[228:231], v240 offset:17408
v_mfma_f32_16x16x32_bf16 v[124:127], v[236:239], v[192:195], v[124:127]
ds_read_b128 v[232:235], v240 offset:18432
ds_read_b128 v[236:239], v241 offset:18432
s_waitcnt lgkmcnt(5)
v_mfma_f32_16x16x32_bf16 v[144:147], v[216:219], v[192:195], 0
s_waitcnt lgkmcnt(4)
v_mfma_f32_16x16x32_bf16 v[144:147], v[220:223], v[204:207], v[144:147]
v_mfma_f32_16x16x32_bf16 v[152:155], v[220:223], v[208:211], 0
v_mfma_f32_16x16x32_bf16 v[152:155], v[216:219], v[196:199], v[152:155]
v_mfma_f32_16x16x32_bf16 v[160:163], v[216:219], v[200:203], 0
ds_read_b128 v[216:219], v241 offset:19456
v_mfma_f32_16x16x32_bf16 v[160:163], v[220:223], v[212:215], v[160:163]
ds_read_b128 v[220:223], v240 offset:19456
s_waitcnt lgkmcnt(5)
v_mfma_f32_16x16x32_bf16 v[164:167], v[224:227], v[212:215], 0
s_waitcnt lgkmcnt(4)
v_mfma_f32_16x16x32_bf16 v[164:167], v[228:231], v[200:203], v[164:167]
v_mfma_f32_16x16x32_bf16 v[156:159], v[228:231], v[196:199], 0
v_mfma_f32_16x16x32_bf16 v[156:159], v[224:227], v[208:211], v[156:159]
v_mfma_f32_16x16x32_bf16 v[148:151], v[224:227], v[204:207], 0
v_mfma_f32_16x16x32_bf16 v[148:151], v[228:231], v[192:195], v[148:151]
s_waitcnt lgkmcnt(3)
v_mfma_f32_16x16x32_bf16 v[168:171], v[232:235], v[192:195], 0
s_waitcnt lgkmcnt(2)
v_mfma_f32_16x16x32_bf16 v[168:171], v[236:239], v[204:207], v[168:171]
v_mfma_f32_16x16x32_bf16 v[176:179], v[236:239], v[208:211], 0
v_mfma_f32_16x16x32_bf16 v[176:179], v[232:235], v[196:199], v[176:179]
v_mfma_f32_16x16x32_bf16 v[184:187], v[232:235], v[200:203], 0
v_mfma_f32_16x16x32_bf16 v[184:187], v[236:239], v[212:215], v[184:187]
s_waitcnt lgkmcnt(1)
v_mfma_f32_16x16x32_bf16 v[188:191], v[216:219], v[212:215], 0
s_waitcnt lgkmcnt(0)
v_mfma_f32_16x16x32_bf16 v[188:191], v[220:223], v[200:203], v[188:191]
v_mfma_f32_16x16x32_bf16 v[180:183], v[220:223], v[196:199], 0
v_mfma_f32_16x16x32_bf16 v[180:183], v[216:219], v[208:211], v[180:183]
s_waitcnt vmcnt(2)
s_barrier
ds_read_b128 v[224:227], v240 offset:32768
v_mfma_f32_16x16x32_bf16 v[172:175], v[216:219], v[204:207], 0
v_mfma_f32_16x16x32_bf16 v[172:175], v[220:223], v[192:195], v[172:175]
ds_read_b128 v[192:195], v242 offset:12288
ds_read_b128 v[228:231], v241 offset:32768
ds_read_b128 v[204:207], v242 offset:15360
ds_read_b128 v[208:211], v242 offset:16384
ds_read_b128 v[196:199], v242 offset:13312
ds_read_b128 v[200:203], v242 offset:14336
ds_read_b128 v[212:215], v242 offset:17408
ds_read_b128 v[232:235], v241 offset:33792
ds_read_b128 v[236:239], v240 offset:33792
ds_read_b128 v[216:219], v240 offset:34816
ds_read_b128 v[220:223], v241 offset:34816
s_waitcnt lgkmcnt(10)
v_mfma_f32_16x16x32_bf16 v[0:3], v[224:227], v[192:195], v[0:3]
s_waitcnt lgkmcnt(8)
v_mfma_f32_16x16x32_bf16 v[0:3], v[228:231], v[204:207], v[0:3]
s_waitcnt lgkmcnt(7)
v_mfma_f32_16x16x32_bf16 v[8:11], v[228:231], v[208:211], v[8:11]
s_waitcnt lgkmcnt(6)
v_mfma_f32_16x16x32_bf16 v[8:11], v[224:227], v[196:199], v[8:11]
s_waitcnt lgkmcnt(5)
v_mfma_f32_16x16x32_bf16 v[16:19], v[224:227], v[200:203], v[16:19]
ds_read_b128 v[224:227], v241 offset:35840
s_waitcnt lgkmcnt(5)
v_mfma_f32_16x16x32_bf16 v[16:19], v[228:231], v[212:215], v[16:19]
ds_read_b128 v[228:231], v240 offset:35840
s_waitcnt lgkmcnt(5)
v_mfma_f32_16x16x32_bf16 v[20:23], v[232:235], v[212:215], v[20:23]
s_waitcnt lgkmcnt(4)
v_mfma_f32_16x16x32_bf16 v[20:23], v[236:239], v[200:203], v[20:23]
v_mfma_f32_16x16x32_bf16 v[12:15], v[236:239], v[196:199], v[12:15]
v_mfma_f32_16x16x32_bf16 v[12:15], v[232:235], v[208:211], v[12:15]
v_mfma_f32_16x16x32_bf16 v[4:7], v[232:235], v[204:207], v[4:7]
v_mfma_f32_16x16x32_bf16 v[4:7], v[236:239], v[192:195], v[4:7]
s_waitcnt lgkmcnt(3)
v_mfma_f32_16x16x32_bf16 v[24:27], v[216:219], v[192:195], v[24:27]
s_waitcnt lgkmcnt(2)
v_mfma_f32_16x16x32_bf16 v[24:27], v[220:223], v[204:207], v[24:27]
v_mfma_f32_16x16x32_bf16 v[32:35], v[220:223], v[208:211], v[32:35]
v_mfma_f32_16x16x32_bf16 v[32:35], v[216:219], v[196:199], v[32:35]
v_mfma_f32_16x16x32_bf16 v[40:43], v[216:219], v[200:203], v[40:43]
v_mfma_f32_16x16x32_bf16 v[40:43], v[220:223], v[212:215], v[40:43]
s_waitcnt lgkmcnt(1)
v_mfma_f32_16x16x32_bf16 v[44:47], v[224:227], v[212:215], v[44:47]
s_waitcnt lgkmcnt(0)
v_mfma_f32_16x16x32_bf16 v[44:47], v[228:231], v[200:203], v[44:47]
v_mfma_f32_16x16x32_bf16 v[36:39], v[228:231], v[196:199], v[36:39]
v_mfma_f32_16x16x32_bf16 v[36:39], v[224:227], v[208:211], v[36:39]
s_waitcnt vmcnt(0)
s_barrier
s_cmp_lg_u32 s41, 0
s_cbranch_scc1 L_hs_c0_2
s_mov_b32 s45, 0
L_hl_c0_2:
s_waitcnt vmcnt(0)
v_readfirstlane_b32 s44, v249
s_add_u32 s45, s45, 1
s_cmp_gt_u32 s45, 0x80000
s_cbranch_scc1 L_hs_c0_2
s_cmp_eq_u32 s44, 1
s_cbranch_scc1 L_hs_c0_2
buffer_load_dword v249, v252, s[60:63], s46 offen sc1
s_branch L_hl_c0_2
L_hs_c0_2:
ds_read_b128 v[232:235], v240 offset:49152
ds_read_b128 v[236:239], v241 offset:49152
v_mfma_f32_16x16x32_bf16 v[28:31], v[224:227], v[204:207], v[28:31]
ds_read_b128 v[216:219], v241 offset:50176
ds_read_b128 v[220:223], v240 offset:50176
v_mfma_f32_16x16x32_bf16 v[28:31], v[228:231], v[192:195], v[28:31]
ds_read_b128 v[224:227], v240 offset:51200
ds_read_b128 v[228:231], v241 offset:51200
s_waitcnt lgkmcnt(5)
v_mfma_f32_16x16x32_bf16 v[48:51], v[232:235], v[192:195], v[48:51]
s_waitcnt lgkmcnt(4)
v_mfma_f32_16x16x32_bf16 v[48:51], v[236:239], v[204:207], v[48:51]
v_mfma_f32_16x16x32_bf16 v[56:59], v[236:239], v[208:211], v[56:59]
v_mfma_f32_16x16x32_bf16 v[56:59], v[232:235], v[196:199], v[56:59]
v_mfma_f32_16x16x32_bf16 v[64:67], v[232:235], v[200:203], v[64:67]
ds_read_b128 v[232:235], v241 offset:52224
v_mfma_f32_16x16x32_bf16 v[64:67], v[236:239], v[212:215], v[64:67]
ds_read_b128 v[236:239], v240 offset:52224
s_waitcnt lgkmcnt(5)
v_mfma_f32_16x16x32_bf16 v[68:71], v[216:219], v[212:215], v[68:71]
s_waitcnt lgkmcnt(4)
v_mfma_f32_16x16x32_bf16 v[68:71], v[220:223], v[200:203], v[68:71]
v_mfma_f32_16x16x32_bf16 v[60:63], v[220:223], v[196:199], v[60:63]
v_mfma_f32_16x16x32_bf16 v[60:63], v[216:219], v[208:211], v[60:63]
v_mfma_f32_16x16x32_bf16 v[52:55], v[216:219], v[204:207], v[52:55]
v_mfma_f32_16x16x32_bf16 v[52:55], v[220:223], v[192:195], v[52:55]
s_waitcnt lgkmcnt(3)
v_mfma_f32_16x16x32_bf16 v[72:75], v[224:227], v[192:195], v[72:75]
s_waitcnt lgkmcnt(2)
v_mfma_f32_16x16x32_bf16 v[72:75], v[228:231], v[204:207], v[72:75]
v_mfma_f32_16x16x32_bf16 v[80:83], v[228:231], v[208:211], v[80:83]
v_mfma_f32_16x16x32_bf16 v[80:83], v[224:227], v[196:199], v[80:83]
v_mfma_f32_16x16x32_bf16 v[88:91], v[224:227], v[200:203], v[88:91]
v_mfma_f32_16x16x32_bf16 v[88:91], v[228:231], v[212:215], v[88:91]
s_waitcnt lgkmcnt(1)
v_mfma_f32_16x16x32_bf16 v[92:95], v[232:235], v[212:215], v[92:95]
s_waitcnt lgkmcnt(0)
v_mfma_f32_16x16x32_bf16 v[92:95], v[236:239], v[200:203], v[92:95]
v_mfma_f32_16x16x32_bf16 v[84:87], v[236:239], v[196:199], v[84:87]
v_mfma_f32_16x16x32_bf16 v[84:87], v[232:235], v[208:211], v[84:87]
s_barrier
v_mfma_f32_16x16x32_bf16 v[76:79], v[232:235], v[204:207], v[76:79]
v_mfma_f32_16x16x32_bf16 v[76:79], v[236:239], v[192:195], v[76:79]
s_add_u32 m0, s42, 81920
v_add_u32 v246, 0x100080, v246
buffer_load_dwordx4 v246, s[16:19], s37 offen offset:3072 lds
s_add_u32 m0, s42, 98304
v_add_u32 v246, 0x80000, v246
buffer_load_dwordx4 v246, s[16:19], 0 offen lds
buffer_load_dwordx4 v246, s[16:19], s35 offen offset:1024 lds
buffer_load_dwordx4 v246, s[16:19], s36 offen offset:2048 lds
buffer_load_dwordx4 v246, s[16:19], s37 offen offset:3072 lds
s_add_u32 m0, s42, 114688
v_add_u32 v246, 0x80000, v246
buffer_load_dwordx4 v246, s[16:19], 0 offen lds
buffer_load_dwordx4 v246, s[16:19], s35 offen offset:1024 lds
buffer_load_dwordx4 v246, s[16:19], s36 offen offset:2048 lds
s_barrier
buffer_load_dwordx4 v246, s[16:19], s37 offen offset:3072 lds
s_add_u32 m0, s42, 0
v_add_u32 v245, 0x10000, v245
buffer_load_dwordx4 v245, s[8:11], s32 offen offset:1024 nt lds
buffer_load_dwordx4 v245, s[8:11], s33 offen offset:2048 nt lds
buffer_load_dwordx4 v245, s[8:11], s34 offen offset:3072 nt lds
s_add_u32 m0, s42, 16384
v_add_u32 v245, 0x10000, v245
buffer_load_dwordx4 v245, s[8:11], 0 offen nt lds
buffer_load_dwordx4 v245, s[8:11], s32 offen offset:1024 nt lds
buffer_load_dwordx4 v245, s[8:11], s33 offen offset:2048 nt lds
buffer_load_dwordx4 v245, s[8:11], s34 offen offset:3072 nt lds
s_barrier
s_add_u32 m0, s42, 32768
v_add_u32 v245, 0xfffd0080, v245
buffer_load_dwordx4 v245, s[8:11], 0 offen nt lds
buffer_load_dwordx4 v245, s[8:11], s32 offen offset:1024 nt lds
buffer_load_dwordx4 v245, s[8:11], s33 offen offset:2048 nt lds
s_waitcnt vmcnt(14)
s_barrier
s_waitcnt vmcnt(10)
s_barrier
s_add_u32 m0, s42, 49152
v_add_u32 v245, 0x10000, v245
buffer_load_dwordx4 v245, s[8:11], s32 offen offset:1024 nt lds
buffer_load_dwordx4 v245, s[8:11], s33 offen offset:2048 nt lds
s_waitcnt vmcnt(9)
s_barrier
v_xor_b32 v240, 0x10000, v240
ds_read_b128 v[216:219], v240
v_xor_b32 v241, 0x10000, v241
ds_read_b128 v[220:223], v241
ds_read_b128 v[224:227], v241 offset:1024
ds_read_b128 v[228:231], v240 offset:1024
ds_read_b128 v[232:235], v240 offset:2048
ds_read_b128 v[236:239], v241 offset:2048
s_waitcnt lgkmcnt(5)
v_mfma_f32_16x16x32_bf16 v[96:99], v[216:219], v[192:195], v[96:99]
s_waitcnt lgkmcnt(4)
v_mfma_f32_16x16x32_bf16 v[96:99], v[220:223], v[204:207], v[96:99]
v_mfma_f32_16x16x32_bf16 v[104:107], v[220:223], v[208:211], v[104:107]
v_mfma_f32_16x16x32_bf16 v[104:107], v[216:219], v[196:199], v[104:107]
v_mfma_f32_16x16x32_bf16 v[112:115], v[216:219], v[200:203], v[112:115]
ds_read_b128 v[216:219], v241 offset:3072
v_mfma_f32_16x16x32_bf16 v[112:115], v[220:223], v[212:215], v[112:115]
ds_read_b128 v[220:223], v240 offset:3072
s_waitcnt lgkmcnt(5)
v_mfma_f32_16x16x32_bf16 v[116:119], v[224:227], v[212:215], v[116:119]
s_waitcnt lgkmcnt(4)
v_mfma_f32_16x16x32_bf16 v[116:119], v[228:231], v[200:203], v[116:119]
v_mfma_f32_16x16x32_bf16 v[108:111], v[228:231], v[196:199], v[108:111]
v_mfma_f32_16x16x32_bf16 v[108:111], v[224:227], v[208:211], v[108:111]
v_mfma_f32_16x16x32_bf16 v[100:103], v[224:227], v[204:207], v[100:103]
v_mfma_f32_16x16x32_bf16 v[100:103], v[228:231], v[192:195], v[100:103]
s_waitcnt lgkmcnt(3)
v_mfma_f32_16x16x32_bf16 v[120:123], v[232:235], v[192:195], v[120:123]
s_waitcnt lgkmcnt(2)
v_mfma_f32_16x16x32_bf16 v[120:123], v[236:239], v[204:207], v[120:123]
v_mfma_f32_16x16x32_bf16 v[128:131], v[236:239], v[208:211], v[128:131]
v_mfma_f32_16x16x32_bf16 v[128:131], v[232:235], v[196:199], v[128:131]
v_mfma_f32_16x16x32_bf16 v[136:139], v[232:235], v[200:203], v[136:139]
v_mfma_f32_16x16x32_bf16 v[136:139], v[236:239], v[212:215], v[136:139]
s_waitcnt lgkmcnt(1)
v_mfma_f32_16x16x32_bf16 v[140:143], v[216:219], v[212:215], v[140:143]
s_waitcnt lgkmcnt(0)
v_mfma_f32_16x16x32_bf16 v[140:143], v[220:223], v[200:203], v[140:143]
v_mfma_f32_16x16x32_bf16 v[132:135], v[220:223], v[196:199], v[132:135]
v_mfma_f32_16x16x32_bf16 v[132:135], v[216:219], v[208:211], v[132:135]
s_waitcnt vmcnt(5)
s_barrier
ds_read_b128 v[224:227], v240 offset:16384
ds_read_b128 v[228:231], v241 offset:16384
v_mfma_f32_16x16x32_bf16 v[124:127], v[216:219], v[204:207], v[124:127]
ds_read_b128 v[232:235], v241 offset:17408
ds_read_b128 v[236:239], v240 offset:17408
v_mfma_f32_16x16x32_bf16 v[124:127], v[220:223], v[192:195], v[124:127]
ds_read_b128 v[216:219], v240 offset:18432
ds_read_b128 v[220:223], v241 offset:18432
s_waitcnt lgkmcnt(5)
v_mfma_f32_16x16x32_bf16 v[144:147], v[224:227], v[192:195], v[144:147]
s_waitcnt lgkmcnt(4)
v_mfma_f32_16x16x32_bf16 v[144:147], v[228:231], v[204:207], v[144:147]
v_mfma_f32_16x16x32_bf16 v[152:155], v[228:231], v[208:211], v[152:155]
v_mfma_f32_16x16x32_bf16 v[152:155], v[224:227], v[196:199], v[152:155]
v_mfma_f32_16x16x32_bf16 v[160:163], v[224:227], v[200:203], v[160:163]
ds_read_b128 v[224:227], v241 offset:19456
v_mfma_f32_16x16x32_bf16 v[160:163], v[228:231], v[212:215], v[160:163]
ds_read_b128 v[228:231], v240 offset:19456
s_waitcnt lgkmcnt(5)
v_mfma_f32_16x16x32_bf16 v[164:167], v[232:235], v[212:215], v[164:167]
s_waitcnt lgkmcnt(4)
v_mfma_f32_16x16x32_bf16 v[164:167], v[236:239], v[200:203], v[164:167]
v_mfma_f32_16x16x32_bf16 v[156:159], v[236:239], v[196:199], v[156:159]
v_mfma_f32_16x16x32_bf16 v[156:159], v[232:235], v[208:211], v[156:159]
v_mfma_f32_16x16x32_bf16 v[148:151], v[232:235], v[204:207], v[148:151]
v_mfma_f32_16x16x32_bf16 v[148:151], v[236:239], v[192:195], v[148:151]
s_waitcnt lgkmcnt(3)
v_mfma_f32_16x16x32_bf16 v[168:171], v[216:219], v[192:195], v[168:171]
s_waitcnt lgkmcnt(2)
v_mfma_f32_16x16x32_bf16 v[168:171], v[220:223], v[204:207], v[168:171]
v_mfma_f32_16x16x32_bf16 v[176:179], v[220:223], v[208:211], v[176:179]
v_mfma_f32_16x16x32_bf16 v[176:179], v[216:219], v[196:199], v[176:179]
v_mfma_f32_16x16x32_bf16 v[184:187], v[216:219], v[200:203], v[184:187]
v_mfma_f32_16x16x32_bf16 v[184:187], v[220:223], v[212:215], v[184:187]
s_waitcnt lgkmcnt(1)
v_mfma_f32_16x16x32_bf16 v[188:191], v[224:227], v[212:215], v[188:191]
s_waitcnt lgkmcnt(0)
v_mfma_f32_16x16x32_bf16 v[188:191], v[228:231], v[200:203], v[188:191]
v_mfma_f32_16x16x32_bf16 v[180:183], v[228:231], v[196:199], v[180:183]
v_mfma_f32_16x16x32_bf16 v[180:183], v[224:227], v[208:211], v[180:183]
s_waitcnt vmcnt(2)
s_barrier
ds_read_b128 v[232:235], v240 offset:32768
v_mfma_f32_16x16x32_bf16 v[172:175], v[224:227], v[204:207], v[172:175]
v_mfma_f32_16x16x32_bf16 v[172:175], v[228:231], v[192:195], v[172:175]
ds_read_b128 v[192:195], v242
ds_read_b128 v[236:239], v241 offset:32768
ds_read_b128 v[204:207], v242 offset:3072
ds_read_b128 v[208:211], v242 offset:4096
ds_read_b128 v[196:199], v242 offset:1024
ds_read_b128 v[200:203], v242 offset:2048
ds_read_b128 v[212:215], v242 offset:5120
ds_read_b128 v[216:219], v241 offset:33792
ds_read_b128 v[220:223], v240 offset:33792
ds_read_b128 v[224:227], v240 offset:34816
ds_read_b128 v[228:231], v241 offset:34816
s_waitcnt lgkmcnt(10)
v_mfma_f32_16x16x32_bf16 v[0:3], v[232:235], v[192:195], v[0:3]
s_waitcnt lgkmcnt(8)
v_mfma_f32_16x16x32_bf16 v[0:3], v[236:239], v[204:207], v[0:3]
s_waitcnt lgkmcnt(7)
v_mfma_f32_16x16x32_bf16 v[8:11], v[236:239], v[208:211], v[8:11]
s_waitcnt lgkmcnt(6)
v_mfma_f32_16x16x32_bf16 v[8:11], v[232:235], v[196:199], v[8:11]
s_waitcnt lgkmcnt(5)
v_mfma_f32_16x16x32_bf16 v[16:19], v[232:235], v[200:203], v[16:19]
ds_read_b128 v[232:235], v241 offset:35840
s_waitcnt lgkmcnt(5)
v_mfma_f32_16x16x32_bf16 v[16:19], v[236:239], v[212:215], v[16:19]
ds_read_b128 v[236:239], v240 offset:35840
s_waitcnt lgkmcnt(5)
v_mfma_f32_16x16x32_bf16 v[20:23], v[216:219], v[212:215], v[20:23]
s_waitcnt lgkmcnt(4)
v_mfma_f32_16x16x32_bf16 v[20:23], v[220:223], v[200:203], v[20:23]
v_mfma_f32_16x16x32_bf16 v[12:15], v[220:223], v[196:199], v[12:15]
v_mfma_f32_16x16x32_bf16 v[12:15], v[216:219], v[208:211], v[12:15]
v_mfma_f32_16x16x32_bf16 v[4:7], v[216:219], v[204:207], v[4:7]
v_mfma_f32_16x16x32_bf16 v[4:7], v[220:223], v[192:195], v[4:7]
s_waitcnt lgkmcnt(3)
v_mfma_f32_16x16x32_bf16 v[24:27], v[224:227], v[192:195], v[24:27]
s_waitcnt lgkmcnt(2)
v_mfma_f32_16x16x32_bf16 v[24:27], v[228:231], v[204:207], v[24:27]
v_mfma_f32_16x16x32_bf16 v[32:35], v[228:231], v[208:211], v[32:35]
v_mfma_f32_16x16x32_bf16 v[32:35], v[224:227], v[196:199], v[32:35]
v_mfma_f32_16x16x32_bf16 v[40:43], v[224:227], v[200:203], v[40:43]
v_mfma_f32_16x16x32_bf16 v[40:43], v[228:231], v[212:215], v[40:43]
s_waitcnt lgkmcnt(1)
v_mfma_f32_16x16x32_bf16 v[44:47], v[232:235], v[212:215], v[44:47]
s_waitcnt lgkmcnt(0)
v_mfma_f32_16x16x32_bf16 v[44:47], v[236:239], v[200:203], v[44:47]
v_mfma_f32_16x16x32_bf16 v[36:39], v[236:239], v[196:199], v[36:39]
v_mfma_f32_16x16x32_bf16 v[36:39], v[232:235], v[208:211], v[36:39]
s_barrier
v_mfma_f32_16x16x32_bf16 v[28:31], v[232:235], v[204:207], v[28:31]
v_mfma_f32_16x16x32_bf16 v[28:31], v[236:239], v[192:195], v[28:31]
s_add_u32 m0, s42, 0
v_add_u32 v246, 0xfff00080, v246
buffer_load_dwordx4 v246, s[16:19], s36 offen offset:2048 lds
buffer_load_dwordx4 v246, s[16:19], s37 offen offset:3072 lds
s_add_u32 m0, s42, 16384
v_add_u32 v246, 0x80000, v246
buffer_load_dwordx4 v246, s[16:19], 0 offen lds
buffer_load_dwordx4 v246, s[16:19], s35 offen offset:1024 lds
buffer_load_dwordx4 v246, s[16:19], s36 offen offset:2048 lds
buffer_load_dwordx4 v246, s[16:19], s37 offen offset:3072 lds
s_add_u32 m0, s42, 32768
v_add_u32 v246, 0x80000, v246
buffer_load_dwordx4 v246, s[16:19], 0 offen lds
buffer_load_dwordx4 v246, s[16:19], s35 offen offset:1024 lds
s_barrier
buffer_load_dwordx4 v246, s[16:19], s36 offen offset:2048 lds
buffer_load_dwordx4 v246, s[16:19], s37 offen offset:3072 lds
s_add_u32 m0, s42, 65536
v_add_u32 v245, 0x10000, v245
buffer_load_dwordx4 v245, s[8:11], 0 offen nt lds
buffer_load_dwordx4 v245, s[8:11], s32 offen offset:1024 nt lds
buffer_load_dwordx4 v245, s[8:11], s33 offen offset:2048 nt lds
buffer_load_dwordx4 v245, s[8:11], s34 offen offset:3072 nt lds
s_add_u32 m0, s42, 81920
v_add_u32 v245, 0x10000, v245
buffer_load_dwordx4 v245, s[8:11], 0 offen nt lds
buffer_load_dwordx4 v245, s[8:11], s32 offen offset:1024 nt lds
s_waitcnt vmcnt(10)
s_barrier
buffer_load_dwordx4 v245, s[8:11], s33 offen offset:2048 nt lds
buffer_load_dwordx4 v245, s[8:11], s34 offen offset:3072 nt lds
s_add_u32 m0, s42, 98304
v_add_u32 v245, 0xfffd0080, v245
buffer_load_dwordx4 v245, s[8:11], 0 offen nt lds
buffer_load_dwordx4 v245, s[8:11], s32 offen offset:1024 nt lds
s_barrier
s_waitcnt vmcnt(10)
s_barrier
s_barrier
ds_read_b128 v[216:219], v240 offset:49152
ds_read_b128 v[220:223], v241 offset:49152
ds_read_b128 v[224:227], v241 offset:50176
ds_read_b128 v[228:231], v240 offset:50176
ds_read_b128 v[232:235], v240 offset:51200
ds_read_b128 v[236:239], v241 offset:51200
s_waitcnt lgkmcnt(5)
v_mfma_f32_16x16x32_bf16 v[48:51], v[216:219], v[192:195], v[48:51]
s_waitcnt lgkmcnt(4)
v_mfma_f32_16x16x32_bf16 v[48:51], v[220:223], v[204:207], v[48:51]
v_mfma_f32_16x16x32_bf16 v[56:59], v[220:223], v[208:211], v[56:59]
v_mfma_f32_16x16x32_bf16 v[56:59], v[216:219], v[196:199], v[56:59]
v_mfma_f32_16x16x32_bf16 v[64:67], v[216:219], v[200:203], v[64:67]
ds_read_b128 v[216:219], v241 offset:52224
v_mfma_f32_16x16x32_bf16 v[64:67], v[220:223], v[212:215], v[64:67]
ds_read_b128 v[220:223], v240 offset:52224
s_waitcnt lgkmcnt(5)
v_mfma_f32_16x16x32_bf16 v[68:71], v[224:227], v[212:215], v[68:71]
s_waitcnt lgkmcnt(4)
v_mfma_f32_16x16x32_bf16 v[68:71], v[228:231], v[200:203], v[68:71]
v_mfma_f32_16x16x32_bf16 v[60:63], v[228:231], v[196:199], v[60:63]
v_mfma_f32_16x16x32_bf16 v[60:63], v[224:227], v[208:211], v[60:63]
v_mfma_f32_16x16x32_bf16 v[52:55], v[224:227], v[204:207], v[52:55]
v_mfma_f32_16x16x32_bf16 v[52:55], v[228:231], v[192:195], v[52:55]
s_waitcnt lgkmcnt(3)
v_mfma_f32_16x16x32_bf16 v[72:75], v[232:235], v[192:195], v[72:75]
s_waitcnt lgkmcnt(2)
v_mfma_f32_16x16x32_bf16 v[72:75], v[236:239], v[204:207], v[72:75]
v_mfma_f32_16x16x32_bf16 v[80:83], v[236:239], v[208:211], v[80:83]
v_mfma_f32_16x16x32_bf16 v[80:83], v[232:235], v[196:199], v[80:83]
v_mfma_f32_16x16x32_bf16 v[88:91], v[232:235], v[200:203], v[88:91]
v_mfma_f32_16x16x32_bf16 v[88:91], v[236:239], v[212:215], v[88:91]
s_waitcnt lgkmcnt(1)
v_mfma_f32_16x16x32_bf16 v[92:95], v[216:219], v[212:215], v[92:95]
s_waitcnt lgkmcnt(0)
v_mfma_f32_16x16x32_bf16 v[92:95], v[220:223], v[200:203], v[92:95]
v_mfma_f32_16x16x32_bf16 v[84:87], v[220:223], v[196:199], v[84:87]
v_mfma_f32_16x16x32_bf16 v[84:87], v[216:219], v[208:211], v[84:87]
s_waitcnt vmcnt(6)
s_barrier
v_xor_b32 v240, 0x10000, v240
ds_read_b128 v[224:227], v240
v_mfma_f32_16x16x32_bf16 v[76:79], v[216:219], v[204:207], v[76:79]
v_xor_b32 v241, 0x10000, v241
ds_read_b128 v[228:231], v241
v_mfma_f32_16x16x32_bf16 v[76:79], v[220:223], v[192:195], v[76:79]
ds_read_b128 v[232:235], v241 offset:1024
ds_read_b128 v[236:239], v240 offset:1024
ds_read_b128 v[216:219], v240 offset:2048
ds_read_b128 v[220:223], v241 offset:2048
s_waitcnt lgkmcnt(5)
v_mfma_f32_16x16x32_bf16 v[96:99], v[224:227], v[192:195], v[96:99]
s_waitcnt lgkmcnt(4)
v_mfma_f32_16x16x32_bf16 v[96:99], v[228:231], v[204:207], v[96:99]
v_mfma_f32_16x16x32_bf16 v[104:107], v[228:231], v[208:211], v[104:107]
v_mfma_f32_16x16x32_bf16 v[104:107], v[224:227], v[196:199], v[104:107]
v_mfma_f32_16x16x32_bf16 v[112:115], v[224:227], v[200:203], v[112:115]
ds_read_b128 v[224:227], v241 offset:3072
v_mfma_f32_16x16x32_bf16 v[112:115], v[228:231], v[212:215], v[112:115]
ds_read_b128 v[228:231], v240 offset:3072
s_waitcnt lgkmcnt(5)
v_mfma_f32_16x16x32_bf16 v[116:119], v[232:235], v[212:215], v[116:119]
s_waitcnt lgkmcnt(4)
v_mfma_f32_16x16x32_bf16 v[116:119], v[236:239], v[200:203], v[116:119]
v_mfma_f32_16x16x32_bf16 v[108:111], v[236:239], v[196:199], v[108:111]
v_mfma_f32_16x16x32_bf16 v[108:111], v[232:235], v[208:211], v[108:111]
v_mfma_f32_16x16x32_bf16 v[100:103], v[232:235], v[204:207], v[100:103]
v_mfma_f32_16x16x32_bf16 v[100:103], v[236:239], v[192:195], v[100:103]
s_waitcnt lgkmcnt(3)
v_mfma_f32_16x16x32_bf16 v[120:123], v[216:219], v[192:195], v[120:123]
s_waitcnt lgkmcnt(2)
v_mfma_f32_16x16x32_bf16 v[120:123], v[220:223], v[204:207], v[120:123]
v_mfma_f32_16x16x32_bf16 v[128:131], v[220:223], v[208:211], v[128:131]
v_mfma_f32_16x16x32_bf16 v[128:131], v[216:219], v[196:199], v[128:131]
v_mfma_f32_16x16x32_bf16 v[136:139], v[216:219], v[200:203], v[136:139]
v_mfma_f32_16x16x32_bf16 v[136:139], v[220:223], v[212:215], v[136:139]
s_waitcnt lgkmcnt(1)
v_mfma_f32_16x16x32_bf16 v[140:143], v[224:227], v[212:215], v[140:143]
s_waitcnt lgkmcnt(0)
v_mfma_f32_16x16x32_bf16 v[140:143], v[228:231], v[200:203], v[140:143]
v_mfma_f32_16x16x32_bf16 v[132:135], v[228:231], v[196:199], v[132:135]
v_mfma_f32_16x16x32_bf16 v[132:135], v[224:227], v[208:211], v[132:135]
s_waitcnt vmcnt(2)
s_barrier
ds_read_b128 v[232:235], v240 offset:16384
ds_read_b128 v[236:239], v241 offset:16384
v_mfma_f32_16x16x32_bf16 v[124:127], v[224:227], v[204:207], v[124:127]
ds_read_b128 v[216:219], v241 offset:17408
ds_read_b128 v[220:223], v240 offset:17408
v_mfma_f32_16x16x32_bf16 v[124:127], v[228:231], v[192:195], v[124:127]
ds_read_b128 v[224:227], v240 offset:18432
ds_read_b128 v[228:231], v241 offset:18432
s_waitcnt lgkmcnt(5)
v_mfma_f32_16x16x32_bf16 v[144:147], v[232:235], v[192:195], v[144:147]
s_waitcnt lgkmcnt(4)
v_mfma_f32_16x16x32_bf16 v[144:147], v[236:239], v[204:207], v[144:147]
v_mfma_f32_16x16x32_bf16 v[152:155], v[236:239], v[208:211], v[152:155]
v_mfma_f32_16x16x32_bf16 v[152:155], v[232:235], v[196:199], v[152:155]
v_mfma_f32_16x16x32_bf16 v[160:163], v[232:235], v[200:203], v[160:163]
ds_read_b128 v[232:235], v241 offset:19456
v_mfma_f32_16x16x32_bf16 v[160:163], v[236:239], v[212:215], v[160:163]
ds_read_b128 v[236:239], v240 offset:19456
s_waitcnt lgkmcnt(5)
v_mfma_f32_16x16x32_bf16 v[164:167], v[216:219], v[212:215], v[164:167]
s_waitcnt lgkmcnt(4)
v_mfma_f32_16x16x32_bf16 v[164:167], v[220:223], v[200:203], v[164:167]
v_mfma_f32_16x16x32_bf16 v[156:159], v[220:223], v[196:199], v[156:159]
v_mfma_f32_16x16x32_bf16 v[156:159], v[216:219], v[208:211], v[156:159]
v_mfma_f32_16x16x32_bf16 v[148:151], v[216:219], v[204:207], v[148:151]
v_mfma_f32_16x16x32_bf16 v[148:151], v[220:223], v[192:195], v[148:151]
s_waitcnt lgkmcnt(3)
v_mfma_f32_16x16x32_bf16 v[168:171], v[224:227], v[192:195], v[168:171]
s_waitcnt lgkmcnt(2)
v_mfma_f32_16x16x32_bf16 v[168:171], v[228:231], v[204:207], v[168:171]
v_mfma_f32_16x16x32_bf16 v[176:179], v[228:231], v[208:211], v[176:179]
v_mfma_f32_16x16x32_bf16 v[176:179], v[224:227], v[196:199], v[176:179]
v_mfma_f32_16x16x32_bf16 v[184:187], v[224:227], v[200:203], v[184:187]
v_mfma_f32_16x16x32_bf16 v[184:187], v[228:231], v[212:215], v[184:187]
s_waitcnt lgkmcnt(1)
v_mfma_f32_16x16x32_bf16 v[188:191], v[232:235], v[212:215], v[188:191]
s_waitcnt lgkmcnt(0)
v_mfma_f32_16x16x32_bf16 v[188:191], v[236:239], v[200:203], v[188:191]
v_mfma_f32_16x16x32_bf16 v[180:183], v[236:239], v[196:199], v[180:183]
v_mfma_f32_16x16x32_bf16 v[180:183], v[232:235], v[208:211], v[180:183]
s_waitcnt vmcnt(0)
s_barrier
ds_read_b128 v[216:219], v240 offset:32768
v_mfma_f32_16x16x32_bf16 v[172:175], v[232:235], v[204:207], v[172:175]
v_mfma_f32_16x16x32_bf16 v[172:175], v[236:239], v[192:195], v[172:175]
ds_read_b128 v[192:195], v242 offset:12288
ds_read_b128 v[220:223], v241 offset:32768
ds_read_b128 v[204:207], v242 offset:15360
ds_read_b128 v[208:211], v242 offset:16384
ds_read_b128 v[196:199], v242 offset:13312
ds_read_b128 v[200:203], v242 offset:14336
ds_read_b128 v[212:215], v242 offset:17408
ds_read_b128 v[224:227], v241 offset:33792
ds_read_b128 v[228:231], v240 offset:33792
ds_read_b128 v[232:235], v240 offset:34816
ds_read_b128 v[236:239], v241 offset:34816
s_waitcnt lgkmcnt(10)
v_mfma_f32_16x16x32_bf16 v[0:3], v[216:219], v[192:195], v[0:3]
s_waitcnt lgkmcnt(8)
v_mfma_f32_16x16x32_bf16 v[0:3], v[220:223], v[204:207], v[0:3]
s_waitcnt lgkmcnt(7)
v_mfma_f32_16x16x32_bf16 v[8:11], v[220:223], v[208:211], v[8:11]
s_waitcnt lgkmcnt(6)
v_mfma_f32_16x16x32_bf16 v[8:11], v[216:219], v[196:199], v[8:11]
s_waitcnt lgkmcnt(5)
v_mfma_f32_16x16x32_bf16 v[16:19], v[216:219], v[200:203], v[16:19]
ds_read_b128 v[216:219], v241 offset:35840
s_waitcnt lgkmcnt(5)
v_mfma_f32_16x16x32_bf16 v[16:19], v[220:223], v[212:215], v[16:19]
ds_read_b128 v[220:223], v240 offset:35840
s_waitcnt lgkmcnt(5)
v_mfma_f32_16x16x32_bf16 v[20:23], v[224:227], v[212:215], v[20:23]
s_waitcnt lgkmcnt(4)
v_mfma_f32_16x16x32_bf16 v[20:23], v[228:231], v[200:203], v[20:23]
v_mfma_f32_16x16x32_bf16 v[12:15], v[228:231], v[196:199], v[12:15]
v_mfma_f32_16x16x32_bf16 v[12:15], v[224:227], v[208:211], v[12:15]
v_mfma_f32_16x16x32_bf16 v[4:7], v[224:227], v[204:207], v[4:7]
v_mfma_f32_16x16x32_bf16 v[4:7], v[228:231], v[192:195], v[4:7]
s_waitcnt lgkmcnt(3)
v_mfma_f32_16x16x32_bf16 v[24:27], v[232:235], v[192:195], v[24:27]
s_waitcnt lgkmcnt(2)
v_mfma_f32_16x16x32_bf16 v[24:27], v[236:239], v[204:207], v[24:27]
v_mfma_f32_16x16x32_bf16 v[32:35], v[236:239], v[208:211], v[32:35]
v_max_f32 v249, v0, v1
v_max_f32 v250, v8, v9
v_mfma_f32_16x16x32_bf16 v[32:35], v[232:235], v[196:199], v[32:35]
v_max_f32 v251, v16, v17
v_max3_f32 v249, v249, v2, v3
v_mfma_f32_16x16x32_bf16 v[40:43], v[232:235], v[200:203], v[40:43]
v_max3_f32 v250, v250, v10, v11
v_max3_f32 v251, v251, v18, v19
v_mfma_f32_16x16x32_bf16 v[40:43], v[236:239], v[212:215], v[40:43]
v_max3_f32 v249, v249, v4, v5
v_max3_f32 v250, v250, v12, v13
s_waitcnt lgkmcnt(1)
v_mfma_f32_16x16x32_bf16 v[44:47], v[216:219], v[212:215], v[44:47]
v_max3_f32 v251, v251, v20, v21
v_max3_f32 v249, v249, v6, v7
s_waitcnt lgkmcnt(0)
v_mfma_f32_16x16x32_bf16 v[44:47], v[220:223], v[200:203], v[44:47]
v_max3_f32 v250, v250, v14, v15
v_max3_f32 v251, v251, v22, v23
v_mfma_f32_16x16x32_bf16 v[36:39], v[220:223], v[196:199], v[36:39]
v_mfma_f32_16x16x32_bf16 v[36:39], v[216:219], v[208:211], v[36:39]
v_mfma_f32_16x16x32_bf16 v[28:31], v[216:219], v[204:207], v[28:31]
v_mfma_f32_16x16x32_bf16 v[28:31], v[220:223], v[192:195], v[28:31]
v_max3_f32 v249, v249, v24, v25
v_max3_f32 v250, v250, v32, v33
v_max3_f32 v251, v251, v40, v41
v_max3_f32 v249, v249, v26, v27
v_max3_f32 v250, v250, v34, v35
v_max3_f32 v251, v251, v42, v43
s_nop 1
v_max3_f32 v249, v249, v28, v29
v_max3_f32 v250, v250, v36, v37
v_max3_f32 v251, v251, v44, v45
v_max3_f32 v249, v249, v30, v31
v_max3_f32 v250, v250, v38, v39
v_max3_f32 v251, v251, v46, v47
v_mul_f32 v249, s43, v249
v_mul_f32 v250, s43, v250
v_mul_f32 v251, s43, v251
v_fma_f32 v0, v0, s43, -v249
v_fma_f32 v1, v1, s43, -v249
v_fma_f32 v2, v2, s43, -v249
v_fma_f32 v3, v3, s43, -v249
v_fma_f32 v4, v4, s43, -v249
v_fma_f32 v5, v5, s43, -v249
v_fma_f32 v6, v6, s43, -v249
v_fma_f32 v7, v7, s43, -v249
v_exp_f32 v0, v0
v_exp_f32 v1, v1
v_exp_f32 v2, v2
v_exp_f32 v3, v3
v_exp_f32 v4, v4
v_exp_f32 v5, v5
v_exp_f32 v6, v6
v_exp_f32 v7, v7
v_fma_f32 v8, v8, s43, -v250
v_fma_f32 v9, v9, s43, -v250
v_fma_f32 v10, v10, s43, -v250
v_fma_f32 v11, v11, s43, -v250
v_fma_f32 v12, v12, s43, -v250
v_fma_f32 v13, v13, s43, -v250
v_fma_f32 v14, v14, s43, -v250
v_fma_f32 v15, v15, s43, -v250
v_exp_f32 v8, v8
v_exp_f32 v9, v9
v_exp_f32 v10, v10
v_exp_f32 v11, v11
v_exp_f32 v12, v12
v_exp_f32 v13, v13
v_exp_f32 v14, v14
v_exp_f32 v15, v15
v_fma_f32 v16, v16, s43, -v251
v_fma_f32 v17, v17, s43, -v251
v_fma_f32 v18, v18, s43, -v251
v_fma_f32 v19, v19, s43, -v251
v_fma_f32 v20, v20, s43, -v251
v_fma_f32 v21, v21, s43, -v251
v_fma_f32 v22, v22, s43, -v251
v_fma_f32 v23, v23, s43, -v251
v_exp_f32 v16, v16
v_exp_f32 v17, v17
v_exp_f32 v18, v18
v_exp_f32 v19, v19
v_exp_f32 v20, v20
v_exp_f32 v21, v21
v_exp_f32 v22, v22
v_exp_f32 v23, v23
v_fma_f32 v24, v24, s43, -v249
v_fma_f32 v25, v25, s43, -v249
v_fma_f32 v26, v26, s43, -v249
v_fma_f32 v27, v27, s43, -v249
v_fma_f32 v28, v28, s43, -v249
v_fma_f32 v29, v29, s43, -v249
v_fma_f32 v30, v30, s43, -v249
v_fma_f32 v31, v31, s43, -v249
v_exp_f32 v24, v24
v_exp_f32 v25, v25
v_exp_f32 v26, v26
v_exp_f32 v27, v27
v_exp_f32 v28, v28
v_exp_f32 v29, v29
v_exp_f32 v30, v30
v_exp_f32 v31, v31
v_fma_f32 v32, v32, s43, -v250
v_fma_f32 v33, v33, s43, -v250
v_fma_f32 v34, v34, s43, -v250
v_fma_f32 v35, v35, s43, -v250
v_fma_f32 v36, v36, s43, -v250
v_fma_f32 v37, v37, s43, -v250
v_fma_f32 v38, v38, s43, -v250
v_fma_f32 v39, v39, s43, -v250
v_exp_f32 v32, v32
v_exp_f32 v33, v33
v_exp_f32 v34, v34
v_exp_f32 v35, v35
v_exp_f32 v36, v36
v_exp_f32 v37, v37
v_exp_f32 v38, v38
v_exp_f32 v39, v39
v_fma_f32 v40, v40, s43, -v251
v_fma_f32 v41, v41, s43, -v251
v_fma_f32 v42, v42, s43, -v251
v_fma_f32 v43, v43, s43, -v251
v_fma_f32 v44, v44, s43, -v251
v_fma_f32 v45, v45, s43, -v251
v_fma_f32 v46, v46, s43, -v251
v_fma_f32 v47, v47, s43, -v251
v_exp_f32 v40, v40
v_exp_f32 v41, v41
v_exp_f32 v42, v42
v_exp_f32 v43, v43
v_exp_f32 v44, v44
v_exp_f32 v45, v45
v_exp_f32 v46, v46
v_exp_f32 v47, v47
s_barrier
ds_read_b128 v[224:227], v240 offset:49152
ds_read_b128 v[228:231], v241 offset:49152
ds_read_b128 v[232:235], v241 offset:50176
ds_read_b128 v[236:239], v240 offset:50176
ds_read_b128 v[216:219], v240 offset:51200
ds_read_b128 v[220:223], v241 offset:51200
s_waitcnt lgkmcnt(5)
v_mfma_f32_16x16x32_bf16 v[48:51], v[224:227], v[192:195], v[48:51]
s_waitcnt lgkmcnt(4)
v_mfma_f32_16x16x32_bf16 v[48:51], v[228:231], v[204:207], v[48:51]
v_mfma_f32_16x16x32_bf16 v[56:59], v[228:231], v[208:211], v[56:59]
v_mfma_f32_16x16x32_bf16 v[56:59], v[224:227], v[196:199], v[56:59]
v_mfma_f32_16x16x32_bf16 v[64:67], v[224:227], v[200:203], v[64:67]
ds_read_b128 v[224:227], v241 offset:52224
v_mfma_f32_16x16x32_bf16 v[64:67], v[228:231], v[212:215], v[64:67]
ds_read_b128 v[228:231], v240 offset:52224
s_waitcnt lgkmcnt(5)
v_mfma_f32_16x16x32_bf16 v[68:71], v[232:235], v[212:215], v[68:71]
s_waitcnt lgkmcnt(4)
v_mfma_f32_16x16x32_bf16 v[68:71], v[236:239], v[200:203], v[68:71]
v_mfma_f32_16x16x32_bf16 v[60:63], v[236:239], v[196:199], v[60:63]
v_mfma_f32_16x16x32_bf16 v[60:63], v[232:235], v[208:211], v[60:63]
v_mfma_f32_16x16x32_bf16 v[52:55], v[232:235], v[204:207], v[52:55]
v_mfma_f32_16x16x32_bf16 v[52:55], v[236:239], v[192:195], v[52:55]
s_waitcnt lgkmcnt(3)
v_mfma_f32_16x16x32_bf16 v[72:75], v[216:219], v[192:195], v[72:75]
s_waitcnt lgkmcnt(2)
v_mfma_f32_16x16x32_bf16 v[72:75], v[220:223], v[204:207], v[72:75]
v_mfma_f32_16x16x32_bf16 v[80:83], v[220:223], v[208:211], v[80:83]
v_max_f32 v252, v48, v49
v_max_f32 v253, v56, v57
v_mfma_f32_16x16x32_bf16 v[80:83], v[216:219], v[196:199], v[80:83]
v_max_f32 v254, v64, v65
v_max3_f32 v252, v252, v50, v51
v_mfma_f32_16x16x32_bf16 v[88:91], v[216:219], v[200:203], v[88:91]
v_max3_f32 v253, v253, v58, v59
v_max3_f32 v254, v254, v66, v67
v_mfma_f32_16x16x32_bf16 v[88:91], v[220:223], v[212:215], v[88:91]
v_max3_f32 v252, v252, v52, v53
v_max3_f32 v253, v253, v60, v61
s_waitcnt lgkmcnt(1)
v_mfma_f32_16x16x32_bf16 v[92:95], v[224:227], v[212:215], v[92:95]
v_max3_f32 v254, v254, v68, v69
v_max3_f32 v252, v252, v54, v55
s_waitcnt lgkmcnt(0)
v_mfma_f32_16x16x32_bf16 v[92:95], v[228:231], v[200:203], v[92:95]
v_max3_f32 v253, v253, v62, v63
v_max3_f32 v254, v254, v70, v71
v_mfma_f32_16x16x32_bf16 v[84:87], v[228:231], v[196:199], v[84:87]
v_mfma_f32_16x16x32_bf16 v[84:87], v[224:227], v[208:211], v[84:87]
v_mfma_f32_16x16x32_bf16 v[76:79], v[224:227], v[204:207], v[76:79]
v_mfma_f32_16x16x32_bf16 v[76:79], v[228:231], v[192:195], v[76:79]
v_max3_f32 v252, v252, v72, v73
v_max3_f32 v253, v253, v80, v81
v_max3_f32 v254, v254, v88, v89
v_max3_f32 v252, v252, v74, v75
v_max3_f32 v253, v253, v82, v83
v_max3_f32 v254, v254, v90, v91
s_nop 1
v_max3_f32 v252, v252, v76, v77
v_max3_f32 v253, v253, v84, v85
v_max3_f32 v254, v254, v92, v93
v_max3_f32 v252, v252, v78, v79
v_max3_f32 v253, v253, v86, v87
v_max3_f32 v254, v254, v94, v95
v_mul_f32 v252, s43, v252
v_mul_f32 v253, s43, v253
v_mul_f32 v254, s43, v254
v_fma_f32 v48, v48, s43, -v252
v_fma_f32 v49, v49, s43, -v252
v_fma_f32 v50, v50, s43, -v252
v_fma_f32 v51, v51, s43, -v252
v_fma_f32 v52, v52, s43, -v252
v_fma_f32 v53, v53, s43, -v252
v_fma_f32 v54, v54, s43, -v252
v_fma_f32 v55, v55, s43, -v252
v_exp_f32 v48, v48
v_exp_f32 v49, v49
v_exp_f32 v50, v50
v_exp_f32 v51, v51
v_exp_f32 v52, v52
v_exp_f32 v53, v53
v_exp_f32 v54, v54
v_exp_f32 v55, v55
v_fma_f32 v56, v56, s43, -v253
v_fma_f32 v57, v57, s43, -v253
v_fma_f32 v58, v58, s43, -v253
v_fma_f32 v59, v59, s43, -v253
v_fma_f32 v60, v60, s43, -v253
v_fma_f32 v61, v61, s43, -v253
v_fma_f32 v62, v62, s43, -v253
v_fma_f32 v63, v63, s43, -v253
v_exp_f32 v56, v56
v_exp_f32 v57, v57
v_exp_f32 v58, v58
v_exp_f32 v59, v59
v_exp_f32 v60, v60
v_exp_f32 v61, v61
v_exp_f32 v62, v62
v_exp_f32 v63, v63
v_fma_f32 v64, v64, s43, -v254
v_fma_f32 v65, v65, s43, -v254
v_fma_f32 v66, v66, s43, -v254
v_fma_f32 v67, v67, s43, -v254
v_fma_f32 v68, v68, s43, -v254
v_fma_f32 v69, v69, s43, -v254
v_fma_f32 v70, v70, s43, -v254
v_fma_f32 v71, v71, s43, -v254
v_exp_f32 v64, v64
v_exp_f32 v65, v65
v_exp_f32 v66, v66
v_exp_f32 v67, v67
v_exp_f32 v68, v68
v_exp_f32 v69, v69
v_exp_f32 v70, v70
s_barrier
v_xor_b32 v240, 0x10000, v240
ds_read_b128 v[232:235], v240
v_xor_b32 v241, 0x10000, v241
ds_read_b128 v[236:239], v241
ds_read_b128 v[216:219], v241 offset:1024
ds_read_b128 v[220:223], v240 offset:1024
ds_read_b128 v[224:227], v240 offset:2048
ds_read_b128 v[228:231], v241 offset:2048
v_exp_f32 v71, v71
v_fma_f32 v72, v72, s43, -v252
v_fma_f32 v73, v73, s43, -v252
v_fma_f32 v74, v74, s43, -v252
v_fma_f32 v75, v75, s43, -v252
v_fma_f32 v76, v76, s43, -v252
v_fma_f32 v77, v77, s43, -v252
v_fma_f32 v78, v78, s43, -v252
v_fma_f32 v79, v79, s43, -v252
v_exp_f32 v72, v72
v_exp_f32 v73, v73
v_exp_f32 v74, v74
s_waitcnt lgkmcnt(5)
v_mfma_f32_16x16x32_bf16 v[96:99], v[232:235], v[192:195], v[96:99]
v_exp_f32 v75, v75
s_waitcnt lgkmcnt(4)
v_mfma_f32_16x16x32_bf16 v[96:99], v[236:239], v[204:207], v[96:99]
v_exp_f32 v76, v76
v_mfma_f32_16x16x32_bf16 v[104:107], v[236:239], v[208:211], v[104:107]
v_exp_f32 v77, v77
v_mfma_f32_16x16x32_bf16 v[104:107], v[232:235], v[196:199], v[104:107]
v_exp_f32 v78, v78
v_mfma_f32_16x16x32_bf16 v[112:115], v[232:235], v[200:203], v[112:115]
ds_read_b128 v[232:235], v241 offset:3072
v_exp_f32 v79, v79
v_mfma_f32_16x16x32_bf16 v[112:115], v[236:239], v[212:215], v[112:115]
ds_read_b128 v[236:239], v240 offset:3072
v_fma_f32 v80, v80, s43, -v253
s_waitcnt lgkmcnt(5)
v_mfma_f32_16x16x32_bf16 v[116:119], v[216:219], v[212:215], v[116:119]
v_fma_f32 v81, v81, s43, -v253
v_fma_f32 v82, v82, s43, -v253
s_waitcnt lgkmcnt(4)
v_mfma_f32_16x16x32_bf16 v[116:119], v[220:223], v[200:203], v[116:119]
v_fma_f32 v83, v83, s43, -v253
v_fma_f32 v84, v84, s43, -v253
v_mfma_f32_16x16x32_bf16 v[108:111], v[220:223], v[196:199], v[108:111]
v_fma_f32 v85, v85, s43, -v253
v_fma_f32 v86, v86, s43, -v253
v_mfma_f32_16x16x32_bf16 v[108:111], v[216:219], v[208:211], v[108:111]
v_fma_f32 v87, v87, s43, -v253
v_exp_f32 v80, v80
v_mfma_f32_16x16x32_bf16 v[100:103], v[216:219], v[204:207], v[100:103]
v_exp_f32 v81, v81
v_mfma_f32_16x16x32_bf16 v[100:103], v[220:223], v[192:195], v[100:103]
v_exp_f32 v82, v82
s_waitcnt lgkmcnt(3)
v_mfma_f32_16x16x32_bf16 v[120:123], v[224:227], v[192:195], v[120:123]
v_exp_f32 v83, v83
s_waitcnt lgkmcnt(2)
v_mfma_f32_16x16x32_bf16 v[120:123], v[228:231], v[204:207], v[120:123]
v_exp_f32 v84, v84
v_mfma_f32_16x16x32_bf16 v[128:131], v[228:231], v[208:211], v[128:131]
v_exp_f32 v85, v85
v_mfma_f32_16x16x32_bf16 v[128:131], v[224:227], v[196:199], v[128:131]
v_exp_f32 v86, v86
v_mfma_f32_16x16x32_bf16 v[136:139], v[224:227], v[200:203], v[136:139]
v_exp_f32 v87, v87
v_mfma_f32_16x16x32_bf16 v[136:139], v[228:231], v[212:215], v[136:139]
v_fma_f32 v88, v88, s43, -v254
v_fma_f32 v89, v89, s43, -v254
s_waitcnt lgkmcnt(1)
v_mfma_f32_16x16x32_bf16 v[140:143], v[232:235], v[212:215], v[140:143]
v_fma_f32 v90, v90, s43, -v254
v_fma_f32 v91, v91, s43, -v254
s_waitcnt lgkmcnt(0)
v_mfma_f32_16x16x32_bf16 v[140:143], v[236:239], v[200:203], v[140:143]
v_fma_f32 v92, v92, s43, -v254
v_fma_f32 v93, v93, s43, -v254
v_mfma_f32_16x16x32_bf16 v[132:135], v[236:239], v[196:199], v[132:135]
v_fma_f32 v94, v94, s43, -v254
v_fma_f32 v95, v95, s43, -v254
v_mfma_f32_16x16x32_bf16 v[132:135], v[232:235], v[208:211], v[132:135]
v_exp_f32 v88, v88
s_barrier
v_mfma_f32_16x16x32_bf16 v[124:127], v[232:235], v[204:207], v[124:127]
v_exp_f32 v89, v89
v_mfma_f32_16x16x32_bf16 v[124:127], v[236:239], v[192:195], v[124:127]
v_exp_f32 v90, v90
v_exp_f32 v91, v91
v_exp_f32 v92, v92
v_exp_f32 v93, v93
v_exp_f32 v94, v94
v_exp_f32 v95, v95
v_max_f32 v245, v96, v97
v_max_f32 v246, v104, v105
v_max_f32 v247, v112, v113
v_max3_f32 v245, v245, v98, v99
v_max3_f32 v246, v246, v106, v107
v_max3_f32 v247, v247, v114, v115
v_max3_f32 v245, v245, v100, v101
v_max3_f32 v246, v246, v108, v109
v_max3_f32 v247, v247, v116, v117
v_max3_f32 v245, v245, v102, v103
v_max3_f32 v246, v246, v110, v111
v_max3_f32 v247, v247, v118, v119
v_max3_f32 v245, v245, v120, v121
v_max3_f32 v246, v246, v128, v129
v_max3_f32 v247, v247, v136, v137
v_max3_f32 v245, v245, v122, v123
v_max3_f32 v246, v246, v130, v131
v_max3_f32 v247, v247, v138, v139
v_max3_f32 v245, v245, v124, v125
v_max3_f32 v246, v246, v132, v133
v_max3_f32 v247, v247, v140, v141
v_max3_f32 v245, v245, v126, v127
v_max3_f32 v246, v246, v134, v135
v_max3_f32 v247, v247, v142, v143
s_barrier
v_xor_b32 v240, 0x10000, v240
ds_read_b128 v[216:219], v240 offset:16384
v_xor_b32 v241, 0x10000, v241
ds_read_b128 v[220:223], v241 offset:16384
ds_read_b128 v[224:227], v241 offset:17408
ds_read_b128 v[228:231], v240 offset:17408
ds_read_b128 v[232:235], v240 offset:18432
ds_read_b128 v[236:239], v241 offset:18432
s_waitcnt lgkmcnt(5)
v_mfma_f32_16x16x32_bf16 v[144:147], v[216:219], v[192:195], v[144:147]
s_waitcnt lgkmcnt(4)
v_mfma_f32_16x16x32_bf16 v[144:147], v[220:223], v[204:207], v[144:147]
v_mfma_f32_16x16x32_bf16 v[152:155], v[220:223], v[208:211], v[152:155]
v_mfma_f32_16x16x32_bf16 v[152:155], v[216:219], v[196:199], v[152:155]
v_mfma_f32_16x16x32_bf16 v[160:163], v[216:219], v[200:203], v[160:163]
ds_read_b128 v[216:219], v241 offset:19456
v_mfma_f32_16x16x32_bf16 v[160:163], v[220:223], v[212:215], v[160:163]
ds_read_b128 v[220:223], v240 offset:19456
s_waitcnt lgkmcnt(5)
v_mfma_f32_16x16x32_bf16 v[164:167], v[224:227], v[212:215], v[164:167]
s_waitcnt lgkmcnt(4)
v_mfma_f32_16x16x32_bf16 v[164:167], v[228:231], v[200:203], v[164:167]
v_mfma_f32_16x16x32_bf16 v[156:159], v[228:231], v[196:199], v[156:159]
v_mfma_f32_16x16x32_bf16 v[156:159], v[224:227], v[208:211], v[156:159]
v_mfma_f32_16x16x32_bf16 v[148:151], v[224:227], v[204:207], v[148:151]
v_mfma_f32_16x16x32_bf16 v[148:151], v[228:231], v[192:195], v[148:151]
s_waitcnt lgkmcnt(3)
v_mfma_f32_16x16x32_bf16 v[168:171], v[232:235], v[192:195], v[168:171]
s_waitcnt lgkmcnt(2)
v_mfma_f32_16x16x32_bf16 v[168:171], v[236:239], v[204:207], v[168:171]
v_mfma_f32_16x16x32_bf16 v[176:179], v[236:239], v[208:211], v[176:179]
v_max3_f32 v245, v245, v144, v145
v_max3_f32 v246, v246, v152, v153
v_mfma_f32_16x16x32_bf16 v[176:179], v[232:235], v[196:199], v[176:179]
v_max3_f32 v247, v247, v160, v161
v_max3_f32 v245, v245, v146, v147
v_mfma_f32_16x16x32_bf16 v[184:187], v[232:235], v[200:203], v[184:187]
v_max3_f32 v246, v246, v154, v155
v_max3_f32 v247, v247, v162, v163
v_mfma_f32_16x16x32_bf16 v[184:187], v[236:239], v[212:215], v[184:187]
v_max3_f32 v245, v245, v148, v149
v_max3_f32 v246, v246, v156, v157
s_waitcnt lgkmcnt(1)
v_mfma_f32_16x16x32_bf16 v[188:191], v[216:219], v[212:215], v[188:191]
v_max3_f32 v247, v247, v164, v165
v_max3_f32 v245, v245, v150, v151
s_waitcnt lgkmcnt(0)
v_mfma_f32_16x16x32_bf16 v[188:191], v[220:223], v[200:203], v[188:191]
v_max3_f32 v246, v246, v158, v159
v_max3_f32 v247, v247, v166, v167
v_mfma_f32_16x16x32_bf16 v[180:183], v[220:223], v[196:199], v[180:183]
v_mfma_f32_16x16x32_bf16 v[180:183], v[216:219], v[208:211], v[180:183]
v_mfma_f32_16x16x32_bf16 v[172:175], v[216:219], v[204:207], v[172:175]
v_mfma_f32_16x16x32_bf16 v[172:175], v[220:223], v[192:195], v[172:175]
v_max3_f32 v245, v245, v168, v169
v_max3_f32 v246, v246, v176, v177
v_max3_f32 v247, v247, v184, v185
v_max3_f32 v245, v245, v170, v171
v_max3_f32 v246, v246, v178, v179
v_max3_f32 v247, v247, v186, v187
s_nop 1
v_max3_f32 v245, v245, v172, v173
v_max3_f32 v246, v246, v180, v181
v_max3_f32 v247, v247, v188, v189
v_max3_f32 v245, v245, v174, v175
v_max3_f32 v246, v246, v182, v183
v_max3_f32 v247, v247, v190, v191
v_mul_f32 v240, s43, v245
v_mul_f32 v241, s43, v246
v_mul_f32 v242, s43, v247
v_max_f32 v240, v240, v249
v_max_f32 v241, v241, v250
v_max_f32 v242, v242, v251
v_max_f32 v240, v240, v252
v_max_f32 v241, v241, v253
v_max_f32 v242, v242, v254
v_mov_b32 v192, v240
v_mov_b32 v193, v241
v_mov_b32 v194, v242
v_permlane32_swap_b32 v192, v240
v_permlane32_swap_b32 v193, v241
v_permlane32_swap_b32 v194, v242
v_max_f32 v240, v240, v192
v_max_f32 v241, v241, v193
v_max_f32 v242, v242, v194
v_mov_b32 v192, v240
v_mov_b32 v193, v241
v_mov_b32 v194, v242
v_permlane16_swap_b32 v192, v240
v_permlane16_swap_b32 v193, v241
v_permlane16_swap_b32 v194, v242
v_max_f32 v240, v240, v192
v_max_f32 v241, v241, v193
v_max_f32 v242, v242, v194
ds_write_b128 v243, v[240:243] offset:6144
v_xor_b32 v245, 32, v244
v_xor_b32 v246, 8192, v244
v_xor_b32 v247, 8224, v244
s_waitcnt lgkmcnt(0)
s_barrier
ds_read_b128 v[192:195], v248 offset:6144
s_waitcnt lgkmcnt(0)
v_max_f32 v240, v240, v192
v_max_f32 v241, v241, v193
v_max_f32 v242, v242, v194
v_sub_f32 v249, v249, v240
v_sub_f32 v250, v250, v241
v_sub_f32 v251, v251, v242
v_exp_f32 v249, v249
v_exp_f32 v250, v250
v_exp_f32 v251, v251
v_sub_f32 v252, v252, v240
v_sub_f32 v253, v253, v241
v_sub_f32 v254, v254, v242
v_exp_f32 v252, v252
v_exp_f32 v253, v253
v_exp_f32 v254, v254
v_mul_f32 v0, v0, v249
v_mul_f32 v1, v1, v249
v_mul_f32 v2, v2, v249
v_mul_f32 v3, v3, v249
v_mul_f32 v4, v4, v249
v_mul_f32 v5, v5, v249
v_mul_f32 v6, v6, v249
v_mul_f32 v7, v7, v249
v_cvt_pk_bf16_f32 v0, v0, v1
v_cvt_pk_bf16_f32 v1, v2, v3
v_cvt_pk_bf16_f32 v2, v4, v5
v_cvt_pk_bf16_f32 v3, v6, v7
v_mul_f32 v8, v8, v250
v_mul_f32 v9, v9, v250
v_mul_f32 v10, v10, v250
v_mul_f32 v11, v11, v250
v_mul_f32 v12, v12, v250
v_mul_f32 v13, v13, v250
v_mul_f32 v14, v14, v250
v_mul_f32 v15, v15, v250
v_cvt_pk_bf16_f32 v8, v8, v9
v_cvt_pk_bf16_f32 v9, v10, v11
v_cvt_pk_bf16_f32 v10, v12, v13
v_cvt_pk_bf16_f32 v11, v14, v15
ds_write_b128 v243, v[0:3]
v_mul_f32 v16, v16, v251
v_mul_f32 v17, v17, v251
v_mul_f32 v18, v18, v251
v_mul_f32 v19, v19, v251
v_mul_f32 v20, v20, v251
v_mul_f32 v21, v21, v251
v_mul_f32 v22, v22, v251
v_mul_f32 v23, v23, v251
v_cvt_pk_bf16_f32 v16, v16, v17
v_cvt_pk_bf16_f32 v17, v18, v19
v_cvt_pk_bf16_f32 v18, v20, v21
v_cvt_pk_bf16_f32 v19, v22, v23
ds_write_b128 v243, v[8:11] offset:1024
v_mul_f32 v24, v24, v249
v_mul_f32 v25, v25, v249
v_mul_f32 v26, v26, v249
v_mul_f32 v27, v27, v249
v_mul_f32 v28, v28, v249
v_mul_f32 v29, v29, v249
v_mul_f32 v30, v30, v249
v_mul_f32 v31, v31, v249
v_cvt_pk_bf16_f32 v24, v24, v25
v_cvt_pk_bf16_f32 v25, v26, v27
v_cvt_pk_bf16_f32 v26, v28, v29
v_cvt_pk_bf16_f32 v27, v30, v31
ds_write_b128 v243, v[16:19] offset:2048
v_mul_f32 v32, v32, v250
v_mul_f32 v33, v33, v250
v_mul_f32 v34, v34, v250
v_mul_f32 v35, v35, v250
v_mul_f32 v36, v36, v250
v_mul_f32 v37, v37, v250
v_mul_f32 v38, v38, v250
v_mul_f32 v39, v39, v250
v_cvt_pk_bf16_f32 v32, v32, v33
v_cvt_pk_bf16_f32 v33, v34, v35
v_cvt_pk_bf16_f32 v34, v36, v37
v_cvt_pk_bf16_f32 v35, v38, v39
s_waitcnt lgkmcnt(0)
s_barrier
ds_read_b128 v[4:7], v248
ds_read_b128 v[12:15], v248 offset:1024
v_mul_f32 v40, v40, v251
v_mul_f32 v41, v41, v251
v_mul_f32 v42, v42, v251
ds_read_b128 v[20:23], v248 offset:2048
v_mul_f32 v43, v43, v251
v_mul_f32 v44, v44, v251
v_mul_f32 v45, v45, v251
ds_write_b128 v243, v[24:27] offset:3072
v_mul_f32 v46, v46, v251
v_mul_f32 v47, v47, v251
v_cvt_pk_bf16_f32 v40, v40, v41
v_cvt_pk_bf16_f32 v41, v42, v43
v_cvt_pk_bf16_f32 v42, v44, v45
v_cvt_pk_bf16_f32 v43, v46, v47
ds_write_b128 v243, v[32:35] offset:4096
v_mul_f32 v48, v48, v252
v_mul_f32 v49, v49, v252
v_mul_f32 v50, v50, v252
v_mul_f32 v51, v51, v252
v_mul_f32 v52, v52, v252
v_mul_f32 v53, v53, v252
v_mul_f32 v54, v54, v252
v_mul_f32 v55, v55, v252
v_cvt_pk_bf16_f32 v48, v48, v49
v_cvt_pk_bf16_f32 v49, v50, v51
v_cvt_pk_bf16_f32 v50, v52, v53
v_cvt_pk_bf16_f32 v51, v54, v55
ds_write_b128 v243, v[40:43] offset:5120
v_mul_f32 v56, v56, v253
v_mul_f32 v57, v57, v253
v_mul_f32 v58, v58, v253
v_mul_f32 v59, v59, v253
v_mul_f32 v60, v60, v253
v_mul_f32 v61, v61, v253
v_mul_f32 v62, v62, v253
v_mul_f32 v63, v63, v253
v_cvt_pk_bf16_f32 v56, v56, v57
v_cvt_pk_bf16_f32 v57, v58, v59
v_cvt_pk_bf16_f32 v58, v60, v61
v_cvt_pk_bf16_f32 v59, v62, v63
s_waitcnt lgkmcnt(0)
s_barrier
ds_read_b128 v[28:31], v248 offset:3072
ds_read_b128 v[36:39], v248 offset:4096
v_mul_f32 v64, v64, v254
v_mul_f32 v65, v65, v254
v_mul_f32 v66, v66, v254
ds_read_b128 v[44:47], v248 offset:5120
v_mul_f32 v67, v67, v254
v_mul_f32 v68, v68, v254
v_mul_f32 v69, v69, v254
ds_write_b128 v243, v[48:51]
v_mul_f32 v70, v70, v254
v_mul_f32 v71, v71, v254
v_cvt_pk_bf16_f32 v64, v64, v65
v_cvt_pk_bf16_f32 v65, v66, v67
v_cvt_pk_bf16_f32 v66, v68, v69
v_cvt_pk_bf16_f32 v67, v70, v71
ds_write_b128 v243, v[56:59] offset:1024
v_mul_f32 v72, v72, v252
v_mul_f32 v73, v73, v252
v_mul_f32 v74, v74, v252
v_mul_f32 v75, v75, v252
v_mul_f32 v76, v76, v252
v_mul_f32 v77, v77, v252
v_mul_f32 v78, v78, v252
v_mul_f32 v79, v79, v252
v_cvt_pk_bf16_f32 v72, v72, v73
v_cvt_pk_bf16_f32 v73, v74, v75
v_cvt_pk_bf16_f32 v74, v76, v77
v_cvt_pk_bf16_f32 v75, v78, v79
ds_write_b128 v243, v[64:67] offset:2048
v_mul_f32 v80, v80, v253
v_mul_f32 v81, v81, v253
v_mul_f32 v82, v82, v253
v_mul_f32 v83, v83, v253
v_mul_f32 v84, v84, v253
v_mul_f32 v85, v85, v253
v_mul_f32 v86, v86, v253
v_mul_f32 v87, v87, v253
v_cvt_pk_bf16_f32 v80, v80, v81
v_cvt_pk_bf16_f32 v81, v82, v83
v_cvt_pk_bf16_f32 v82, v84, v85
v_cvt_pk_bf16_f32 v83, v86, v87
s_waitcnt lgkmcnt(0)
s_barrier
ds_read_b128 v[52:55], v248
ds_read_b128 v[60:63], v248 offset:1024
v_mul_f32 v88, v88, v254
v_mul_f32 v89, v89, v254
v_mul_f32 v90, v90, v254
ds_read_b128 v[68:71], v248 offset:2048
v_mul_f32 v91, v91, v254
v_mul_f32 v92, v92, v254
v_mul_f32 v93, v93, v254
ds_write_b128 v243, v[72:75] offset:3072
v_mul_f32 v94, v94, v254
v_mul_f32 v95, v95, v254
v_cvt_pk_bf16_f32 v88, v88, v89
v_cvt_pk_bf16_f32 v89, v90, v91
v_cvt_pk_bf16_f32 v90, v92, v93
v_cvt_pk_bf16_f32 v91, v94, v95
ds_write_b128 v243, v[80:83] offset:4096
v_fma_f32 v96, v96, s43, -v240
v_fma_f32 v97, v97, s43, -v240
v_fma_f32 v98, v98, s43, -v240
v_fma_f32 v99, v99, s43, -v240
v_fma_f32 v100, v100, s43, -v240
v_fma_f32 v101, v101, s43, -v240
v_fma_f32 v102, v102, s43, -v240
v_fma_f32 v103, v103, s43, -v240
v_exp_f32 v96, v96
v_exp_f32 v97, v97
v_exp_f32 v98, v98
v_exp_f32 v99, v99
v_exp_f32 v100, v100
v_exp_f32 v101, v101
v_exp_f32 v102, v102
v_exp_f32 v103, v103
v_cvt_pk_bf16_f32 v96, v96, v97
v_cvt_pk_bf16_f32 v97, v98, v99
v_cvt_pk_bf16_f32 v98, v100, v101
v_cvt_pk_bf16_f32 v99, v102, v103
ds_write_b128 v243, v[88:91] offset:5120
v_fma_f32 v104, v104, s43, -v241
v_fma_f32 v105, v105, s43, -v241
v_fma_f32 v106, v106, s43, -v241
v_fma_f32 v107, v107, s43, -v241
v_fma_f32 v108, v108, s43, -v241
v_fma_f32 v109, v109, s43, -v241
v_fma_f32 v110, v110, s43, -v241
v_fma_f32 v111, v111, s43, -v241
v_exp_f32 v104, v104
v_exp_f32 v105, v105
v_exp_f32 v106, v106
v_exp_f32 v107, v107
v_exp_f32 v108, v108
v_exp_f32 v109, v109
v_exp_f32 v110, v110
v_exp_f32 v111, v111
v_cvt_pk_bf16_f32 v104, v104, v105
v_cvt_pk_bf16_f32 v105, v106, v107
v_cvt_pk_bf16_f32 v106, v108, v109
v_cvt_pk_bf16_f32 v107, v110, v111
s_waitcnt lgkmcnt(0)
s_barrier
ds_read_b128 v[76:79], v248 offset:3072
ds_read_b128 v[84:87], v248 offset:4096
v_fma_f32 v112, v112, s43, -v242
v_fma_f32 v113, v113, s43, -v242
v_fma_f32 v114, v114, s43, -v242
ds_read_b128 v[92:95], v248 offset:5120
v_fma_f32 v115, v115, s43, -v242
v_fma_f32 v116, v116, s43, -v242
v_fma_f32 v117, v117, s43, -v242
v_fma_f32 v118, v118, s43, -v242
v_fma_f32 v119, v119, s43, -v242
v_exp_f32 v112, v112
v_exp_f32 v113, v113
ds_write_b128 v243, v[96:99]
v_exp_f32 v114, v114
v_exp_f32 v115, v115
v_exp_f32 v116, v116
v_exp_f32 v117, v117
v_exp_f32 v118, v118
v_exp_f32 v119, v119
v_cvt_pk_bf16_f32 v112, v112, v113
v_cvt_pk_bf16_f32 v113, v114, v115
v_cvt_pk_bf16_f32 v114, v116, v117
v_cvt_pk_bf16_f32 v115, v118, v119
ds_write_b128 v243, v[104:107] offset:1024
v_fma_f32 v120, v120, s43, -v240
v_fma_f32 v121, v121, s43, -v240
v_fma_f32 v122, v122, s43, -v240
v_fma_f32 v123, v123, s43, -v240
v_fma_f32 v124, v124, s43, -v240
v_fma_f32 v125, v125, s43, -v240
v_fma_f32 v126, v126, s43, -v240
v_fma_f32 v127, v127, s43, -v240
v_exp_f32 v120, v120
v_exp_f32 v121, v121
v_exp_f32 v122, v122
v_exp_f32 v123, v123
v_exp_f32 v124, v124
v_exp_f32 v125, v125
v_exp_f32 v126, v126
v_exp_f32 v127, v127
v_cvt_pk_bf16_f32 v120, v120, v121
v_cvt_pk_bf16_f32 v121, v122, v123
v_cvt_pk_bf16_f32 v122, v124, v125
v_cvt_pk_bf16_f32 v123, v126, v127
ds_write_b128 v243, v[112:115] offset:2048
v_fma_f32 v128, v128, s43, -v241
v_fma_f32 v129, v129, s43, -v241
v_fma_f32 v130, v130, s43, -v241
v_fma_f32 v131, v131, s43, -v241
v_fma_f32 v132, v132, s43, -v241
v_fma_f32 v133, v133, s43, -v241
v_fma_f32 v134, v134, s43, -v241
v_fma_f32 v135, v135, s43, -v241
v_exp_f32 v128, v128
v_exp_f32 v129, v129
v_exp_f32 v130, v130
v_exp_f32 v131, v131
v_exp_f32 v132, v132
v_exp_f32 v133, v133
v_exp_f32 v134, v134
v_exp_f32 v135, v135
v_cvt_pk_bf16_f32 v128, v128, v129
v_cvt_pk_bf16_f32 v129, v130, v131
v_cvt_pk_bf16_f32 v130, v132, v133
v_cvt_pk_bf16_f32 v131, v134, v135
s_waitcnt lgkmcnt(0)
s_barrier
ds_read_b128 v[100:103], v248
ds_read_b128 v[108:111], v248 offset:1024
v_fma_f32 v136, v136, s43, -v242
v_fma_f32 v137, v137, s43, -v242
v_fma_f32 v138, v138, s43, -v242
ds_read_b128 v[116:119], v248 offset:2048
v_fma_f32 v139, v139, s43, -v242
v_fma_f32 v140, v140, s43, -v242
v_fma_f32 v141, v141, s43, -v242
v_fma_f32 v142, v142, s43, -v242
v_fma_f32 v143, v143, s43, -v242
v_exp_f32 v136, v136
v_exp_f32 v137, v137
ds_write_b128 v243, v[120:123] offset:3072
v_exp_f32 v138, v138
v_exp_f32 v139, v139
v_exp_f32 v140, v140
v_exp_f32 v141, v141
v_exp_f32 v142, v142
v_exp_f32 v143, v143
v_cvt_pk_bf16_f32 v136, v136, v137
v_cvt_pk_bf16_f32 v137, v138, v139
v_cvt_pk_bf16_f32 v138, v140, v141
v_cvt_pk_bf16_f32 v139, v142, v143
ds_write_b128 v243, v[128:131] offset:4096
v_fma_f32 v144, v144, s43, -v240
v_fma_f32 v145, v145, s43, -v240
v_fma_f32 v146, v146, s43, -v240
v_fma_f32 v147, v147, s43, -v240
v_fma_f32 v148, v148, s43, -v240
v_fma_f32 v149, v149, s43, -v240
v_fma_f32 v150, v150, s43, -v240
v_fma_f32 v151, v151, s43, -v240
v_exp_f32 v144, v144
v_exp_f32 v145, v145
v_exp_f32 v146, v146
v_exp_f32 v147, v147
v_exp_f32 v148, v148
v_exp_f32 v149, v149
v_exp_f32 v150, v150
v_exp_f32 v151, v151
v_cvt_pk_bf16_f32 v144, v144, v145
v_cvt_pk_bf16_f32 v145, v146, v147
v_cvt_pk_bf16_f32 v146, v148, v149
v_cvt_pk_bf16_f32 v147, v150, v151
ds_write_b128 v243, v[136:139] offset:5120
v_fma_f32 v152, v152, s43, -v241
v_fma_f32 v153, v153, s43, -v241
v_fma_f32 v154, v154, s43, -v241
v_fma_f32 v155, v155, s43, -v241
v_fma_f32 v156, v156, s43, -v241
v_fma_f32 v157, v157, s43, -v241
v_fma_f32 v158, v158, s43, -v241
v_fma_f32 v159, v159, s43, -v241
v_exp_f32 v152, v152
v_exp_f32 v153, v153
v_exp_f32 v154, v154
v_exp_f32 v155, v155
v_exp_f32 v156, v156
v_exp_f32 v157, v157
v_exp_f32 v158, v158
v_exp_f32 v159, v159
v_cvt_pk_bf16_f32 v152, v152, v153
v_cvt_pk_bf16_f32 v153, v154, v155
v_cvt_pk_bf16_f32 v154, v156, v157
v_cvt_pk_bf16_f32 v155, v158, v159
s_waitcnt lgkmcnt(0)
s_barrier
ds_read_b128 v[124:127], v248 offset:3072
ds_read_b128 v[132:135], v248 offset:4096
v_fma_f32 v160, v160, s43, -v242
v_fma_f32 v161, v161, s43, -v242
v_fma_f32 v162, v162, s43, -v242
ds_read_b128 v[140:143], v248 offset:5120
v_fma_f32 v163, v163, s43, -v242
v_fma_f32 v164, v164, s43, -v242
v_fma_f32 v165, v165, s43, -v242
v_fma_f32 v166, v166, s43, -v242
v_fma_f32 v167, v167, s43, -v242
v_exp_f32 v160, v160
v_exp_f32 v161, v161
ds_write_b128 v243, v[144:147]
v_exp_f32 v162, v162
v_exp_f32 v163, v163
v_exp_f32 v164, v164
v_exp_f32 v165, v165
v_exp_f32 v166, v166
v_exp_f32 v167, v167
v_cvt_pk_bf16_f32 v160, v160, v161
v_cvt_pk_bf16_f32 v161, v162, v163
v_cvt_pk_bf16_f32 v162, v164, v165
v_cvt_pk_bf16_f32 v163, v166, v167
ds_write_b128 v243, v[152:155] offset:1024
v_fma_f32 v168, v168, s43, -v240
v_fma_f32 v169, v169, s43, -v240
v_fma_f32 v170, v170, s43, -v240
v_fma_f32 v171, v171, s43, -v240
v_fma_f32 v172, v172, s43, -v240
v_fma_f32 v173, v173, s43, -v240
v_fma_f32 v174, v174, s43, -v240
v_fma_f32 v175, v175, s43, -v240
v_exp_f32 v168, v168
v_exp_f32 v169, v169
v_exp_f32 v170, v170
v_exp_f32 v171, v171
v_exp_f32 v172, v172
v_exp_f32 v173, v173
v_exp_f32 v174, v174
v_exp_f32 v175, v175
v_cvt_pk_bf16_f32 v168, v168, v169
v_cvt_pk_bf16_f32 v169, v170, v171
v_cvt_pk_bf16_f32 v170, v172, v173
v_cvt_pk_bf16_f32 v171, v174, v175
ds_write_b128 v243, v[160:163] offset:2048
v_fma_f32 v176, v176, s43, -v241
v_fma_f32 v177, v177, s43, -v241
v_fma_f32 v178, v178, s43, -v241
v_fma_f32 v179, v179, s43, -v241
v_fma_f32 v180, v180, s43, -v241
v_fma_f32 v181, v181, s43, -v241
v_fma_f32 v182, v182, s43, -v241
v_fma_f32 v183, v183, s43, -v241
v_exp_f32 v176, v176
v_exp_f32 v177, v177
v_exp_f32 v178, v178
v_exp_f32 v179, v179
v_exp_f32 v180, v180
v_exp_f32 v181, v181
v_exp_f32 v182, v182
v_exp_f32 v183, v183
v_cvt_pk_bf16_f32 v176, v176, v177
v_cvt_pk_bf16_f32 v177, v178, v179
v_cvt_pk_bf16_f32 v178, v180, v181
v_cvt_pk_bf16_f32 v179, v182, v183
s_waitcnt lgkmcnt(0)
s_barrier
ds_read_b128 v[148:151], v248
ds_read_b128 v[156:159], v248 offset:1024
v_fma_f32 v184, v184, s43, -v242
v_fma_f32 v185, v185, s43, -v242
v_fma_f32 v186, v186, s43, -v242
ds_read_b128 v[164:167], v248 offset:2048
v_fma_f32 v187, v187, s43, -v242
v_fma_f32 v188, v188, s43, -v242
v_fma_f32 v189, v189, s43, -v242
v_fma_f32 v190, v190, s43, -v242
v_fma_f32 v191, v191, s43, -v242
v_exp_f32 v184, v184
v_exp_f32 v185, v185
ds_write_b128 v243, v[168:171] offset:3072
v_exp_f32 v186, v186
v_exp_f32 v187, v187
v_exp_f32 v188, v188
v_exp_f32 v189, v189
v_exp_f32 v190, v190
v_exp_f32 v191, v191
v_cvt_pk_bf16_f32 v184, v184, v185
v_cvt_pk_bf16_f32 v185, v186, v187
v_cvt_pk_bf16_f32 v186, v188, v189
v_cvt_pk_bf16_f32 v187, v190, v191
ds_write_b128 v243, v[176:179] offset:4096
ds_write_b128 v243, v[184:187] offset:5120
s_waitcnt lgkmcnt(0)
s_barrier
v_xor_b32 v244, 0x10000, v244
ds_read_b64_tr_b16 v[224:225], v244 offset:16384
ds_read_b64_tr_b16 v[226:227], v244 offset:17408
ds_read_b64_tr_b16 v[228:229], v244 offset:18432
ds_read_b64_tr_b16 v[230:231], v244 offset:19456
v_xor_b32 v245, 0x10000, v245
ds_read_b64_tr_b16 v[232:233], v245 offset:18432
ds_read_b64_tr_b16 v[234:235], v245 offset:19456
ds_read_b64_tr_b16 v[236:237], v245 offset:16384
ds_read_b64_tr_b16 v[238:239], v245 offset:17408
v_xor_b32 v247, 0x10000, v247
ds_read_b64_tr_b16 v[216:217], v247 offset:16384
ds_read_b64_tr_b16 v[218:219], v247 offset:17408
ds_read_b64_tr_b16 v[220:221], v247 offset:18432
ds_read_b64_tr_b16 v[222:223], v247 offset:19456
v_xor_b32 v246, 0x10000, v246
s_waitcnt lgkmcnt(10)
v_mfma_f32_16x16x32_bf16 v[192:195], v[224:227], v[0:3], 0
v_mbcnt_lo_u32_b32 v254, -1, 0
v_mbcnt_hi_u32_b32 v254, -1, v254
s_waitcnt lgkmcnt(8)
v_mfma_f32_16x16x32_bf16 v[192:195], v[228:231], v[24:27], v[192:195]
v_lshrrev_b32 v251, 3, v254
v_and_b32 v250, 6, v251
v_mfma_f32_16x16x32_bf16 v[196:199], v[228:231], v[32:35], 0
v_xor_b32 v254, v254, v250
v_and_b32 v254, 7, v254
v_mfma_f32_16x16x32_bf16 v[196:199], v[224:227], v[8:11], v[196:199]
s_lshl_b32 s44, s41, 5
v_add_u32 v250, s44, v251
v_mfma_f32_16x16x32_bf16 v[200:203], v[224:227], v[16:19], 0
ds_read_b64_tr_b16 v[224:225], v246 offset:18432
ds_read_b64_tr_b16 v[226:227], v246 offset:19456
v_mfma_f32_16x16x32_bf16 v[200:203], v[228:231], v[40:43], v[200:203]
ds_read_b64_tr_b16 v[228:229], v246 offset:16384
ds_read_b64_tr_b16 v[230:231], v246 offset:17408
s_waitcnt lgkmcnt(10)
v_mfma_f32_16x16x32_bf16 v[212:215], v[232:235], v[40:43], 0
ds_read_b128 v[172:175], v248 offset:3072
ds_read_b128 v[180:183], v248 offset:4096
s_waitcnt lgkmcnt(10)
v_mfma_f32_16x16x32_bf16 v[212:215], v[236:239], v[16:19], v[212:215]
ds_read_b128 v[188:191], v248 offset:5120
v_lshlrev_b32 v250, 9, v250
v_mfma_f32_16x16x32_bf16 v[208:211], v[236:239], v[8:11], 0
v_lshl_add_u32 v250, v254, 4, v250
s_and_b32 s44, s41, 1
v_mfma_f32_16x16x32_bf16 v[208:211], v[232:235], v[32:35], v[208:211]
s_lshl_b32 s44, s44, 5
v_add_u32 v251, s44, v251
v_mfma_f32_16x16x32_bf16 v[204:207], v[232:235], v[24:27], 0
s_lshr_b32 s44, s41, 1
s_lshl_b32 s44, s44, 8
v_mfma_f32_16x16x32_bf16 v[204:207], v[236:239], v[0:3], v[204:207]
v_add_u32 v251, s44, v251
v_mul_u32_u24 v251, 896, v251
s_waitcnt lgkmcnt(9)
v_mfma_f32_16x16x32_bf16 v[204:207], v[216:219], v[4:7], v[204:207]
v_lshl_add_u32 v251, v254, 4, v251
s_waitcnt lgkmcnt(7)
v_mfma_f32_16x16x32_bf16 v[204:207], v[220:223], v[28:31], v[204:207]
v_mfma_f32_16x16x32_bf16 v[208:211], v[220:223], v[36:39], v[208:211]
v_mfma_f32_16x16x32_bf16 v[208:211], v[216:219], v[12:15], v[208:211]
v_mfma_f32_16x16x32_bf16 v[212:215], v[216:219], v[20:23], v[212:215]
v_mfma_f32_16x16x32_bf16 v[212:215], v[220:223], v[44:47], v[212:215]
s_waitcnt lgkmcnt(5)
v_mfma_f32_16x16x32_bf16 v[200:203], v[224:227], v[44:47], v[200:203]
s_waitcnt lgkmcnt(3)
v_mfma_f32_16x16x32_bf16 v[200:203], v[228:231], v[20:23], v[200:203]
v_mfma_f32_16x16x32_bf16 v[196:199], v[228:231], v[12:15], v[196:199]
v_mfma_f32_16x16x32_bf16 v[196:199], v[224:227], v[36:39], v[196:199]
s_waitcnt lgkmcnt(0)
s_barrier
ds_read_b64_tr_b16 v[232:233], v244 offset:32768
ds_read_b64_tr_b16 v[234:235], v244 offset:33792
v_mfma_f32_16x16x32_bf16 v[192:195], v[224:227], v[28:31], v[192:195]
ds_read_b64_tr_b16 v[236:237], v244 offset:34816
ds_read_b64_tr_b16 v[238:239], v244 offset:35840
v_mfma_f32_16x16x32_bf16 v[192:195], v[228:231], v[4:7], v[192:195]
ds_read_b64_tr_b16 v[216:217], v245 offset:34816
ds_read_b64_tr_b16 v[218:219], v245 offset:35840
ds_read_b64_tr_b16 v[220:221], v245 offset:32768
ds_read_b64_tr_b16 v[222:223], v245 offset:33792
ds_read_b64_tr_b16 v[224:225], v247 offset:32768
ds_read_b64_tr_b16 v[226:227], v247 offset:33792
ds_read_b64_tr_b16 v[228:229], v247 offset:34816
ds_read_b64_tr_b16 v[230:231], v247 offset:35840
s_waitcnt lgkmcnt(10)
v_mfma_f32_16x16x32_bf16 v[192:195], v[232:235], v[48:51], v[192:195]
s_waitcnt lgkmcnt(8)
v_mfma_f32_16x16x32_bf16 v[192:195], v[236:239], v[72:75], v[192:195]
v_mfma_f32_16x16x32_bf16 v[196:199], v[236:239], v[80:83], v[196:199]
v_mfma_f32_16x16x32_bf16 v[196:199], v[232:235], v[56:59], v[196:199]
v_mfma_f32_16x16x32_bf16 v[200:203], v[232:235], v[64:67], v[200:203]
ds_read_b64_tr_b16 v[232:233], v246 offset:34816
ds_read_b64_tr_b16 v[234:235], v246 offset:35840
v_mfma_f32_16x16x32_bf16 v[200:203], v[236:239], v[88:91], v[200:203]
ds_read_b64_tr_b16 v[236:237], v246 offset:32768
ds_read_b64_tr_b16 v[238:239], v246 offset:33792
s_waitcnt lgkmcnt(10)
v_mfma_f32_16x16x32_bf16 v[212:215], v[216:219], v[88:91], v[212:215]
s_waitcnt lgkmcnt(8)
v_mfma_f32_16x16x32_bf16 v[212:215], v[220:223], v[64:67], v[212:215]
v_mfma_f32_16x16x32_bf16 v[208:211], v[220:223], v[56:59], v[208:211]
v_mfma_f32_16x16x32_bf16 v[208:211], v[216:219], v[80:83], v[208:211]
v_mfma_f32_16x16x32_bf16 v[204:207], v[216:219], v[72:75], v[204:207]
v_mfma_f32_16x16x32_bf16 v[204:207], v[220:223], v[48:51], v[204:207]
s_waitcnt lgkmcnt(6)
v_mfma_f32_16x16x32_bf16 v[204:207], v[224:227], v[52:55], v[204:207]
s_waitcnt lgkmcnt(4)
v_mfma_f32_16x16x32_bf16 v[204:207], v[228:231], v[76:79], v[204:207]
v_mfma_f32_16x16x32_bf16 v[208:211], v[228:231], v[84:87], v[208:211]
v_mfma_f32_16x16x32_bf16 v[208:211], v[224:227], v[60:63], v[208:211]
v_mfma_f32_16x16x32_bf16 v[212:215], v[224:227], v[68:71], v[212:215]
v_mfma_f32_16x16x32_bf16 v[212:215], v[228:231], v[92:95], v[212:215]
s_waitcnt lgkmcnt(2)
v_mfma_f32_16x16x32_bf16 v[200:203], v[232:235], v[92:95], v[200:203]
s_waitcnt lgkmcnt(0)
v_mfma_f32_16x16x32_bf16 v[200:203], v[236:239], v[68:71], v[200:203]
v_mfma_f32_16x16x32_bf16 v[196:199], v[236:239], v[60:63], v[196:199]
v_mfma_f32_16x16x32_bf16 v[196:199], v[232:235], v[84:87], v[196:199]
s_barrier
ds_read_b64_tr_b16 v[216:217], v244 offset:49152
ds_read_b64_tr_b16 v[218:219], v244 offset:50176
v_mfma_f32_16x16x32_bf16 v[192:195], v[232:235], v[76:79], v[192:195]
ds_read_b64_tr_b16 v[220:221], v244 offset:51200
ds_read_b64_tr_b16 v[222:223], v244 offset:52224
v_mfma_f32_16x16x32_bf16 v[192:195], v[236:239], v[52:55], v[192:195]
ds_read_b64_tr_b16 v[224:225], v245 offset:51200
ds_read_b64_tr_b16 v[226:227], v245 offset:52224
ds_read_b64_tr_b16 v[228:229], v245 offset:49152
ds_read_b64_tr_b16 v[230:231], v245 offset:50176
ds_read_b64_tr_b16 v[232:233], v247 offset:49152
ds_read_b64_tr_b16 v[234:235], v247 offset:50176
ds_read_b64_tr_b16 v[236:237], v247 offset:51200
ds_read_b64_tr_b16 v[238:239], v247 offset:52224
s_waitcnt lgkmcnt(10)
v_mfma_f32_16x16x32_bf16 v[192:195], v[216:219], v[96:99], v[192:195]
v_mbcnt_lo_u32_b32 v249, -1, 0
v_mbcnt_hi_u32_b32 v249, -1, v249
s_waitcnt lgkmcnt(8)
v_mfma_f32_16x16x32_bf16 v[192:195], v[220:223], v[120:123], v[192:195]
s_mul_i32 s44, s41, 7168
s_add_u32 s44, s44, 137216
v_mfma_f32_16x16x32_bf16 v[196:199], v[220:223], v[128:131], v[196:199]
v_lshl_add_u32 v249, v249, 2, s44
ds_read_b32 v240, v249
v_mfma_f32_16x16x32_bf16 v[196:199], v[216:219], v[104:107], v[196:199]
ds_read_b32 v241, v249 offset:256
ds_read_b32 v242, v249 offset:512
v_mfma_f32_16x16x32_bf16 v[200:203], v[216:219], v[112:115], v[200:203]
ds_read_b64_tr_b16 v[216:217], v246 offset:51200
ds_read_b64_tr_b16 v[218:219], v246 offset:52224
v_mfma_f32_16x16x32_bf16 v[200:203], v[220:223], v[136:139], v[200:203]
ds_read_b64_tr_b16 v[220:221], v246 offset:49152
ds_read_b64_tr_b16 v[222:223], v246 offset:50176
s_waitcnt lgkmcnt(13)
v_mfma_f32_16x16x32_bf16 v[212:215], v[224:227], v[136:139], v[212:215]
s_waitcnt lgkmcnt(11)
v_mfma_f32_16x16x32_bf16 v[212:215], v[228:231], v[112:115], v[212:215]
v_mfma_f32_16x16x32_bf16 v[208:211], v[228:231], v[104:107], v[208:211]
v_mfma_f32_16x16x32_bf16 v[208:211], v[224:227], v[128:131], v[208:211]
v_mfma_f32_16x16x32_bf16 v[204:207], v[224:227], v[120:123], v[204:207]
v_mfma_f32_16x16x32_bf16 v[204:207], v[228:231], v[96:99], v[204:207]
s_waitcnt lgkmcnt(9)
v_mfma_f32_16x16x32_bf16 v[204:207], v[232:235], v[100:103], v[204:207]
s_waitcnt lgkmcnt(7)
v_mfma_f32_16x16x32_bf16 v[204:207], v[236:239], v[124:127], v[204:207]
v_mfma_f32_16x16x32_bf16 v[208:211], v[236:239], v[132:135], v[208:211]
v_mfma_f32_16x16x32_bf16 v[208:211], v[232:235], v[108:111], v[208:211]
v_mfma_f32_16x16x32_bf16 v[212:215], v[232:235], v[116:119], v[212:215]
v_mfma_f32_16x16x32_bf16 v[212:215], v[236:239], v[140:143], v[212:215]
s_waitcnt lgkmcnt(2)
v_mfma_f32_16x16x32_bf16 v[200:203], v[216:219], v[140:143], v[200:203]
s_waitcnt lgkmcnt(0)
v_mfma_f32_16x16x32_bf16 v[200:203], v[220:223], v[116:119], v[200:203]
v_mfma_f32_16x16x32_bf16 v[196:199], v[220:223], v[108:111], v[196:199]
v_mfma_f32_16x16x32_bf16 v[196:199], v[216:219], v[132:135], v[196:199]
s_barrier
v_mfma_f32_16x16x32_bf16 v[192:195], v[216:219], v[124:127], v[192:195]
v_mfma_f32_16x16x32_bf16 v[192:195], v[220:223], v[100:103], v[192:195]
s_barrier
s_barrier
s_barrier
v_xor_b32 v244, 0x10000, v244
ds_read_b64_tr_b16 v[224:225], v244
ds_read_b64_tr_b16 v[226:227], v244 offset:1024
ds_read_b64_tr_b16 v[228:229], v244 offset:2048
ds_read_b64_tr_b16 v[230:231], v244 offset:3072
v_xor_b32 v246, 0x10000, v246
ds_read_b64_tr_b16 v[232:233], v246
ds_read_b64_tr_b16 v[234:235], v246 offset:1024
ds_read_b64_tr_b16 v[236:237], v246 offset:2048
ds_read_b64_tr_b16 v[238:239], v246 offset:3072
v_xor_b32 v247, 0x10000, v247
ds_read_b64_tr_b16 v[216:217], v247 offset:2048
ds_read_b64_tr_b16 v[218:219], v247 offset:3072
ds_read_b64_tr_b16 v[220:221], v247
ds_read_b64_tr_b16 v[222:223], v247 offset:1024
v_xor_b32 v245, 0x10000, v245
s_waitcnt lgkmcnt(10)
v_mfma_f32_16x16x32_bf16 v[192:195], v[224:227], v[144:147], v[192:195]
s_waitcnt lgkmcnt(8)
v_mfma_f32_16x16x32_bf16 v[192:195], v[228:231], v[168:171], v[192:195]
s_waitcnt lgkmcnt(6)
v_mfma_f32_16x16x32_bf16 v[192:195], v[232:235], v[148:151], v[192:195]
s_waitcnt lgkmcnt(4)
v_mfma_f32_16x16x32_bf16 v[192:195], v[236:239], v[172:175], v[192:195]
v_mfma_f32_16x16x32_bf16 v[196:199], v[236:239], v[180:183], v[196:199]
v_mfma_f32_16x16x32_bf16 v[196:199], v[232:235], v[156:159], v[196:199]
v_mfma_f32_16x16x32_bf16 v[196:199], v[228:231], v[176:179], v[196:199]
s_nop 4
v_mul_f32 v192, v192, v240
v_mul_f32 v193, v193, v240
v_mfma_f32_16x16x32_bf16 v[196:199], v[224:227], v[152:155], v[196:199]
v_mul_f32 v194, v194, v240
v_mul_f32 v195, v195, v240
v_mfma_f32_16x16x32_bf16 v[200:203], v[224:227], v[160:163], v[200:203]
ds_read_b64_tr_b16 v[224:225], v245 offset:2048
ds_read_b64_tr_b16 v[226:227], v245 offset:3072
v_mfma_f32_16x16x32_bf16 v[200:203], v[228:231], v[184:187], v[200:203]
ds_read_b64_tr_b16 v[228:229], v245
ds_read_b64_tr_b16 v[230:231], v245 offset:1024
v_mfma_f32_16x16x32_bf16 v[200:203], v[232:235], v[164:167], v[200:203]
v_cvt_pk_bf16_f32 v192, v192, v193
v_cvt_pk_bf16_f32 v193, v194, v195
v_mfma_f32_16x16x32_bf16 v[200:203], v[236:239], v[188:191], v[200:203]
v_mul_f32 v196, v196, v241
v_mul_f32 v197, v197, v241
s_waitcnt lgkmcnt(6)
v_mfma_f32_16x16x32_bf16 v[212:215], v[216:219], v[188:191], v[212:215]
v_mul_f32 v198, v198, v241
v_mul_f32 v199, v199, v241
s_waitcnt lgkmcnt(4)
v_mfma_f32_16x16x32_bf16 v[212:215], v[220:223], v[164:167], v[212:215]
v_cvt_pk_bf16_f32 v196, v196, v197
v_cvt_pk_bf16_f32 v197, v198, v199
s_waitcnt lgkmcnt(2)
v_mfma_f32_16x16x32_bf16 v[212:215], v[224:227], v[184:187], v[212:215]
v_mul_f32 v200, v200, v242
v_mul_f32 v201, v201, v242
s_waitcnt lgkmcnt(0)
v_mfma_f32_16x16x32_bf16 v[212:215], v[228:231], v[160:163], v[212:215]
v_mul_f32 v202, v202, v242
v_mul_f32 v203, v203, v242
v_mfma_f32_16x16x32_bf16 v[208:211], v[228:231], v[152:155], v[208:211]
v_cvt_pk_bf16_f32 v200, v200, v201
v_cvt_pk_bf16_f32 v201, v202, v203
v_mfma_f32_16x16x32_bf16 v[208:211], v[224:227], v[176:179], v[208:211]
v_mfma_f32_16x16x32_bf16 v[208:211], v[220:223], v[156:159], v[208:211]
s_nop 0
v_mul_f32 v212, v212, v242
v_mul_f32 v213, v213, v242
v_mfma_f32_16x16x32_bf16 v[208:211], v[216:219], v[180:183], v[208:211]
v_mul_f32 v214, v214, v242
v_mul_f32 v215, v215, v242
v_mfma_f32_16x16x32_bf16 v[204:207], v[216:219], v[172:175], v[204:207]
v_cvt_pk_bf16_f32 v202, v212, v213
v_cvt_pk_bf16_f32 v203, v214, v215
v_mfma_f32_16x16x32_bf16 v[204:207], v[220:223], v[148:151], v[204:207]
ds_write_b128 v243, v[200:203] offset:2048
v_mfma_f32_16x16x32_bf16 v[204:207], v[224:227], v[168:171], v[204:207]
v_mul_f32 v208, v208, v241
v_mul_f32 v209, v209, v241
v_mfma_f32_16x16x32_bf16 v[204:207], v[228:231], v[144:147], v[204:207]
v_mul_f32 v210, v210, v241
v_mul_f32 v211, v211, v241
v_cvt_pk_bf16_f32 v198, v208, v209
v_cvt_pk_bf16_f32 v199, v210, v211
ds_write_b128 v243, v[196:199] offset:1024
s_nop 2
v_mul_f32 v204, v204, v240
v_mul_f32 v205, v205, v240
v_mul_f32 v206, v206, v240
v_mul_f32 v207, v207, v240
v_cvt_pk_bf16_f32 v194, v204, v205
v_cvt_pk_bf16_f32 v195, v206, v207
ds_write_b128 v243, v[192:195]
s_waitcnt lgkmcnt(0)
s_barrier
ds_read_b64_tr_b16 v[232:233], v244 offset:16384
ds_read_b64_tr_b16 v[234:235], v244 offset:17408
ds_read_b64_tr_b16 v[236:237], v244 offset:18432
ds_read_b64_tr_b16 v[238:239], v244 offset:19456
ds_read_b64_tr_b16 v[216:217], v245 offset:18432
ds_read_b64_tr_b16 v[218:219], v245 offset:19456
ds_read_b64_tr_b16 v[220:221], v245 offset:16384
ds_read_b64_tr_b16 v[222:223], v245 offset:17408
ds_read_b64_tr_b16 v[224:225], v247 offset:16384
ds_read_b64_tr_b16 v[226:227], v247 offset:17408
ds_read_b64_tr_b16 v[228:229], v247 offset:18432
ds_read_b64_tr_b16 v[230:231], v247 offset:19456
s_waitcnt lgkmcnt(10)
v_mfma_f32_16x16x32_bf16 v[192:195], v[232:235], v[0:3], 0
s_waitcnt lgkmcnt(8)
v_mfma_f32_16x16x32_bf16 v[192:195], v[236:239], v[24:27], v[192:195]
v_mfma_f32_16x16x32_bf16 v[196:199], v[236:239], v[32:35], 0
v_mfma_f32_16x16x32_bf16 v[196:199], v[232:235], v[8:11], v[196:199]
v_mfma_f32_16x16x32_bf16 v[200:203], v[232:235], v[16:19], 0
ds_read_b64_tr_b16 v[232:233], v246 offset:18432
ds_read_b64_tr_b16 v[234:235], v246 offset:19456
v_mfma_f32_16x16x32_bf16 v[200:203], v[236:239], v[40:43], v[200:203]
ds_read_b64_tr_b16 v[236:237], v246 offset:16384
ds_read_b64_tr_b16 v[238:239], v246 offset:17408
s_waitcnt lgkmcnt(10)
v_mfma_f32_16x16x32_bf16 v[212:215], v[216:219], v[40:43], 0
s_waitcnt lgkmcnt(8)
v_mfma_f32_16x16x32_bf16 v[212:215], v[220:223], v[16:19], v[212:215]
v_mfma_f32_16x16x32_bf16 v[208:211], v[220:223], v[8:11], 0
v_mfma_f32_16x16x32_bf16 v[208:211], v[216:219], v[32:35], v[208:211]
v_mfma_f32_16x16x32_bf16 v[204:207], v[216:219], v[24:27], 0
v_mfma_f32_16x16x32_bf16 v[204:207], v[220:223], v[0:3], v[204:207]
s_waitcnt lgkmcnt(6)
v_mfma_f32_16x16x32_bf16 v[204:207], v[224:227], v[4:7], v[204:207]
s_waitcnt lgkmcnt(4)
v_mfma_f32_16x16x32_bf16 v[204:207], v[228:231], v[28:31], v[204:207]
v_mfma_f32_16x16x32_bf16 v[208:211], v[228:231], v[36:39], v[208:211]
v_mfma_f32_16x16x32_bf16 v[208:211], v[224:227], v[12:15], v[208:211]
v_mfma_f32_16x16x32_bf16 v[212:215], v[224:227], v[20:23], v[212:215]
v_mfma_f32_16x16x32_bf16 v[212:215], v[228:231], v[44:47], v[212:215]
s_waitcnt lgkmcnt(2)
v_mfma_f32_16x16x32_bf16 v[200:203], v[232:235], v[44:47], v[200:203]
s_waitcnt lgkmcnt(0)
v_mfma_f32_16x16x32_bf16 v[200:203], v[236:239], v[20:23], v[200:203]
v_mfma_f32_16x16x32_bf16 v[196:199], v[236:239], v[12:15], v[196:199]
v_mfma_f32_16x16x32_bf16 v[196:199], v[232:235], v[36:39], v[196:199]
s_barrier
ds_read_b64_tr_b16 v[216:217], v244 offset:32768
ds_read_b64_tr_b16 v[218:219], v244 offset:33792
v_mfma_f32_16x16x32_bf16 v[192:195], v[232:235], v[28:31], v[192:195]
ds_read_b64_tr_b16 v[220:221], v244 offset:34816
ds_read_b64_tr_b16 v[222:223], v244 offset:35840
v_mfma_f32_16x16x32_bf16 v[192:195], v[236:239], v[4:7], v[192:195]
ds_read_b64_tr_b16 v[224:225], v245 offset:34816
ds_read_b64_tr_b16 v[226:227], v245 offset:35840
ds_read_b64_tr_b16 v[228:229], v245 offset:32768
ds_read_b64_tr_b16 v[230:231], v245 offset:33792
ds_read_b64_tr_b16 v[232:233], v247 offset:32768
ds_read_b64_tr_b16 v[234:235], v247 offset:33792
ds_read_b64_tr_b16 v[236:237], v247 offset:34816
ds_read_b64_tr_b16 v[238:239], v247 offset:35840
s_waitcnt lgkmcnt(10)
v_mfma_f32_16x16x32_bf16 v[192:195], v[216:219], v[48:51], v[192:195]
s_waitcnt lgkmcnt(8)
v_mfma_f32_16x16x32_bf16 v[192:195], v[220:223], v[72:75], v[192:195]
v_mfma_f32_16x16x32_bf16 v[196:199], v[220:223], v[80:83], v[196:199]
v_mfma_f32_16x16x32_bf16 v[196:199], v[216:219], v[56:59], v[196:199]
v_mfma_f32_16x16x32_bf16 v[200:203], v[216:219], v[64:67], v[200:203]
ds_read_b64_tr_b16 v[216:217], v246 offset:34816
ds_read_b64_tr_b16 v[218:219], v246 offset:35840
v_mfma_f32_16x16x32_bf16 v[200:203], v[220:223], v[88:91], v[200:203]
ds_read_b64_tr_b16 v[220:221], v246 offset:32768
ds_read_b64_tr_b16 v[222:223], v246 offset:33792
s_waitcnt lgkmcnt(10)
v_mfma_f32_16x16x32_bf16 v[212:215], v[224:227], v[88:91], v[212:215]
s_waitcnt lgkmcnt(8)
v_mfma_f32_16x16x32_bf16 v[212:215], v[228:231], v[64:67], v[212:215]
v_mfma_f32_16x16x32_bf16 v[208:211], v[228:231], v[56:59], v[208:211]
v_mfma_f32_16x16x32_bf16 v[208:211], v[224:227], v[80:83], v[208:211]
v_mfma_f32_16x16x32_bf16 v[204:207], v[224:227], v[72:75], v[204:207]
v_mfma_f32_16x16x32_bf16 v[204:207], v[228:231], v[48:51], v[204:207]
s_waitcnt lgkmcnt(6)
v_mfma_f32_16x16x32_bf16 v[204:207], v[232:235], v[52:55], v[204:207]
s_waitcnt lgkmcnt(4)
v_mfma_f32_16x16x32_bf16 v[204:207], v[236:239], v[76:79], v[204:207]
v_mfma_f32_16x16x32_bf16 v[208:211], v[236:239], v[84:87], v[208:211]
v_mfma_f32_16x16x32_bf16 v[208:211], v[232:235], v[60:63], v[208:211]
v_mfma_f32_16x16x32_bf16 v[212:215], v[232:235], v[68:71], v[212:215]
v_mfma_f32_16x16x32_bf16 v[212:215], v[236:239], v[92:95], v[212:215]
s_waitcnt lgkmcnt(2)
v_mfma_f32_16x16x32_bf16 v[200:203], v[216:219], v[92:95], v[200:203]
s_waitcnt lgkmcnt(0)
v_mfma_f32_16x16x32_bf16 v[200:203], v[220:223], v[68:71], v[200:203]
v_mfma_f32_16x16x32_bf16 v[196:199], v[220:223], v[60:63], v[196:199]
v_mfma_f32_16x16x32_bf16 v[196:199], v[216:219], v[84:87], v[196:199]
s_barrier
v_mfma_f32_16x16x32_bf16 v[192:195], v[216:219], v[76:79], v[192:195]
v_mfma_f32_16x16x32_bf16 v[192:195], v[220:223], v[52:55], v[192:195]
s_barrier
ds_read_b64_tr_b16 v[224:225], v244 offset:49152
ds_read_b64_tr_b16 v[226:227], v244 offset:50176
ds_read_b64_tr_b16 v[228:229], v244 offset:51200
ds_read_b64_tr_b16 v[230:231], v244 offset:52224
ds_read_b64_tr_b16 v[232:233], v245 offset:51200
ds_read_b64_tr_b16 v[234:235], v245 offset:52224
ds_read_b64_tr_b16 v[236:237], v245 offset:49152
ds_read_b64_tr_b16 v[238:239], v245 offset:50176
ds_read_b64_tr_b16 v[216:217], v247 offset:49152
ds_read_b64_tr_b16 v[218:219], v247 offset:50176
ds_read_b64_tr_b16 v[220:221], v247 offset:51200
ds_read_b64_tr_b16 v[222:223], v247 offset:52224
s_waitcnt lgkmcnt(10)
v_mfma_f32_16x16x32_bf16 v[192:195], v[224:227], v[96:99], v[192:195]
s_waitcnt lgkmcnt(8)
v_mfma_f32_16x16x32_bf16 v[192:195], v[228:231], v[120:123], v[192:195]
v_mfma_f32_16x16x32_bf16 v[196:199], v[228:231], v[128:131], v[196:199]
v_mfma_f32_16x16x32_bf16 v[196:199], v[224:227], v[104:107], v[196:199]
v_mfma_f32_16x16x32_bf16 v[200:203], v[224:227], v[112:115], v[200:203]
ds_read_b64_tr_b16 v[224:225], v246 offset:51200
ds_read_b64_tr_b16 v[226:227], v246 offset:52224
v_mfma_f32_16x16x32_bf16 v[200:203], v[228:231], v[136:139], v[200:203]
ds_read_b64_tr_b16 v[228:229], v246 offset:49152
ds_read_b64_tr_b16 v[230:231], v246 offset:50176
s_waitcnt lgkmcnt(10)
v_mfma_f32_16x16x32_bf16 v[212:215], v[232:235], v[136:139], v[212:215]
s_waitcnt lgkmcnt(8)
v_mfma_f32_16x16x32_bf16 v[212:215], v[236:239], v[112:115], v[212:215]
v_mfma_f32_16x16x32_bf16 v[208:211], v[236:239], v[104:107], v[208:211]
v_mfma_f32_16x16x32_bf16 v[208:211], v[232:235], v[128:131], v[208:211]
v_mfma_f32_16x16x32_bf16 v[204:207], v[232:235], v[120:123], v[204:207]
v_mfma_f32_16x16x32_bf16 v[204:207], v[236:239], v[96:99], v[204:207]
s_waitcnt lgkmcnt(6)
v_mfma_f32_16x16x32_bf16 v[204:207], v[216:219], v[100:103], v[204:207]
s_waitcnt lgkmcnt(4)
v_mfma_f32_16x16x32_bf16 v[204:207], v[220:223], v[124:127], v[204:207]
v_mfma_f32_16x16x32_bf16 v[208:211], v[220:223], v[132:135], v[208:211]
v_mfma_f32_16x16x32_bf16 v[208:211], v[216:219], v[108:111], v[208:211]
v_mfma_f32_16x16x32_bf16 v[212:215], v[216:219], v[116:119], v[212:215]
v_mfma_f32_16x16x32_bf16 v[212:215], v[220:223], v[140:143], v[212:215]
s_waitcnt lgkmcnt(2)
v_mfma_f32_16x16x32_bf16 v[200:203], v[224:227], v[140:143], v[200:203]
s_waitcnt lgkmcnt(0)
v_mfma_f32_16x16x32_bf16 v[200:203], v[228:231], v[116:119], v[200:203]
v_mfma_f32_16x16x32_bf16 v[196:199], v[228:231], v[108:111], v[196:199]
v_mfma_f32_16x16x32_bf16 v[196:199], v[224:227], v[132:135], v[196:199]
s_barrier
v_xor_b32 v244, 0x10000, v244
ds_read_b64_tr_b16 v[232:233], v244 offset:16384
v_mfma_f32_16x16x32_bf16 v[192:195], v[224:227], v[124:127], v[192:195]
ds_read_b64_tr_b16 v[234:235], v244 offset:17408
ds_read_b64_tr_b16 v[236:237], v244 offset:18432
v_mfma_f32_16x16x32_bf16 v[192:195], v[228:231], v[100:103], v[192:195]
ds_read_b64_tr_b16 v[238:239], v244 offset:19456
v_xor_b32 v246, 0x10000, v246
ds_read_b64_tr_b16 v[216:217], v246 offset:16384
ds_read_b64_tr_b16 v[218:219], v246 offset:17408
ds_read_b64_tr_b16 v[220:221], v246 offset:18432
ds_read_b64_tr_b16 v[222:223], v246 offset:19456
v_xor_b32 v247, 0x10000, v247
ds_read_b64_tr_b16 v[224:225], v247 offset:18432
ds_read_b64_tr_b16 v[226:227], v247 offset:19456
ds_read_b64_tr_b16 v[228:229], v247 offset:16384
ds_read_b64_tr_b16 v[230:231], v247 offset:17408
v_xor_b32 v245, 0x10000, v245
s_waitcnt lgkmcnt(10)
v_mfma_f32_16x16x32_bf16 v[192:195], v[232:235], v[144:147], v[192:195]
s_waitcnt lgkmcnt(8)
v_mfma_f32_16x16x32_bf16 v[192:195], v[236:239], v[168:171], v[192:195]
s_waitcnt lgkmcnt(6)
v_mfma_f32_16x16x32_bf16 v[192:195], v[216:219], v[148:151], v[192:195]
s_waitcnt lgkmcnt(4)
v_mfma_f32_16x16x32_bf16 v[192:195], v[220:223], v[172:175], v[192:195]
v_mfma_f32_16x16x32_bf16 v[196:199], v[220:223], v[180:183], v[196:199]
v_mfma_f32_16x16x32_bf16 v[196:199], v[216:219], v[156:159], v[196:199]
v_mfma_f32_16x16x32_bf16 v[196:199], v[236:239], v[176:179], v[196:199]
s_nop 4
v_mul_f32 v192, v192, v240
v_mul_f32 v193, v193, v240
v_mfma_f32_16x16x32_bf16 v[196:199], v[232:235], v[152:155], v[196:199]
v_mul_f32 v194, v194, v240
v_mul_f32 v195, v195, v240
v_mfma_f32_16x16x32_bf16 v[200:203], v[232:235], v[160:163], v[200:203]
ds_read_b64_tr_b16 v[232:233], v245 offset:18432
ds_read_b64_tr_b16 v[234:235], v245 offset:19456
v_mfma_f32_16x16x32_bf16 v[200:203], v[236:239], v[184:187], v[200:203]
ds_read_b64_tr_b16 v[236:237], v245 offset:16384
ds_read_b64_tr_b16 v[238:239], v245 offset:17408
v_mfma_f32_16x16x32_bf16 v[200:203], v[216:219], v[164:167], v[200:203]
v_cvt_pk_bf16_f32 v192, v192, v193
v_cvt_pk_bf16_f32 v193, v194, v195
v_mfma_f32_16x16x32_bf16 v[200:203], v[220:223], v[188:191], v[200:203]
v_mul_f32 v196, v196, v241
v_mul_f32 v197, v197, v241
s_waitcnt lgkmcnt(6)
v_mfma_f32_16x16x32_bf16 v[212:215], v[224:227], v[188:191], v[212:215]
v_mul_f32 v198, v198, v241
v_mul_f32 v199, v199, v241
s_waitcnt lgkmcnt(4)
v_mfma_f32_16x16x32_bf16 v[212:215], v[228:231], v[164:167], v[212:215]
v_cvt_pk_bf16_f32 v196, v196, v197
v_cvt_pk_bf16_f32 v197, v198, v199
s_waitcnt lgkmcnt(2)
v_mfma_f32_16x16x32_bf16 v[212:215], v[232:235], v[184:187], v[212:215]
v_mul_f32 v200, v200, v242
v_mul_f32 v201, v201, v242
s_waitcnt lgkmcnt(0)
v_mfma_f32_16x16x32_bf16 v[212:215], v[236:239], v[160:163], v[212:215]
v_mul_f32 v202, v202, v242
v_mul_f32 v203, v203, v242
v_mfma_f32_16x16x32_bf16 v[208:211], v[236:239], v[152:155], v[208:211]
v_cvt_pk_bf16_f32 v200, v200, v201
v_cvt_pk_bf16_f32 v201, v202, v203
v_mfma_f32_16x16x32_bf16 v[208:211], v[232:235], v[176:179], v[208:211]
v_mfma_f32_16x16x32_bf16 v[208:211], v[228:231], v[156:159], v[208:211]
s_nop 0
v_mul_f32 v212, v212, v242
v_mul_f32 v213, v213, v242
v_mfma_f32_16x16x32_bf16 v[208:211], v[224:227], v[180:183], v[208:211]
v_mul_f32 v214, v214, v242
v_mul_f32 v215, v215, v242
v_mfma_f32_16x16x32_bf16 v[204:207], v[224:227], v[172:175], v[204:207]
v_cvt_pk_bf16_f32 v202, v212, v213
v_cvt_pk_bf16_f32 v203, v214, v215
v_mfma_f32_16x16x32_bf16 v[204:207], v[228:231], v[148:151], v[204:207]
ds_write_b128 v243, v[200:203] offset:2048
v_mfma_f32_16x16x32_bf16 v[204:207], v[232:235], v[168:171], v[204:207]
v_mul_f32 v208, v208, v241
v_mul_f32 v209, v209, v241
v_mfma_f32_16x16x32_bf16 v[204:207], v[236:239], v[144:147], v[204:207]
v_mul_f32 v210, v210, v241
v_mul_f32 v211, v211, v241
v_cvt_pk_bf16_f32 v198, v208, v209
v_cvt_pk_bf16_f32 v199, v210, v211
ds_write_b128 v243, v[196:199] offset:1024
s_nop 2
v_mul_f32 v204, v204, v240
v_mul_f32 v205, v205, v240
v_mul_f32 v206, v206, v240
v_mul_f32 v207, v207, v240
v_cvt_pk_bf16_f32 v194, v204, v205
v_cvt_pk_bf16_f32 v195, v206, v207
ds_write_b128 v243, v[192:195]
s_waitcnt lgkmcnt(0)
s_barrier
ds_read_b64_tr_b16 v[216:217], v244
ds_read_b64_tr_b16 v[218:219], v244 offset:1024
ds_read_b64_tr_b16 v[220:221], v244 offset:2048
ds_read_b64_tr_b16 v[222:223], v244 offset:3072
ds_read_b64_tr_b16 v[224:225], v245 offset:2048
ds_read_b64_tr_b16 v[226:227], v245 offset:3072
ds_read_b64_tr_b16 v[228:229], v245
ds_read_b64_tr_b16 v[230:231], v245 offset:1024
ds_read_b64_tr_b16 v[232:233], v247
ds_read_b64_tr_b16 v[234:235], v247 offset:1024
ds_read_b64_tr_b16 v[236:237], v247 offset:2048
ds_read_b64_tr_b16 v[238:239], v247 offset:3072
s_waitcnt lgkmcnt(10)
v_mfma_f32_16x16x32_bf16 v[192:195], v[216:219], v[0:3], 0
s_waitcnt lgkmcnt(8)
v_mfma_f32_16x16x32_bf16 v[192:195], v[220:223], v[24:27], v[192:195]
v_mfma_f32_16x16x32_bf16 v[196:199], v[220:223], v[32:35], 0
v_mfma_f32_16x16x32_bf16 v[196:199], v[216:219], v[8:11], v[196:199]
v_mfma_f32_16x16x32_bf16 v[200:203], v[216:219], v[16:19], 0
ds_read_b64_tr_b16 v[216:217], v246 offset:2048
ds_read_b64_tr_b16 v[218:219], v246 offset:3072
v_mfma_f32_16x16x32_bf16 v[200:203], v[220:223], v[40:43], v[200:203]
ds_read_b64_tr_b16 v[220:221], v246
ds_read_b64_tr_b16 v[222:223], v246 offset:1024
s_waitcnt lgkmcnt(10)
v_mfma_f32_16x16x32_bf16 v[212:215], v[224:227], v[40:43], 0
s_waitcnt lgkmcnt(8)
v_mfma_f32_16x16x32_bf16 v[212:215], v[228:231], v[16:19], v[212:215]
v_mfma_f32_16x16x32_bf16 v[208:211], v[228:231], v[8:11], 0
v_mfma_f32_16x16x32_bf16 v[208:211], v[224:227], v[32:35], v[208:211]
v_mfma_f32_16x16x32_bf16 v[204:207], v[224:227], v[24:27], 0
v_mfma_f32_16x16x32_bf16 v[204:207], v[228:231], v[0:3], v[204:207]
s_waitcnt lgkmcnt(6)
v_mfma_f32_16x16x32_bf16 v[204:207], v[232:235], v[4:7], v[204:207]
s_waitcnt lgkmcnt(4)
v_mfma_f32_16x16x32_bf16 v[204:207], v[236:239], v[28:31], v[204:207]
v_mfma_f32_16x16x32_bf16 v[208:211], v[236:239], v[36:39], v[208:211]
v_mfma_f32_16x16x32_bf16 v[208:211], v[232:235], v[12:15], v[208:211]
v_mfma_f32_16x16x32_bf16 v[212:215], v[232:235], v[20:23], v[212:215]
v_mfma_f32_16x16x32_bf16 v[212:215], v[236:239], v[44:47], v[212:215]
s_waitcnt lgkmcnt(2)
v_mfma_f32_16x16x32_bf16 v[200:203], v[216:219], v[44:47], v[200:203]
s_waitcnt lgkmcnt(0)
v_mfma_f32_16x16x32_bf16 v[200:203], v[220:223], v[20:23], v[200:203]
v_mfma_f32_16x16x32_bf16 v[196:199], v[220:223], v[12:15], v[196:199]
v_mfma_f32_16x16x32_bf16 v[196:199], v[216:219], v[36:39], v[196:199]
s_barrier
ds_read_b64_tr_b16 v[224:225], v244 offset:32768
ds_read_b64_tr_b16 v[226:227], v244 offset:33792
v_mfma_f32_16x16x32_bf16 v[192:195], v[216:219], v[28:31], v[192:195]
ds_read_b64_tr_b16 v[228:229], v244 offset:34816
ds_read_b64_tr_b16 v[230:231], v244 offset:35840
v_mfma_f32_16x16x32_bf16 v[192:195], v[220:223], v[4:7], v[192:195]
ds_read_b64_tr_b16 v[232:233], v245 offset:34816
ds_read_b64_tr_b16 v[234:235], v245 offset:35840
ds_read_b64_tr_b16 v[236:237], v245 offset:32768
ds_read_b64_tr_b16 v[238:239], v245 offset:33792
ds_read_b64_tr_b16 v[216:217], v247 offset:32768
ds_read_b64_tr_b16 v[218:219], v247 offset:33792
ds_read_b64_tr_b16 v[220:221], v247 offset:34816
ds_read_b64_tr_b16 v[222:223], v247 offset:35840
s_waitcnt lgkmcnt(10)
v_mfma_f32_16x16x32_bf16 v[192:195], v[224:227], v[48:51], v[192:195]
s_waitcnt lgkmcnt(8)
v_mfma_f32_16x16x32_bf16 v[192:195], v[228:231], v[72:75], v[192:195]
v_mfma_f32_16x16x32_bf16 v[196:199], v[228:231], v[80:83], v[196:199]
v_mfma_f32_16x16x32_bf16 v[196:199], v[224:227], v[56:59], v[196:199]
v_mfma_f32_16x16x32_bf16 v[200:203], v[224:227], v[64:67], v[200:203]
ds_read_b64_tr_b16 v[224:225], v246 offset:34816
ds_read_b64_tr_b16 v[226:227], v246 offset:35840
v_mfma_f32_16x16x32_bf16 v[200:203], v[228:231], v[88:91], v[200:203]
ds_read_b64_tr_b16 v[228:229], v246 offset:32768
ds_read_b64_tr_b16 v[230:231], v246 offset:33792
s_waitcnt lgkmcnt(10)
v_mfma_f32_16x16x32_bf16 v[212:215], v[232:235], v[88:91], v[212:215]
s_waitcnt lgkmcnt(8)
v_mfma_f32_16x16x32_bf16 v[212:215], v[236:239], v[64:67], v[212:215]
v_mfma_f32_16x16x32_bf16 v[208:211], v[236:239], v[56:59], v[208:211]
v_mfma_f32_16x16x32_bf16 v[208:211], v[232:235], v[80:83], v[208:211]
v_mfma_f32_16x16x32_bf16 v[204:207], v[232:235], v[72:75], v[204:207]
v_mfma_f32_16x16x32_bf16 v[204:207], v[236:239], v[48:51], v[204:207]
s_waitcnt lgkmcnt(6)
v_mfma_f32_16x16x32_bf16 v[204:207], v[216:219], v[52:55], v[204:207]
s_waitcnt lgkmcnt(4)
v_mfma_f32_16x16x32_bf16 v[204:207], v[220:223], v[76:79], v[204:207]
v_mfma_f32_16x16x32_bf16 v[208:211], v[220:223], v[84:87], v[208:211]
v_mfma_f32_16x16x32_bf16 v[208:211], v[216:219], v[60:63], v[208:211]
v_mfma_f32_16x16x32_bf16 v[212:215], v[216:219], v[68:71], v[212:215]
v_mfma_f32_16x16x32_bf16 v[212:215], v[220:223], v[92:95], v[212:215]
s_waitcnt lgkmcnt(2)
v_mfma_f32_16x16x32_bf16 v[200:203], v[224:227], v[92:95], v[200:203]
s_waitcnt lgkmcnt(0)
v_mfma_f32_16x16x32_bf16 v[200:203], v[228:231], v[68:71], v[200:203]
v_mfma_f32_16x16x32_bf16 v[196:199], v[228:231], v[60:63], v[196:199]
v_mfma_f32_16x16x32_bf16 v[196:199], v[224:227], v[84:87], v[196:199]
s_barrier
ds_read_b64_tr_b16 v[232:233], v244 offset:49152
ds_read_b64_tr_b16 v[234:235], v244 offset:50176
v_mfma_f32_16x16x32_bf16 v[192:195], v[224:227], v[76:79], v[192:195]
ds_read_b64_tr_b16 v[236:237], v244 offset:51200
ds_read_b64_tr_b16 v[238:239], v244 offset:52224
v_mfma_f32_16x16x32_bf16 v[192:195], v[228:231], v[52:55], v[192:195]
ds_read_b64_tr_b16 v[216:217], v245 offset:51200
ds_read_b64_tr_b16 v[218:219], v245 offset:52224
ds_read_b64_tr_b16 v[220:221], v245 offset:49152
ds_read_b64_tr_b16 v[222:223], v245 offset:50176
ds_read_b64_tr_b16 v[224:225], v247 offset:49152
ds_read_b64_tr_b16 v[226:227], v247 offset:50176
ds_read_b64_tr_b16 v[228:229], v247 offset:51200
ds_read_b64_tr_b16 v[230:231], v247 offset:52224
s_waitcnt lgkmcnt(10)
v_mfma_f32_16x16x32_bf16 v[192:195], v[232:235], v[96:99], v[192:195]
s_waitcnt lgkmcnt(8)
v_mfma_f32_16x16x32_bf16 v[192:195], v[236:239], v[120:123], v[192:195]
v_mfma_f32_16x16x32_bf16 v[196:199], v[236:239], v[128:131], v[196:199]
v_mfma_f32_16x16x32_bf16 v[196:199], v[232:235], v[104:107], v[196:199]
v_mfma_f32_16x16x32_bf16 v[200:203], v[232:235], v[112:115], v[200:203]
ds_read_b64_tr_b16 v[232:233], v246 offset:51200
ds_read_b64_tr_b16 v[234:235], v246 offset:52224
v_mfma_f32_16x16x32_bf16 v[200:203], v[236:239], v[136:139], v[200:203]
ds_read_b64_tr_b16 v[236:237], v246 offset:49152
ds_read_b64_tr_b16 v[238:239], v246 offset:50176
s_waitcnt lgkmcnt(10)
v_mfma_f32_16x16x32_bf16 v[212:215], v[216:219], v[136:139], v[212:215]
s_waitcnt lgkmcnt(8)
v_mfma_f32_16x16x32_bf16 v[212:215], v[220:223], v[112:115], v[212:215]
v_mfma_f32_16x16x32_bf16 v[208:211], v[220:223], v[104:107], v[208:211]
v_mfma_f32_16x16x32_bf16 v[208:211], v[216:219], v[128:131], v[208:211]
v_mfma_f32_16x16x32_bf16 v[204:207], v[216:219], v[120:123], v[204:207]
v_mfma_f32_16x16x32_bf16 v[204:207], v[220:223], v[96:99], v[204:207]
s_waitcnt lgkmcnt(6)
v_mfma_f32_16x16x32_bf16 v[204:207], v[224:227], v[100:103], v[204:207]
s_waitcnt lgkmcnt(4)
v_mfma_f32_16x16x32_bf16 v[204:207], v[228:231], v[124:127], v[204:207]
v_mfma_f32_16x16x32_bf16 v[208:211], v[228:231], v[132:135], v[208:211]
v_mfma_f32_16x16x32_bf16 v[208:211], v[224:227], v[108:111], v[208:211]
v_mfma_f32_16x16x32_bf16 v[212:215], v[224:227], v[116:119], v[212:215]
v_mfma_f32_16x16x32_bf16 v[212:215], v[228:231], v[140:143], v[212:215]
s_waitcnt lgkmcnt(2)
v_mfma_f32_16x16x32_bf16 v[200:203], v[232:235], v[140:143], v[200:203]
s_waitcnt lgkmcnt(0)
v_mfma_f32_16x16x32_bf16 v[200:203], v[236:239], v[116:119], v[200:203]
v_mfma_f32_16x16x32_bf16 v[196:199], v[236:239], v[108:111], v[196:199]
v_mfma_f32_16x16x32_bf16 v[196:199], v[232:235], v[132:135], v[196:199]
s_barrier
v_mfma_f32_16x16x32_bf16 v[192:195], v[232:235], v[124:127], v[192:195]
v_mfma_f32_16x16x32_bf16 v[192:195], v[236:239], v[100:103], v[192:195]
s_barrier
v_xor_b32 v244, 0x10000, v244
ds_read_b64_tr_b16 v[216:217], v244
ds_read_b64_tr_b16 v[218:219], v244 offset:1024
ds_read_b64_tr_b16 v[220:221], v244 offset:2048
ds_read_b64_tr_b16 v[222:223], v244 offset:3072
v_xor_b32 v246, 0x10000, v246
ds_read_b64_tr_b16 v[224:225], v246
ds_read_b64_tr_b16 v[226:227], v246 offset:1024
ds_read_b64_tr_b16 v[228:229], v246 offset:2048
ds_read_b64_tr_b16 v[230:231], v246 offset:3072
v_xor_b32 v247, 0x10000, v247
ds_read_b64_tr_b16 v[232:233], v247 offset:2048
ds_read_b64_tr_b16 v[234:235], v247 offset:3072
ds_read_b64_tr_b16 v[236:237], v247
ds_read_b64_tr_b16 v[238:239], v247 offset:1024
v_xor_b32 v245, 0x10000, v245
s_waitcnt lgkmcnt(10)
v_mfma_f32_16x16x32_bf16 v[192:195], v[216:219], v[144:147], v[192:195]
s_waitcnt lgkmcnt(8)
v_mfma_f32_16x16x32_bf16 v[192:195], v[220:223], v[168:171], v[192:195]
s_waitcnt lgkmcnt(6)
v_mfma_f32_16x16x32_bf16 v[192:195], v[224:227], v[148:151], v[192:195]
s_waitcnt lgkmcnt(4)
v_mfma_f32_16x16x32_bf16 v[192:195], v[228:231], v[172:175], v[192:195]
v_mfma_f32_16x16x32_bf16 v[196:199], v[228:231], v[180:183], v[196:199]
v_mfma_f32_16x16x32_bf16 v[196:199], v[224:227], v[156:159], v[196:199]
v_mfma_f32_16x16x32_bf16 v[196:199], v[220:223], v[176:179], v[196:199]
s_nop 4
v_mul_f32 v192, v192, v240
v_mul_f32 v193, v193, v240
v_mfma_f32_16x16x32_bf16 v[196:199], v[216:219], v[152:155], v[196:199]
v_mul_f32 v194, v194, v240
v_mul_f32 v195, v195, v240
v_mfma_f32_16x16x32_bf16 v[200:203], v[216:219], v[160:163], v[200:203]
ds_read_b64_tr_b16 v[216:217], v245 offset:2048
ds_read_b64_tr_b16 v[218:219], v245 offset:3072
v_mfma_f32_16x16x32_bf16 v[200:203], v[220:223], v[184:187], v[200:203]
ds_read_b64_tr_b16 v[220:221], v245
ds_read_b64_tr_b16 v[222:223], v245 offset:1024
v_mfma_f32_16x16x32_bf16 v[200:203], v[224:227], v[164:167], v[200:203]
v_cvt_pk_bf16_f32 v192, v192, v193
v_cvt_pk_bf16_f32 v193, v194, v195
v_mfma_f32_16x16x32_bf16 v[200:203], v[228:231], v[188:191], v[200:203]
v_mul_f32 v196, v196, v241
v_mul_f32 v197, v197, v241
s_waitcnt lgkmcnt(6)
v_mfma_f32_16x16x32_bf16 v[212:215], v[232:235], v[188:191], v[212:215]
v_mul_f32 v198, v198, v241
v_mul_f32 v199, v199, v241
s_waitcnt lgkmcnt(4)
v_mfma_f32_16x16x32_bf16 v[212:215], v[236:239], v[164:167], v[212:215]
v_cvt_pk_bf16_f32 v196, v196, v197
v_cvt_pk_bf16_f32 v197, v198, v199
s_waitcnt lgkmcnt(2)
v_mfma_f32_16x16x32_bf16 v[212:215], v[216:219], v[184:187], v[212:215]
v_mul_f32 v200, v200, v242
v_mul_f32 v201, v201, v242
s_waitcnt lgkmcnt(0)
v_mfma_f32_16x16x32_bf16 v[212:215], v[220:223], v[160:163], v[212:215]
v_mul_f32 v202, v202, v242
v_mul_f32 v203, v203, v242
v_mfma_f32_16x16x32_bf16 v[208:211], v[220:223], v[152:155], v[208:211]
v_cvt_pk_bf16_f32 v200, v200, v201
v_cvt_pk_bf16_f32 v201, v202, v203
v_mfma_f32_16x16x32_bf16 v[208:211], v[216:219], v[176:179], v[208:211]
v_mfma_f32_16x16x32_bf16 v[208:211], v[236:239], v[156:159], v[208:211]
s_nop 0
v_mul_f32 v212, v212, v242
v_mul_f32 v213, v213, v242
v_mfma_f32_16x16x32_bf16 v[208:211], v[232:235], v[180:183], v[208:211]
v_mul_f32 v214, v214, v242
v_mul_f32 v215, v215, v242
v_mfma_f32_16x16x32_bf16 v[204:207], v[232:235], v[172:175], v[204:207]
v_cvt_pk_bf16_f32 v202, v212, v213
v_cvt_pk_bf16_f32 v203, v214, v215
v_mfma_f32_16x16x32_bf16 v[204:207], v[236:239], v[148:151], v[204:207]
ds_write_b128 v243, v[200:203] offset:2048
v_mfma_f32_16x16x32_bf16 v[204:207], v[216:219], v[168:171], v[204:207]
v_mul_f32 v208, v208, v241
v_mul_f32 v209, v209, v241
v_mfma_f32_16x16x32_bf16 v[204:207], v[220:223], v[144:147], v[204:207]
v_mul_f32 v210, v210, v241
v_mul_f32 v211, v211, v241
v_cvt_pk_bf16_f32 v198, v208, v209
v_cvt_pk_bf16_f32 v199, v210, v211
ds_write_b128 v243, v[196:199] offset:1024
s_nop 2
v_mul_f32 v204, v204, v240
v_mul_f32 v205, v205, v240
v_mul_f32 v206, v206, v240
v_mul_f32 v207, v207, v240
v_cvt_pk_bf16_f32 v194, v204, v205
v_cvt_pk_bf16_f32 v195, v206, v207
ds_write_b128 v243, v[192:195]
s_waitcnt lgkmcnt(0)
s_barrier
v_mbcnt_lo_u32_b32 v224, -1, 0
v_mbcnt_hi_u32_b32 v224, -1, v224
v_lshlrev_b32 v226, 4, v224
v_lshlrev_b32 v227, 3, v224
v_and_b32 v229, 7, v224
v_lshlrev_b32 v229, 2, v229
s_lshl_b32 s44, s49, 9
s_lshl_b32 s45, s41, 7
s_add_u32 s44, s44, s45
v_add_u32 v229, s44, v229
v_and_b32 v228, 15, v224
v_mul_u32_u24 v228, 896, v228
v_lshrrev_b32 v225, 4, v224
v_lshl_add_u32 v228, v225, 3, v228
s_mul_i32 s44, s48, 344064
s_mul_i32 s45, s49, 6144
s_add_u32 s44, s44, s45
s_mul_i32 s45, s41, 1536
s_add_u32 s44, s44, s45
s_add_u32 s4, s78, s44
s_addc_u32 s5, s79, 0
s_mov_b32 s6, 302592
s_mov_b32 s7, 0x20000
s_mul_i32 s44, s48, 43008
s_add_u32 s28, s74, s44
s_addc_u32 s29, s75, 0
s_mov_b32 s30, 43008
s_mov_b32 s31, 0x20000
s_lshl_b32 s90, s41, 5
s_lshl_b32 s45, s49, 7
s_add_u32 s90, s90, s45
s_add_u32 s91, s90, 14336
s_add_u32 s92, s90, 28672
s_mov_b32 s93, 1
s_mov_b32 s94, 0
v_bfe_u32 v231, v224, 2, 2
v_cmp_eq_u32 vcc, v231, v225
v_and_b32 v231, 1, v224
v_lshlrev_b32 v231, 4, v231
v_mov_b32 v232, 0x3f80
v_lshlrev_b32 v231, v231, v232
v_cndmask_b32 v231, 0, v231, vcc
v_and_b32 v233, 2, v224
v_cmp_eq_u32 vcc, 0, v233
v_mov_b32 v234, 0
s_nop 0
v_cndmask_b32 v232, v234, v231, vcc
v_cndmask_b32 v233, v231, v234, vcc
v_mov_b32 v234, v232
v_mov_b32 v235, v233
v_mov_b32 v0, 0
v_mov_b32 v1, 0
v_mov_b32 v16, 0
v_mov_b32 v17, 0
v_mov_b32 v32, 0
v_mov_b32 v33, 0
s_add_u32 s44, s49, 1
s_and_b32 s44, s44, 7
s_mul_i32 s65, s44, 43008
s_add_u32 s44, s49, 2
s_and_b32 s44, s44, 7
s_mul_i32 s66, s44, 43008
s_add_u32 s44, s49, 3
s_and_b32 s44, s44, 7
s_mul_i32 s67, s44, 43008
s_add_u32 s44, s49, 4
s_and_b32 s44, s44, 7
s_mul_i32 s68, s44, 43008
s_add_u32 s44, s49, 5
s_and_b32 s44, s44, 7
s_mul_i32 s69, s44, 43008
s_add_u32 s44, s49, 6
s_and_b32 s44, s44, 7
s_mul_i32 s70, s44, 43008
s_add_u32 s44, s49, 7
s_and_b32 s44, s44, 7
s_mul_i32 s71, s44, 43008
s_barrier
s_barrier
s_barrier
s_cmp_eq_u32 s49, 7
s_cbranch_scc1 L_rend_c0
s_barrier
ds_read_b128 v[96:99], v243 offset:3072
ds_read_b128 v[100:103], v243 offset:4096
ds_read_b128 v[104:107], v243 offset:5120
buffer_load_dword v230, v229, s[24:27], 0 offen sc1
L_rl_c0:
s_waitcnt vmcnt(0)
L_rl2_c0:
v_cmp_ne_u32 vcc, 0, v230
s_add_u32 s94, s94, 1
s_cmp_gt_u32 s94, 0x80000
s_cbranch_scc1 L_rsum_c0
s_and_b32 s95, vcc_lo, 0xff
s_andn2_b32 s95, s95, s93
s_cbranch_scc0 L_rp_c0
s_and_b32 s44, s95, 14
s_cbranch_scc0 L_rx_c0
s_bitcmp0_b32 s95, 1
s_cbranch_scc1 L_ra1_c0
buffer_load_dwordx2 v[2:3], v226, s[4:7], s65 offen sc1
buffer_load_dwordx2 v[18:19], v226, s[4:7], s65 offen offset:8 sc1
buffer_load_dwordx2 v[34:35], v227, s[4:7], s65 offen offset:1024 sc1
L_ra1_c0:
s_bitcmp0_b32 s95, 2
s_cbranch_scc1 L_ra2_c0
buffer_load_dwordx2 v[4:5], v226, s[4:7], s66 offen sc1
buffer_load_dwordx2 v[20:21], v226, s[4:7], s66 offen offset:8 sc1
buffer_load_dwordx2 v[36:37], v227, s[4:7], s66 offen offset:1024 sc1
L_ra2_c0:
s_bitcmp0_b32 s95, 3
s_cbranch_scc1 L_ra3_c0
buffer_load_dwordx2 v[6:7], v226, s[4:7], s67 offen sc1
buffer_load_dwordx2 v[22:23], v226, s[4:7], s67 offen offset:8 sc1
buffer_load_dwordx2 v[38:39], v227, s[4:7], s67 offen offset:1024 sc1
L_ra3_c0:
L_rx_c0:
s_and_b32 s44, s95, 48
s_cbranch_scc0 L_ry_c0
s_bitcmp0_b32 s95, 4
s_cbranch_scc1 L_ra4_c0
buffer_load_dwordx2 v[8:9], v226, s[4:7], s68 offen sc1
buffer_load_dwordx2 v[24:25], v226, s[4:7], s68 offen offset:8 sc1
buffer_load_dwordx2 v[40:41], v227, s[4:7], s68 offen offset:1024 sc1
L_ra4_c0:
s_bitcmp0_b32 s95, 5
s_cbranch_scc1 L_ra5_c0
buffer_load_dwordx2 v[10:11], v226, s[4:7], s69 offen sc1
buffer_load_dwordx2 v[26:27], v226, s[4:7], s69 offen offset:8 sc1
buffer_load_dwordx2 v[42:43], v227, s[4:7], s69 offen offset:1024 sc1
L_ra5_c0:
L_ry_c0:
s_and_b32 s44, s95, 192
s_cbranch_scc0 L_rz_c0
s_bitcmp0_b32 s95, 6
s_cbranch_scc1 L_ra6_c0
buffer_load_dwordx2 v[12:13], v226, s[4:7], s70 offen sc1
buffer_load_dwordx2 v[28:29], v226, s[4:7], s70 offen offset:8 sc1
buffer_load_dwordx2 v[44:45], v227, s[4:7], s70 offen offset:1024 sc1
L_ra6_c0:
s_bitcmp0_b32 s95, 7
s_cbranch_scc1 L_ra7_c0
buffer_load_dwordx2 v[14:15], v226, s[4:7], s71 offen sc1
buffer_load_dwordx2 v[30:31], v226, s[4:7], s71 offen offset:8 sc1
buffer_load_dwordx2 v[46:47], v227, s[4:7], s71 offen offset:1024 sc1
L_ra7_c0:
L_rz_c0:
s_or_b32 s93, s93, s95
s_cmp_eq_u32 s93, 0xff
s_cbranch_scc1 L_rsum_c0
L_rp_c0:
buffer_load_dword v230, v229, s[24:27], 0 offen sc1
s_branch L_rl_c0
L_rsum_c0:
s_waitcnt vmcnt(0) lgkmcnt(0)
v_mfma_f32_16x16x32_bf16 v[96:99], v[232:235], v[0:3], v[96:99]
v_mfma_f32_16x16x32_bf16 v[96:99], v[232:235], v[4:7], v[96:99]
v_mfma_f32_16x16x32_bf16 v[96:99], v[232:235], v[8:11], v[96:99]
v_mfma_f32_16x16x32_bf16 v[96:99], v[232:235], v[12:15], v[96:99]
v_mfma_f32_16x16x32_bf16 v[100:103], v[232:235], v[16:19], v[100:103]
v_mfma_f32_16x16x32_bf16 v[100:103], v[232:235], v[20:23], v[100:103]
v_mfma_f32_16x16x32_bf16 v[100:103], v[232:235], v[24:27], v[100:103]
v_mfma_f32_16x16x32_bf16 v[100:103], v[232:235], v[28:31], v[100:103]
v_mfma_f32_16x16x32_bf16 v[104:107], v[232:235], v[32:35], v[104:107]
v_mfma_f32_16x16x32_bf16 v[104:107], v[232:235], v[36:39], v[104:107]
v_mfma_f32_16x16x32_bf16 v[104:107], v[232:235], v[40:43], v[104:107]
v_mfma_f32_16x16x32_bf16 v[104:107], v[232:235], v[44:47], v[104:107]
v_cvt_pk_bf16_f32 v96, v96, v97
v_cvt_pk_bf16_f32 v97, v98, v99
buffer_store_dwordx2 v[96:97], v228, s[28:31], s90 offen
s_nop 0
v_cvt_pk_bf16_f32 v100, v100, v101
v_cvt_pk_bf16_f32 v101, v102, v103
buffer_store_dwordx2 v[100:101], v228, s[28:31], s91 offen
s_nop 0
v_cvt_pk_bf16_f32 v104, v104, v105
v_cvt_pk_bf16_f32 v105, v106, v107
buffer_store_dwordx2 v[104:105], v228, s[28:31], s92 offen
L_rend_c0:
L_last_c0:
s_endpgm
.p2align 6
L_p_c1:
s_add_u32 m0, s42, 34560
s_nop 0
buffer_load_dwordx4 v233, s[4:7], 0 offen offset:256 lds
s_add_u32 m0, s42, 35456
s_nop 0
buffer_load_dwordx4 v233, s[4:7], s59 offen offset:384 lds
v_mbcnt_lo_u32_b32 v251, -1, 0
v_min_u32 v251, 20, v251
s_lshl_b32 s45, s48, 2
s_add_u32 s44, s41, s45
s_mul_i32 s44, s44, 21
v_add_u32 v251, s44, v251
v_mul_u32_u24 v252, 21846, v251
v_lshrrev_b32 v252, 16, v252
v_add3_u32 v251, v251, v252, 1
v_lshrrev_b32 v252, 3, v251
v_and_b32 v251, 7, v251
v_lshlrev_b32 v251, 7, v251
v_lshl_add_u32 v251, v252, 13, v251
buffer_load_dword v252, v251, s[16:19], 0 offen
s_add_u32 m0, s42, 49152
s_nop 0
buffer_load_dwordx4 v232, s[8:11], 0 offen nt lds
s_waitcnt vmcnt(10)
s_barrier
ds_read_b128 v[0:3], v234
buffer_load_dwordx4 v232, s[8:11], s32 offen offset:1024 nt lds
ds_read_b128 v[12:15], v235
ds_read_b128 v[24:27], v234 offset:1024
ds_read_b128 v[36:39], v235 offset:1024
ds_read_b128 v[48:51], v234 offset:2048
ds_read_b128 v[60:63], v235 offset:2048
ds_read_b128 v[72:75], v234 offset:3072
ds_read_b128 v[84:87], v235 offset:3072
ds_read_b128 v[96:99], v234 offset:8192
ds_read_b128 v[108:111], v235 offset:8192
ds_read_b128 v[120:123], v234 offset:9216
ds_read_b128 v[132:135], v235 offset:9216
buffer_load_dwordx4 v232, s[8:11], s33 offen offset:2048 nt lds
ds_read_b128 v[144:147], v234 offset:10240
ds_read_b128 v[156:159], v235 offset:10240
buffer_load_dwordx4 v232, s[8:11], s34 offen offset:3072 nt lds
s_add_u32 m0, s42, 65536
v_add_u32 v232, 0x10000, v232
buffer_load_dwordx4 v232, s[8:11], 0 offen nt lds
buffer_load_dwordx4 v232, s[8:11], s32 offen offset:1024 nt lds
buffer_load_dwordx4 v232, s[8:11], s33 offen offset:2048 nt lds
buffer_load_dwordx4 v232, s[8:11], s34 offen offset:3072 nt lds
s_waitcnt vmcnt(9) lgkmcnt(0)
s_barrier
ds_read_b128 v[4:7], v234 offset:16384
ds_read_b128 v[8:11], v234 offset:32768
ds_read_b128 v[16:19], v235 offset:16384
ds_read_b128 v[20:23], v235 offset:32768
s_add_u32 m0, s42, 81920
s_nop 0
buffer_load_dwordx4 v245, s[16:19], 0 offen lds
ds_read_b128 v[28:31], v234 offset:17408
ds_read_b128 v[32:35], v234 offset:33792
ds_read_b128 v[40:43], v235 offset:17408
ds_read_b128 v[44:47], v235 offset:33792
ds_read_b128 v[52:55], v234 offset:18432
ds_read_b128 v[56:59], v234 offset:34816
ds_read_b128 v[64:67], v235 offset:18432
ds_read_b128 v[68:71], v235 offset:34816
ds_read_b128 v[76:79], v234 offset:19456
ds_read_b128 v[80:83], v234 offset:35840
ds_read_b128 v[88:91], v235 offset:19456
ds_read_b128 v[92:95], v235 offset:35840
buffer_load_dwordx4 v245, s[16:19], s35 offen offset:1024 lds
ds_read_b128 v[100:103], v234 offset:24576
ds_read_b128 v[104:107], v234 offset:40960
ds_read_b128 v[112:115], v235 offset:24576
ds_read_b128 v[116:119], v235 offset:40960
buffer_load_dwordx4 v245, s[16:19], s36 offen offset:2048 lds
ds_read_b128 v[124:127], v234 offset:25600
ds_read_b128 v[128:131], v234 offset:41984
ds_read_b128 v[136:139], v235 offset:25600
ds_read_b128 v[140:143], v235 offset:41984
ds_read_b128 v[148:151], v234 offset:26624
ds_read_b128 v[152:155], v234 offset:43008
ds_read_b128 v[160:163], v235 offset:26624
ds_read_b128 v[164:167], v235 offset:43008
buffer_load_dwordx4 v245, s[16:19], s37 offen offset:3072 lds
s_add_u32 m0, s42, 98304
v_add_u32 v245, 0x80000, v245
buffer_load_dwordx4 v245, s[16:19], 0 offen lds
buffer_load_dwordx4 v245, s[16:19], s35 offen offset:1024 lds
buffer_load_dwordx4 v245, s[16:19], s36 offen offset:2048 lds
buffer_load_dwordx4 v245, s[16:19], s37 offen offset:3072 lds
s_add_u32 m0, s42, 114688
v_add_u32 v245, 0x80000, v245
buffer_load_dwordx4 v245, s[16:19], 0 offen lds
buffer_load_dwordx4 v245, s[16:19], s35 offen offset:1024 lds
buffer_load_dwordx4 v245, s[16:19], s36 offen offset:2048 lds
buffer_load_dwordx4 v245, s[16:19], s37 offen offset:3072 lds
s_waitcnt vmcnt(8) lgkmcnt(0)
s_barrier
v_xor_b32 v236, 0x10000, v236
ds_read_b64_tr_b16 v[192:193], v236 offset:16384
ds_read_b64_tr_b16 v[194:195], v236 offset:16896
ds_read_b64_tr_b16 v[196:197], v236 offset:18432
ds_read_b64_tr_b16 v[198:199], v236 offset:18944
v_xor_b32 v237, 0x10000, v237
ds_read_b64_tr_b16 v[200:201], v237 offset:18432
ds_read_b64_tr_b16 v[202:203], v237 offset:18944
ds_read_b64_tr_b16 v[204:205], v237 offset:16384
ds_read_b64_tr_b16 v[206:207], v237 offset:16896
s_waitcnt lgkmcnt(6)
v_mfma_f32_16x16x32_bf16 v[168:171], v[192:195], v[0:3], 0
s_waitcnt lgkmcnt(4)
v_mfma_f32_16x16x32_bf16 v[168:171], v[196:199], v[12:15], v[168:171]
v_mfma_f32_16x16x32_bf16 v[172:175], v[196:199], v[16:19], 0
v_mfma_f32_16x16x32_bf16 v[172:175], v[192:195], v[4:7], v[172:175]
v_mfma_f32_16x16x32_bf16 v[176:179], v[192:195], v[8:11], 0
v_mfma_f32_16x16x32_bf16 v[176:179], v[196:199], v[20:23], v[176:179]
s_waitcnt lgkmcnt(2)
v_mfma_f32_16x16x32_bf16 v[188:191], v[200:203], v[20:23], 0
s_waitcnt lgkmcnt(0)
v_mfma_f32_16x16x32_bf16 v[188:191], v[204:207], v[8:11], v[188:191]
v_mfma_f32_16x16x32_bf16 v[184:187], v[204:207], v[4:7], 0
v_mfma_f32_16x16x32_bf16 v[184:187], v[200:203], v[16:19], v[184:187]
s_waitcnt vmcnt(4)
s_barrier
ds_read_b64_tr_b16 v[208:209], v236 offset:32768
ds_read_b64_tr_b16 v[210:211], v236 offset:33280
v_mfma_f32_16x16x32_bf16 v[180:183], v[200:203], v[12:15], 0
ds_read_b64_tr_b16 v[212:213], v236 offset:34816
ds_read_b64_tr_b16 v[214:215], v236 offset:35328
v_mfma_f32_16x16x32_bf16 v[180:183], v[204:207], v[0:3], v[180:183]
ds_read_b64_tr_b16 v[216:217], v237 offset:34816
ds_read_b64_tr_b16 v[218:219], v237 offset:35328
ds_read_b64_tr_b16 v[220:221], v237 offset:32768
ds_read_b64_tr_b16 v[222:223], v237 offset:33280
s_waitcnt lgkmcnt(6)
v_mfma_f32_16x16x32_bf16 v[168:171], v[208:211], v[24:27], v[168:171]
s_waitcnt lgkmcnt(4)
v_mfma_f32_16x16x32_bf16 v[168:171], v[212:215], v[36:39], v[168:171]
v_mfma_f32_16x16x32_bf16 v[172:175], v[212:215], v[40:43], v[172:175]
v_mfma_f32_16x16x32_bf16 v[172:175], v[208:211], v[28:31], v[172:175]
v_mfma_f32_16x16x32_bf16 v[176:179], v[208:211], v[32:35], v[176:179]
v_mfma_f32_16x16x32_bf16 v[176:179], v[212:215], v[44:47], v[176:179]
s_waitcnt lgkmcnt(2)
v_mfma_f32_16x16x32_bf16 v[188:191], v[216:219], v[44:47], v[188:191]
s_waitcnt lgkmcnt(0)
v_mfma_f32_16x16x32_bf16 v[188:191], v[220:223], v[32:35], v[188:191]
v_mfma_f32_16x16x32_bf16 v[184:187], v[220:223], v[28:31], v[184:187]
v_mfma_f32_16x16x32_bf16 v[184:187], v[216:219], v[40:43], v[184:187]
s_waitcnt vmcnt(0)
s_barrier
ds_read_b64_tr_b16 v[192:193], v236 offset:49152
ds_read_b64_tr_b16 v[194:195], v236 offset:49664
v_mfma_f32_16x16x32_bf16 v[180:183], v[216:219], v[36:39], v[180:183]
ds_read_b64_tr_b16 v[196:197], v236 offset:51200
ds_read_b64_tr_b16 v[198:199], v236 offset:51712
v_mfma_f32_16x16x32_bf16 v[180:183], v[220:223], v[24:27], v[180:183]
ds_read_b64_tr_b16 v[200:201], v237 offset:51200
ds_read_b64_tr_b16 v[202:203], v237 offset:51712
ds_read_b64_tr_b16 v[204:205], v237 offset:49152
ds_read_b64_tr_b16 v[206:207], v237 offset:49664
s_waitcnt lgkmcnt(6)
v_mfma_f32_16x16x32_bf16 v[168:171], v[192:195], v[48:51], v[168:171]
s_waitcnt lgkmcnt(4)
v_mfma_f32_16x16x32_bf16 v[168:171], v[196:199], v[60:63], v[168:171]
v_mfma_f32_16x16x32_bf16 v[172:175], v[196:199], v[64:67], v[172:175]
v_mfma_f32_16x16x32_bf16 v[172:175], v[192:195], v[52:55], v[172:175]
v_mfma_f32_16x16x32_bf16 v[176:179], v[192:195], v[56:59], v[176:179]
v_mfma_f32_16x16x32_bf16 v[176:179], v[196:199], v[68:71], v[176:179]
s_waitcnt lgkmcnt(0)
s_barrier
v_mfma_f32_16x16x32_bf16 v[188:191], v[200:203], v[68:71], v[188:191]
v_mfma_f32_16x16x32_bf16 v[188:191], v[204:207], v[56:59], v[188:191]
v_mfma_f32_16x16x32_bf16 v[184:187], v[204:207], v[52:55], v[184:187]
v_mfma_f32_16x16x32_bf16 v[184:187], v[200:203], v[64:67], v[184:187]
v_mfma_f32_16x16x32_bf16 v[180:183], v[200:203], v[60:63], v[180:183]
v_mfma_f32_16x16x32_bf16 v[180:183], v[204:207], v[48:51], v[180:183]
s_barrier
v_xor_b32 v236, 0x10000, v236
s_add_u32 m0, s42, 81920
v_add_u32 v245, 0x200000, v245
buffer_load_dwordx4 v245, s[16:19], 0 offen lds
ds_read_b64_tr_b16 v[208:209], v236
ds_read_b64_tr_b16 v[210:211], v236 offset:512
ds_read_b64_tr_b16 v[212:213], v236 offset:2048
ds_read_b64_tr_b16 v[214:215], v236 offset:2560
v_xor_b32 v237, 0x10000, v237
ds_read_b64_tr_b16 v[216:217], v237 offset:2048
ds_read_b64_tr_b16 v[218:219], v237 offset:2560
ds_read_b64_tr_b16 v[220:221], v237
ds_read_b64_tr_b16 v[222:223], v237 offset:512
buffer_load_dwordx4 v245, s[16:19], s35 offen offset:1024 lds
s_waitcnt lgkmcnt(6)
v_mfma_f32_16x16x32_bf16 v[168:171], v[208:211], v[72:75], v[168:171]
buffer_load_dwordx4 v245, s[16:19], s36 offen offset:2048 lds
s_waitcnt lgkmcnt(4)
v_mfma_f32_16x16x32_bf16 v[168:171], v[212:215], v[84:87], v[168:171]
v_mfma_f32_16x16x32_bf16 v[172:175], v[212:215], v[88:91], v[172:175]
v_mfma_f32_16x16x32_bf16 v[172:175], v[208:211], v[76:79], v[172:175]
buffer_load_dwordx4 v245, s[16:19], s37 offen offset:3072 lds
v_mfma_f32_16x16x32_bf16 v[176:179], v[208:211], v[80:83], v[176:179]
v_mfma_f32_16x16x32_bf16 v[176:179], v[212:215], v[92:95], v[176:179]
s_waitcnt lgkmcnt(2)
v_mfma_f32_16x16x32_bf16 v[188:191], v[216:219], v[92:95], v[188:191]
s_add_u32 m0, s42, 98304
v_add_u32 v232, 0x10000, v232
buffer_load_dwordx4 v232, s[8:11], 0 offen nt lds
s_waitcnt lgkmcnt(0)
v_mfma_f32_16x16x32_bf16 v[188:191], v[220:223], v[80:83], v[188:191]
v_mfma_f32_16x16x32_bf16 v[184:187], v[220:223], v[76:79], v[184:187]
v_mfma_f32_16x16x32_bf16 v[184:187], v[216:219], v[88:91], v[184:187]
buffer_load_dwordx4 v232, s[8:11], s32 offen offset:1024 nt lds
buffer_load_dwordx4 v232, s[8:11], s33 offen offset:2048 nt lds
s_barrier
ds_read_b64_tr_b16 v[192:193], v236 offset:16384
ds_read_b64_tr_b16 v[194:195], v236 offset:16896
buffer_load_dwordx4 v232, s[8:11], s34 offen offset:3072 nt lds
v_mfma_f32_16x16x32_bf16 v[180:183], v[216:219], v[84:87], v[180:183]
ds_read_b64_tr_b16 v[196:197], v236 offset:18432
ds_read_b64_tr_b16 v[198:199], v236 offset:18944
v_mfma_f32_16x16x32_bf16 v[180:183], v[220:223], v[72:75], v[180:183]
ds_read_b64_tr_b16 v[200:201], v237 offset:18432
ds_read_b64_tr_b16 v[202:203], v237 offset:18944
ds_read_b64_tr_b16 v[204:205], v237 offset:16384
v_mbcnt_lo_u32_b32 v251, -1, 0
v_min_u32 v251, 27, v251
s_lshl_b32 s45, s48, 2
s_add_u32 s44, s41, s45
s_mul_i32 s44, s44, 28
v_add_u32 v251, s44, v251
v_lshlrev_b32 v251, 7, v251
buffer_load_dword v252, v251, s[20:23], 0 offen
s_waitcnt lgkmcnt(5)
v_mfma_f32_16x16x32_bf16 v[168:171], v[192:195], v[96:99], v[168:171]
ds_read_b64_tr_b16 v[206:207], v237 offset:16896
s_waitcnt lgkmcnt(4)
v_mfma_f32_16x16x32_bf16 v[168:171], v[196:199], v[108:111], v[168:171]
v_mfma_f32_16x16x32_bf16 v[172:175], v[196:199], v[112:115], v[172:175]
v_mfma_f32_16x16x32_bf16 v[172:175], v[192:195], v[100:103], v[172:175]
v_mfma_f32_16x16x32_bf16 v[176:179], v[192:195], v[104:107], v[176:179]
v_mfma_f32_16x16x32_bf16 v[176:179], v[196:199], v[116:119], v[176:179]
s_waitcnt lgkmcnt(2)
v_mfma_f32_16x16x32_bf16 v[188:191], v[200:203], v[116:119], v[188:191]
s_waitcnt lgkmcnt(0)
v_mfma_f32_16x16x32_bf16 v[188:191], v[204:207], v[104:107], v[188:191]
v_mfma_f32_16x16x32_bf16 v[184:187], v[204:207], v[100:103], v[184:187]
v_mfma_f32_16x16x32_bf16 v[184:187], v[200:203], v[112:115], v[184:187]
s_add_u32 m0, s42, 114688
v_add_u32 v232, 0x10000, v232
buffer_load_dwordx4 v232, s[8:11], 0 offen nt lds
buffer_load_dwordx4 v232, s[8:11], s32 offen offset:1024 nt lds
buffer_load_dwordx4 v232, s[8:11], s33 offen offset:2048 nt lds
s_waitcnt vmcnt(8)
s_barrier
ds_read_b64_tr_b16 v[208:209], v236 offset:32768
ds_read_b64_tr_b16 v[210:211], v236 offset:33280
v_mfma_f32_16x16x32_bf16 v[180:183], v[200:203], v[108:111], v[180:183]
ds_read_b64_tr_b16 v[212:213], v236 offset:34816
ds_read_b64_tr_b16 v[214:215], v236 offset:35328
v_mfma_f32_16x16x32_bf16 v[180:183], v[204:207], v[96:99], v[180:183]
ds_read_b64_tr_b16 v[216:217], v237 offset:34816
ds_read_b64_tr_b16 v[218:219], v237 offset:35328
ds_read_b64_tr_b16 v[220:221], v237 offset:32768
ds_read_b64_tr_b16 v[222:223], v237 offset:33280
v_xor_b32 v236, 0x10000, v236
ds_read_b64_tr_b16 v[192:193], v236 offset:16384
ds_read_b64_tr_b16 v[194:195], v236 offset:16896
ds_read_b64_tr_b16 v[196:197], v236 offset:18432
ds_read_b64_tr_b16 v[198:199], v236 offset:18944
v_xor_b32 v237, 0x10000, v237
ds_read_b64_tr_b16 v[200:201], v237 offset:18432
ds_read_b64_tr_b16 v[202:203], v237 offset:18944
ds_read_b64_tr_b16 v[204:205], v237 offset:16384
ds_read_b64_tr_b16 v[206:207], v237 offset:16896
s_waitcnt lgkmcnt(14)
v_mfma_f32_16x16x32_bf16 v[168:171], v[208:211], v[120:123], v[168:171]
s_waitcnt lgkmcnt(12)
v_mfma_f32_16x16x32_bf16 v[168:171], v[212:215], v[132:135], v[168:171]
v_mfma_f32_16x16x32_bf16 v[172:175], v[212:215], v[136:139], v[172:175]
v_mfma_f32_16x16x32_bf16 v[172:175], v[208:211], v[124:127], v[172:175]
v_mfma_f32_16x16x32_bf16 v[176:179], v[208:211], v[128:131], v[176:179]
v_mfma_f32_16x16x32_bf16 v[176:179], v[212:215], v[140:143], v[176:179]
s_waitcnt lgkmcnt(10)
v_mfma_f32_16x16x32_bf16 v[188:191], v[216:219], v[140:143], v[188:191]
s_waitcnt lgkmcnt(8)
v_mfma_f32_16x16x32_bf16 v[188:191], v[220:223], v[128:131], v[188:191]
v_mfma_f32_16x16x32_bf16 v[184:187], v[220:223], v[124:127], v[184:187]
v_mfma_f32_16x16x32_bf16 v[184:187], v[216:219], v[136:139], v[184:187]
v_mfma_f32_16x16x32_bf16 v[180:183], v[216:219], v[132:135], v[180:183]
v_mfma_f32_16x16x32_bf16 v[180:183], v[220:223], v[120:123], v[180:183]
s_waitcnt lgkmcnt(6)
v_mfma_f32_16x16x32_bf16 v[168:171], v[192:195], v[144:147], v[168:171]
s_waitcnt lgkmcnt(4)
v_mfma_f32_16x16x32_bf16 v[168:171], v[196:199], v[156:159], v[168:171]
v_mfma_f32_16x16x32_bf16 v[172:175], v[196:199], v[160:163], v[172:175]
v_mfma_f32_16x16x32_bf16 v[172:175], v[192:195], v[148:151], v[172:175]
v_mfma_f32_16x16x32_bf16 v[176:179], v[192:195], v[152:155], v[176:179]
v_mfma_f32_16x16x32_bf16 v[176:179], v[196:199], v[164:167], v[176:179]
s_waitcnt lgkmcnt(2)
v_mfma_f32_16x16x32_bf16 v[188:191], v[200:203], v[164:167], v[188:191]
s_waitcnt lgkmcnt(0)
v_mfma_f32_16x16x32_bf16 v[188:191], v[204:207], v[152:155], v[188:191]
v_mfma_f32_16x16x32_bf16 v[184:187], v[204:207], v[148:151], v[184:187]
v_mfma_f32_16x16x32_bf16 v[184:187], v[200:203], v[160:163], v[184:187]
v_mfma_f32_16x16x32_bf16 v[180:183], v[200:203], v[156:159], v[180:183]
v_mfma_f32_16x16x32_bf16 v[180:183], v[204:207], v[144:147], v[180:183]
v_cvt_pk_bf16_f32 v224, v168, v169
v_cvt_pk_bf16_f32 v225, v170, v171
v_cvt_pk_bf16_f32 v226, v172, v173
v_cvt_pk_bf16_f32 v227, v174, v175
v_cvt_pk_bf16_f32 v228, v176, v177
v_cvt_pk_bf16_f32 v229, v178, v179
s_nop 1
v_cvt_pk_bf16_f32 v230, v180, v181
v_cvt_pk_bf16_f32 v231, v182, v183
v_cvt_pk_bf16_f32 v240, v184, v185
v_cvt_pk_bf16_f32 v241, v186, v187
v_cvt_pk_bf16_f32 v242, v188, v189
v_cvt_pk_bf16_f32 v243, v190, v191
ds_write_b64 v238, v[224:225]
ds_write_b64 v238, v[226:227] offset:1024
ds_write_b64 v238, v[228:229] offset:2048
ds_write_b64 v238, v[230:231] offset:512
ds_write_b64 v238, v[240:241] offset:1536
ds_write_b64 v238, v[242:243] offset:2560
s_waitcnt lgkmcnt(0)
s_barrier
s_add_u32 m0, s42, 16384
v_add_u32 v245, 0xffd00080, v245
buffer_load_dwordx4 v245, s[16:19], 0 offen lds
buffer_load_dwordx4 v245, s[16:19], s35 offen offset:1024 lds
buffer_load_dwordx4 v245, s[16:19], s36 offen offset:2048 lds
buffer_load_dwordx4 v245, s[16:19], s37 offen offset:3072 lds
s_add_u32 m0, s42, 32768
v_add_u32 v245, 0x80000, v245
buffer_load_dwordx4 v245, s[16:19], 0 offen lds
buffer_load_dwordx4 v245, s[16:19], s35 offen offset:1024 lds
s_barrier
s_waitcnt vmcnt(10)
s_barrier
s_waitcnt vmcnt(6)
s_barrier
buffer_load_dwordx4 v245, s[16:19], s36 offen offset:2048 lds
buffer_load_dwordx4 v245, s[16:19], s37 offen offset:3072 lds
s_add_u32 m0, s42, 81920
v_add_u32 v245, 0x80000, v245
buffer_load_dwordx4 v245, s[16:19], 0 offen lds
buffer_load_dwordx4 v245, s[16:19], s35 offen offset:1024 lds
buffer_load_dwordx4 v245, s[16:19], s36 offen offset:2048 lds
buffer_load_dwordx4 v245, s[16:19], s37 offen offset:3072 lds
s_add_u32 m0, s42, 49152
v_add_u32 v245, 0x80000, v245
buffer_load_dwordx4 v245, s[16:19], 0 offen lds
s_waitcnt vmcnt(9)
s_barrier
v_xor_b32 v236, 0x10000, v236
ds_read_b64_tr_b16 v[208:209], v236 offset:16384
ds_read_b64_tr_b16 v[210:211], v236 offset:16896
ds_read_b64_tr_b16 v[212:213], v236 offset:18432
ds_read_b64_tr_b16 v[214:215], v236 offset:18944
v_xor_b32 v237, 0x10000, v237
ds_read_b64_tr_b16 v[216:217], v237 offset:18432
ds_read_b64_tr_b16 v[218:219], v237 offset:18944
ds_read_b64_tr_b16 v[220:221], v237 offset:16384
ds_read_b64_tr_b16 v[222:223], v237 offset:16896
s_waitcnt lgkmcnt(6)
v_mfma_f32_16x16x32_bf16 v[168:171], v[208:211], v[0:3], 0
s_waitcnt lgkmcnt(4)
v_mfma_f32_16x16x32_bf16 v[168:171], v[212:215], v[12:15], v[168:171]
v_mfma_f32_16x16x32_bf16 v[172:175], v[212:215], v[16:19], 0
v_mfma_f32_16x16x32_bf16 v[172:175], v[208:211], v[4:7], v[172:175]
v_mfma_f32_16x16x32_bf16 v[176:179], v[208:211], v[8:11], 0
v_mfma_f32_16x16x32_bf16 v[176:179], v[212:215], v[20:23], v[176:179]
s_waitcnt lgkmcnt(2)
v_mfma_f32_16x16x32_bf16 v[188:191], v[216:219], v[20:23], 0
s_waitcnt lgkmcnt(0)
v_mfma_f32_16x16x32_bf16 v[188:191], v[220:223], v[8:11], v[188:191]
v_mfma_f32_16x16x32_bf16 v[184:187], v[220:223], v[4:7], 0
v_mfma_f32_16x16x32_bf16 v[184:187], v[216:219], v[16:19], v[184:187]
s_waitcnt vmcnt(5)
s_barrier
ds_read_b64_tr_b16 v[192:193], v236 offset:32768
ds_read_b64_tr_b16 v[194:195], v236 offset:33280
v_mfma_f32_16x16x32_bf16 v[180:183], v[216:219], v[12:15], 0
ds_read_b64_tr_b16 v[196:197], v236 offset:34816
ds_read_b64_tr_b16 v[198:199], v236 offset:35328
v_mfma_f32_16x16x32_bf16 v[180:183], v[220:223], v[0:3], v[180:183]
ds_read_b64_tr_b16 v[200:201], v237 offset:34816
ds_read_b64_tr_b16 v[202:203], v237 offset:35328
ds_read_b64_tr_b16 v[204:205], v237 offset:32768
ds_read_b64_tr_b16 v[206:207], v237 offset:33280
s_waitcnt lgkmcnt(6)
v_mfma_f32_16x16x32_bf16 v[168:171], v[192:195], v[24:27], v[168:171]
s_waitcnt lgkmcnt(4)
v_mfma_f32_16x16x32_bf16 v[168:171], v[196:199], v[36:39], v[168:171]
v_mfma_f32_16x16x32_bf16 v[172:175], v[196:199], v[40:43], v[172:175]
v_mfma_f32_16x16x32_bf16 v[172:175], v[192:195], v[28:31], v[172:175]
v_mfma_f32_16x16x32_bf16 v[176:179], v[192:195], v[32:35], v[176:179]
v_mfma_f32_16x16x32_bf16 v[176:179], v[196:199], v[44:47], v[176:179]
s_waitcnt lgkmcnt(2)
v_mfma_f32_16x16x32_bf16 v[188:191], v[200:203], v[44:47], v[188:191]
s_waitcnt lgkmcnt(0)
v_mfma_f32_16x16x32_bf16 v[188:191], v[204:207], v[32:35], v[188:191]
v_mfma_f32_16x16x32_bf16 v[184:187], v[204:207], v[28:31], v[184:187]
v_mfma_f32_16x16x32_bf16 v[184:187], v[200:203], v[40:43], v[184:187]
s_waitcnt vmcnt(1)
s_barrier
v_xor_b32 v236, 0x10000, v236
ds_read_b64_tr_b16 v[208:209], v236 offset:16384
v_mfma_f32_16x16x32_bf16 v[180:183], v[200:203], v[36:39], v[180:183]
ds_read_b64_tr_b16 v[210:211], v236 offset:16896
ds_read_b64_tr_b16 v[212:213], v236 offset:18432
v_mfma_f32_16x16x32_bf16 v[180:183], v[204:207], v[24:27], v[180:183]
ds_read_b64_tr_b16 v[214:215], v236 offset:18944
v_xor_b32 v237, 0x10000, v237
ds_read_b64_tr_b16 v[216:217], v237 offset:18432
ds_read_b64_tr_b16 v[218:219], v237 offset:18944
ds_read_b64_tr_b16 v[220:221], v237 offset:16384
ds_read_b64_tr_b16 v[222:223], v237 offset:16896
s_waitcnt lgkmcnt(6)
v_mfma_f32_16x16x32_bf16 v[168:171], v[208:211], v[48:51], v[168:171]
s_waitcnt lgkmcnt(4)
v_mfma_f32_16x16x32_bf16 v[168:171], v[212:215], v[60:63], v[168:171]
v_mfma_f32_16x16x32_bf16 v[172:175], v[212:215], v[64:67], v[172:175]
v_mfma_f32_16x16x32_bf16 v[172:175], v[208:211], v[52:55], v[172:175]
v_mfma_f32_16x16x32_bf16 v[176:179], v[208:211], v[56:59], v[176:179]
v_mfma_f32_16x16x32_bf16 v[176:179], v[212:215], v[68:71], v[176:179]
s_waitcnt lgkmcnt(2)
v_mfma_f32_16x16x32_bf16 v[188:191], v[216:219], v[68:71], v[188:191]
s_waitcnt lgkmcnt(0)
v_mfma_f32_16x16x32_bf16 v[188:191], v[220:223], v[56:59], v[188:191]
v_mfma_f32_16x16x32_bf16 v[184:187], v[220:223], v[52:55], v[184:187]
v_mfma_f32_16x16x32_bf16 v[184:187], v[216:219], v[64:67], v[184:187]
s_waitcnt vmcnt(0)
s_barrier
v_xor_b32 v236, 0x10000, v236
ds_read_b64_tr_b16 v[192:193], v236 offset:49152
v_mfma_f32_16x16x32_bf16 v[180:183], v[216:219], v[60:63], v[180:183]
ds_read_b64_tr_b16 v[194:195], v236 offset:49664
ds_read_b64_tr_b16 v[196:197], v236 offset:51200
v_mfma_f32_16x16x32_bf16 v[180:183], v[220:223], v[48:51], v[180:183]
ds_read_b64_tr_b16 v[198:199], v236 offset:51712
v_xor_b32 v237, 0x10000, v237
ds_read_b64_tr_b16 v[200:201], v237 offset:51200
ds_read_b64_tr_b16 v[202:203], v237 offset:51712
ds_read_b64_tr_b16 v[204:205], v237 offset:49152
ds_read_b64_tr_b16 v[206:207], v237 offset:49664
s_waitcnt lgkmcnt(6)
v_mfma_f32_16x16x32_bf16 v[168:171], v[192:195], v[72:75], v[168:171]
s_waitcnt lgkmcnt(4)
v_mfma_f32_16x16x32_bf16 v[168:171], v[196:199], v[84:87], v[168:171]
v_mfma_f32_16x16x32_bf16 v[172:175], v[196:199], v[88:91], v[172:175]
v_mfma_f32_16x16x32_bf16 v[172:175], v[192:195], v[76:79], v[172:175]
v_mfma_f32_16x16x32_bf16 v[176:179], v[192:195], v[80:83], v[176:179]
v_mfma_f32_16x16x32_bf16 v[176:179], v[196:199], v[92:95], v[176:179]
s_waitcnt lgkmcnt(2)
v_mfma_f32_16x16x32_bf16 v[188:191], v[200:203], v[92:95], v[188:191]
s_waitcnt lgkmcnt(0)
v_mfma_f32_16x16x32_bf16 v[188:191], v[204:207], v[80:83], v[188:191]
v_mfma_f32_16x16x32_bf16 v[184:187], v[204:207], v[76:79], v[184:187]
v_mfma_f32_16x16x32_bf16 v[184:187], v[200:203], v[88:91], v[184:187]
s_barrier
v_xor_b32 v236, 0x10000, v236
ds_read_b64_tr_b16 v[208:209], v236
v_mfma_f32_16x16x32_bf16 v[180:183], v[200:203], v[84:87], v[180:183]
ds_read_b64_tr_b16 v[210:211], v236 offset:512
ds_read_b64_tr_b16 v[212:213], v236 offset:2048
v_mfma_f32_16x16x32_bf16 v[180:183], v[204:207], v[72:75], v[180:183]
ds_read_b64_tr_b16 v[214:215], v236 offset:2560
v_xor_b32 v237, 0x10000, v237
ds_read_b64_tr_b16 v[216:217], v237 offset:2048
ds_read_b64_tr_b16 v[218:219], v237 offset:2560
ds_read_b64_tr_b16 v[220:221], v237
ds_read_b64_tr_b16 v[222:223], v237 offset:512
s_waitcnt lgkmcnt(6)
v_mfma_f32_16x16x32_bf16 v[168:171], v[208:211], v[96:99], v[168:171]
s_waitcnt lgkmcnt(4)
v_mfma_f32_16x16x32_bf16 v[168:171], v[212:215], v[108:111], v[168:171]
v_mfma_f32_16x16x32_bf16 v[172:175], v[212:215], v[112:115], v[172:175]
v_mfma_f32_16x16x32_bf16 v[172:175], v[208:211], v[100:103], v[172:175]
v_mfma_f32_16x16x32_bf16 v[176:179], v[208:211], v[104:107], v[176:179]
v_mfma_f32_16x16x32_bf16 v[176:179], v[212:215], v[116:119], v[176:179]
s_waitcnt lgkmcnt(2)
v_mfma_f32_16x16x32_bf16 v[188:191], v[216:219], v[116:119], v[188:191]
s_waitcnt lgkmcnt(0)
v_mfma_f32_16x16x32_bf16 v[188:191], v[220:223], v[104:107], v[188:191]
v_mfma_f32_16x16x32_bf16 v[184:187], v[220:223], v[100:103], v[184:187]
v_mfma_f32_16x16x32_bf16 v[184:187], v[216:219], v[112:115], v[184:187]
s_barrier
ds_read_b64_tr_b16 v[192:193], v236 offset:32768
ds_read_b64_tr_b16 v[194:195], v236 offset:33280
v_mfma_f32_16x16x32_bf16 v[180:183], v[216:219], v[108:111], v[180:183]
ds_read_b64_tr_b16 v[196:197], v236 offset:34816
ds_read_b64_tr_b16 v[198:199], v236 offset:35328
v_mfma_f32_16x16x32_bf16 v[180:183], v[220:223], v[96:99], v[180:183]
ds_read_b64_tr_b16 v[200:201], v237 offset:34816
ds_read_b64_tr_b16 v[202:203], v237 offset:35328
ds_read_b64_tr_b16 v[204:205], v237 offset:32768
ds_read_b64_tr_b16 v[206:207], v237 offset:33280
s_waitcnt lgkmcnt(6)
v_mfma_f32_16x16x32_bf16 v[168:171], v[192:195], v[120:123], v[168:171]
s_waitcnt lgkmcnt(4)
v_mfma_f32_16x16x32_bf16 v[168:171], v[196:199], v[132:135], v[168:171]
v_mfma_f32_16x16x32_bf16 v[172:175], v[196:199], v[136:139], v[172:175]
v_mfma_f32_16x16x32_bf16 v[172:175], v[192:195], v[124:127], v[172:175]
v_mfma_f32_16x16x32_bf16 v[176:179], v[192:195], v[128:131], v[176:179]
v_mfma_f32_16x16x32_bf16 v[176:179], v[196:199], v[140:143], v[176:179]
s_waitcnt lgkmcnt(2)
v_mfma_f32_16x16x32_bf16 v[188:191], v[200:203], v[140:143], v[188:191]
s_waitcnt lgkmcnt(0)
v_mfma_f32_16x16x32_bf16 v[188:191], v[204:207], v[128:131], v[188:191]
v_mfma_f32_16x16x32_bf16 v[184:187], v[204:207], v[124:127], v[184:187]
v_mfma_f32_16x16x32_bf16 v[184:187], v[200:203], v[136:139], v[184:187]
s_barrier
ds_read_b64_tr_b16 v[208:209], v236 offset:49152
ds_read_b64_tr_b16 v[210:211], v236 offset:49664
v_mfma_f32_16x16x32_bf16 v[180:183], v[200:203], v[132:135], v[180:183]
ds_read_b64_tr_b16 v[212:213], v236 offset:51200
ds_read_b64_tr_b16 v[214:215], v236 offset:51712
v_mfma_f32_16x16x32_bf16 v[180:183], v[204:207], v[120:123], v[180:183]
ds_read_b64_tr_b16 v[216:217], v237 offset:51200
ds_read_b64_tr_b16 v[218:219], v237 offset:51712
ds_read_b64_tr_b16 v[220:221], v237 offset:49152
ds_read_b64_tr_b16 v[222:223], v237 offset:49664
s_waitcnt lgkmcnt(6)
v_mfma_f32_16x16x32_bf16 v[168:171], v[208:211], v[144:147], v[168:171]
s_waitcnt lgkmcnt(4)
v_mfma_f32_16x16x32_bf16 v[168:171], v[212:215], v[156:159], v[168:171]
v_mfma_f32_16x16x32_bf16 v[172:175], v[212:215], v[160:163], v[172:175]
v_mfma_f32_16x16x32_bf16 v[172:175], v[208:211], v[148:151], v[172:175]
v_mfma_f32_16x16x32_bf16 v[176:179], v[208:211], v[152:155], v[176:179]
v_mfma_f32_16x16x32_bf16 v[176:179], v[212:215], v[164:167], v[176:179]
s_waitcnt lgkmcnt(2)
v_mfma_f32_16x16x32_bf16 v[188:191], v[216:219], v[164:167], v[188:191]
s_waitcnt lgkmcnt(0)
v_mfma_f32_16x16x32_bf16 v[188:191], v[220:223], v[152:155], v[188:191]
v_mfma_f32_16x16x32_bf16 v[184:187], v[220:223], v[148:151], v[184:187]
v_mfma_f32_16x16x32_bf16 v[184:187], v[216:219], v[160:163], v[184:187]
v_mfma_f32_16x16x32_bf16 v[180:183], v[216:219], v[156:159], v[180:183]
v_mfma_f32_16x16x32_bf16 v[180:183], v[220:223], v[144:147], v[180:183]
v_cvt_pk_bf16_f32 v224, v168, v169
v_cvt_pk_bf16_f32 v225, v170, v171
v_cvt_pk_bf16_f32 v226, v172, v173
v_cvt_pk_bf16_f32 v227, v174, v175
v_cvt_pk_bf16_f32 v228, v176, v177
v_cvt_pk_bf16_f32 v229, v178, v179
s_nop 1
v_cvt_pk_bf16_f32 v230, v180, v181
v_cvt_pk_bf16_f32 v231, v182, v183
v_cvt_pk_bf16_f32 v240, v184, v185
v_cvt_pk_bf16_f32 v241, v186, v187
v_cvt_pk_bf16_f32 v242, v188, v189
v_cvt_pk_bf16_f32 v243, v190, v191
ds_write_b64 v238, v[224:225] offset:12288
ds_write_b64 v238, v[226:227] offset:13312
ds_write_b64 v238, v[228:229] offset:14336
ds_write_b64 v238, v[230:231] offset:12800
ds_write_b64 v238, v[240:241] offset:13824
ds_write_b64 v238, v[242:243] offset:14848
s_waitcnt lgkmcnt(0)
s_barrier
s_add_u32 m0, s42, 81920
v_add_u32 v232, 0x80, v232
buffer_load_dwordx4 v232, s[8:11], s34 offen offset:3072 nt lds
s_add_u32 m0, s42, 49152
v_add_u32 v232, 0xfffd0080, v232
buffer_load_dwordx4 v232, s[8:11], 0 offen nt lds
buffer_load_dwordx4 v232, s[8:11], s32 offen offset:1024 nt lds
buffer_load_dwordx4 v232, s[8:11], s33 offen offset:2048 nt lds
buffer_load_dwordx4 v232, s[8:11], s34 offen offset:3072 nt lds
s_barrier
s_add_u32 m0, s42, 65536
v_add_u32 v245, 0xffe80080, v245
buffer_load_dwordx4 v245, s[16:19], 0 offen lds
buffer_load_dwordx4 v245, s[16:19], s35 offen offset:1024 lds
buffer_load_dwordx4 v245, s[16:19], s36 offen offset:2048 lds
s_barrier
buffer_load_dwordx4 v245, s[16:19], s37 offen offset:3072 lds
s_add_u32 m0, s42, 98304
v_add_u32 v245, 0x80000, v245
buffer_load_dwordx4 v245, s[16:19], 0 offen lds
buffer_load_dwordx4 v245, s[16:19], s35 offen offset:1024 lds
buffer_load_dwordx4 v245, s[16:19], s36 offen offset:2048 lds
buffer_load_dwordx4 v245, s[16:19], s37 offen offset:3072 lds
s_add_u32 m0, s42, 114688
v_add_u32 v245, 0x80000, v245
buffer_load_dwordx4 v245, s[16:19], 0 offen lds
buffer_load_dwordx4 v245, s[16:19], s35 offen offset:1024 lds
s_waitcnt vmcnt(14)
s_barrier
buffer_load_dwordx4 v245, s[16:19], s36 offen offset:2048 lds
buffer_load_dwordx4 v245, s[16:19], s37 offen offset:3072 lds
s_add_u32 m0, s42, 0
v_add_u32 v245, 0x80000, v245
buffer_load_dwordx4 v245, s[16:19], 0 offen lds
s_waitcnt vmcnt(9)
s_barrier
ds_read_b64_tr_b16 v[192:193], v236
ds_read_b64_tr_b16 v[194:195], v236 offset:512
ds_read_b64_tr_b16 v[196:197], v236 offset:2048
ds_read_b64_tr_b16 v[198:199], v236 offset:2560
ds_read_b64_tr_b16 v[200:201], v237 offset:2048
ds_read_b64_tr_b16 v[202:203], v237 offset:2560
ds_read_b64_tr_b16 v[204:205], v237
ds_read_b64_tr_b16 v[206:207], v237 offset:512
s_waitcnt lgkmcnt(6)
v_mfma_f32_16x16x32_bf16 v[168:171], v[192:195], v[0:3], 0
s_waitcnt lgkmcnt(4)
v_mfma_f32_16x16x32_bf16 v[168:171], v[196:199], v[12:15], v[168:171]
v_mfma_f32_16x16x32_bf16 v[172:175], v[196:199], v[16:19], 0
v_mfma_f32_16x16x32_bf16 v[172:175], v[192:195], v[4:7], v[172:175]
v_mfma_f32_16x16x32_bf16 v[176:179], v[192:195], v[8:11], 0
v_mfma_f32_16x16x32_bf16 v[176:179], v[196:199], v[20:23], v[176:179]
s_waitcnt lgkmcnt(2)
v_mfma_f32_16x16x32_bf16 v[188:191], v[200:203], v[20:23], 0
s_waitcnt lgkmcnt(0)
v_mfma_f32_16x16x32_bf16 v[188:191], v[204:207], v[8:11], v[188:191]
v_mfma_f32_16x16x32_bf16 v[184:187], v[204:207], v[4:7], 0
v_mfma_f32_16x16x32_bf16 v[184:187], v[200:203], v[16:19], v[184:187]
s_waitcnt vmcnt(5)
s_barrier
ds_read_b64_tr_b16 v[208:209], v236 offset:32768
ds_read_b64_tr_b16 v[210:211], v236 offset:33280
v_mfma_f32_16x16x32_bf16 v[180:183], v[200:203], v[12:15], 0
ds_read_b64_tr_b16 v[212:213], v236 offset:34816
ds_read_b64_tr_b16 v[214:215], v236 offset:35328
v_mfma_f32_16x16x32_bf16 v[180:183], v[204:207], v[0:3], v[180:183]
ds_read_b64_tr_b16 v[216:217], v237 offset:34816
ds_read_b64_tr_b16 v[218:219], v237 offset:35328
ds_read_b64_tr_b16 v[220:221], v237 offset:32768
ds_read_b64_tr_b16 v[222:223], v237 offset:33280
s_waitcnt lgkmcnt(6)
v_mfma_f32_16x16x32_bf16 v[168:171], v[208:211], v[24:27], v[168:171]
s_waitcnt lgkmcnt(4)
v_mfma_f32_16x16x32_bf16 v[168:171], v[212:215], v[36:39], v[168:171]
v_mfma_f32_16x16x32_bf16 v[172:175], v[212:215], v[40:43], v[172:175]
v_mfma_f32_16x16x32_bf16 v[172:175], v[208:211], v[28:31], v[172:175]
v_mfma_f32_16x16x32_bf16 v[176:179], v[208:211], v[32:35], v[176:179]
v_mfma_f32_16x16x32_bf16 v[176:179], v[212:215], v[44:47], v[176:179]
s_waitcnt lgkmcnt(2)
v_mfma_f32_16x16x32_bf16 v[188:191], v[216:219], v[44:47], v[188:191]
s_waitcnt lgkmcnt(0)
v_mfma_f32_16x16x32_bf16 v[188:191], v[220:223], v[32:35], v[188:191]
v_mfma_f32_16x16x32_bf16 v[184:187], v[220:223], v[28:31], v[184:187]
v_mfma_f32_16x16x32_bf16 v[184:187], v[216:219], v[40:43], v[184:187]
s_waitcnt vmcnt(1)
s_barrier
ds_read_b64_tr_b16 v[192:193], v236 offset:49152
ds_read_b64_tr_b16 v[194:195], v236 offset:49664
v_mfma_f32_16x16x32_bf16 v[180:183], v[216:219], v[36:39], v[180:183]
ds_read_b64_tr_b16 v[196:197], v236 offset:51200
ds_read_b64_tr_b16 v[198:199], v236 offset:51712
v_mfma_f32_16x16x32_bf16 v[180:183], v[220:223], v[24:27], v[180:183]
ds_read_b64_tr_b16 v[200:201], v237 offset:51200
ds_read_b64_tr_b16 v[202:203], v237 offset:51712
ds_read_b64_tr_b16 v[204:205], v237 offset:49152
ds_read_b64_tr_b16 v[206:207], v237 offset:49664
s_waitcnt lgkmcnt(6)
v_mfma_f32_16x16x32_bf16 v[168:171], v[192:195], v[48:51], v[168:171]
s_waitcnt lgkmcnt(4)
v_mfma_f32_16x16x32_bf16 v[168:171], v[196:199], v[60:63], v[168:171]
v_mfma_f32_16x16x32_bf16 v[172:175], v[196:199], v[64:67], v[172:175]
v_mfma_f32_16x16x32_bf16 v[172:175], v[192:195], v[52:55], v[172:175]
v_mfma_f32_16x16x32_bf16 v[176:179], v[192:195], v[56:59], v[176:179]
v_mfma_f32_16x16x32_bf16 v[176:179], v[196:199], v[68:71], v[176:179]
s_waitcnt lgkmcnt(2)
v_mfma_f32_16x16x32_bf16 v[188:191], v[200:203], v[68:71], v[188:191]
s_waitcnt lgkmcnt(0)
v_mfma_f32_16x16x32_bf16 v[188:191], v[204:207], v[56:59], v[188:191]
v_mfma_f32_16x16x32_bf16 v[184:187], v[204:207], v[52:55], v[184:187]
v_mfma_f32_16x16x32_bf16 v[184:187], v[200:203], v[64:67], v[184:187]
s_waitcnt vmcnt(0)
s_barrier
v_xor_b32 v236, 0x10000, v236
ds_read_b64_tr_b16 v[208:209], v236
v_mfma_f32_16x16x32_bf16 v[180:183], v[200:203], v[60:63], v[180:183]
ds_read_b64_tr_b16 v[210:211], v236 offset:512
ds_read_b64_tr_b16 v[212:213], v236 offset:2048
v_mfma_f32_16x16x32_bf16 v[180:183], v[204:207], v[48:51], v[180:183]
ds_read_b64_tr_b16 v[214:215], v236 offset:2560
v_xor_b32 v237, 0x10000, v237
ds_read_b64_tr_b16 v[216:217], v237 offset:2048
ds_read_b64_tr_b16 v[218:219], v237 offset:2560
ds_read_b64_tr_b16 v[220:221], v237
ds_read_b64_tr_b16 v[222:223], v237 offset:512
s_waitcnt lgkmcnt(6)
v_mfma_f32_16x16x32_bf16 v[168:171], v[208:211], v[72:75], v[168:171]
s_waitcnt lgkmcnt(4)
v_mfma_f32_16x16x32_bf16 v[168:171], v[212:215], v[84:87], v[168:171]
v_mfma_f32_16x16x32_bf16 v[172:175], v[212:215], v[88:91], v[172:175]
v_mfma_f32_16x16x32_bf16 v[172:175], v[208:211], v[76:79], v[172:175]
v_mfma_f32_16x16x32_bf16 v[176:179], v[208:211], v[80:83], v[176:179]
v_mfma_f32_16x16x32_bf16 v[176:179], v[212:215], v[92:95], v[176:179]
s_waitcnt lgkmcnt(2)
v_mfma_f32_16x16x32_bf16 v[188:191], v[216:219], v[92:95], v[188:191]
s_waitcnt lgkmcnt(0)
v_mfma_f32_16x16x32_bf16 v[188:191], v[220:223], v[80:83], v[188:191]
v_mfma_f32_16x16x32_bf16 v[184:187], v[220:223], v[76:79], v[184:187]
v_mfma_f32_16x16x32_bf16 v[184:187], v[216:219], v[88:91], v[184:187]
s_barrier
ds_read_b64_tr_b16 v[192:193], v236 offset:16384
ds_read_b64_tr_b16 v[194:195], v236 offset:16896
v_mfma_f32_16x16x32_bf16 v[180:183], v[216:219], v[84:87], v[180:183]
ds_read_b64_tr_b16 v[196:197], v236 offset:18432
ds_read_b64_tr_b16 v[198:199], v236 offset:18944
v_mfma_f32_16x16x32_bf16 v[180:183], v[220:223], v[72:75], v[180:183]
ds_read_b64_tr_b16 v[200:201], v237 offset:18432
ds_read_b64_tr_b16 v[202:203], v237 offset:18944
ds_read_b64_tr_b16 v[204:205], v237 offset:16384
ds_read_b64_tr_b16 v[206:207], v237 offset:16896
s_waitcnt lgkmcnt(6)
v_mfma_f32_16x16x32_bf16 v[168:171], v[192:195], v[96:99], v[168:171]
s_waitcnt lgkmcnt(4)
v_mfma_f32_16x16x32_bf16 v[168:171], v[196:199], v[108:111], v[168:171]
v_mfma_f32_16x16x32_bf16 v[172:175], v[196:199], v[112:115], v[172:175]
v_mfma_f32_16x16x32_bf16 v[172:175], v[192:195], v[100:103], v[172:175]
v_mfma_f32_16x16x32_bf16 v[176:179], v[192:195], v[104:107], v[176:179]
v_mfma_f32_16x16x32_bf16 v[176:179], v[196:199], v[116:119], v[176:179]
s_waitcnt lgkmcnt(2)
v_mfma_f32_16x16x32_bf16 v[188:191], v[200:203], v[116:119], v[188:191]
s_waitcnt lgkmcnt(0)
v_mfma_f32_16x16x32_bf16 v[188:191], v[204:207], v[104:107], v[188:191]
v_mfma_f32_16x16x32_bf16 v[184:187], v[204:207], v[100:103], v[184:187]
v_mfma_f32_16x16x32_bf16 v[184:187], v[200:203], v[112:115], v[184:187]
s_barrier
ds_read_b64_tr_b16 v[208:209], v236 offset:32768
ds_read_b64_tr_b16 v[210:211], v236 offset:33280
v_mfma_f32_16x16x32_bf16 v[180:183], v[200:203], v[108:111], v[180:183]
ds_read_b64_tr_b16 v[212:213], v236 offset:34816
ds_read_b64_tr_b16 v[214:215], v236 offset:35328
v_mfma_f32_16x16x32_bf16 v[180:183], v[204:207], v[96:99], v[180:183]
ds_read_b64_tr_b16 v[216:217], v237 offset:34816
ds_read_b64_tr_b16 v[218:219], v237 offset:35328
ds_read_b64_tr_b16 v[220:221], v237 offset:32768
ds_read_b64_tr_b16 v[222:223], v237 offset:33280
s_waitcnt lgkmcnt(6)
v_mfma_f32_16x16x32_bf16 v[168:171], v[208:211], v[120:123], v[168:171]
s_waitcnt lgkmcnt(4)
v_mfma_f32_16x16x32_bf16 v[168:171], v[212:215], v[132:135], v[168:171]
v_mfma_f32_16x16x32_bf16 v[172:175], v[212:215], v[136:139], v[172:175]
v_mfma_f32_16x16x32_bf16 v[172:175], v[208:211], v[124:127], v[172:175]
v_mfma_f32_16x16x32_bf16 v[176:179], v[208:211], v[128:131], v[176:179]
v_mfma_f32_16x16x32_bf16 v[176:179], v[212:215], v[140:143], v[176:179]
s_waitcnt lgkmcnt(2)
v_mfma_f32_16x16x32_bf16 v[188:191], v[216:219], v[140:143], v[188:191]
s_waitcnt lgkmcnt(0)
v_mfma_f32_16x16x32_bf16 v[188:191], v[220:223], v[128:131], v[188:191]
v_mfma_f32_16x16x32_bf16 v[184:187], v[220:223], v[124:127], v[184:187]
v_mfma_f32_16x16x32_bf16 v[184:187], v[216:219], v[136:139], v[184:187]
s_barrier
v_xor_b32 v236, 0x10000, v236
ds_read_b64_tr_b16 v[192:193], v236 offset:16384
v_mfma_f32_16x16x32_bf16 v[180:183], v[216:219], v[132:135], v[180:183]
ds_read_b64_tr_b16 v[194:195], v236 offset:16896
ds_read_b64_tr_b16 v[196:197], v236 offset:18432
v_mfma_f32_16x16x32_bf16 v[180:183], v[220:223], v[120:123], v[180:183]
ds_read_b64_tr_b16 v[198:199], v236 offset:18944
v_xor_b32 v237, 0x10000, v237
ds_read_b64_tr_b16 v[200:201], v237 offset:18432
ds_read_b64_tr_b16 v[202:203], v237 offset:18944
ds_read_b64_tr_b16 v[204:205], v237 offset:16384
ds_read_b64_tr_b16 v[206:207], v237 offset:16896
s_waitcnt lgkmcnt(6)
v_mfma_f32_16x16x32_bf16 v[168:171], v[192:195], v[144:147], v[168:171]
s_waitcnt lgkmcnt(4)
v_mfma_f32_16x16x32_bf16 v[168:171], v[196:199], v[156:159], v[168:171]
v_mfma_f32_16x16x32_bf16 v[172:175], v[196:199], v[160:163], v[172:175]
v_mfma_f32_16x16x32_bf16 v[172:175], v[192:195], v[148:151], v[172:175]
v_mfma_f32_16x16x32_bf16 v[176:179], v[192:195], v[152:155], v[176:179]
v_mfma_f32_16x16x32_bf16 v[176:179], v[196:199], v[164:167], v[176:179]
s_waitcnt lgkmcnt(2)
v_mfma_f32_16x16x32_bf16 v[188:191], v[200:203], v[164:167], v[188:191]
s_waitcnt lgkmcnt(0)
v_mfma_f32_16x16x32_bf16 v[188:191], v[204:207], v[152:155], v[188:191]
v_mfma_f32_16x16x32_bf16 v[184:187], v[204:207], v[148:151], v[184:187]
v_mfma_f32_16x16x32_bf16 v[184:187], v[200:203], v[160:163], v[184:187]
v_mfma_f32_16x16x32_bf16 v[180:183], v[200:203], v[156:159], v[180:183]
v_mfma_f32_16x16x32_bf16 v[180:183], v[204:207], v[144:147], v[180:183]
v_cvt_pk_bf16_f32 v224, v168, v169
v_cvt_pk_bf16_f32 v225, v170, v171
v_cvt_pk_bf16_f32 v226, v172, v173
v_cvt_pk_bf16_f32 v227, v174, v175
v_cvt_pk_bf16_f32 v228, v176, v177
v_cvt_pk_bf16_f32 v229, v178, v179
s_nop 1
v_cvt_pk_bf16_f32 v230, v180, v181
v_cvt_pk_bf16_f32 v231, v182, v183
v_cvt_pk_bf16_f32 v240, v184, v185
v_cvt_pk_bf16_f32 v241, v186, v187
v_cvt_pk_bf16_f32 v242, v188, v189
v_cvt_pk_bf16_f32 v243, v190, v191
ds_write_b64 v238, v[224:225]
ds_write_b64 v238, v[226:227] offset:1024
ds_write_b64 v238, v[228:229] offset:2048
ds_write_b64 v238, v[230:231] offset:512
ds_write_b64 v238, v[240:241] offset:1536
ds_write_b64 v238, v[242:243] offset:2560
s_waitcnt lgkmcnt(0)
s_barrier
s_add_u32 m0, s42, 0
v_add_u32 v232, 0x80, v232
buffer_load_dwordx4 v232, s[8:11], 0 offen nt lds
buffer_load_dwordx4 v232, s[8:11], s32 offen offset:1024 nt lds
s_add_u32 m0, s42, 16384
v_add_u32 v245, 0xffe80080, v245
buffer_load_dwordx4 v245, s[16:19], 0 offen lds
buffer_load_dwordx4 v245, s[16:19], s35 offen offset:1024 lds
buffer_load_dwordx4 v245, s[16:19], s36 offen offset:2048 lds
buffer_load_dwordx4 v245, s[16:19], s37 offen offset:3072 lds
s_barrier
s_barrier
s_add_u32 m0, s42, 32768
v_add_u32 v245, 0x80000, v245
buffer_load_dwordx4 v245, s[16:19], 0 offen lds
s_barrier
buffer_load_dwordx4 v245, s[16:19], s35 offen offset:1024 lds
buffer_load_dwordx4 v245, s[16:19], s36 offen offset:2048 lds
buffer_load_dwordx4 v245, s[16:19], s37 offen offset:3072 lds
s_add_u32 m0, s42, 81920
v_add_u32 v245, 0x80000, v245
buffer_load_dwordx4 v245, s[16:19], 0 offen lds
buffer_load_dwordx4 v245, s[16:19], s35 offen offset:1024 lds
buffer_load_dwordx4 v245, s[16:19], s36 offen offset:2048 lds
buffer_load_dwordx4 v245, s[16:19], s37 offen offset:3072 lds
s_barrier
s_add_u32 m0, s42, 49152
v_add_u32 v245, 0x80000, v245
buffer_load_dwordx4 v245, s[16:19], 0 offen lds
buffer_load_dwordx4 v245, s[16:19], s35 offen offset:1024 lds
buffer_load_dwordx4 v245, s[16:19], s36 offen offset:2048 lds
buffer_load_dwordx4 v245, s[16:19], s37 offen offset:3072 lds
s_add_u32 m0, s42, 65536
v_add_u32 v245, 0x80000, v245
buffer_load_dwordx4 v245, s[16:19], 0 offen lds
buffer_load_dwordx4 v245, s[16:19], s35 offen offset:1024 lds
buffer_load_dwordx4 v245, s[16:19], s36 offen offset:2048 lds
s_waitcnt vmcnt(11)
s_barrier
v_xor_b32 v236, 0x10000, v236
ds_read_b64_tr_b16 v[208:209], v236 offset:16384
ds_read_b64_tr_b16 v[210:211], v236 offset:16896
ds_read_b64_tr_b16 v[212:213], v236 offset:18432
ds_read_b64_tr_b16 v[214:215], v236 offset:18944
v_xor_b32 v237, 0x10000, v237
ds_read_b64_tr_b16 v[216:217], v237 offset:18432
ds_read_b64_tr_b16 v[218:219], v237 offset:18944
ds_read_b64_tr_b16 v[220:221], v237 offset:16384
ds_read_b64_tr_b16 v[222:223], v237 offset:16896
ds_read_b64_tr_b16 v[192:193], v236 offset:32768
ds_read_b64_tr_b16 v[194:195], v236 offset:33280
ds_read_b64_tr_b16 v[196:197], v236 offset:34816
ds_read_b64_tr_b16 v[198:199], v236 offset:35328
ds_read_b64_tr_b16 v[200:201], v237 offset:34816
ds_read_b64_tr_b16 v[202:203], v237 offset:35328
ds_read_b64_tr_b16 v[204:205], v237 offset:32768
ds_read_b64_tr_b16 v[206:207], v237 offset:33280
s_waitcnt lgkmcnt(14)
v_mfma_f32_16x16x32_bf16 v[168:171], v[208:211], v[0:3], 0
s_waitcnt lgkmcnt(12)
v_mfma_f32_16x16x32_bf16 v[168:171], v[212:215], v[12:15], v[168:171]
v_mfma_f32_16x16x32_bf16 v[172:175], v[212:215], v[16:19], 0
v_mfma_f32_16x16x32_bf16 v[172:175], v[208:211], v[4:7], v[172:175]
v_mfma_f32_16x16x32_bf16 v[176:179], v[208:211], v[8:11], 0
v_mfma_f32_16x16x32_bf16 v[176:179], v[212:215], v[20:23], v[176:179]
s_waitcnt lgkmcnt(10)
v_mfma_f32_16x16x32_bf16 v[188:191], v[216:219], v[20:23], 0
s_waitcnt lgkmcnt(8)
v_mfma_f32_16x16x32_bf16 v[188:191], v[220:223], v[8:11], v[188:191]
v_mfma_f32_16x16x32_bf16 v[184:187], v[220:223], v[4:7], 0
v_mfma_f32_16x16x32_bf16 v[184:187], v[216:219], v[16:19], v[184:187]
v_mfma_f32_16x16x32_bf16 v[180:183], v[216:219], v[12:15], 0
v_mfma_f32_16x16x32_bf16 v[180:183], v[220:223], v[0:3], v[180:183]
s_waitcnt lgkmcnt(6)
v_mfma_f32_16x16x32_bf16 v[168:171], v[192:195], v[24:27], v[168:171]
s_waitcnt lgkmcnt(4)
v_mfma_f32_16x16x32_bf16 v[168:171], v[196:199], v[36:39], v[168:171]
v_mfma_f32_16x16x32_bf16 v[172:175], v[196:199], v[40:43], v[172:175]
v_mfma_f32_16x16x32_bf16 v[172:175], v[192:195], v[28:31], v[172:175]
v_mfma_f32_16x16x32_bf16 v[176:179], v[192:195], v[32:35], v[176:179]
v_mfma_f32_16x16x32_bf16 v[176:179], v[196:199], v[44:47], v[176:179]
s_waitcnt lgkmcnt(2)
v_mfma_f32_16x16x32_bf16 v[188:191], v[200:203], v[44:47], v[188:191]
s_waitcnt lgkmcnt(0)
v_mfma_f32_16x16x32_bf16 v[188:191], v[204:207], v[32:35], v[188:191]
v_mfma_f32_16x16x32_bf16 v[184:187], v[204:207], v[28:31], v[184:187]
v_mfma_f32_16x16x32_bf16 v[184:187], v[200:203], v[40:43], v[184:187]
s_waitcnt vmcnt(3)
s_barrier
v_xor_b32 v236, 0x10000, v236
ds_read_b64_tr_b16 v[208:209], v236 offset:16384
v_mfma_f32_16x16x32_bf16 v[180:183], v[200:203], v[36:39], v[180:183]
ds_read_b64_tr_b16 v[210:211], v236 offset:16896
ds_read_b64_tr_b16 v[212:213], v236 offset:18432
v_mfma_f32_16x16x32_bf16 v[180:183], v[204:207], v[24:27], v[180:183]
ds_read_b64_tr_b16 v[214:215], v236 offset:18944
v_xor_b32 v237, 0x10000, v237
ds_read_b64_tr_b16 v[216:217], v237 offset:18432
ds_read_b64_tr_b16 v[218:219], v237 offset:18944
ds_read_b64_tr_b16 v[220:221], v237 offset:16384
ds_read_b64_tr_b16 v[222:223], v237 offset:16896
v_xor_b32 v236, 0x10000, v236
ds_read_b64_tr_b16 v[192:193], v236 offset:49152
ds_read_b64_tr_b16 v[194:195], v236 offset:49664
ds_read_b64_tr_b16 v[196:197], v236 offset:51200
ds_read_b64_tr_b16 v[198:199], v236 offset:51712
v_xor_b32 v237, 0x10000, v237
ds_read_b64_tr_b16 v[200:201], v237 offset:51200
ds_read_b64_tr_b16 v[202:203], v237 offset:51712
ds_read_b64_tr_b16 v[204:205], v237 offset:49152
ds_read_b64_tr_b16 v[206:207], v237 offset:49664
s_waitcnt lgkmcnt(14)
v_mfma_f32_16x16x32_bf16 v[168:171], v[208:211], v[48:51], v[168:171]
s_waitcnt lgkmcnt(12)
v_mfma_f32_16x16x32_bf16 v[168:171], v[212:215], v[60:63], v[168:171]
v_mfma_f32_16x16x32_bf16 v[172:175], v[212:215], v[64:67], v[172:175]
v_mfma_f32_16x16x32_bf16 v[172:175], v[208:211], v[52:55], v[172:175]
v_mfma_f32_16x16x32_bf16 v[176:179], v[208:211], v[56:59], v[176:179]
v_mfma_f32_16x16x32_bf16 v[176:179], v[212:215], v[68:71], v[176:179]
s_waitcnt lgkmcnt(10)
v_mfma_f32_16x16x32_bf16 v[188:191], v[216:219], v[68:71], v[188:191]
s_waitcnt lgkmcnt(8)
v_mfma_f32_16x16x32_bf16 v[188:191], v[220:223], v[56:59], v[188:191]
v_mfma_f32_16x16x32_bf16 v[184:187], v[220:223], v[52:55], v[184:187]
v_mfma_f32_16x16x32_bf16 v[184:187], v[216:219], v[64:67], v[184:187]
v_mfma_f32_16x16x32_bf16 v[180:183], v[216:219], v[60:63], v[180:183]
v_mfma_f32_16x16x32_bf16 v[180:183], v[220:223], v[48:51], v[180:183]
s_waitcnt lgkmcnt(6)
v_mfma_f32_16x16x32_bf16 v[168:171], v[192:195], v[72:75], v[168:171]
s_waitcnt lgkmcnt(4)
v_mfma_f32_16x16x32_bf16 v[168:171], v[196:199], v[84:87], v[168:171]
v_mfma_f32_16x16x32_bf16 v[172:175], v[196:199], v[88:91], v[172:175]
v_mfma_f32_16x16x32_bf16 v[172:175], v[192:195], v[76:79], v[172:175]
v_mfma_f32_16x16x32_bf16 v[176:179], v[192:195], v[80:83], v[176:179]
v_mfma_f32_16x16x32_bf16 v[176:179], v[196:199], v[92:95], v[176:179]
s_waitcnt lgkmcnt(2)
v_mfma_f32_16x16x32_bf16 v[188:191], v[200:203], v[92:95], v[188:191]
s_waitcnt lgkmcnt(0)
v_mfma_f32_16x16x32_bf16 v[188:191], v[204:207], v[80:83], v[188:191]
v_mfma_f32_16x16x32_bf16 v[184:187], v[204:207], v[76:79], v[184:187]
v_mfma_f32_16x16x32_bf16 v[184:187], v[200:203], v[88:91], v[184:187]
s_waitcnt vmcnt(0)
s_barrier
v_xor_b32 v236, 0x10000, v236
s_add_u32 m0, s42, 16384
v_add_u32 v232, 0x10000, v232
buffer_load_dwordx4 v232, s[8:11], s34 offen offset:3072 nt lds
ds_read_b64_tr_b16 v[208:209], v236
v_mfma_f32_16x16x32_bf16 v[180:183], v[200:203], v[84:87], v[180:183]
ds_read_b64_tr_b16 v[210:211], v236 offset:512
ds_read_b64_tr_b16 v[212:213], v236 offset:2048
v_mfma_f32_16x16x32_bf16 v[180:183], v[204:207], v[72:75], v[180:183]
ds_read_b64_tr_b16 v[214:215], v236 offset:2560
v_xor_b32 v237, 0x10000, v237
s_add_u32 m0, s42, 32768
v_add_u32 v232, 0x10000, v232
buffer_load_dwordx4 v232, s[8:11], 0 offen nt lds
ds_read_b64_tr_b16 v[216:217], v237 offset:2048
ds_read_b64_tr_b16 v[218:219], v237 offset:2560
ds_read_b64_tr_b16 v[220:221], v237
ds_read_b64_tr_b16 v[222:223], v237 offset:512
s_waitcnt lgkmcnt(6)
v_mfma_f32_16x16x32_bf16 v[168:171], v[208:211], v[96:99], v[168:171]
buffer_load_dwordx4 v232, s[8:11], s32 offen offset:1024 nt lds
s_waitcnt lgkmcnt(4)
v_mfma_f32_16x16x32_bf16 v[168:171], v[212:215], v[108:111], v[168:171]
v_mfma_f32_16x16x32_bf16 v[172:175], v[212:215], v[112:115], v[172:175]
v_mfma_f32_16x16x32_bf16 v[172:175], v[208:211], v[100:103], v[172:175]
v_mfma_f32_16x16x32_bf16 v[176:179], v[208:211], v[104:107], v[176:179]
v_mfma_f32_16x16x32_bf16 v[176:179], v[212:215], v[116:119], v[176:179]
s_waitcnt lgkmcnt(2)
v_mfma_f32_16x16x32_bf16 v[188:191], v[216:219], v[116:119], v[188:191]
s_waitcnt lgkmcnt(0)
v_mfma_f32_16x16x32_bf16 v[188:191], v[220:223], v[104:107], v[188:191]
v_mfma_f32_16x16x32_bf16 v[184:187], v[220:223], v[100:103], v[184:187]
v_mfma_f32_16x16x32_bf16 v[184:187], v[216:219], v[112:115], v[184:187]
s_barrier
ds_read_b64_tr_b16 v[192:193], v236 offset:32768
ds_read_b64_tr_b16 v[194:195], v236 offset:33280
v_mfma_f32_16x16x32_bf16 v[180:183], v[216:219], v[108:111], v[180:183]
ds_read_b64_tr_b16 v[196:197], v236 offset:34816
ds_read_b64_tr_b16 v[198:199], v236 offset:35328
v_mfma_f32_16x16x32_bf16 v[180:183], v[220:223], v[96:99], v[180:183]
ds_read_b64_tr_b16 v[200:201], v237 offset:34816
ds_read_b64_tr_b16 v[202:203], v237 offset:35328
ds_read_b64_tr_b16 v[204:205], v237 offset:32768
ds_read_b64_tr_b16 v[206:207], v237 offset:33280
ds_read_b64_tr_b16 v[208:209], v236 offset:49152
ds_read_b64_tr_b16 v[210:211], v236 offset:49664
ds_read_b64_tr_b16 v[212:213], v236 offset:51200
ds_read_b64_tr_b16 v[214:215], v236 offset:51712
buffer_load_dwordx4 v232, s[8:11], s33 offen offset:2048 nt lds
ds_read_b64_tr_b16 v[216:217], v237 offset:51200
ds_read_b64_tr_b16 v[218:219], v237 offset:51712
ds_read_b64_tr_b16 v[220:221], v237 offset:49152
s_waitcnt lgkmcnt(13)
v_mfma_f32_16x16x32_bf16 v[168:171], v[192:195], v[120:123], v[168:171]
ds_read_b64_tr_b16 v[222:223], v237 offset:49664
s_waitcnt lgkmcnt(12)
v_mfma_f32_16x16x32_bf16 v[168:171], v[196:199], v[132:135], v[168:171]
v_mfma_f32_16x16x32_bf16 v[172:175], v[196:199], v[136:139], v[172:175]
v_mfma_f32_16x16x32_bf16 v[172:175], v[192:195], v[124:127], v[172:175]
v_mfma_f32_16x16x32_bf16 v[176:179], v[192:195], v[128:131], v[176:179]
v_mfma_f32_16x16x32_bf16 v[176:179], v[196:199], v[140:143], v[176:179]
s_waitcnt lgkmcnt(10)
v_mfma_f32_16x16x32_bf16 v[188:191], v[200:203], v[140:143], v[188:191]
s_waitcnt lgkmcnt(8)
v_mfma_f32_16x16x32_bf16 v[188:191], v[204:207], v[128:131], v[188:191]
v_mfma_f32_16x16x32_bf16 v[184:187], v[204:207], v[124:127], v[184:187]
v_mfma_f32_16x16x32_bf16 v[184:187], v[200:203], v[136:139], v[184:187]
v_mfma_f32_16x16x32_bf16 v[180:183], v[200:203], v[132:135], v[180:183]
v_mfma_f32_16x16x32_bf16 v[180:183], v[204:207], v[120:123], v[180:183]
s_waitcnt lgkmcnt(6)
v_mfma_f32_16x16x32_bf16 v[168:171], v[208:211], v[144:147], v[168:171]
s_waitcnt lgkmcnt(4)
v_mfma_f32_16x16x32_bf16 v[168:171], v[212:215], v[156:159], v[168:171]
v_mfma_f32_16x16x32_bf16 v[172:175], v[212:215], v[160:163], v[172:175]
v_mfma_f32_16x16x32_bf16 v[172:175], v[208:211], v[148:151], v[172:175]
v_mfma_f32_16x16x32_bf16 v[176:179], v[208:211], v[152:155], v[176:179]
v_mfma_f32_16x16x32_bf16 v[176:179], v[212:215], v[164:167], v[176:179]
s_waitcnt lgkmcnt(2)
v_mfma_f32_16x16x32_bf16 v[188:191], v[216:219], v[164:167], v[188:191]
s_waitcnt lgkmcnt(0)
v_mfma_f32_16x16x32_bf16 v[188:191], v[220:223], v[152:155], v[188:191]
v_mfma_f32_16x16x32_bf16 v[184:187], v[220:223], v[148:151], v[184:187]
v_mfma_f32_16x16x32_bf16 v[184:187], v[216:219], v[160:163], v[184:187]
v_mfma_f32_16x16x32_bf16 v[180:183], v[216:219], v[156:159], v[180:183]
v_mfma_f32_16x16x32_bf16 v[180:183], v[220:223], v[144:147], v[180:183]
v_cvt_pk_bf16_f32 v224, v168, v169
v_cvt_pk_bf16_f32 v225, v170, v171
v_cvt_pk_bf16_f32 v226, v172, v173
v_cvt_pk_bf16_f32 v227, v174, v175
v_cvt_pk_bf16_f32 v228, v176, v177
v_cvt_pk_bf16_f32 v229, v178, v179
s_nop 1
v_cvt_pk_bf16_f32 v230, v180, v181
v_cvt_pk_bf16_f32 v231, v182, v183
v_cvt_pk_bf16_f32 v240, v184, v185
v_cvt_pk_bf16_f32 v241, v186, v187
v_cvt_pk_bf16_f32 v242, v188, v189
v_cvt_pk_bf16_f32 v243, v190, v191
ds_write_b64 v238, v[224:225] offset:12288
ds_write_b64 v238, v[226:227] offset:13312
ds_write_b64 v238, v[228:229] offset:14336
ds_write_b64 v238, v[230:231] offset:12800
ds_write_b64 v238, v[240:241] offset:13824
ds_write_b64 v238, v[242:243] offset:14848
buffer_load_dwordx4 v232, s[8:11], s34 offen offset:3072 nt lds
s_add_u32 m0, s42, 81920
v_add_u32 v232, 0x10000, v232
buffer_load_dwordx4 v232, s[8:11], 0 offen nt lds
s_waitcnt lgkmcnt(0)
s_barrier
buffer_load_dwordx4 v232, s[8:11], s32 offen offset:1024 nt lds
buffer_load_dwordx4 v232, s[8:11], s33 offen offset:2048 nt lds
buffer_load_dwordx4 v232, s[8:11], s34 offen offset:3072 nt lds
s_add_u32 m0, s42, 49152
s_nop 0
buffer_load_dwordx4 v244, s[12:15], 0 offen nt lds
buffer_load_dwordx4 v244, s[12:15], s32 offen offset:1024 nt lds
buffer_load_dwordx4 v244, s[12:15], s33 offen offset:2048 nt lds
buffer_load_dwordx4 v244, s[12:15], s34 offen offset:3072 nt lds
s_waitcnt vmcnt(12)
s_barrier
s_add_u32 m0, s42, 65536
v_add_u32 v244, 0x10000, v244
buffer_load_dwordx4 v244, s[12:15], 0 offen nt lds
buffer_load_dwordx4 v244, s[12:15], s32 offen offset:1024 nt lds
buffer_load_dwordx4 v244, s[12:15], s33 offen offset:2048 nt lds
buffer_load_dwordx4 v244, s[12:15], s34 offen offset:3072 nt lds
s_add_u32 m0, s42, 98304
v_add_u32 v244, 0x10000, v244
buffer_load_dwordx4 v244, s[12:15], 0 offen nt lds
buffer_load_dwordx4 v244, s[12:15], s32 offen offset:1024 nt lds
s_barrier
buffer_load_dwordx4 v244, s[12:15], s33 offen offset:2048 nt lds
s_waitcnt vmcnt(15)
s_barrier
buffer_load_dwordx4 v244, s[12:15], s34 offen offset:3072 nt lds
s_add_u32 m0, s42, 114688
v_add_u32 v245, s50, v246
buffer_load_dwordx4 v245, s[20:23], 0 offen lds
s_waitcnt vmcnt(13)
s_barrier
buffer_load_dwordx4 v245, s[20:23], s38 offen offset:1024 lds
buffer_load_dwordx4 v245, s[20:23], s39 offen offset:2048 lds
buffer_load_dwordx4 v245, s[20:23], s40 offen offset:3072 lds
s_add_u32 m0, s42, 0
v_add_u32 v245, s51, v246
buffer_load_dwordx4 v245, s[20:23], 0 offen lds
buffer_load_dwordx4 v245, s[20:23], s38 offen offset:1024 lds
s_barrier
buffer_load_dwordx4 v245, s[20:23], s39 offen offset:2048 lds
s_waitcnt vmcnt(15)
s_barrier
s_lshr_b32 s44, s41, 1
s_mul_i32 s44, s44, 14336
s_mul_i32 s45, s41, 7168
v_add_u32 v160, s44, v248
v_add_u32 v161, s45, v248
v_mbcnt_lo_u32_b32 v162, -1, 0
v_mbcnt_hi_u32_b32 v162, -1, v162
s_add_u32 s45, s45, 137216
v_lshl_add_u32 v162, v162, 2, s45
v_and_b32 v164, 0x1ff, v236
v_bfe_u32 v163, v236, 12, 1
v_lshl_or_b32 v164, v163, 9, v164
v_bfe_u32 v163, v236, 10, 1
v_lshl_or_b32 v164, v163, 12, v164
v_xor_b32 v165, 32, v164
v_mov_b32 v168, 0x3f803f80
v_mov_b32 v169, 0x3f803f80
v_mov_b32 v170, 0x3f803f80
v_mov_b32 v171, 0x3f803f80
ds_read_b128 v[112:115], v160
buffer_load_dwordx4 v245, s[20:23], s40 offen offset:3072 lds
ds_read_b128 v[124:127], v160 offset:7168
ds_read_b128 v[128:131], v160 offset:8192
ds_read_b128 v[116:119], v160 offset:1024
ds_read_b128 v[120:123], v160 offset:2048
ds_read_b128 v[132:135], v160 offset:9216
ds_read_b64_tr_b16 v[140:141], v164 offset:57344
ds_read_b64_tr_b16 v[142:143], v164 offset:58368
ds_read_b64_tr_b16 v[136:137], v164 offset:49152
ds_read_b64_tr_b16 v[138:139], v164 offset:50176
s_add_u32 m0, s42, 16384
v_add_u32 v245, s52, v246
buffer_load_dwordx4 v245, s[20:23], 0 offen lds
s_waitcnt lgkmcnt(9)
v_mfma_f32_16x16x32_bf16 v[172:175], v[168:171], v[112:115], 0
ds_read_b64_tr_b16 v[144:145], v165 offset:49152
ds_read_b64_tr_b16 v[146:147], v165 offset:50176
s_waitcnt lgkmcnt(10)
v_mfma_f32_16x16x32_bf16 v[172:175], v[168:171], v[124:127], v[172:175]
buffer_load_dwordx4 v245, s[20:23], s38 offen offset:1024 lds
ds_read_b64_tr_b16 v[148:149], v165 offset:57344
s_waitcnt lgkmcnt(10)
v_mfma_f32_16x16x32_bf16 v[176:179], v[168:171], v[128:131], 0
ds_read_b64_tr_b16 v[150:151], v165 offset:58368
s_waitcnt lgkmcnt(10)
v_mfma_f32_16x16x32_bf16 v[176:179], v[168:171], v[116:119], v[176:179]
s_waitcnt lgkmcnt(9)
v_mfma_f32_16x16x32_bf16 v[180:183], v[168:171], v[120:123], 0
buffer_load_dwordx4 v245, s[20:23], s39 offen offset:2048 lds
s_waitcnt lgkmcnt(8)
v_mfma_f32_16x16x32_bf16 v[180:183], v[168:171], v[132:135], v[180:183]
s_waitcnt lgkmcnt(6)
v_mfma_f32_16x16x32_bf16 v[192:195], v[140:143], v[132:135], 0
s_waitcnt lgkmcnt(4)
v_mfma_f32_16x16x32_bf16 v[192:195], v[136:139], v[120:123], v[192:195]
buffer_load_dwordx4 v245, s[20:23], s40 offen offset:3072 lds
v_mfma_f32_16x16x32_bf16 v[188:191], v[136:139], v[116:119], 0
v_mfma_f32_16x16x32_bf16 v[188:191], v[140:143], v[128:131], v[188:191]
v_mfma_f32_16x16x32_bf16 v[184:187], v[140:143], v[124:127], 0
s_add_u32 m0, s42, 32768
v_add_u32 v245, s53, v246
buffer_load_dwordx4 v245, s[20:23], 0 offen lds
v_mfma_f32_16x16x32_bf16 v[184:187], v[136:139], v[112:115], v[184:187]
buffer_load_dwordx4 v245, s[20:23], s38 offen offset:1024 lds
s_waitcnt vmcnt(10) lgkmcnt(0)
s_barrier
v_mfma_f32_16x16x32_bf16 v[196:199], v[144:147], v[112:115], 0
buffer_load_dwordx4 v245, s[20:23], s39 offen offset:2048 lds
ds_read_b128 v[112:115], v160 offset:3072
v_mfma_f32_16x16x32_bf16 v[196:199], v[148:151], v[124:127], v[196:199]
ds_read_b128 v[124:127], v160 offset:10240
v_xor_b32 v247, 0x10000, v247
v_mfma_f32_16x16x32_bf16 v[200:203], v[148:151], v[128:131], 0
ds_read_b128 v[128:131], v160 offset:11264
ds_read_b64_tr_b16 v[0:1], v247 offset:49152
buffer_load_dwordx4 v245, s[20:23], s40 offen offset:3072 lds
v_mfma_f32_16x16x32_bf16 v[200:203], v[144:147], v[116:119], v[200:203]
ds_read_b128 v[116:119], v160 offset:4096
ds_read_b64_tr_b16 v[2:3], v247 offset:51200
v_mfma_f32_16x16x32_bf16 v[204:207], v[144:147], v[120:123], 0
ds_read_b128 v[120:123], v160 offset:5120
ds_read_b64_tr_b16 v[4:5], v247 offset:53248
v_mfma_f32_16x16x32_bf16 v[204:207], v[148:151], v[132:135], v[204:207]
s_add_u32 m0, s42, 81920
v_add_u32 v245, s54, v246
buffer_load_dwordx4 v245, s[20:23], 0 offen lds
s_waitcnt lgkmcnt(7)
v_mfma_f32_16x16x32_bf16 v[172:175], v[168:171], v[112:115], v[172:175]
ds_read_b128 v[132:135], v160 offset:12288
ds_read_b64_tr_b16 v[156:157], v164 offset:59392
s_waitcnt lgkmcnt(8)
v_mfma_f32_16x16x32_bf16 v[172:175], v[168:171], v[124:127], v[172:175]
ds_read_b64_tr_b16 v[158:159], v164 offset:60416
buffer_load_dwordx4 v245, s[20:23], s38 offen offset:1024 lds
s_waitcnt lgkmcnt(8)
v_mfma_f32_16x16x32_bf16 v[176:179], v[168:171], v[128:131], v[176:179]
ds_read_b64_tr_b16 v[152:153], v164 offset:51200
ds_read_b64_tr_b16 v[154:155], v164 offset:52224
s_waitcnt lgkmcnt(8)
v_mfma_f32_16x16x32_bf16 v[176:179], v[168:171], v[116:119], v[176:179]
ds_read_b64_tr_b16 v[208:209], v165 offset:51200
buffer_load_dwordx4 v245, s[20:23], s39 offen offset:2048 lds
s_waitcnt lgkmcnt(7)
v_mfma_f32_16x16x32_bf16 v[180:183], v[168:171], v[120:123], v[180:183]
ds_read_b64_tr_b16 v[210:211], v165 offset:52224
ds_read_b64_tr_b16 v[212:213], v165 offset:59392
s_waitcnt lgkmcnt(7)
v_mfma_f32_16x16x32_bf16 v[180:183], v[168:171], v[132:135], v[180:183]
ds_read_b64_tr_b16 v[214:215], v165 offset:60416
buffer_load_dwordx4 v245, s[20:23], s40 offen offset:3072 lds
s_waitcnt lgkmcnt(6)
v_mfma_f32_16x16x32_bf16 v[192:195], v[156:159], v[132:135], v[192:195]
ds_read_b64_tr_b16 v[6:7], v247 offset:55296
ds_read_b64_tr_b16 v[8:9], v247 offset:57344
s_waitcnt lgkmcnt(6)
v_mfma_f32_16x16x32_bf16 v[192:195], v[152:155], v[120:123], v[192:195]
ds_read_b64_tr_b16 v[10:11], v247 offset:59392
ds_read_b64_tr_b16 v[12:13], v247 offset:61440
v_mfma_f32_16x16x32_bf16 v[188:191], v[152:155], v[116:119], v[188:191]
ds_read_b64_tr_b16 v[14:15], v247 offset:63488
v_mfma_f32_16x16x32_bf16 v[188:191], v[156:159], v[128:131], v[188:191]
v_mfma_f32_16x16x32_bf16 v[184:187], v[156:159], v[124:127], v[184:187]
v_mfma_f32_16x16x32_bf16 v[184:187], v[152:155], v[112:115], v[184:187]
s_waitcnt vmcnt(12) lgkmcnt(0)
s_barrier
v_mfma_f32_16x16x32_bf16 v[196:199], v[208:211], v[112:115], v[196:199]
s_add_u32 m0, s42, 114688
v_add_u32 v245, s55, v246
buffer_load_dwordx4 v245, s[20:23], 0 offen lds
v_mfma_f32_16x16x32_bf16 v[196:199], v[212:215], v[124:127], v[196:199]
ds_read_b128 v[112:115], v160
ds_read_b128 v[124:127], v160 offset:7168
v_mfma_f32_16x16x32_bf16 v[200:203], v[212:215], v[128:131], v[200:203]
ds_read_b128 v[128:131], v160 offset:8192
v_xor_b32 v247, 0x10000, v247
v_mfma_f32_16x16x32_bf16 v[200:203], v[208:211], v[116:119], v[200:203]
buffer_load_dwordx4 v245, s[20:23], s38 offen offset:1024 lds
ds_read_b128 v[116:119], v160 offset:1024
v_mfma_f32_16x16x32_bf16 v[204:207], v[208:211], v[120:123], v[204:207]
ds_read_b128 v[120:123], v160 offset:2048
ds_read_b64_tr_b16 v[28:29], v247 offset:12288
v_mfma_f32_16x16x32_bf16 v[204:207], v[212:215], v[132:135], v[204:207]
ds_read_b128 v[132:135], v160 offset:9216
v_xor_b32 v164, 0x10000, v164
buffer_load_dwordx4 v245, s[20:23], s39 offen offset:2048 lds
s_waitcnt lgkmcnt(6)
v_mfma_f32_16x16x32_bf16 v[172:175], v[168:171], v[112:115], v[172:175]
ds_read_b64_tr_b16 v[140:141], v164 offset:8192
ds_read_b64_tr_b16 v[142:143], v164 offset:9216
s_waitcnt lgkmcnt(7)
v_mfma_f32_16x16x32_bf16 v[172:175], v[168:171], v[124:127], v[172:175]
ds_read_b64_tr_b16 v[136:137], v164
buffer_load_dwordx4 v245, s[20:23], s40 offen offset:3072 lds
s_waitcnt lgkmcnt(7)
v_mfma_f32_16x16x32_bf16 v[176:179], v[168:171], v[128:131], v[176:179]
ds_read_b64_tr_b16 v[138:139], v164 offset:1024
v_xor_b32 v165, 0x10000, v165
s_waitcnt lgkmcnt(7)
v_mfma_f32_16x16x32_bf16 v[176:179], v[168:171], v[116:119], v[176:179]
ds_read_b64_tr_b16 v[144:145], v165
s_add_u32 m0, s42, 49152
v_add_u32 v245, s56, v246
buffer_load_dwordx4 v245, s[20:23], 0 offen lds
s_waitcnt lgkmcnt(7)
v_mfma_f32_16x16x32_bf16 v[180:183], v[168:171], v[120:123], v[180:183]
ds_read_b64_tr_b16 v[146:147], v165 offset:1024
ds_read_b64_tr_b16 v[148:149], v165 offset:8192
s_waitcnt lgkmcnt(7)
v_mfma_f32_16x16x32_bf16 v[180:183], v[168:171], v[132:135], v[180:183]
ds_read_b64_tr_b16 v[150:151], v165 offset:9216
buffer_load_dwordx4 v245, s[20:23], s38 offen offset:1024 lds
s_waitcnt lgkmcnt(6)
v_mfma_f32_16x16x32_bf16 v[192:195], v[140:143], v[132:135], v[192:195]
ds_read_b64_tr_b16 v[30:31], v247 offset:14336
ds_read_b64_tr_b16 v[24:25], v247 offset:8192
s_waitcnt lgkmcnt(6)
v_mfma_f32_16x16x32_bf16 v[192:195], v[136:139], v[120:123], v[192:195]
ds_read_b64_tr_b16 v[26:27], v247 offset:10240
buffer_load_dwordx4 v245, s[20:23], s39 offen offset:2048 lds
v_mfma_f32_16x16x32_bf16 v[188:191], v[136:139], v[116:119], v[188:191]
ds_read_b64_tr_b16 v[20:21], v247 offset:4096
ds_read_b64_tr_b16 v[22:23], v247 offset:6144
v_mfma_f32_16x16x32_bf16 v[188:191], v[140:143], v[128:131], v[188:191]
ds_read_b64_tr_b16 v[16:17], v247
ds_read_b64_tr_b16 v[18:19], v247 offset:2048
v_mfma_f32_16x16x32_bf16 v[184:187], v[140:143], v[124:127], v[184:187]
buffer_load_dwordx4 v245, s[20:23], s40 offen offset:3072 lds
v_mfma_f32_16x16x32_bf16 v[184:187], v[136:139], v[112:115], v[184:187]
s_waitcnt vmcnt(12) lgkmcnt(0)
s_barrier
v_mfma_f32_16x16x32_bf16 v[196:199], v[144:147], v[112:115], v[196:199]
s_add_u32 m0, s42, 0
v_add_u32 v244, 0x10000, v244
buffer_load_dwordx4 v244, s[12:15], 0 offen nt lds
v_mfma_f32_16x16x32_bf16 v[196:199], v[148:151], v[124:127], v[196:199]
ds_read_b128 v[112:115], v160 offset:3072
ds_read_b128 v[124:127], v160 offset:10240
v_mfma_f32_16x16x32_bf16 v[200:203], v[148:151], v[128:131], v[200:203]
ds_read_b128 v[128:131], v160 offset:11264
ds_read_b64_tr_b16 v[32:33], v247 offset:16384
v_mfma_f32_16x16x32_bf16 v[200:203], v[144:147], v[116:119], v[200:203]
buffer_load_dwordx4 v244, s[12:15], s32 offen offset:1024 nt lds
ds_read_b128 v[116:119], v160 offset:4096
v_mfma_f32_16x16x32_bf16 v[204:207], v[144:147], v[120:123], v[204:207]
ds_read_b128 v[120:123], v160 offset:5120
ds_read_b64_tr_b16 v[34:35], v247 offset:18432
v_mfma_f32_16x16x32_bf16 v[204:207], v[148:151], v[132:135], v[204:207]
ds_read_b128 v[132:135], v160 offset:12288
ds_read_b64_tr_b16 v[156:157], v164 offset:10240
buffer_load_dwordx4 v244, s[12:15], s33 offen offset:2048 nt lds
s_waitcnt lgkmcnt(8)
v_mfma_f32_16x16x32_bf16 v[172:175], v[168:171], v[112:115], v[172:175]
ds_read_b64_tr_b16 v[158:159], v164 offset:11264
ds_read_b64_tr_b16 v[152:153], v164 offset:2048
s_waitcnt lgkmcnt(9)
v_mfma_f32_16x16x32_bf16 v[172:175], v[168:171], v[124:127], v[172:175]
ds_read_b64_tr_b16 v[154:155], v164 offset:3072
buffer_load_dwordx4 v244, s[12:15], s34 offen offset:3072 nt lds
s_waitcnt lgkmcnt(9)
v_mfma_f32_16x16x32_bf16 v[176:179], v[168:171], v[128:131], v[176:179]
ds_read_b64_tr_b16 v[208:209], v165 offset:2048
ds_read_b64_tr_b16 v[210:211], v165 offset:3072
s_waitcnt lgkmcnt(9)
v_mfma_f32_16x16x32_bf16 v[176:179], v[168:171], v[116:119], v[176:179]
ds_read_b64_tr_b16 v[212:213], v165 offset:10240
ds_read_b64_tr_b16 v[214:215], v165 offset:11264
s_waitcnt lgkmcnt(10)
v_mfma_f32_16x16x32_bf16 v[180:183], v[168:171], v[120:123], v[180:183]
ds_read_b64_tr_b16 v[36:37], v247 offset:20480
ds_read_b64_tr_b16 v[38:39], v247 offset:22528
s_waitcnt lgkmcnt(10)
v_mfma_f32_16x16x32_bf16 v[180:183], v[168:171], v[132:135], v[180:183]
ds_read_b64_tr_b16 v[40:41], v247 offset:24576
ds_read_b64_tr_b16 v[42:43], v247 offset:26624
s_waitcnt lgkmcnt(10)
v_mfma_f32_16x16x32_bf16 v[192:195], v[156:159], v[132:135], v[192:195]
ds_read_b64_tr_b16 v[44:45], v247 offset:28672
ds_read_b64_tr_b16 v[46:47], v247 offset:30720
s_waitcnt lgkmcnt(10)
v_mfma_f32_16x16x32_bf16 v[192:195], v[152:155], v[120:123], v[192:195]
ds_read_b64_tr_b16 v[60:61], v247 offset:45056
ds_read_b64_tr_b16 v[62:63], v247 offset:47104
v_mfma_f32_16x16x32_bf16 v[188:191], v[152:155], v[116:119], v[188:191]
ds_read_b64_tr_b16 v[56:57], v247 offset:40960
ds_read_b64_tr_b16 v[58:59], v247 offset:43008
v_mfma_f32_16x16x32_bf16 v[188:191], v[156:159], v[128:131], v[188:191]
ds_read_b64_tr_b16 v[52:53], v247 offset:36864
ds_read_b64_tr_b16 v[54:55], v247 offset:38912
v_mfma_f32_16x16x32_bf16 v[184:187], v[156:159], v[124:127], v[184:187]
ds_read_b64_tr_b16 v[48:49], v247 offset:32768
ds_read_b64_tr_b16 v[50:51], v247 offset:34816
v_mfma_f32_16x16x32_bf16 v[184:187], v[152:155], v[112:115], v[184:187]
s_waitcnt vmcnt(8) lgkmcnt(0)
s_barrier
v_mfma_f32_16x16x32_bf16 v[196:199], v[208:211], v[112:115], v[196:199]
s_add_u32 m0, s42, 16384
v_add_u32 v244, 0xfffd0080, v244
buffer_load_dwordx4 v244, s[12:15], 0 offen nt lds
v_mfma_f32_16x16x32_bf16 v[196:199], v[212:215], v[124:127], v[196:199]
ds_read_b128 v[112:115], v160
ds_read_b128 v[124:127], v160 offset:7168
v_mfma_f32_16x16x32_bf16 v[200:203], v[212:215], v[128:131], v[200:203]
ds_read_b128 v[128:131], v160 offset:8192
v_xor_b32 v247, 0x10000, v247
v_mfma_f32_16x16x32_bf16 v[200:203], v[208:211], v[116:119], v[200:203]
buffer_load_dwordx4 v244, s[12:15], s32 offen offset:1024 nt lds
ds_read_b128 v[116:119], v160 offset:1024
v_mfma_f32_16x16x32_bf16 v[204:207], v[208:211], v[120:123], v[204:207]
ds_read_b128 v[120:123], v160 offset:2048
ds_read_b64_tr_b16 v[64:65], v247 offset:16384
v_mfma_f32_16x16x32_bf16 v[204:207], v[212:215], v[132:135], v[204:207]
ds_read_b128 v[132:135], v160 offset:9216
ds_read_b64_tr_b16 v[140:141], v164 offset:40960
buffer_load_dwordx4 v244, s[12:15], s33 offen offset:2048 nt lds
s_waitcnt lgkmcnt(7)
v_mfma_f32_16x16x32_bf16 v[172:175], v[168:171], v[112:115], v[172:175]
ds_read_b64_tr_b16 v[142:143], v164 offset:41984
ds_read_b64_tr_b16 v[136:137], v164 offset:32768
s_waitcnt lgkmcnt(8)
v_mfma_f32_16x16x32_bf16 v[172:175], v[168:171], v[124:127], v[172:175]
ds_read_b64_tr_b16 v[138:139], v164 offset:33792
buffer_load_dwordx4 v244, s[12:15], s34 offen offset:3072 nt lds
s_waitcnt lgkmcnt(8)
v_mfma_f32_16x16x32_bf16 v[176:179], v[168:171], v[128:131], v[176:179]
ds_read_b64_tr_b16 v[144:145], v165 offset:32768
ds_read_b64_tr_b16 v[146:147], v165 offset:33792
s_waitcnt lgkmcnt(9)
v_mfma_f32_16x16x32_bf16 v[176:179], v[168:171], v[116:119], v[176:179]
ds_read_b64_tr_b16 v[148:149], v165 offset:40960
s_add_u32 m0, s42, 32768
v_add_u32 v244, 0x10000, v244
buffer_load_dwordx4 v244, s[12:15], 0 offen nt lds
s_waitcnt lgkmcnt(9)
v_mfma_f32_16x16x32_bf16 v[180:183], v[168:171], v[120:123], v[180:183]
ds_read_b64_tr_b16 v[150:151], v165 offset:41984
ds_read_b64_tr_b16 v[66:67], v247 offset:18432
s_waitcnt lgkmcnt(9)
v_mfma_f32_16x16x32_bf16 v[180:183], v[168:171], v[132:135], v[180:183]
ds_read_b64_tr_b16 v[68:69], v247 offset:20480
buffer_load_dwordx4 v244, s[12:15], s32 offen offset:1024 nt lds
s_waitcnt lgkmcnt(8)
v_mfma_f32_16x16x32_bf16 v[192:195], v[140:143], v[132:135], v[192:195]
ds_read_b64_tr_b16 v[70:71], v247 offset:22528
ds_read_b64_tr_b16 v[72:73], v247 offset:24576
s_waitcnt lgkmcnt(8)
v_mfma_f32_16x16x32_bf16 v[192:195], v[136:139], v[120:123], v[192:195]
ds_read_b64_tr_b16 v[74:75], v247 offset:26624
buffer_load_dwordx4 v244, s[12:15], s33 offen offset:2048 nt lds
v_mfma_f32_16x16x32_bf16 v[188:191], v[136:139], v[116:119], v[188:191]
ds_read_b64_tr_b16 v[76:77], v247 offset:28672
ds_read_b64_tr_b16 v[78:79], v247 offset:30720
v_mfma_f32_16x16x32_bf16 v[188:191], v[140:143], v[128:131], v[188:191]
ds_read_b64_tr_b16 v[92:93], v247 offset:61440
ds_read_b64_tr_b16 v[94:95], v247 offset:63488
v_mfma_f32_16x16x32_bf16 v[184:187], v[140:143], v[124:127], v[184:187]
buffer_load_dwordx4 v244, s[12:15], s34 offen offset:3072 nt lds
ds_read_b64_tr_b16 v[88:89], v247 offset:57344
v_mfma_f32_16x16x32_bf16 v[184:187], v[136:139], v[112:115], v[184:187]
ds_read_b64_tr_b16 v[90:91], v247 offset:59392
ds_read_b64_tr_b16 v[84:85], v247 offset:53248
ds_read_b64_tr_b16 v[86:87], v247 offset:55296
ds_read_b64_tr_b16 v[80:81], v247 offset:49152
ds_read_b64_tr_b16 v[82:83], v247 offset:51200
s_waitcnt vmcnt(12) lgkmcnt(0)
s_barrier
v_mfma_f32_16x16x32_bf16 v[196:199], v[144:147], v[112:115], v[196:199]
ds_read_b128 v[112:115], v160 offset:3072
v_xor_b32 v247, 0x10000, v247
v_mfma_f32_16x16x32_bf16 v[196:199], v[148:151], v[124:127], v[196:199]
ds_read_b128 v[124:127], v160 offset:10240
ds_read_b64_tr_b16 v[96:97], v247 offset:49152
v_mfma_f32_16x16x32_bf16 v[200:203], v[148:151], v[128:131], v[200:203]
ds_read_b128 v[128:131], v160 offset:11264
ds_read_b64_tr_b16 v[98:99], v247 offset:51200
v_mfma_f32_16x16x32_bf16 v[200:203], v[144:147], v[116:119], v[200:203]
ds_read_b128 v[116:119], v160 offset:4096
ds_read_b64_tr_b16 v[100:101], v247 offset:53248
v_mfma_f32_16x16x32_bf16 v[204:207], v[144:147], v[120:123], v[204:207]
ds_read_b128 v[120:123], v160 offset:5120
ds_read_b64_tr_b16 v[102:103], v247 offset:55296
v_mfma_f32_16x16x32_bf16 v[204:207], v[148:151], v[132:135], v[204:207]
ds_read_b128 v[132:135], v160 offset:12288
ds_read_b64_tr_b16 v[156:157], v164 offset:43008
s_waitcnt lgkmcnt(10)
v_mfma_f32_16x16x32_bf16 v[172:175], v[168:171], v[112:115], v[172:175]
ds_read_b64_tr_b16 v[158:159], v164 offset:44032
ds_read_b64_tr_b16 v[152:153], v164 offset:34816
s_waitcnt lgkmcnt(11)
v_mfma_f32_16x16x32_bf16 v[172:175], v[168:171], v[124:127], v[172:175]
ds_read_b64_tr_b16 v[154:155], v164 offset:35840
ds_read_b64_tr_b16 v[208:209], v165 offset:34816
s_waitcnt lgkmcnt(11)
v_mfma_f32_16x16x32_bf16 v[176:179], v[168:171], v[128:131], v[176:179]
ds_read_b64_tr_b16 v[210:211], v165 offset:35840
ds_read_b64_tr_b16 v[212:213], v165 offset:43008
s_waitcnt lgkmcnt(11)
v_mfma_f32_16x16x32_bf16 v[176:179], v[168:171], v[116:119], v[176:179]
ds_read_b64_tr_b16 v[214:215], v165 offset:44032
ds_read_b64_tr_b16 v[104:105], v247 offset:57344
s_waitcnt lgkmcnt(11)
v_mfma_f32_16x16x32_bf16 v[180:183], v[168:171], v[120:123], v[180:183]
ds_read_b64_tr_b16 v[106:107], v247 offset:59392
ds_read_b64_tr_b16 v[108:109], v247 offset:61440
s_waitcnt lgkmcnt(11)
v_mfma_f32_16x16x32_bf16 v[180:183], v[168:171], v[132:135], v[180:183]
ds_read_b64_tr_b16 v[110:111], v247 offset:63488
s_waitcnt lgkmcnt(10)
v_mfma_f32_16x16x32_bf16 v[192:195], v[156:159], v[132:135], v[192:195]
s_waitcnt lgkmcnt(8)
v_mfma_f32_16x16x32_bf16 v[192:195], v[152:155], v[120:123], v[192:195]
v_mfma_f32_16x16x32_bf16 v[188:191], v[152:155], v[116:119], v[188:191]
s_add_u32 m0, s42, 65536
v_add_u32 v244, 0x10000, v244
buffer_load_dwordx4 v244, s[12:15], 0 offen nt lds
v_mfma_f32_16x16x32_bf16 v[188:191], v[156:159], v[128:131], v[188:191]
v_mfma_f32_16x16x32_bf16 v[184:187], v[156:159], v[124:127], v[184:187]
v_mfma_f32_16x16x32_bf16 v[184:187], v[152:155], v[112:115], v[184:187]
buffer_load_dwordx4 v244, s[12:15], s32 offen offset:1024 nt lds
s_waitcnt vmcnt(10) lgkmcnt(0)
s_barrier
v_mfma_f32_16x16x32_bf16 v[196:199], v[208:211], v[112:115], v[196:199]
buffer_load_dwordx4 v244, s[12:15], s33 offen offset:2048 nt lds
ds_read_b128 v[112:115], v160
v_mfma_f32_16x16x32_bf16 v[196:199], v[212:215], v[124:127], v[196:199]
ds_read_b128 v[124:127], v160 offset:7168
v_mfma_f32_16x16x32_bf16 v[200:203], v[212:215], v[128:131], v[200:203]
ds_read_b128 v[128:131], v160 offset:8192
v_mfma_f32_16x16x32_bf16 v[200:203], v[208:211], v[116:119], v[200:203]
buffer_load_dwordx4 v244, s[12:15], s34 offen offset:3072 nt lds
ds_read_b128 v[116:119], v160 offset:1024
v_mfma_f32_16x16x32_bf16 v[204:207], v[208:211], v[120:123], v[204:207]
ds_read_b128 v[120:123], v160 offset:2048
v_mfma_f32_16x16x32_bf16 v[204:207], v[212:215], v[132:135], v[204:207]
ds_read_b128 v[132:135], v160 offset:9216
v_xor_b32 v164, 0x10000, v164
s_add_u32 m0, s42, 81920
v_add_u32 v244, 0x10000, v244
buffer_load_dwordx4 v244, s[12:15], 0 offen nt lds
s_waitcnt lgkmcnt(5)
v_mfma_f32_16x16x32_bf16 v[172:175], v[168:171], v[112:115], v[172:175]
ds_read_b64_tr_b16 v[140:141], v164 offset:8192
ds_read_b64_tr_b16 v[142:143], v164 offset:9216
s_waitcnt lgkmcnt(6)
v_mfma_f32_16x16x32_bf16 v[172:175], v[168:171], v[124:127], v[172:175]
ds_read_b64_tr_b16 v[136:137], v164
ds_read_b64_tr_b16 v[138:139], v164 offset:1024
s_waitcnt lgkmcnt(7)
v_mfma_f32_16x16x32_bf16 v[176:179], v[168:171], v[128:131], v[176:179]
v_xor_b32 v165, 0x10000, v165
ds_read_b64_tr_b16 v[144:145], v165
s_waitcnt lgkmcnt(7)
v_mfma_f32_16x16x32_bf16 v[176:179], v[168:171], v[116:119], v[176:179]
ds_read_b64_tr_b16 v[146:147], v165 offset:1024
ds_read_b64_tr_b16 v[148:149], v165 offset:8192
s_waitcnt lgkmcnt(8)
v_mfma_f32_16x16x32_bf16 v[180:183], v[168:171], v[120:123], v[180:183]
ds_read_b64_tr_b16 v[150:151], v165 offset:9216
s_waitcnt lgkmcnt(8)
v_mfma_f32_16x16x32_bf16 v[180:183], v[168:171], v[132:135], v[180:183]
s_waitcnt lgkmcnt(6)
v_mfma_f32_16x16x32_bf16 v[192:195], v[140:143], v[132:135], v[192:195]
s_waitcnt lgkmcnt(4)
v_mfma_f32_16x16x32_bf16 v[192:195], v[136:139], v[120:123], v[192:195]
v_mfma_f32_16x16x32_bf16 v[188:191], v[136:139], v[116:119], v[188:191]
v_mfma_f32_16x16x32_bf16 v[188:191], v[140:143], v[128:131], v[188:191]
v_mfma_f32_16x16x32_bf16 v[184:187], v[140:143], v[124:127], v[184:187]
v_mfma_f32_16x16x32_bf16 v[184:187], v[136:139], v[112:115], v[184:187]
s_waitcnt lgkmcnt(0)
s_barrier
v_mfma_f32_16x16x32_bf16 v[196:199], v[144:147], v[112:115], v[196:199]
ds_read_b128 v[112:115], v160 offset:3072
v_mfma_f32_16x16x32_bf16 v[196:199], v[148:151], v[124:127], v[196:199]
ds_read_b128 v[124:127], v160 offset:10240
v_mfma_f32_16x16x32_bf16 v[200:203], v[148:151], v[128:131], v[200:203]
ds_read_b128 v[128:131], v160 offset:11264
v_mfma_f32_16x16x32_bf16 v[200:203], v[144:147], v[116:119], v[200:203]
ds_read_b128 v[116:119], v160 offset:4096
v_mfma_f32_16x16x32_bf16 v[204:207], v[144:147], v[120:123], v[204:207]
ds_read_b128 v[120:123], v160 offset:5120
v_mfma_f32_16x16x32_bf16 v[204:207], v[148:151], v[132:135], v[204:207]
ds_read_b128 v[132:135], v160 offset:12288
ds_read_b64_tr_b16 v[156:157], v164 offset:10240
s_waitcnt lgkmcnt(6)
v_mfma_f32_16x16x32_bf16 v[172:175], v[168:171], v[112:115], v[172:175]
ds_read_b64_tr_b16 v[158:159], v164 offset:11264
ds_read_b64_tr_b16 v[152:153], v164 offset:2048
s_waitcnt lgkmcnt(7)
v_mfma_f32_16x16x32_bf16 v[172:175], v[168:171], v[124:127], v[172:175]
ds_read_b64_tr_b16 v[154:155], v164 offset:3072
ds_read_b64_tr_b16 v[208:209], v165 offset:2048
s_waitcnt lgkmcnt(8)
v_mfma_f32_16x16x32_bf16 v[176:179], v[168:171], v[128:131], v[176:179]
ds_read_b64_tr_b16 v[210:211], v165 offset:3072
ds_read_b64_tr_b16 v[212:213], v165 offset:10240
s_waitcnt lgkmcnt(9)
v_mfma_f32_16x16x32_bf16 v[176:179], v[168:171], v[116:119], v[176:179]
ds_read_b64_tr_b16 v[214:215], v165 offset:11264
s_waitcnt lgkmcnt(9)
v_mfma_f32_16x16x32_bf16 v[180:183], v[168:171], v[120:123], v[180:183]
s_waitcnt lgkmcnt(8)
v_mfma_f32_16x16x32_bf16 v[180:183], v[168:171], v[132:135], v[180:183]
s_waitcnt lgkmcnt(6)
v_mfma_f32_16x16x32_bf16 v[192:195], v[156:159], v[132:135], v[192:195]
s_waitcnt lgkmcnt(4)
v_mfma_f32_16x16x32_bf16 v[192:195], v[152:155], v[120:123], v[192:195]
v_mfma_f32_16x16x32_bf16 v[188:191], v[152:155], v[116:119], v[188:191]
v_rcp_f32 v172, v172
v_mfma_f32_16x16x32_bf16 v[188:191], v[156:159], v[128:131], v[188:191]
v_rcp_f32 v176, v176
v_mfma_f32_16x16x32_bf16 v[184:187], v[156:159], v[124:127], v[184:187]
v_rcp_f32 v180, v180
v_mfma_f32_16x16x32_bf16 v[184:187], v[152:155], v[112:115], v[184:187]
s_nop 0
v_mul_f32 v192, v192, v180
v_mul_f32 v193, v193, v180
s_waitcnt lgkmcnt(2)
v_mfma_f32_16x16x32_bf16 v[196:199], v[208:211], v[112:115], v[196:199]
v_mul_f32 v194, v194, v180
v_mul_f32 v195, v195, v180
s_waitcnt lgkmcnt(0)
v_mfma_f32_16x16x32_bf16 v[196:199], v[212:215], v[124:127], v[196:199]
v_cvt_pk_bf16_f32 v192, v192, v193
v_cvt_pk_bf16_f32 v193, v194, v195
v_mfma_f32_16x16x32_bf16 v[200:203], v[212:215], v[128:131], v[200:203]
v_mul_f32 v188, v188, v176
v_mul_f32 v189, v189, v176
v_mfma_f32_16x16x32_bf16 v[200:203], v[208:211], v[116:119], v[200:203]
v_mul_f32 v190, v190, v176
v_mul_f32 v191, v191, v176
v_mfma_f32_16x16x32_bf16 v[204:207], v[208:211], v[120:123], v[204:207]
v_cvt_pk_bf16_f32 v188, v188, v189
v_cvt_pk_bf16_f32 v189, v190, v191
v_mfma_f32_16x16x32_bf16 v[204:207], v[212:215], v[132:135], v[204:207]
v_mul_f32 v184, v184, v172
v_mul_f32 v185, v185, v172
v_mul_f32 v186, v186, v172
v_mul_f32 v187, v187, v172
v_cvt_pk_bf16_f32 v184, v184, v185
v_cvt_pk_bf16_f32 v185, v186, v187
v_mul_f32 v196, v196, v172
v_mul_f32 v197, v197, v172
v_mul_f32 v198, v198, v172
v_mul_f32 v199, v199, v172
v_cvt_pk_bf16_f32 v186, v196, v197
v_cvt_pk_bf16_f32 v187, v198, v199
ds_write_b128 v161, v[184:187]
v_mul_f32 v200, v200, v176
v_mul_f32 v201, v201, v176
v_mul_f32 v202, v202, v176
v_mul_f32 v203, v203, v176
v_cvt_pk_bf16_f32 v190, v200, v201
v_cvt_pk_bf16_f32 v191, v202, v203
ds_write_b128 v161, v[188:191] offset:1024
v_mul_f32 v204, v204, v180
v_mul_f32 v205, v205, v180
v_mul_f32 v206, v206, v180
v_mul_f32 v207, v207, v180
v_cvt_pk_bf16_f32 v194, v204, v205
v_cvt_pk_bf16_f32 v195, v206, v207
ds_write_b128 v161, v[192:195] offset:2048
ds_write_b32 v162, v172
ds_write_b32 v162, v176 offset:256
ds_write_b32 v162, v180 offset:512
buffer_load_dwordx4 v244, s[12:15], s32 offen offset:1024 nt lds
buffer_load_dwordx4 v244, s[12:15], s33 offen offset:2048 nt lds
s_waitcnt lgkmcnt(0)
s_barrier
ds_read_b128 v[112:115], v248
buffer_load_dwordx4 v244, s[12:15], s34 offen offset:3072 nt lds
ds_read_b128 v[124:127], v248 offset:7168
ds_read_b128 v[136:139], v248 offset:14336
ds_read_b128 v[148:151], v248 offset:21504
ds_read_b128 v[152:155], v248 offset:22528
ds_read_b128 v[140:143], v248 offset:15360
ds_read_b128 v[128:131], v248 offset:8192
ds_read_b128 v[116:119], v248 offset:1024
ds_read_b128 v[120:123], v248 offset:2048
ds_read_b128 v[132:135], v248 offset:9216
s_add_u32 m0, s42, 114688
v_add_u32 v244, 0xfffd0080, v244
buffer_load_dwordx4 v244, s[12:15], 0 offen nt lds
s_waitcnt lgkmcnt(9)
v_mfma_f32_16x16x32_bf16 v[160:163], v[0:3], v[112:115], 0
ds_read_b128 v[144:147], v248 offset:16384
ds_read_b128 v[156:159], v248 offset:23552
s_waitcnt lgkmcnt(10)
v_mfma_f32_16x16x32_bf16 v[160:163], v[4:7], v[124:127], v[160:163]
buffer_load_dwordx4 v244, s[12:15], s32 offen offset:1024 nt lds
s_waitcnt lgkmcnt(9)
v_mfma_f32_16x16x32_bf16 v[160:163], v[8:11], v[136:139], v[160:163]
s_waitcnt lgkmcnt(8)
v_mfma_f32_16x16x32_bf16 v[160:163], v[12:15], v[148:151], v[160:163]
s_waitcnt lgkmcnt(7)
v_mfma_f32_16x16x32_bf16 v[164:167], v[12:15], v[152:155], 0
buffer_load_dwordx4 v244, s[12:15], s33 offen offset:2048 nt lds
s_waitcnt lgkmcnt(6)
v_mfma_f32_16x16x32_bf16 v[164:167], v[8:11], v[140:143], v[164:167]
s_waitcnt lgkmcnt(5)
v_mfma_f32_16x16x32_bf16 v[164:167], v[4:7], v[128:131], v[164:167]
s_waitcnt lgkmcnt(4)
v_mfma_f32_16x16x32_bf16 v[164:167], v[0:3], v[116:119], v[164:167]
buffer_load_dwordx4 v244, s[12:15], s34 offen offset:3072 nt lds
s_waitcnt lgkmcnt(3)
v_mfma_f32_16x16x32_bf16 v[168:171], v[0:3], v[120:123], 0
s_waitcnt lgkmcnt(2)
v_mfma_f32_16x16x32_bf16 v[168:171], v[4:7], v[132:135], v[168:171]
s_waitcnt lgkmcnt(1)
v_mfma_f32_16x16x32_bf16 v[168:171], v[8:11], v[144:147], v[168:171]
s_add_u32 m0, s42, 49152
v_add_u32 v244, 0x10000, v244
buffer_load_dwordx4 v244, s[12:15], 0 offen nt lds
s_waitcnt lgkmcnt(0)
v_mfma_f32_16x16x32_bf16 v[168:171], v[12:15], v[156:159], v[168:171]
v_mfma_f32_16x16x32_bf16 v[180:183], v[28:31], v[156:159], 0
v_mfma_f32_16x16x32_bf16 v[180:183], v[24:27], v[144:147], v[180:183]
buffer_load_dwordx4 v244, s[12:15], s32 offen offset:1024 nt lds
v_mfma_f32_16x16x32_bf16 v[180:183], v[20:23], v[132:135], v[180:183]
v_mfma_f32_16x16x32_bf16 v[180:183], v[16:19], v[120:123], v[180:183]
v_mfma_f32_16x16x32_bf16 v[176:179], v[16:19], v[116:119], 0
buffer_load_dwordx4 v244, s[12:15], s33 offen offset:2048 nt lds
v_mfma_f32_16x16x32_bf16 v[176:179], v[20:23], v[128:131], v[176:179]
v_mfma_f32_16x16x32_bf16 v[176:179], v[24:27], v[140:143], v[176:179]
v_mfma_f32_16x16x32_bf16 v[176:179], v[28:31], v[152:155], v[176:179]
buffer_load_dwordx4 v244, s[12:15], s34 offen offset:3072 nt lds
v_mfma_f32_16x16x32_bf16 v[172:175], v[28:31], v[148:151], 0
v_mfma_f32_16x16x32_bf16 v[172:175], v[24:27], v[136:139], v[172:175]
v_mfma_f32_16x16x32_bf16 v[172:175], v[20:23], v[124:127], v[172:175]
s_add_u32 m0, s42, 98304
v_add_u32 v244, 0x10000, v244
buffer_load_dwordx4 v244, s[12:15], 0 offen nt lds
v_mfma_f32_16x16x32_bf16 v[172:175], v[16:19], v[112:115], v[172:175]
v_mfma_f32_16x16x32_bf16 v[184:187], v[32:35], v[112:115], 0
v_mfma_f32_16x16x32_bf16 v[184:187], v[36:39], v[124:127], v[184:187]
v_mfma_f32_16x16x32_bf16 v[184:187], v[40:43], v[136:139], v[184:187]
v_mfma_f32_16x16x32_bf16 v[184:187], v[44:47], v[148:151], v[184:187]
v_mfma_f32_16x16x32_bf16 v[188:191], v[44:47], v[152:155], 0
v_mfma_f32_16x16x32_bf16 v[188:191], v[40:43], v[140:143], v[188:191]
v_mfma_f32_16x16x32_bf16 v[188:191], v[36:39], v[128:131], v[188:191]
v_mfma_f32_16x16x32_bf16 v[188:191], v[32:35], v[116:119], v[188:191]
v_mfma_f32_16x16x32_bf16 v[192:195], v[32:35], v[120:123], 0
v_mfma_f32_16x16x32_bf16 v[192:195], v[36:39], v[132:135], v[192:195]
s_waitcnt vmcnt(21)
s_barrier
v_mfma_f32_16x16x32_bf16 v[192:195], v[40:43], v[144:147], v[192:195]
v_mfma_f32_16x16x32_bf16 v[192:195], v[44:47], v[156:159], v[192:195]
v_mfma_f32_16x16x32_bf16 v[204:207], v[60:63], v[156:159], 0
v_mfma_f32_16x16x32_bf16 v[204:207], v[56:59], v[144:147], v[204:207]
v_mfma_f32_16x16x32_bf16 v[204:207], v[52:55], v[132:135], v[204:207]
v_mfma_f32_16x16x32_bf16 v[204:207], v[48:51], v[120:123], v[204:207]
v_mfma_f32_16x16x32_bf16 v[200:203], v[48:51], v[116:119], 0
v_mfma_f32_16x16x32_bf16 v[200:203], v[52:55], v[128:131], v[200:203]
v_mfma_f32_16x16x32_bf16 v[200:203], v[56:59], v[140:143], v[200:203]
v_mfma_f32_16x16x32_bf16 v[200:203], v[60:63], v[152:155], v[200:203]
v_mfma_f32_16x16x32_bf16 v[196:199], v[60:63], v[148:151], 0
v_mfma_f32_16x16x32_bf16 v[196:199], v[56:59], v[136:139], v[196:199]
v_mfma_f32_16x16x32_bf16 v[196:199], v[52:55], v[124:127], v[196:199]
v_mfma_f32_16x16x32_bf16 v[196:199], v[48:51], v[112:115], v[196:199]
v_mfma_f32_16x16x32_bf16 v[208:211], v[64:67], v[112:115], 0
v_mfma_f32_16x16x32_bf16 v[208:211], v[68:71], v[124:127], v[208:211]
v_mfma_f32_16x16x32_bf16 v[208:211], v[72:75], v[136:139], v[208:211]
v_mfma_f32_16x16x32_bf16 v[208:211], v[76:79], v[148:151], v[208:211]
v_mfma_f32_16x16x32_bf16 v[212:215], v[76:79], v[152:155], 0
v_mfma_f32_16x16x32_bf16 v[212:215], v[72:75], v[140:143], v[212:215]
v_mfma_f32_16x16x32_bf16 v[212:215], v[68:71], v[128:131], v[212:215]
v_mfma_f32_16x16x32_bf16 v[212:215], v[64:67], v[116:119], v[212:215]
v_mfma_f32_16x16x32_bf16 v[216:219], v[64:67], v[120:123], 0
v_mfma_f32_16x16x32_bf16 v[216:219], v[68:71], v[132:135], v[216:219]
buffer_load_dwordx4 v244, s[12:15], s32 offen offset:1024 nt lds
s_waitcnt vmcnt(18)
s_barrier
v_mfma_f32_16x16x32_bf16 v[216:219], v[72:75], v[144:147], v[216:219]
v_mfma_f32_16x16x32_bf16 v[216:219], v[76:79], v[156:159], v[216:219]
v_mfma_f32_16x16x32_bf16 v[228:231], v[92:95], v[156:159], 0
v_mfma_f32_16x16x32_bf16 v[228:231], v[88:91], v[144:147], v[228:231]
v_mfma_f32_16x16x32_bf16 v[228:231], v[84:87], v[132:135], v[228:231]
v_mfma_f32_16x16x32_bf16 v[228:231], v[80:83], v[120:123], v[228:231]
v_mfma_f32_16x16x32_bf16 v[224:227], v[80:83], v[116:119], 0
v_mfma_f32_16x16x32_bf16 v[224:227], v[84:87], v[128:131], v[224:227]
v_mfma_f32_16x16x32_bf16 v[224:227], v[88:91], v[140:143], v[224:227]
s_add_u32 m0, s42, 0
v_add_u32 v246, 0xe000, v246
v_add_u32 v245, s50, v246
buffer_load_dwordx4 v245, s[20:23], 0 offen lds
v_mfma_f32_16x16x32_bf16 v[224:227], v[92:95], v[152:155], v[224:227]
v_mfma_f32_16x16x32_bf16 v[220:223], v[92:95], v[148:151], 0
v_mfma_f32_16x16x32_bf16 v[220:223], v[88:91], v[136:139], v[220:223]
buffer_load_dwordx4 v245, s[20:23], s38 offen offset:1024 lds
v_mfma_f32_16x16x32_bf16 v[220:223], v[84:87], v[124:127], v[220:223]
v_mfma_f32_16x16x32_bf16 v[220:223], v[80:83], v[112:115], v[220:223]
v_mfma_f32_16x16x32_bf16 v[232:235], v[96:99], v[112:115], 0
buffer_load_dwordx4 v245, s[20:23], s39 offen offset:2048 lds
v_mfma_f32_16x16x32_bf16 v[232:235], v[100:103], v[124:127], v[232:235]
v_mfma_f32_16x16x32_bf16 v[232:235], v[104:107], v[136:139], v[232:235]
v_mfma_f32_16x16x32_bf16 v[232:235], v[108:111], v[148:151], v[232:235]
v_mfma_f32_16x16x32_bf16 v[236:239], v[108:111], v[152:155], 0
v_mfma_f32_16x16x32_bf16 v[236:239], v[104:107], v[140:143], v[236:239]
v_mfma_f32_16x16x32_bf16 v[236:239], v[100:103], v[128:131], v[236:239]
v_mfma_f32_16x16x32_bf16 v[236:239], v[96:99], v[116:119], v[236:239]
v_mfma_f32_16x16x32_bf16 v[240:243], v[96:99], v[120:123], 0
v_mfma_f32_16x16x32_bf16 v[240:243], v[100:103], v[132:135], v[240:243]
s_waitcnt vmcnt(17)
s_barrier
v_mfma_f32_16x16x32_bf16 v[240:243], v[104:107], v[144:147], v[240:243]
v_mfma_f32_16x16x32_bf16 v[240:243], v[108:111], v[156:159], v[240:243]
buffer_load_dwordx4 v245, s[20:23], s40 offen offset:3072 lds
s_add_u32 m0, s42, 98304
s_nop 0
buffer_load_dwordx4 v244, s[12:15], s33 offen offset:2048 nt lds
buffer_load_dwordx4 v244, s[12:15], s34 offen offset:3072 nt lds
s_add_u32 m0, s42, 16384
v_add_u32 v245, s51, v246
buffer_load_dwordx4 v245, s[20:23], 0 offen lds
s_waitcnt vmcnt(17)
s_barrier
buffer_load_dwordx4 v245, s[20:23], s38 offen offset:1024 lds
buffer_load_dwordx4 v245, s[20:23], s39 offen offset:2048 lds
buffer_load_dwordx4 v245, s[20:23], s40 offen offset:3072 lds
s_add_u32 m0, s42, 32768
v_add_u32 v244, 0x10000, v244
buffer_load_dwordx4 v244, s[12:15], 0 offen nt lds
s_waitcnt vmcnt(17)
s_barrier
s_add_u32 m0, s42, 65536
v_add_u32 v245, s52, v246
buffer_load_dwordx4 v245, s[20:23], 0 offen lds
buffer_load_dwordx4 v245, s[20:23], s38 offen offset:1024 lds
s_waitcnt vmcnt(15)
s_barrier
buffer_load_dwordx4 v245, s[20:23], s39 offen offset:2048 lds
buffer_load_dwordx4 v245, s[20:23], s40 offen offset:3072 lds
s_add_u32 m0, s42, 32768
s_nop 0
buffer_load_dwordx4 v244, s[12:15], s32 offen offset:1024 nt lds
s_add_u32 m0, s42, 81920
v_add_u32 v245, s53, v246
buffer_load_dwordx4 v245, s[20:23], 0 offen lds
s_waitcnt vmcnt(13)
s_barrier
ds_read_b128 v[112:115], v248
ds_read_b128 v[124:127], v248 offset:7168
ds_read_b128 v[136:139], v248 offset:14336
ds_read_b128 v[148:151], v248 offset:21504
ds_read_b128 v[152:155], v248 offset:22528
ds_read_b128 v[140:143], v248 offset:15360
ds_read_b128 v[128:131], v248 offset:8192
ds_read_b128 v[116:119], v248 offset:1024
ds_read_b128 v[120:123], v248 offset:2048
ds_read_b128 v[132:135], v248 offset:9216
ds_read_b128 v[144:147], v248 offset:16384
ds_read_b128 v[156:159], v248 offset:23552
ds_read_b64_tr_b16 v[0:1], v247
ds_read_b64_tr_b16 v[2:3], v247 offset:2048
ds_read_b64_tr_b16 v[4:5], v247 offset:4096
ds_read_b64_tr_b16 v[6:7], v247 offset:6144
ds_read_b64_tr_b16 v[8:9], v247 offset:8192
ds_read_b64_tr_b16 v[10:11], v247 offset:10240
ds_read_b64_tr_b16 v[12:13], v247 offset:12288
ds_read_b64_tr_b16 v[14:15], v247 offset:14336
s_waitcnt lgkmcnt(6)
v_mfma_f32_16x16x32_bf16 v[160:163], v[0:3], v[112:115], v[160:163]
s_waitcnt lgkmcnt(4)
v_mfma_f32_16x16x32_bf16 v[160:163], v[4:7], v[124:127], v[160:163]
s_waitcnt lgkmcnt(2)
v_mfma_f32_16x16x32_bf16 v[160:163], v[8:11], v[136:139], v[160:163]
s_waitcnt lgkmcnt(0)
v_mfma_f32_16x16x32_bf16 v[160:163], v[12:15], v[148:151], v[160:163]
v_mfma_f32_16x16x32_bf16 v[164:167], v[12:15], v[152:155], v[164:167]
v_mfma_f32_16x16x32_bf16 v[164:167], v[8:11], v[140:143], v[164:167]
v_mfma_f32_16x16x32_bf16 v[164:167], v[4:7], v[128:131], v[164:167]
v_mfma_f32_16x16x32_bf16 v[164:167], v[0:3], v[116:119], v[164:167]
v_mfma_f32_16x16x32_bf16 v[168:171], v[0:3], v[120:123], v[168:171]
v_mfma_f32_16x16x32_bf16 v[168:171], v[4:7], v[132:135], v[168:171]
s_waitcnt vmcnt(11)
s_barrier
v_mfma_f32_16x16x32_bf16 v[168:171], v[8:11], v[144:147], v[168:171]
buffer_load_dwordx4 v245, s[20:23], s38 offen offset:1024 lds
v_mfma_f32_16x16x32_bf16 v[168:171], v[12:15], v[156:159], v[168:171]
buffer_load_dwordx4 v245, s[20:23], s39 offen offset:2048 lds
buffer_load_dwordx4 v245, s[20:23], s40 offen offset:3072 lds
s_add_u32 m0, s42, 32768
s_nop 0
buffer_load_dwordx4 v244, s[12:15], s33 offen offset:2048 nt lds
buffer_load_dwordx4 v244, s[12:15], s34 offen offset:3072 nt lds
s_add_u32 m0, s42, 114688
v_add_u32 v244, 0xfffd0080, v244
buffer_load_dwordx4 v244, s[12:15], 0 offen nt lds
buffer_load_dwordx4 v244, s[12:15], s32 offen offset:1024 nt lds
s_waitcnt vmcnt(14)
s_barrier
ds_read_b64_tr_b16 v[28:29], v247 offset:28672
s_add_u32 m0, s42, 49152
v_add_u32 v245, s54, v246
buffer_load_dwordx4 v245, s[20:23], 0 offen lds
ds_read_b64_tr_b16 v[30:31], v247 offset:30720
ds_read_b64_tr_b16 v[24:25], v247 offset:24576
ds_read_b64_tr_b16 v[26:27], v247 offset:26624
ds_read_b64_tr_b16 v[20:21], v247 offset:20480
ds_read_b64_tr_b16 v[22:23], v247 offset:22528
ds_read_b64_tr_b16 v[16:17], v247 offset:16384
ds_read_b64_tr_b16 v[18:19], v247 offset:18432
s_waitcnt lgkmcnt(6)
v_mfma_f32_16x16x32_bf16 v[180:183], v[28:31], v[156:159], v[180:183]
buffer_load_dwordx4 v245, s[20:23], s38 offen offset:1024 lds
s_waitcnt lgkmcnt(4)
v_mfma_f32_16x16x32_bf16 v[180:183], v[24:27], v[144:147], v[180:183]
s_waitcnt lgkmcnt(2)
v_mfma_f32_16x16x32_bf16 v[180:183], v[20:23], v[132:135], v[180:183]
s_waitcnt lgkmcnt(0)
v_mfma_f32_16x16x32_bf16 v[180:183], v[16:19], v[120:123], v[180:183]
v_mfma_f32_16x16x32_bf16 v[176:179], v[16:19], v[116:119], v[176:179]
v_mfma_f32_16x16x32_bf16 v[176:179], v[20:23], v[128:131], v[176:179]
v_mfma_f32_16x16x32_bf16 v[176:179], v[24:27], v[140:143], v[176:179]
v_mfma_f32_16x16x32_bf16 v[176:179], v[28:31], v[152:155], v[176:179]
v_mfma_f32_16x16x32_bf16 v[172:175], v[28:31], v[148:151], v[172:175]
v_mfma_f32_16x16x32_bf16 v[172:175], v[24:27], v[136:139], v[172:175]
s_waitcnt vmcnt(11)
s_barrier
v_xor_b32 v247, 0x10000, v247
ds_read_b64_tr_b16 v[32:33], v247
v_mfma_f32_16x16x32_bf16 v[172:175], v[20:23], v[124:127], v[172:175]
ds_read_b64_tr_b16 v[34:35], v247 offset:2048
ds_read_b64_tr_b16 v[36:37], v247 offset:4096
v_mfma_f32_16x16x32_bf16 v[172:175], v[16:19], v[112:115], v[172:175]
ds_read_b64_tr_b16 v[38:39], v247 offset:6144
ds_read_b64_tr_b16 v[40:41], v247 offset:8192
ds_read_b64_tr_b16 v[42:43], v247 offset:10240
ds_read_b64_tr_b16 v[44:45], v247 offset:12288
ds_read_b64_tr_b16 v[46:47], v247 offset:14336
s_waitcnt lgkmcnt(6)
v_mfma_f32_16x16x32_bf16 v[184:187], v[32:35], v[112:115], v[184:187]
s_waitcnt lgkmcnt(4)
v_mfma_f32_16x16x32_bf16 v[184:187], v[36:39], v[124:127], v[184:187]
s_waitcnt lgkmcnt(2)
v_mfma_f32_16x16x32_bf16 v[184:187], v[40:43], v[136:139], v[184:187]
s_waitcnt lgkmcnt(0)
v_mfma_f32_16x16x32_bf16 v[184:187], v[44:47], v[148:151], v[184:187]
v_mfma_f32_16x16x32_bf16 v[188:191], v[44:47], v[152:155], v[188:191]
v_mfma_f32_16x16x32_bf16 v[188:191], v[40:43], v[140:143], v[188:191]
v_mfma_f32_16x16x32_bf16 v[188:191], v[36:39], v[128:131], v[188:191]
v_mfma_f32_16x16x32_bf16 v[188:191], v[32:35], v[116:119], v[188:191]
v_mfma_f32_16x16x32_bf16 v[192:195], v[32:35], v[120:123], v[192:195]
v_mfma_f32_16x16x32_bf16 v[192:195], v[36:39], v[132:135], v[192:195]
buffer_load_dwordx4 v245, s[20:23], s39 offen offset:2048 lds
buffer_load_dwordx4 v245, s[20:23], s40 offen offset:3072 lds
s_waitcnt vmcnt(8)
s_barrier
ds_read_b64_tr_b16 v[60:61], v247 offset:28672
ds_read_b64_tr_b16 v[62:63], v247 offset:30720
v_mfma_f32_16x16x32_bf16 v[192:195], v[40:43], v[144:147], v[192:195]
ds_read_b64_tr_b16 v[56:57], v247 offset:24576
ds_read_b64_tr_b16 v[58:59], v247 offset:26624
v_mfma_f32_16x16x32_bf16 v[192:195], v[44:47], v[156:159], v[192:195]
ds_read_b64_tr_b16 v[52:53], v247 offset:20480
ds_read_b64_tr_b16 v[54:55], v247 offset:22528
ds_read_b64_tr_b16 v[48:49], v247 offset:16384
ds_read_b64_tr_b16 v[50:51], v247 offset:18432
s_waitcnt lgkmcnt(6)
v_mfma_f32_16x16x32_bf16 v[204:207], v[60:63], v[156:159], v[204:207]
s_waitcnt lgkmcnt(4)
v_mfma_f32_16x16x32_bf16 v[204:207], v[56:59], v[144:147], v[204:207]
s_waitcnt lgkmcnt(2)
v_mfma_f32_16x16x32_bf16 v[204:207], v[52:55], v[132:135], v[204:207]
s_add_u32 m0, s42, 0
v_add_u32 v245, s55, v246
buffer_load_dwordx4 v245, s[20:23], 0 offen lds
s_waitcnt lgkmcnt(0)
v_mfma_f32_16x16x32_bf16 v[204:207], v[48:51], v[120:123], v[204:207]
v_mfma_f32_16x16x32_bf16 v[200:203], v[48:51], v[116:119], v[200:203]
v_mfma_f32_16x16x32_bf16 v[200:203], v[52:55], v[128:131], v[200:203]
buffer_load_dwordx4 v245, s[20:23], s38 offen offset:1024 lds
v_mfma_f32_16x16x32_bf16 v[200:203], v[56:59], v[140:143], v[200:203]
v_mfma_f32_16x16x32_bf16 v[200:203], v[60:63], v[152:155], v[200:203]
v_mfma_f32_16x16x32_bf16 v[196:199], v[60:63], v[148:151], v[196:199]
buffer_load_dwordx4 v245, s[20:23], s39 offen offset:2048 lds
v_mfma_f32_16x16x32_bf16 v[196:199], v[56:59], v[136:139], v[196:199]
s_waitcnt vmcnt(9)
s_barrier
v_mfma_f32_16x16x32_bf16 v[196:199], v[52:55], v[124:127], v[196:199]
buffer_load_dwordx4 v245, s[20:23], s40 offen offset:3072 lds
v_mfma_f32_16x16x32_bf16 v[196:199], v[48:51], v[112:115], v[196:199]
s_add_u32 m0, s42, 98304
v_add_u32 v245, s56, v246
buffer_load_dwordx4 v245, s[20:23], 0 offen lds
buffer_load_dwordx4 v245, s[20:23], s38 offen offset:1024 lds
buffer_load_dwordx4 v245, s[20:23], s39 offen offset:2048 lds
buffer_load_dwordx4 v245, s[20:23], s40 offen offset:3072 lds
s_add_u32 m0, s42, 114688
s_nop 0
buffer_load_dwordx4 v244, s[12:15], s33 offen offset:2048 nt lds
buffer_load_dwordx4 v244, s[12:15], s34 offen offset:3072 nt lds
s_add_u32 m0, s42, 16384
v_add_u32 v244, 0x10000, v244
buffer_load_dwordx4 v244, s[12:15], 0 offen nt lds
buffer_load_dwordx4 v244, s[12:15], s32 offen offset:1024 nt lds
buffer_load_dwordx4 v244, s[12:15], s33 offen offset:2048 nt lds
buffer_load_dwordx4 v244, s[12:15], s34 offen offset:3072 nt lds
s_waitcnt vmcnt(10)
s_barrier
v_xor_b32 v247, 0x10000, v247
s_add_u32 m0, s42, 65536
v_add_u32 v244, 0x10000, v244
buffer_load_dwordx4 v244, s[12:15], 0 offen nt lds
ds_read_b64_tr_b16 v[64:65], v247 offset:49152
ds_read_b64_tr_b16 v[66:67], v247 offset:51200
ds_read_b64_tr_b16 v[68:69], v247 offset:53248
ds_read_b64_tr_b16 v[70:71], v247 offset:55296
ds_read_b64_tr_b16 v[72:73], v247 offset:57344
ds_read_b64_tr_b16 v[74:75], v247 offset:59392
ds_read_b64_tr_b16 v[76:77], v247 offset:61440
ds_read_b64_tr_b16 v[78:79], v247 offset:63488
ds_read_b64_tr_b16 v[92:93], v247 offset:12288
buffer_load_dwordx4 v244, s[12:15], s32 offen offset:1024 nt lds
ds_read_b64_tr_b16 v[94:95], v247 offset:14336
ds_read_b64_tr_b16 v[88:89], v247 offset:8192
ds_read_b64_tr_b16 v[90:91], v247 offset:10240
ds_read_b64_tr_b16 v[84:85], v247 offset:4096
ds_read_b64_tr_b16 v[86:87], v247 offset:6144
ds_read_b64_tr_b16 v[80:81], v247
ds_read_b64_tr_b16 v[82:83], v247 offset:2048
s_waitcnt lgkmcnt(14)
v_mfma_f32_16x16x32_bf16 v[208:211], v[64:67], v[112:115], v[208:211]
buffer_load_dwordx4 v244, s[12:15], s33 offen offset:2048 nt lds
s_waitcnt lgkmcnt(12)
v_mfma_f32_16x16x32_bf16 v[208:211], v[68:71], v[124:127], v[208:211]
s_waitcnt lgkmcnt(10)
v_mfma_f32_16x16x32_bf16 v[208:211], v[72:75], v[136:139], v[208:211]
s_waitcnt lgkmcnt(8)
v_mfma_f32_16x16x32_bf16 v[208:211], v[76:79], v[148:151], v[208:211]
buffer_load_dwordx4 v244, s[12:15], s34 offen offset:3072 nt lds
v_mfma_f32_16x16x32_bf16 v[212:215], v[76:79], v[152:155], v[212:215]
v_mfma_f32_16x16x32_bf16 v[212:215], v[72:75], v[140:143], v[212:215]
v_mfma_f32_16x16x32_bf16 v[212:215], v[68:71], v[128:131], v[212:215]
s_add_u32 m0, s42, 81920
v_add_u32 v244, 0x10000, v244
buffer_load_dwordx4 v244, s[12:15], 0 offen nt lds
v_mfma_f32_16x16x32_bf16 v[212:215], v[64:67], v[116:119], v[212:215]
v_mfma_f32_16x16x32_bf16 v[216:219], v[64:67], v[120:123], v[216:219]
v_mfma_f32_16x16x32_bf16 v[216:219], v[68:71], v[132:135], v[216:219]
v_mfma_f32_16x16x32_bf16 v[216:219], v[72:75], v[144:147], v[216:219]
v_mfma_f32_16x16x32_bf16 v[216:219], v[76:79], v[156:159], v[216:219]
s_waitcnt lgkmcnt(6)
v_mfma_f32_16x16x32_bf16 v[228:231], v[92:95], v[156:159], v[228:231]
s_waitcnt lgkmcnt(4)
v_mfma_f32_16x16x32_bf16 v[228:231], v[88:91], v[144:147], v[228:231]
s_waitcnt lgkmcnt(2)
v_mfma_f32_16x16x32_bf16 v[228:231], v[84:87], v[132:135], v[228:231]
s_waitcnt lgkmcnt(0)
v_mfma_f32_16x16x32_bf16 v[228:231], v[80:83], v[120:123], v[228:231]
v_mfma_f32_16x16x32_bf16 v[224:227], v[80:83], v[116:119], v[224:227]
v_mfma_f32_16x16x32_bf16 v[224:227], v[84:87], v[128:131], v[224:227]
v_mfma_f32_16x16x32_bf16 v[224:227], v[88:91], v[140:143], v[224:227]
v_mfma_f32_16x16x32_bf16 v[224:227], v[92:95], v[152:155], v[224:227]
v_mfma_f32_16x16x32_bf16 v[220:223], v[92:95], v[148:151], v[220:223]
v_mfma_f32_16x16x32_bf16 v[220:223], v[88:91], v[136:139], v[220:223]
buffer_load_dwordx4 v244, s[12:15], s32 offen offset:1024 nt lds
buffer_load_dwordx4 v244, s[12:15], s33 offen offset:2048 nt lds
s_waitcnt vmcnt(13)
s_barrier
v_xor_b32 v247, 0x10000, v247
ds_read_b64_tr_b16 v[96:97], v247 offset:32768
v_mfma_f32_16x16x32_bf16 v[220:223], v[84:87], v[124:127], v[220:223]
ds_read_b64_tr_b16 v[98:99], v247 offset:34816
ds_read_b64_tr_b16 v[100:101], v247 offset:36864
v_mfma_f32_16x16x32_bf16 v[220:223], v[80:83], v[112:115], v[220:223]
ds_read_b64_tr_b16 v[102:103], v247 offset:38912
ds_read_b64_tr_b16 v[104:105], v247 offset:40960
ds_read_b64_tr_b16 v[106:107], v247 offset:43008
ds_read_b64_tr_b16 v[108:109], v247 offset:45056
ds_read_b64_tr_b16 v[110:111], v247 offset:47104
s_waitcnt lgkmcnt(6)
v_mfma_f32_16x16x32_bf16 v[232:235], v[96:99], v[112:115], v[232:235]
s_waitcnt lgkmcnt(4)
v_mfma_f32_16x16x32_bf16 v[232:235], v[100:103], v[124:127], v[232:235]
s_waitcnt lgkmcnt(2)
v_mfma_f32_16x16x32_bf16 v[232:235], v[104:107], v[136:139], v[232:235]
s_waitcnt lgkmcnt(0)
v_mfma_f32_16x16x32_bf16 v[232:235], v[108:111], v[148:151], v[232:235]
v_mfma_f32_16x16x32_bf16 v[236:239], v[108:111], v[152:155], v[236:239]
v_mfma_f32_16x16x32_bf16 v[236:239], v[104:107], v[140:143], v[236:239]
v_mfma_f32_16x16x32_bf16 v[236:239], v[100:103], v[128:131], v[236:239]
v_mfma_f32_16x16x32_bf16 v[236:239], v[96:99], v[116:119], v[236:239]
v_mfma_f32_16x16x32_bf16 v[240:243], v[96:99], v[120:123], v[240:243]
v_mfma_f32_16x16x32_bf16 v[240:243], v[100:103], v[132:135], v[240:243]
buffer_load_dwordx4 v244, s[12:15], s34 offen offset:3072 nt lds
s_add_u32 m0, s42, 32768
v_add_u32 v246, 0xe000, v246
v_add_u32 v245, s50, v246
buffer_load_dwordx4 v245, s[20:23], 0 offen lds
s_waitcnt vmcnt(13)
s_barrier
v_mfma_f32_16x16x32_bf16 v[240:243], v[104:107], v[144:147], v[240:243]
buffer_load_dwordx4 v245, s[20:23], s38 offen offset:1024 lds
v_mfma_f32_16x16x32_bf16 v[240:243], v[108:111], v[156:159], v[240:243]
s_waitcnt vmcnt(10)
s_barrier
s_waitcnt vmcnt(6)
s_barrier
buffer_load_dwordx4 v245, s[20:23], s39 offen offset:2048 lds
buffer_load_dwordx4 v245, s[20:23], s40 offen offset:3072 lds
s_add_u32 m0, s42, 49152
v_add_u32 v245, s51, v246
buffer_load_dwordx4 v245, s[20:23], 0 offen lds
buffer_load_dwordx4 v245, s[20:23], s38 offen offset:1024 lds
buffer_load_dwordx4 v245, s[20:23], s39 offen offset:2048 lds
buffer_load_dwordx4 v245, s[20:23], s40 offen offset:3072 lds
s_add_u32 m0, s42, 0
v_add_u32 v245, s52, v246
buffer_load_dwordx4 v245, s[20:23], 0 offen lds
buffer_load_dwordx4 v245, s[20:23], s38 offen offset:1024 lds
buffer_load_dwordx4 v245, s[20:23], s39 offen offset:2048 lds
buffer_load_dwordx4 v245, s[20:23], s40 offen offset:3072 lds
s_waitcnt vmcnt(8)
s_barrier
ds_read_b128 v[112:115], v248
s_add_u32 m0, s42, 98304
v_add_u32 v245, s53, v246
buffer_load_dwordx4 v245, s[20:23], 0 offen lds
ds_read_b128 v[124:127], v248 offset:7168
ds_read_b128 v[136:139], v248 offset:14336
ds_read_b128 v[148:151], v248 offset:21504
ds_read_b128 v[152:155], v248 offset:22528
ds_read_b128 v[140:143], v248 offset:15360
ds_read_b128 v[128:131], v248 offset:8192
ds_read_b128 v[116:119], v248 offset:1024
ds_read_b128 v[120:123], v248 offset:2048
ds_read_b128 v[132:135], v248 offset:9216
buffer_load_dwordx4 v245, s[20:23], s38 offen offset:1024 lds
ds_read_b128 v[144:147], v248 offset:16384
ds_read_b128 v[156:159], v248 offset:23552
v_xor_b32 v247, 0x10000, v247
ds_read_b64_tr_b16 v[0:1], v247 offset:32768
ds_read_b64_tr_b16 v[2:3], v247 offset:34816
ds_read_b64_tr_b16 v[4:5], v247 offset:36864
ds_read_b64_tr_b16 v[6:7], v247 offset:38912
ds_read_b64_tr_b16 v[8:9], v247 offset:40960
ds_read_b64_tr_b16 v[10:11], v247 offset:43008
buffer_load_dwordx4 v245, s[20:23], s39 offen offset:2048 lds
ds_read_b64_tr_b16 v[12:13], v247 offset:45056
ds_read_b64_tr_b16 v[14:15], v247 offset:47104
v_mbcnt_lo_u32_b32 v252, -1, 0
v_and_b32 v254, 7, v252
v_lshlrev_b32 v254, 2, v254
v_sub_u32 v253, s49, v252
v_and_b32 v253, 7, v253
v_lshlrev_b32 v252, 9, v252
v_lshl_add_u32 v252, v253, 2, v252
buffer_load_dwordx4 v245, s[20:23], s40 offen offset:3072 lds
s_lshl_b32 s46, s48, 12
s_add_u32 s46, s46, 16777216
s_add_u32 s4, s78, s46
s_addc_u32 s5, s79, 0
s_mov_b32 s6, 4096
s_lshl_b32 s46, s41, 7
s_lshl_b32 s47, s49, 9
s_waitcnt lgkmcnt(6)
v_mfma_f32_16x16x32_bf16 v[160:163], v[0:3], v[112:115], v[160:163]
s_add_u32 m0, s42, 114688
v_add_u32 v245, s54, v246
buffer_load_dwordx4 v245, s[20:23], 0 offen lds
s_waitcnt lgkmcnt(4)
v_mfma_f32_16x16x32_bf16 v[160:163], v[4:7], v[124:127], v[160:163]
s_waitcnt lgkmcnt(2)
v_mfma_f32_16x16x32_bf16 v[160:163], v[8:11], v[136:139], v[160:163]
s_waitcnt lgkmcnt(0)
v_mfma_f32_16x16x32_bf16 v[160:163], v[12:15], v[148:151], v[160:163]
buffer_load_dwordx4 v245, s[20:23], s38 offen offset:1024 lds
v_mfma_f32_16x16x32_bf16 v[164:167], v[12:15], v[152:155], v[164:167]
v_mfma_f32_16x16x32_bf16 v[164:167], v[8:11], v[140:143], v[164:167]
v_mfma_f32_16x16x32_bf16 v[164:167], v[4:7], v[128:131], v[164:167]
buffer_load_dwordx4 v245, s[20:23], s39 offen offset:2048 lds
v_mfma_f32_16x16x32_bf16 v[164:167], v[0:3], v[116:119], v[164:167]
v_mfma_f32_16x16x32_bf16 v[168:171], v[0:3], v[120:123], v[168:171]
v_mfma_f32_16x16x32_bf16 v[168:171], v[4:7], v[132:135], v[168:171]
buffer_load_dwordx4 v245, s[20:23], s40 offen offset:3072 lds
s_waitcnt vmcnt(12)
s_barrier
ds_read_b64_tr_b16 v[28:29], v247 offset:61440
s_add_u32 m0, s42, 16384
v_add_u32 v245, s55, v246
buffer_load_dwordx4 v245, s[20:23], 0 offen lds
ds_read_b64_tr_b16 v[30:31], v247 offset:63488
v_mfma_f32_16x16x32_bf16 v[168:171], v[8:11], v[144:147], v[168:171]
ds_read_b64_tr_b16 v[24:25], v247 offset:57344
ds_read_b64_tr_b16 v[26:27], v247 offset:59392
v_mfma_f32_16x16x32_bf16 v[168:171], v[12:15], v[156:159], v[168:171]
ds_read_b64_tr_b16 v[20:21], v247 offset:53248
ds_read_b64_tr_b16 v[22:23], v247 offset:55296
buffer_load_dwordx4 v245, s[20:23], s38 offen offset:1024 lds
ds_read_b64_tr_b16 v[16:17], v247 offset:49152
ds_read_b64_tr_b16 v[18:19], v247 offset:51200
s_waitcnt lgkmcnt(6)
v_mfma_f32_16x16x32_bf16 v[180:183], v[28:31], v[156:159], v[180:183]
buffer_load_dwordx4 v245, s[20:23], s39 offen offset:2048 lds
s_waitcnt lgkmcnt(4)
v_mfma_f32_16x16x32_bf16 v[180:183], v[24:27], v[144:147], v[180:183]
s_waitcnt lgkmcnt(2)
v_mfma_f32_16x16x32_bf16 v[180:183], v[20:23], v[132:135], v[180:183]
s_waitcnt lgkmcnt(0)
v_mfma_f32_16x16x32_bf16 v[180:183], v[16:19], v[120:123], v[180:183]
buffer_load_dwordx4 v245, s[20:23], s40 offen offset:3072 lds
v_mfma_f32_16x16x32_bf16 v[176:179], v[16:19], v[116:119], v[176:179]
v_mfma_f32_16x16x32_bf16 v[176:179], v[20:23], v[128:131], v[176:179]
v_mfma_f32_16x16x32_bf16 v[176:179], v[24:27], v[140:143], v[176:179]
s_add_u32 m0, s42, 65536
v_add_u32 v245, s56, v246
buffer_load_dwordx4 v245, s[20:23], 0 offen lds
v_mfma_f32_16x16x32_bf16 v[176:179], v[28:31], v[152:155], v[176:179]
v_mfma_f32_16x16x32_bf16 v[172:175], v[28:31], v[148:151], v[172:175]
v_mfma_f32_16x16x32_bf16 v[172:175], v[24:27], v[136:139], v[172:175]
buffer_load_dwordx4 v245, s[20:23], s38 offen offset:1024 lds
buffer_load_dwordx4 v245, s[20:23], s39 offen offset:2048 lds
buffer_load_dwordx4 v245, s[20:23], s40 offen offset:3072 lds
s_add_u32 m0, s42, 32768
v_add_u32 v246, 0xe000, v246
v_add_u32 v245, s50, v246
buffer_load_dwordx4 v245, s[20:23], 0 offen lds
buffer_load_dwordx4 v245, s[20:23], s38 offen offset:1024 lds
buffer_load_dwordx4 v245, s[20:23], s39 offen offset:2048 lds
s_waitcnt vmcnt(11)
s_barrier
ds_read_b64_tr_b16 v[32:33], v247
buffer_load_dwordx4 v245, s[20:23], s40 offen offset:3072 lds
ds_read_b64_tr_b16 v[34:35], v247 offset:2048
v_mfma_f32_16x16x32_bf16 v[172:175], v[20:23], v[124:127], v[172:175]
ds_read_b64_tr_b16 v[36:37], v247 offset:4096
ds_read_b64_tr_b16 v[38:39], v247 offset:6144
v_mfma_f32_16x16x32_bf16 v[172:175], v[16:19], v[112:115], v[172:175]
ds_read_b64_tr_b16 v[40:41], v247 offset:8192
ds_read_b64_tr_b16 v[42:43], v247 offset:10240
s_add_u32 m0, s42, 81920
v_add_u32 v245, s51, v246
buffer_load_dwordx4 v245, s[20:23], 0 offen lds
ds_read_b64_tr_b16 v[44:45], v247 offset:12288
ds_read_b64_tr_b16 v[46:47], v247 offset:14336
v_xor_b32 v247, 0x10000, v247
ds_read_b64_tr_b16 v[60:61], v247 offset:45056
ds_read_b64_tr_b16 v[62:63], v247 offset:47104
ds_read_b64_tr_b16 v[56:57], v247 offset:40960
s_waitcnt lgkmcnt(9)
v_mfma_f32_16x16x32_bf16 v[184:187], v[32:35], v[112:115], v[184:187]
buffer_load_dwordx4 v245, s[20:23], s38 offen offset:1024 lds
ds_read_b64_tr_b16 v[58:59], v247 offset:43008
s_waitcnt lgkmcnt(8)
v_mfma_f32_16x16x32_bf16 v[184:187], v[36:39], v[124:127], v[184:187]
ds_read_b64_tr_b16 v[52:53], v247 offset:36864
ds_read_b64_tr_b16 v[54:55], v247 offset:38912
s_waitcnt lgkmcnt(8)
v_mfma_f32_16x16x32_bf16 v[184:187], v[40:43], v[136:139], v[184:187]
buffer_load_dwordx4 v245, s[20:23], s39 offen offset:2048 lds
ds_read_b64_tr_b16 v[48:49], v247 offset:32768
s_waitcnt lgkmcnt(7)
v_mfma_f32_16x16x32_bf16 v[184:187], v[44:47], v[148:151], v[184:187]
ds_read_b64_tr_b16 v[50:51], v247 offset:34816
ds_read_b64_tr_b16 v[64:65], v247 offset:49152
v_mfma_f32_16x16x32_bf16 v[188:191], v[44:47], v[152:155], v[188:191]
ds_read_b64_tr_b16 v[66:67], v247 offset:51200
buffer_load_dwordx4 v245, s[20:23], s40 offen offset:3072 lds
v_mfma_f32_16x16x32_bf16 v[188:191], v[40:43], v[140:143], v[188:191]
ds_read_b64_tr_b16 v[68:69], v247 offset:53248
ds_read_b64_tr_b16 v[70:71], v247 offset:55296
v_mfma_f32_16x16x32_bf16 v[188:191], v[36:39], v[128:131], v[188:191]
ds_read_b64_tr_b16 v[72:73], v247 offset:57344
ds_read_b64_tr_b16 v[74:75], v247 offset:59392
v_mfma_f32_16x16x32_bf16 v[188:191], v[32:35], v[116:119], v[188:191]
s_add_u32 m0, s42, 49152
v_add_u32 v245, s52, v246
buffer_load_dwordx4 v245, s[20:23], 0 offen lds
v_mfma_f32_16x16x32_bf16 v[192:195], v[32:35], v[120:123], v[192:195]
ds_read_b64_tr_b16 v[76:77], v247 offset:61440
ds_read_b64_tr_b16 v[78:79], v247 offset:63488
v_mfma_f32_16x16x32_bf16 v[192:195], v[36:39], v[132:135], v[192:195]
v_mfma_f32_16x16x32_bf16 v[192:195], v[40:43], v[144:147], v[192:195]
buffer_load_dwordx4 v245, s[20:23], s38 offen offset:1024 lds
v_mfma_f32_16x16x32_bf16 v[192:195], v[44:47], v[156:159], v[192:195]
s_waitcnt lgkmcnt(14)
v_mfma_f32_16x16x32_bf16 v[204:207], v[60:63], v[156:159], v[204:207]
s_waitcnt lgkmcnt(12)
v_mfma_f32_16x16x32_bf16 v[204:207], v[56:59], v[144:147], v[204:207]
buffer_load_dwordx4 v245, s[20:23], s39 offen offset:2048 lds
s_waitcnt lgkmcnt(10)
v_mfma_f32_16x16x32_bf16 v[204:207], v[52:55], v[132:135], v[204:207]
s_waitcnt lgkmcnt(8)
v_mfma_f32_16x16x32_bf16 v[204:207], v[48:51], v[120:123], v[204:207]
v_mfma_f32_16x16x32_bf16 v[200:203], v[48:51], v[116:119], v[200:203]
buffer_load_dwordx4 v245, s[20:23], s40 offen offset:3072 lds
v_mfma_f32_16x16x32_bf16 v[200:203], v[52:55], v[128:131], v[200:203]
v_mfma_f32_16x16x32_bf16 v[200:203], v[56:59], v[140:143], v[200:203]
v_mfma_f32_16x16x32_bf16 v[200:203], v[60:63], v[152:155], v[200:203]
v_mfma_f32_16x16x32_bf16 v[196:199], v[60:63], v[148:151], v[196:199]
v_mfma_f32_16x16x32_bf16 v[196:199], v[56:59], v[136:139], v[196:199]
v_mfma_f32_16x16x32_bf16 v[196:199], v[52:55], v[124:127], v[196:199]
v_mfma_f32_16x16x32_bf16 v[196:199], v[48:51], v[112:115], v[196:199]
s_waitcnt lgkmcnt(6)
v_mfma_f32_16x16x32_bf16 v[208:211], v[64:67], v[112:115], v[208:211]
s_waitcnt lgkmcnt(4)
v_mfma_f32_16x16x32_bf16 v[208:211], v[68:71], v[124:127], v[208:211]
s_waitcnt lgkmcnt(2)
v_mfma_f32_16x16x32_bf16 v[208:211], v[72:75], v[136:139], v[208:211]
s_waitcnt lgkmcnt(0)
v_mfma_f32_16x16x32_bf16 v[208:211], v[76:79], v[148:151], v[208:211]
v_mfma_f32_16x16x32_bf16 v[212:215], v[76:79], v[152:155], v[212:215]
v_mfma_f32_16x16x32_bf16 v[212:215], v[72:75], v[140:143], v[212:215]
v_mfma_f32_16x16x32_bf16 v[212:215], v[68:71], v[128:131], v[212:215]
v_mfma_f32_16x16x32_bf16 v[212:215], v[64:67], v[116:119], v[212:215]
v_mfma_f32_16x16x32_bf16 v[216:219], v[64:67], v[120:123], v[216:219]
v_mfma_f32_16x16x32_bf16 v[216:219], v[68:71], v[132:135], v[216:219]
s_waitcnt vmcnt(8)
s_barrier
v_xor_b32 v247, 0x10000, v247
s_add_u32 m0, s42, 0
v_add_u32 v245, s53, v246
buffer_load_dwordx4 v245, s[20:23], 0 offen lds
ds_read_b64_tr_b16 v[92:93], v247 offset:28672
v_mfma_f32_16x16x32_bf16 v[216:219], v[72:75], v[144:147], v[216:219]
ds_read_b64_tr_b16 v[94:95], v247 offset:30720
ds_read_b64_tr_b16 v[88:89], v247 offset:24576
v_mfma_f32_16x16x32_bf16 v[216:219], v[76:79], v[156:159], v[216:219]
ds_read_b64_tr_b16 v[90:91], v247 offset:26624
ds_read_b64_tr_b16 v[84:85], v247 offset:20480
buffer_load_dwordx4 v245, s[20:23], s38 offen offset:1024 lds
ds_read_b64_tr_b16 v[86:87], v247 offset:22528
ds_read_b64_tr_b16 v[80:81], v247 offset:16384
ds_read_b64_tr_b16 v[82:83], v247 offset:18432
v_xor_b32 v247, 0x10000, v247
ds_read_b64_tr_b16 v[96:97], v247
ds_read_b64_tr_b16 v[98:99], v247 offset:2048
ds_read_b64_tr_b16 v[100:101], v247 offset:4096
ds_read_b64_tr_b16 v[102:103], v247 offset:6144
ds_read_b64_tr_b16 v[104:105], v247 offset:8192
buffer_load_dwordx4 v245, s[20:23], s39 offen offset:2048 lds
s_waitcnt lgkmcnt(11)
v_mfma_f32_16x16x32_bf16 v[228:231], v[92:95], v[156:159], v[228:231]
ds_read_b64_tr_b16 v[106:107], v247 offset:10240
ds_read_b64_tr_b16 v[108:109], v247 offset:12288
s_waitcnt lgkmcnt(11)
v_mfma_f32_16x16x32_bf16 v[228:231], v[88:91], v[144:147], v[228:231]
ds_read_b64_tr_b16 v[110:111], v247 offset:14336
buffer_load_dwordx4 v245, s[20:23], s40 offen offset:3072 lds
s_waitcnt lgkmcnt(10)
v_mfma_f32_16x16x32_bf16 v[228:231], v[84:87], v[132:135], v[228:231]
s_waitcnt lgkmcnt(8)
v_mfma_f32_16x16x32_bf16 v[228:231], v[80:83], v[120:123], v[228:231]
v_mfma_f32_16x16x32_bf16 v[224:227], v[80:83], v[116:119], v[224:227]
s_add_u32 m0, s42, 98304
v_add_u32 v245, s54, v246
buffer_load_dwordx4 v245, s[20:23], 0 offen lds
v_mfma_f32_16x16x32_bf16 v[224:227], v[84:87], v[128:131], v[224:227]
v_mfma_f32_16x16x32_bf16 v[224:227], v[88:91], v[140:143], v[224:227]
v_mfma_f32_16x16x32_bf16 v[224:227], v[92:95], v[152:155], v[224:227]
buffer_load_dwordx4 v245, s[20:23], s38 offen offset:1024 lds
v_mfma_f32_16x16x32_bf16 v[220:223], v[92:95], v[148:151], v[220:223]
v_mfma_f32_16x16x32_bf16 v[220:223], v[88:91], v[136:139], v[220:223]
v_mfma_f32_16x16x32_bf16 v[220:223], v[84:87], v[124:127], v[220:223]
buffer_load_dwordx4 v245, s[20:23], s39 offen offset:2048 lds
v_mfma_f32_16x16x32_bf16 v[220:223], v[80:83], v[112:115], v[220:223]
s_waitcnt lgkmcnt(6)
v_mfma_f32_16x16x32_bf16 v[232:235], v[96:99], v[112:115], v[232:235]
ds_read_b128 v[112:115], v248
s_waitcnt lgkmcnt(5)
v_mfma_f32_16x16x32_bf16 v[232:235], v[100:103], v[124:127], v[232:235]
buffer_load_dwordx4 v245, s[20:23], s40 offen offset:3072 lds
ds_read_b128 v[124:127], v248 offset:7168
s_waitcnt lgkmcnt(4)
v_mfma_f32_16x16x32_bf16 v[232:235], v[104:107], v[136:139], v[232:235]
ds_read_b128 v[136:139], v248 offset:14336
s_waitcnt lgkmcnt(3)
v_mfma_f32_16x16x32_bf16 v[232:235], v[108:111], v[148:151], v[232:235]
ds_read_b128 v[148:151], v248 offset:21504
s_add_u32 m0, s42, 114688
v_add_u32 v245, s55, v246
buffer_load_dwordx4 v245, s[20:23], 0 offen lds
v_mfma_f32_16x16x32_bf16 v[236:239], v[108:111], v[152:155], v[236:239]
ds_read_b128 v[152:155], v248 offset:22528
v_mfma_f32_16x16x32_bf16 v[236:239], v[104:107], v[140:143], v[236:239]
ds_read_b128 v[140:143], v248 offset:15360
v_mfma_f32_16x16x32_bf16 v[236:239], v[100:103], v[128:131], v[236:239]
buffer_load_dwordx4 v245, s[20:23], s38 offen offset:1024 lds
ds_read_b128 v[128:131], v248 offset:8192
v_mfma_f32_16x16x32_bf16 v[236:239], v[96:99], v[116:119], v[236:239]
ds_read_b128 v[116:119], v248 offset:1024
v_mfma_f32_16x16x32_bf16 v[240:243], v[96:99], v[120:123], v[240:243]
ds_read_b128 v[120:123], v248 offset:2048
v_mfma_f32_16x16x32_bf16 v[240:243], v[100:103], v[132:135], v[240:243]
buffer_load_dwordx4 v245, s[20:23], s39 offen offset:2048 lds
ds_read_b128 v[132:135], v248 offset:9216
v_mfma_f32_16x16x32_bf16 v[240:243], v[104:107], v[144:147], v[240:243]
ds_read_b128 v[144:147], v248 offset:16384
v_mfma_f32_16x16x32_bf16 v[240:243], v[108:111], v[156:159], v[240:243]
ds_read_b128 v[156:159], v248 offset:23552
v_xor_b32 v247, 0x10000, v247
buffer_load_dwordx4 v245, s[20:23], s40 offen offset:3072 lds
ds_read_b64_tr_b16 v[0:1], v247 offset:32768
ds_read_b64_tr_b16 v[2:3], v247 offset:34816
ds_read_b64_tr_b16 v[4:5], v247 offset:36864
ds_read_b64_tr_b16 v[6:7], v247 offset:38912
ds_read_b64_tr_b16 v[8:9], v247 offset:40960
ds_read_b64_tr_b16 v[10:11], v247 offset:43008
ds_read_b64_tr_b16 v[12:13], v247 offset:45056
ds_read_b64_tr_b16 v[14:15], v247 offset:47104
s_waitcnt lgkmcnt(6)
v_mfma_f32_16x16x32_bf16 v[160:163], v[0:3], v[112:115], v[160:163]
s_waitcnt lgkmcnt(4)
v_mfma_f32_16x16x32_bf16 v[160:163], v[4:7], v[124:127], v[160:163]
s_waitcnt lgkmcnt(2)
v_mfma_f32_16x16x32_bf16 v[160:163], v[8:11], v[136:139], v[160:163]
s_waitcnt lgkmcnt(0)
v_mfma_f32_16x16x32_bf16 v[160:163], v[12:15], v[148:151], v[160:163]
v_mfma_f32_16x16x32_bf16 v[164:167], v[12:15], v[152:155], v[164:167]
v_mfma_f32_16x16x32_bf16 v[164:167], v[8:11], v[140:143], v[164:167]
v_mfma_f32_16x16x32_bf16 v[164:167], v[4:7], v[128:131], v[164:167]
v_mfma_f32_16x16x32_bf16 v[164:167], v[0:3], v[116:119], v[164:167]
v_mfma_f32_16x16x32_bf16 v[168:171], v[0:3], v[120:123], v[168:171]
v_mfma_f32_16x16x32_bf16 v[168:171], v[4:7], v[132:135], v[168:171]
s_waitcnt vmcnt(4)
s_barrier
v_xor_b32 v247, 0x10000, v247
s_add_u32 m0, s42, 16384
v_add_u32 v245, s56, v246
buffer_load_dwordx4 v245, s[20:23], 0 offen lds
ds_read_b64_tr_b16 v[28:29], v247 offset:28672
v_mfma_f32_16x16x32_bf16 v[168:171], v[8:11], v[144:147], v[168:171]
ds_read_b64_tr_b16 v[30:31], v247 offset:30720
ds_read_b64_tr_b16 v[24:25], v247 offset:24576
v_mfma_f32_16x16x32_bf16 v[168:171], v[12:15], v[156:159], v[168:171]
ds_read_b64_tr_b16 v[26:27], v247 offset:26624
ds_read_b64_tr_b16 v[20:21], v247 offset:20480
buffer_load_dwordx4 v245, s[20:23], s38 offen offset:1024 lds
ds_read_b64_tr_b16 v[22:23], v247 offset:22528
ds_read_b64_tr_b16 v[16:17], v247 offset:16384
ds_read_b64_tr_b16 v[18:19], v247 offset:18432
v_xor_b32 v247, 0x10000, v247
ds_read_b64_tr_b16 v[32:33], v247 offset:49152
ds_read_b64_tr_b16 v[34:35], v247 offset:51200
ds_read_b64_tr_b16 v[36:37], v247 offset:53248
ds_read_b64_tr_b16 v[38:39], v247 offset:55296
ds_read_b64_tr_b16 v[40:41], v247 offset:57344
buffer_load_dwordx4 v245, s[20:23], s39 offen offset:2048 lds
s_waitcnt lgkmcnt(11)
v_mfma_f32_16x16x32_bf16 v[180:183], v[28:31], v[156:159], v[180:183]
ds_read_b64_tr_b16 v[42:43], v247 offset:59392
ds_read_b64_tr_b16 v[44:45], v247 offset:61440
s_waitcnt lgkmcnt(11)
v_mfma_f32_16x16x32_bf16 v[180:183], v[24:27], v[144:147], v[180:183]
ds_read_b64_tr_b16 v[46:47], v247 offset:63488
buffer_load_dwordx4 v245, s[20:23], s40 offen offset:3072 lds
s_waitcnt lgkmcnt(10)
v_mfma_f32_16x16x32_bf16 v[180:183], v[20:23], v[132:135], v[180:183]
ds_read_b64_tr_b16 v[60:61], v247 offset:12288
ds_read_b64_tr_b16 v[62:63], v247 offset:14336
s_waitcnt lgkmcnt(10)
v_mfma_f32_16x16x32_bf16 v[180:183], v[16:19], v[120:123], v[180:183]
ds_read_b64_tr_b16 v[56:57], v247 offset:8192
ds_read_b64_tr_b16 v[58:59], v247 offset:10240
v_mfma_f32_16x16x32_bf16 v[176:179], v[16:19], v[116:119], v[176:179]
ds_read_b64_tr_b16 v[52:53], v247 offset:4096
ds_read_b64_tr_b16 v[54:55], v247 offset:6144
v_mfma_f32_16x16x32_bf16 v[176:179], v[20:23], v[128:131], v[176:179]
ds_read_b64_tr_b16 v[48:49], v247
ds_read_b64_tr_b16 v[50:51], v247 offset:2048
v_mfma_f32_16x16x32_bf16 v[176:179], v[24:27], v[140:143], v[176:179]
v_xor_b32 v247, 0x10000, v247
ds_read_b64_tr_b16 v[64:65], v247 offset:32768
v_mfma_f32_16x16x32_bf16 v[176:179], v[28:31], v[152:155], v[176:179]
ds_read_b64_tr_b16 v[66:67], v247 offset:34816
ds_read_b64_tr_b16 v[68:69], v247 offset:36864
v_mfma_f32_16x16x32_bf16 v[172:175], v[28:31], v[148:151], v[172:175]
ds_read_b64_tr_b16 v[70:71], v247 offset:38912
ds_read_b64_tr_b16 v[72:73], v247 offset:40960
v_mfma_f32_16x16x32_bf16 v[172:175], v[24:27], v[136:139], v[172:175]
ds_read_b64_tr_b16 v[74:75], v247 offset:43008
ds_read_b64_tr_b16 v[76:77], v247 offset:45056
v_mfma_f32_16x16x32_bf16 v[172:175], v[20:23], v[124:127], v[172:175]
ds_read_b64_tr_b16 v[78:79], v247 offset:47104
v_cvt_pk_bf16_f32 v160, v160, v161
v_mfma_f32_16x16x32_bf16 v[172:175], v[16:19], v[112:115], v[172:175]
v_cvt_pk_bf16_f32 v161, v162, v163
v_cvt_pk_bf16_f32 v162, v164, v165
s_waitcnt lgkmcnt(14)
v_mfma_f32_16x16x32_bf16 v[184:187], v[32:35], v[112:115], v[184:187]
v_cvt_pk_bf16_f32 v163, v166, v167
v_cvt_pk_bf16_f32 v168, v168, v169
v_mfma_f32_16x16x32_bf16 v[184:187], v[36:39], v[124:127], v[184:187]
v_cvt_pk_bf16_f32 v169, v170, v171
s_mul_i32 s44, s50, 48
v_mfma_f32_16x16x32_bf16 v[184:187], v[40:43], v[136:139], v[184:187]
buffer_store_dwordx4 v[160:163], v249, s[24:27], s44 offen sc1
v_mfma_f32_16x16x32_bf16 v[184:187], v[44:47], v[148:151], v[184:187]
buffer_store_dwordx2 v[168:169], v250, s[24:27], s44 offen offset:1024 sc1
v_mfma_f32_16x16x32_bf16 v[188:191], v[44:47], v[152:155], v[188:191]
v_cvt_pk_bf16_f32 v172, v172, v173
v_cvt_pk_bf16_f32 v173, v174, v175
v_mfma_f32_16x16x32_bf16 v[188:191], v[40:43], v[140:143], v[188:191]
v_cvt_pk_bf16_f32 v174, v176, v177
v_cvt_pk_bf16_f32 v175, v178, v179
v_mfma_f32_16x16x32_bf16 v[188:191], v[36:39], v[128:131], v[188:191]
v_cvt_pk_bf16_f32 v180, v180, v181
v_cvt_pk_bf16_f32 v181, v182, v183
v_mfma_f32_16x16x32_bf16 v[188:191], v[32:35], v[116:119], v[188:191]
s_mul_i32 s44, s51, 48
buffer_store_dwordx4 v[172:175], v249, s[24:27], s44 offen sc1
v_mfma_f32_16x16x32_bf16 v[192:195], v[32:35], v[120:123], v[192:195]
buffer_store_dwordx2 v[180:181], v250, s[24:27], s44 offen offset:1024 sc1
v_mfma_f32_16x16x32_bf16 v[192:195], v[36:39], v[132:135], v[192:195]
v_mfma_f32_16x16x32_bf16 v[192:195], v[40:43], v[144:147], v[192:195]
v_mfma_f32_16x16x32_bf16 v[192:195], v[44:47], v[156:159], v[192:195]
v_mfma_f32_16x16x32_bf16 v[204:207], v[60:63], v[156:159], v[204:207]
s_waitcnt lgkmcnt(12)
v_mfma_f32_16x16x32_bf16 v[204:207], v[56:59], v[144:147], v[204:207]
s_waitcnt lgkmcnt(10)
v_mfma_f32_16x16x32_bf16 v[204:207], v[52:55], v[132:135], v[204:207]
s_waitcnt lgkmcnt(8)
v_mfma_f32_16x16x32_bf16 v[204:207], v[48:51], v[120:123], v[204:207]
v_cvt_pk_bf16_f32 v184, v184, v185
v_cvt_pk_bf16_f32 v185, v186, v187
v_mfma_f32_16x16x32_bf16 v[200:203], v[48:51], v[116:119], v[200:203]
v_cvt_pk_bf16_f32 v186, v188, v189
v_cvt_pk_bf16_f32 v187, v190, v191
v_mfma_f32_16x16x32_bf16 v[200:203], v[52:55], v[128:131], v[200:203]
v_cvt_pk_bf16_f32 v192, v192, v193
v_cvt_pk_bf16_f32 v193, v194, v195
v_mfma_f32_16x16x32_bf16 v[200:203], v[56:59], v[140:143], v[200:203]
s_mul_i32 s44, s52, 48
buffer_store_dwordx4 v[184:187], v249, s[24:27], s44 offen sc1
v_mfma_f32_16x16x32_bf16 v[200:203], v[60:63], v[152:155], v[200:203]
buffer_store_dwordx2 v[192:193], v250, s[24:27], s44 offen offset:1024 sc1
v_mfma_f32_16x16x32_bf16 v[196:199], v[60:63], v[148:151], v[196:199]
v_mfma_f32_16x16x32_bf16 v[196:199], v[56:59], v[136:139], v[196:199]
s_waitcnt vmcnt(6) lgkmcnt(0)
s_barrier
ds_read_b64_tr_b16 v[92:93], v247 offset:61440
ds_read_b64_tr_b16 v[94:95], v247 offset:63488
v_mfma_f32_16x16x32_bf16 v[196:199], v[52:55], v[124:127], v[196:199]
ds_read_b64_tr_b16 v[88:89], v247 offset:57344
ds_read_b64_tr_b16 v[90:91], v247 offset:59392
v_mfma_f32_16x16x32_bf16 v[196:199], v[48:51], v[112:115], v[196:199]
ds_read_b64_tr_b16 v[84:85], v247 offset:53248
ds_read_b64_tr_b16 v[86:87], v247 offset:55296
v_mfma_f32_16x16x32_bf16 v[208:211], v[64:67], v[112:115], v[208:211]
ds_read_b64_tr_b16 v[80:81], v247 offset:49152
ds_read_b64_tr_b16 v[82:83], v247 offset:51200
v_mfma_f32_16x16x32_bf16 v[208:211], v[68:71], v[124:127], v[208:211]
v_xor_b32 v247, 0x10000, v247
ds_read_b64_tr_b16 v[96:97], v247 offset:16384
v_mfma_f32_16x16x32_bf16 v[208:211], v[72:75], v[136:139], v[208:211]
ds_read_b64_tr_b16 v[98:99], v247 offset:18432
ds_read_b64_tr_b16 v[100:101], v247 offset:20480
v_mfma_f32_16x16x32_bf16 v[208:211], v[76:79], v[148:151], v[208:211]
ds_read_b64_tr_b16 v[102:103], v247 offset:22528
ds_read_b64_tr_b16 v[104:105], v247 offset:24576
v_mfma_f32_16x16x32_bf16 v[212:215], v[76:79], v[152:155], v[212:215]
ds_read_b64_tr_b16 v[106:107], v247 offset:26624
ds_read_b64_tr_b16 v[108:109], v247 offset:28672
v_mfma_f32_16x16x32_bf16 v[212:215], v[72:75], v[140:143], v[212:215]
ds_read_b64_tr_b16 v[110:111], v247 offset:30720
v_cvt_pk_bf16_f32 v196, v196, v197
v_mfma_f32_16x16x32_bf16 v[212:215], v[68:71], v[128:131], v[212:215]
v_cvt_pk_bf16_f32 v197, v198, v199
v_cvt_pk_bf16_f32 v198, v200, v201
v_mfma_f32_16x16x32_bf16 v[212:215], v[64:67], v[116:119], v[212:215]
v_cvt_pk_bf16_f32 v199, v202, v203
v_cvt_pk_bf16_f32 v204, v204, v205
v_mfma_f32_16x16x32_bf16 v[216:219], v[64:67], v[120:123], v[216:219]
v_cvt_pk_bf16_f32 v205, v206, v207
s_mul_i32 s44, s53, 48
v_mfma_f32_16x16x32_bf16 v[216:219], v[68:71], v[132:135], v[216:219]
buffer_store_dwordx4 v[196:199], v249, s[24:27], s44 offen sc1
v_mfma_f32_16x16x32_bf16 v[216:219], v[72:75], v[144:147], v[216:219]
buffer_store_dwordx2 v[204:205], v250, s[24:27], s44 offen offset:1024 sc1
v_mfma_f32_16x16x32_bf16 v[216:219], v[76:79], v[156:159], v[216:219]
s_waitcnt lgkmcnt(14)
v_mfma_f32_16x16x32_bf16 v[228:231], v[92:95], v[156:159], v[228:231]
s_waitcnt lgkmcnt(12)
v_mfma_f32_16x16x32_bf16 v[228:231], v[88:91], v[144:147], v[228:231]
s_waitcnt lgkmcnt(10)
v_mfma_f32_16x16x32_bf16 v[228:231], v[84:87], v[132:135], v[228:231]
s_waitcnt lgkmcnt(8)
v_mfma_f32_16x16x32_bf16 v[228:231], v[80:83], v[120:123], v[228:231]
v_cvt_pk_bf16_f32 v208, v208, v209
v_cvt_pk_bf16_f32 v209, v210, v211
v_mfma_f32_16x16x32_bf16 v[224:227], v[80:83], v[116:119], v[224:227]
v_cvt_pk_bf16_f32 v210, v212, v213
v_cvt_pk_bf16_f32 v211, v214, v215
v_mfma_f32_16x16x32_bf16 v[224:227], v[84:87], v[128:131], v[224:227]
v_cvt_pk_bf16_f32 v216, v216, v217
v_cvt_pk_bf16_f32 v217, v218, v219
v_mfma_f32_16x16x32_bf16 v[224:227], v[88:91], v[140:143], v[224:227]
s_mul_i32 s44, s54, 48
buffer_store_dwordx4 v[208:211], v249, s[24:27], s44 offen sc1
v_mfma_f32_16x16x32_bf16 v[224:227], v[92:95], v[152:155], v[224:227]
buffer_store_dwordx2 v[216:217], v250, s[24:27], s44 offen offset:1024 sc1
v_mfma_f32_16x16x32_bf16 v[220:223], v[92:95], v[148:151], v[220:223]
v_mfma_f32_16x16x32_bf16 v[220:223], v[88:91], v[136:139], v[220:223]
v_mfma_f32_16x16x32_bf16 v[220:223], v[84:87], v[124:127], v[220:223]
v_mfma_f32_16x16x32_bf16 v[220:223], v[80:83], v[112:115], v[220:223]
s_waitcnt lgkmcnt(6)
v_mfma_f32_16x16x32_bf16 v[232:235], v[96:99], v[112:115], v[232:235]
s_waitcnt lgkmcnt(4)
v_mfma_f32_16x16x32_bf16 v[232:235], v[100:103], v[124:127], v[232:235]
s_waitcnt lgkmcnt(2)
v_mfma_f32_16x16x32_bf16 v[232:235], v[104:107], v[136:139], v[232:235]
s_waitcnt lgkmcnt(0)
v_mfma_f32_16x16x32_bf16 v[232:235], v[108:111], v[148:151], v[232:235]
v_cvt_pk_bf16_f32 v220, v220, v221
v_cvt_pk_bf16_f32 v221, v222, v223
v_mfma_f32_16x16x32_bf16 v[236:239], v[108:111], v[152:155], v[236:239]
v_cvt_pk_bf16_f32 v222, v224, v225
v_cvt_pk_bf16_f32 v223, v226, v227
v_mfma_f32_16x16x32_bf16 v[236:239], v[104:107], v[140:143], v[236:239]
v_cvt_pk_bf16_f32 v228, v228, v229
v_cvt_pk_bf16_f32 v229, v230, v231
v_mfma_f32_16x16x32_bf16 v[236:239], v[100:103], v[128:131], v[236:239]
s_mul_i32 s44, s55, 48
buffer_store_dwordx4 v[220:223], v249, s[24:27], s44 offen sc1
v_mfma_f32_16x16x32_bf16 v[236:239], v[96:99], v[116:119], v[236:239]
buffer_store_dwordx2 v[228:229], v250, s[24:27], s44 offen offset:1024 sc1
v_mfma_f32_16x16x32_bf16 v[240:243], v[96:99], v[120:123], v[240:243]
v_mfma_f32_16x16x32_bf16 v[240:243], v[100:103], v[132:135], v[240:243]
v_mfma_f32_16x16x32_bf16 v[240:243], v[104:107], v[144:147], v[240:243]
v_mfma_f32_16x16x32_bf16 v[240:243], v[108:111], v[156:159], v[240:243]
s_mul_i32 s45, s41, 7168
v_add_u32 v251, s45, v248
ds_write_b128 v251, v[232:235] offset:3072
ds_write_b128 v251, v[236:239] offset:4096
s_nop 3
ds_write_b128 v251, v[240:243] offset:5120
s_cmp_lg_u32 s49, 7
s_cbranch_scc1 L_own_c1
v_cvt_pk_bf16_f32 v232, v232, v233
v_cvt_pk_bf16_f32 v233, v234, v235
v_cvt_pk_bf16_f32 v234, v236, v237
v_cvt_pk_bf16_f32 v235, v238, v239
v_cvt_pk_bf16_f32 v240, v240, v241
v_cvt_pk_bf16_f32 v241, v242, v243
s_mul_i32 s44, s56, 48
buffer_store_dwordx4 v[232:235], v249, s[24:27], s44 offen sc1
buffer_store_dwordx2 v[240:241], v250, s[24:27], s44 offen offset:1024 sc1
L_own_c1:
v_mov_b32 v112, 1
s_waitcnt lgkmcnt(0)
s_barrier
s_mov_b64 exec, 0x7f
s_waitcnt vmcnt(0)
buffer_store_dword v112, v252, s[4:7], s46 offen sc1
s_mov_b64 exec, -1
s_endpgm
.p2align 6
L_a_c1:
s_barrier
s_barrier
s_barrier
s_add_u32 m0, s42, 0
v_add_u32 v246, 0x180000, v246
buffer_load_dwordx4 v246, s[16:19], 0 offen lds
buffer_load_dwordx4 v246, s[16:19], s35 offen offset:1024 lds
buffer_load_dwordx4 v246, s[16:19], s36 offen offset:2048 lds
buffer_load_dwordx4 v246, s[16:19], s37 offen offset:3072 lds
s_barrier
s_add_u32 m0, s42, 16384
v_add_u32 v246, 0x80000, v246
buffer_load_dwordx4 v246, s[16:19], 0 offen lds
buffer_load_dwordx4 v246, s[16:19], s35 offen offset:1024 lds
buffer_load_dwordx4 v246, s[16:19], s36 offen offset:2048 lds
buffer_load_dwordx4 v246, s[16:19], s37 offen offset:3072 lds
s_barrier
s_or_b32 s44, s41, s47
s_cbranch_scc1 L_hs_c1_0
s_mov_b64 exec, 1
buffer_store_dword v253, v252, s[60:63], s46 offen sc1
s_mov_b64 exec, -1
L_hs_c1_0:
s_add_u32 m0, s42, 32768
v_add_u32 v246, 0x80000, v246
buffer_load_dwordx4 v246, s[16:19], 0 offen lds
buffer_load_dwordx4 v246, s[16:19], s35 offen offset:1024 lds
buffer_load_dwordx4 v246, s[16:19], s36 offen offset:2048 lds
buffer_load_dwordx4 v246, s[16:19], s37 offen offset:3072 lds
s_barrier
s_waitcnt vmcnt(8)
s_barrier
s_waitcnt vmcnt(4)
s_barrier
s_waitcnt vmcnt(0)
s_barrier
s_add_u32 m0, s42, 114688
v_add_u32 v245, 0x30000, v245
buffer_load_dwordx4 v245, s[8:11], s34 offen offset:3072 nt lds
s_add_u32 m0, s42, 0
v_add_u32 v245, 0xfffd0080, v245
buffer_load_dwordx4 v245, s[8:11], 0 offen nt lds
buffer_load_dwordx4 v245, s[8:11], s32 offen offset:1024 nt lds
buffer_load_dwordx4 v245, s[8:11], s33 offen offset:2048 nt lds
buffer_load_dwordx4 v245, s[8:11], s34 offen offset:3072 nt lds
s_barrier
ds_read_b128 v[216:219], v240 offset:49152
ds_read_b128 v[192:195], v242
ds_read_b128 v[220:223], v241 offset:49152
ds_read_b128 v[204:207], v242 offset:3072
ds_read_b128 v[208:211], v242 offset:4096
ds_read_b128 v[196:199], v242 offset:1024
ds_read_b128 v[200:203], v242 offset:2048
ds_read_b128 v[212:215], v242 offset:5120
ds_read_b128 v[224:227], v241 offset:50176
ds_read_b128 v[228:231], v240 offset:50176
ds_read_b128 v[232:235], v240 offset:51200
ds_read_b128 v[236:239], v241 offset:51200
s_waitcnt lgkmcnt(10)
v_mfma_f32_16x16x32_bf16 v[0:3], v[216:219], v[192:195], 0
s_waitcnt lgkmcnt(8)
v_mfma_f32_16x16x32_bf16 v[0:3], v[220:223], v[204:207], v[0:3]
s_waitcnt lgkmcnt(7)
v_mfma_f32_16x16x32_bf16 v[8:11], v[220:223], v[208:211], 0
s_waitcnt lgkmcnt(6)
v_mfma_f32_16x16x32_bf16 v[8:11], v[216:219], v[196:199], v[8:11]
s_waitcnt lgkmcnt(5)
v_mfma_f32_16x16x32_bf16 v[16:19], v[216:219], v[200:203], 0
ds_read_b128 v[216:219], v241 offset:52224
s_waitcnt lgkmcnt(5)
v_mfma_f32_16x16x32_bf16 v[16:19], v[220:223], v[212:215], v[16:19]
ds_read_b128 v[220:223], v240 offset:52224
s_waitcnt lgkmcnt(5)
v_mfma_f32_16x16x32_bf16 v[20:23], v[224:227], v[212:215], 0
s_waitcnt lgkmcnt(4)
v_mfma_f32_16x16x32_bf16 v[20:23], v[228:231], v[200:203], v[20:23]
v_mfma_f32_16x16x32_bf16 v[12:15], v[228:231], v[196:199], 0
v_mfma_f32_16x16x32_bf16 v[12:15], v[224:227], v[208:211], v[12:15]
v_mfma_f32_16x16x32_bf16 v[4:7], v[224:227], v[204:207], 0
v_mfma_f32_16x16x32_bf16 v[4:7], v[228:231], v[192:195], v[4:7]
s_waitcnt lgkmcnt(3)
v_mfma_f32_16x16x32_bf16 v[24:27], v[232:235], v[192:195], 0
s_waitcnt lgkmcnt(2)
v_mfma_f32_16x16x32_bf16 v[24:27], v[236:239], v[204:207], v[24:27]
v_mfma_f32_16x16x32_bf16 v[32:35], v[236:239], v[208:211], 0
v_mfma_f32_16x16x32_bf16 v[32:35], v[232:235], v[196:199], v[32:35]
v_mfma_f32_16x16x32_bf16 v[40:43], v[232:235], v[200:203], 0
v_mfma_f32_16x16x32_bf16 v[40:43], v[236:239], v[212:215], v[40:43]
s_waitcnt lgkmcnt(1)
v_mfma_f32_16x16x32_bf16 v[44:47], v[216:219], v[212:215], 0
s_waitcnt lgkmcnt(0)
v_mfma_f32_16x16x32_bf16 v[44:47], v[220:223], v[200:203], v[44:47]
v_mfma_f32_16x16x32_bf16 v[36:39], v[220:223], v[196:199], 0
v_mfma_f32_16x16x32_bf16 v[36:39], v[216:219], v[208:211], v[36:39]
s_barrier
v_xor_b32 v240, 0x10000, v240
ds_read_b128 v[224:227], v240
v_mfma_f32_16x16x32_bf16 v[28:31], v[216:219], v[204:207], 0
v_xor_b32 v241, 0x10000, v241
ds_read_b128 v[228:231], v241
v_mfma_f32_16x16x32_bf16 v[28:31], v[220:223], v[192:195], v[28:31]
ds_read_b128 v[232:235], v241 offset:1024
ds_read_b128 v[236:239], v240 offset:1024
ds_read_b128 v[216:219], v240 offset:2048
ds_read_b128 v[220:223], v241 offset:2048
s_waitcnt lgkmcnt(5)
v_mfma_f32_16x16x32_bf16 v[48:51], v[224:227], v[192:195], 0
s_waitcnt lgkmcnt(4)
v_mfma_f32_16x16x32_bf16 v[48:51], v[228:231], v[204:207], v[48:51]
v_mfma_f32_16x16x32_bf16 v[56:59], v[228:231], v[208:211], 0
v_mfma_f32_16x16x32_bf16 v[56:59], v[224:227], v[196:199], v[56:59]
v_mfma_f32_16x16x32_bf16 v[64:67], v[224:227], v[200:203], 0
ds_read_b128 v[224:227], v241 offset:3072
v_mfma_f32_16x16x32_bf16 v[64:67], v[228:231], v[212:215], v[64:67]
ds_read_b128 v[228:231], v240 offset:3072
s_waitcnt lgkmcnt(5)
v_mfma_f32_16x16x32_bf16 v[68:71], v[232:235], v[212:215], 0
s_waitcnt lgkmcnt(4)
v_mfma_f32_16x16x32_bf16 v[68:71], v[236:239], v[200:203], v[68:71]
v_mfma_f32_16x16x32_bf16 v[60:63], v[236:239], v[196:199], 0
v_mfma_f32_16x16x32_bf16 v[60:63], v[232:235], v[208:211], v[60:63]
v_mfma_f32_16x16x32_bf16 v[52:55], v[232:235], v[204:207], 0
v_mfma_f32_16x16x32_bf16 v[52:55], v[236:239], v[192:195], v[52:55]
s_waitcnt lgkmcnt(3)
v_mfma_f32_16x16x32_bf16 v[72:75], v[216:219], v[192:195], 0
s_waitcnt lgkmcnt(2)
v_mfma_f32_16x16x32_bf16 v[72:75], v[220:223], v[204:207], v[72:75]
v_mfma_f32_16x16x32_bf16 v[80:83], v[220:223], v[208:211], 0
v_mfma_f32_16x16x32_bf16 v[80:83], v[216:219], v[196:199], v[80:83]
v_mfma_f32_16x16x32_bf16 v[88:91], v[216:219], v[200:203], 0
v_mfma_f32_16x16x32_bf16 v[88:91], v[220:223], v[212:215], v[88:91]
s_waitcnt lgkmcnt(1)
v_mfma_f32_16x16x32_bf16 v[92:95], v[224:227], v[212:215], 0
s_waitcnt lgkmcnt(0)
v_mfma_f32_16x16x32_bf16 v[92:95], v[228:231], v[200:203], v[92:95]
v_mfma_f32_16x16x32_bf16 v[84:87], v[228:231], v[196:199], 0
v_mfma_f32_16x16x32_bf16 v[84:87], v[224:227], v[208:211], v[84:87]
s_barrier
s_cmp_lg_u32 s41, 0
s_cbranch_scc1 L_hs_c1_1
buffer_load_dword v249, v252, s[60:63], s46 offen sc1
L_hs_c1_1:
ds_read_b128 v[232:235], v240 offset:32768
ds_read_b128 v[236:239], v241 offset:32768
v_mfma_f32_16x16x32_bf16 v[76:79], v[224:227], v[204:207], 0
ds_read_b128 v[216:219], v241 offset:33792
ds_read_b128 v[220:223], v240 offset:33792
v_mfma_f32_16x16x32_bf16 v[76:79], v[228:231], v[192:195], v[76:79]
ds_read_b128 v[224:227], v240 offset:34816
ds_read_b128 v[228:231], v241 offset:34816
s_waitcnt lgkmcnt(5)
v_mfma_f32_16x16x32_bf16 v[96:99], v[232:235], v[192:195], 0
s_waitcnt lgkmcnt(4)
v_mfma_f32_16x16x32_bf16 v[96:99], v[236:239], v[204:207], v[96:99]
v_mfma_f32_16x16x32_bf16 v[104:107], v[236:239], v[208:211], 0
v_mfma_f32_16x16x32_bf16 v[104:107], v[232:235], v[196:199], v[104:107]
v_mfma_f32_16x16x32_bf16 v[112:115], v[232:235], v[200:203], 0
ds_read_b128 v[232:235], v241 offset:35840
v_mfma_f32_16x16x32_bf16 v[112:115], v[236:239], v[212:215], v[112:115]
ds_read_b128 v[236:239], v240 offset:35840
s_waitcnt lgkmcnt(5)
v_mfma_f32_16x16x32_bf16 v[116:119], v[216:219], v[212:215], 0
s_waitcnt lgkmcnt(4)
v_mfma_f32_16x16x32_bf16 v[116:119], v[220:223], v[200:203], v[116:119]
v_mfma_f32_16x16x32_bf16 v[108:111], v[220:223], v[196:199], 0
v_mfma_f32_16x16x32_bf16 v[108:111], v[216:219], v[208:211], v[108:111]
v_mfma_f32_16x16x32_bf16 v[100:103], v[216:219], v[204:207], 0
v_mfma_f32_16x16x32_bf16 v[100:103], v[220:223], v[192:195], v[100:103]
s_waitcnt lgkmcnt(3)
v_mfma_f32_16x16x32_bf16 v[120:123], v[224:227], v[192:195], 0
s_waitcnt lgkmcnt(2)
v_mfma_f32_16x16x32_bf16 v[120:123], v[228:231], v[204:207], v[120:123]
v_mfma_f32_16x16x32_bf16 v[128:131], v[228:231], v[208:211], 0
v_mfma_f32_16x16x32_bf16 v[128:131], v[224:227], v[196:199], v[128:131]
v_mfma_f32_16x16x32_bf16 v[136:139], v[224:227], v[200:203], 0
v_mfma_f32_16x16x32_bf16 v[136:139], v[228:231], v[212:215], v[136:139]
s_waitcnt lgkmcnt(1)
v_mfma_f32_16x16x32_bf16 v[140:143], v[232:235], v[212:215], 0
s_waitcnt lgkmcnt(0)
v_mfma_f32_16x16x32_bf16 v[140:143], v[236:239], v[200:203], v[140:143]
v_mfma_f32_16x16x32_bf16 v[132:135], v[236:239], v[196:199], 0
v_mfma_f32_16x16x32_bf16 v[132:135], v[232:235], v[208:211], v[132:135]
s_waitcnt vmcnt(4)
s_barrier
ds_read_b128 v[216:219], v240 offset:49152
ds_read_b128 v[220:223], v241 offset:49152
v_mfma_f32_16x16x32_bf16 v[124:127], v[232:235], v[204:207], 0
ds_read_b128 v[224:227], v241 offset:50176
ds_read_b128 v[228:231], v240 offset:50176
v_mfma_f32_16x16x32_bf16 v[124:127], v[236:239], v[192:195], v[124:127]
ds_read_b128 v[232:235], v240 offset:51200
ds_read_b128 v[236:239], v241 offset:51200
s_waitcnt lgkmcnt(5)
v_mfma_f32_16x16x32_bf16 v[144:147], v[216:219], v[192:195], 0
s_waitcnt lgkmcnt(4)
v_mfma_f32_16x16x32_bf16 v[144:147], v[220:223], v[204:207], v[144:147]
v_mfma_f32_16x16x32_bf16 v[152:155], v[220:223], v[208:211], 0
v_mfma_f32_16x16x32_bf16 v[152:155], v[216:219], v[196:199], v[152:155]
v_mfma_f32_16x16x32_bf16 v[160:163], v[216:219], v[200:203], 0
ds_read_b128 v[216:219], v241 offset:52224
v_mfma_f32_16x16x32_bf16 v[160:163], v[220:223], v[212:215], v[160:163]
ds_read_b128 v[220:223], v240 offset:52224
s_waitcnt lgkmcnt(5)
v_mfma_f32_16x16x32_bf16 v[164:167], v[224:227], v[212:215], 0
s_waitcnt lgkmcnt(4)
v_mfma_f32_16x16x32_bf16 v[164:167], v[228:231], v[200:203], v[164:167]
v_mfma_f32_16x16x32_bf16 v[156:159], v[228:231], v[196:199], 0
v_mfma_f32_16x16x32_bf16 v[156:159], v[224:227], v[208:211], v[156:159]
v_mfma_f32_16x16x32_bf16 v[148:151], v[224:227], v[204:207], 0
v_mfma_f32_16x16x32_bf16 v[148:151], v[228:231], v[192:195], v[148:151]
s_waitcnt lgkmcnt(3)
v_mfma_f32_16x16x32_bf16 v[168:171], v[232:235], v[192:195], 0
s_waitcnt lgkmcnt(2)
v_mfma_f32_16x16x32_bf16 v[168:171], v[236:239], v[204:207], v[168:171]
v_mfma_f32_16x16x32_bf16 v[176:179], v[236:239], v[208:211], 0
v_mfma_f32_16x16x32_bf16 v[176:179], v[232:235], v[196:199], v[176:179]
v_mfma_f32_16x16x32_bf16 v[184:187], v[232:235], v[200:203], 0
v_mfma_f32_16x16x32_bf16 v[184:187], v[236:239], v[212:215], v[184:187]
s_waitcnt lgkmcnt(1)
v_mfma_f32_16x16x32_bf16 v[188:191], v[216:219], v[212:215], 0
s_waitcnt lgkmcnt(0)
v_mfma_f32_16x16x32_bf16 v[188:191], v[220:223], v[200:203], v[188:191]
v_mfma_f32_16x16x32_bf16 v[180:183], v[220:223], v[196:199], 0
v_mfma_f32_16x16x32_bf16 v[180:183], v[216:219], v[208:211], v[180:183]
s_barrier
v_mfma_f32_16x16x32_bf16 v[172:175], v[216:219], v[204:207], 0
v_mfma_f32_16x16x32_bf16 v[172:175], v[220:223], v[192:195], v[172:175]
s_add_u32 m0, s42, 49152
v_add_u32 v246, 0xfff00080, v246
s_waitcnt vmcnt(3)
buffer_load_dwordx4 v246, s[16:19], s35 offen offset:1024 lds
s_waitcnt vmcnt(3)
buffer_load_dwordx4 v246, s[16:19], s36 offen offset:2048 lds
s_waitcnt vmcnt(3)
buffer_load_dwordx4 v246, s[16:19], s37 offen offset:3072 lds
s_barrier
s_add_u32 m0, s42, 65536
v_add_u32 v246, 0x80000, v246
buffer_load_dwordx4 v246, s[16:19], 0 offen lds
buffer_load_dwordx4 v246, s[16:19], s35 offen offset:1024 lds
buffer_load_dwordx4 v246, s[16:19], s36 offen offset:2048 lds
buffer_load_dwordx4 v246, s[16:19], s37 offen offset:3072 lds
s_barrier
s_cmp_lg_u32 s41, 0
s_cbranch_scc1 L_hs_c1_2
s_mov_b32 s45, 0
L_hl_c1_2:
s_waitcnt vmcnt(0)
v_readfirstlane_b32 s44, v249
s_add_u32 s45, s45, 1
s_cmp_gt_u32 s45, 0x80000
s_cbranch_scc1 L_hs_c1_2
s_cmp_eq_u32 s44, 1
s_cbranch_scc1 L_hs_c1_2
buffer_load_dword v249, v252, s[60:63], s46 offen sc1
s_branch L_hl_c1_2
L_hs_c1_2:
s_add_u32 m0, s42, 98304
v_add_u32 v246, 0x80000, v246
buffer_load_dwordx4 v246, s[16:19], 0 offen lds
buffer_load_dwordx4 v246, s[16:19], s35 offen offset:1024 lds
buffer_load_dwordx4 v246, s[16:19], s36 offen offset:2048 lds
buffer_load_dwordx4 v246, s[16:19], s37 offen offset:3072 lds
s_add_u32 m0, s42, 114688
v_add_u32 v246, 0x80000, v246
buffer_load_dwordx4 v246, s[16:19], 0 offen lds
buffer_load_dwordx4 v246, s[16:19], s35 offen offset:1024 lds
buffer_load_dwordx4 v246, s[16:19], s36 offen offset:2048 lds
buffer_load_dwordx4 v246, s[16:19], s37 offen offset:3072 lds
s_waitcnt vmcnt(12)
s_barrier
s_add_u32 m0, s42, 16384
v_add_u32 v245, 0x10000, v245
buffer_load_dwordx4 v245, s[8:11], 0 offen nt lds
s_waitcnt vmcnt(9)
s_barrier
buffer_load_dwordx4 v245, s[8:11], s32 offen offset:1024 nt lds
buffer_load_dwordx4 v245, s[8:11], s33 offen offset:2048 nt lds
buffer_load_dwordx4 v245, s[8:11], s34 offen offset:3072 nt lds
s_waitcnt vmcnt(8)
s_barrier
s_add_u32 m0, s42, 32768
v_add_u32 v245, 0x10000, v245
buffer_load_dwordx4 v245, s[8:11], 0 offen nt lds
buffer_load_dwordx4 v245, s[8:11], s32 offen offset:1024 nt lds
buffer_load_dwordx4 v245, s[8:11], s33 offen offset:2048 nt lds
buffer_load_dwordx4 v245, s[8:11], s34 offen offset:3072 nt lds
s_waitcnt vmcnt(8)
s_barrier
s_add_u32 m0, s42, 81920
v_add_u32 v245, 0x10000, v245
buffer_load_dwordx4 v245, s[8:11], 0 offen nt lds
buffer_load_dwordx4 v245, s[8:11], s32 offen offset:1024 nt lds
buffer_load_dwordx4 v245, s[8:11], s33 offen offset:2048 nt lds
s_barrier
v_xor_b32 v240, 0x10000, v240
ds_read_b128 v[224:227], v240
ds_read_b128 v[192:195], v242 offset:12288
v_xor_b32 v241, 0x10000, v241
ds_read_b128 v[228:231], v241
ds_read_b128 v[204:207], v242 offset:15360
ds_read_b128 v[208:211], v242 offset:16384
ds_read_b128 v[196:199], v242 offset:13312
ds_read_b128 v[200:203], v242 offset:14336
ds_read_b128 v[212:215], v242 offset:17408
ds_read_b128 v[232:235], v241 offset:1024
ds_read_b128 v[236:239], v240 offset:1024
ds_read_b128 v[216:219], v240 offset:2048
ds_read_b128 v[220:223], v241 offset:2048
s_waitcnt lgkmcnt(10)
v_mfma_f32_16x16x32_bf16 v[0:3], v[224:227], v[192:195], v[0:3]
s_waitcnt lgkmcnt(8)
v_mfma_f32_16x16x32_bf16 v[0:3], v[228:231], v[204:207], v[0:3]
s_waitcnt lgkmcnt(7)
v_mfma_f32_16x16x32_bf16 v[8:11], v[228:231], v[208:211], v[8:11]
s_waitcnt lgkmcnt(6)
v_mfma_f32_16x16x32_bf16 v[8:11], v[224:227], v[196:199], v[8:11]
s_waitcnt lgkmcnt(5)
v_mfma_f32_16x16x32_bf16 v[16:19], v[224:227], v[200:203], v[16:19]
ds_read_b128 v[224:227], v241 offset:3072
s_waitcnt lgkmcnt(5)
v_mfma_f32_16x16x32_bf16 v[16:19], v[228:231], v[212:215], v[16:19]
ds_read_b128 v[228:231], v240 offset:3072
s_waitcnt lgkmcnt(5)
v_mfma_f32_16x16x32_bf16 v[20:23], v[232:235], v[212:215], v[20:23]
s_waitcnt lgkmcnt(4)
v_mfma_f32_16x16x32_bf16 v[20:23], v[236:239], v[200:203], v[20:23]
v_mfma_f32_16x16x32_bf16 v[12:15], v[236:239], v[196:199], v[12:15]
v_mfma_f32_16x16x32_bf16 v[12:15], v[232:235], v[208:211], v[12:15]
v_mfma_f32_16x16x32_bf16 v[4:7], v[232:235], v[204:207], v[4:7]
v_mfma_f32_16x16x32_bf16 v[4:7], v[236:239], v[192:195], v[4:7]
s_waitcnt lgkmcnt(3)
v_mfma_f32_16x16x32_bf16 v[24:27], v[216:219], v[192:195], v[24:27]
s_waitcnt lgkmcnt(2)
v_mfma_f32_16x16x32_bf16 v[24:27], v[220:223], v[204:207], v[24:27]
v_mfma_f32_16x16x32_bf16 v[32:35], v[220:223], v[208:211], v[32:35]
v_mfma_f32_16x16x32_bf16 v[32:35], v[216:219], v[196:199], v[32:35]
v_mfma_f32_16x16x32_bf16 v[40:43], v[216:219], v[200:203], v[40:43]
v_mfma_f32_16x16x32_bf16 v[40:43], v[220:223], v[212:215], v[40:43]
s_waitcnt lgkmcnt(1)
v_mfma_f32_16x16x32_bf16 v[44:47], v[224:227], v[212:215], v[44:47]
s_waitcnt lgkmcnt(0)
v_mfma_f32_16x16x32_bf16 v[44:47], v[228:231], v[200:203], v[44:47]
v_mfma_f32_16x16x32_bf16 v[36:39], v[228:231], v[196:199], v[36:39]
v_mfma_f32_16x16x32_bf16 v[36:39], v[224:227], v[208:211], v[36:39]
s_waitcnt vmcnt(7)
s_barrier
ds_read_b128 v[232:235], v240 offset:16384
ds_read_b128 v[236:239], v241 offset:16384
v_mfma_f32_16x16x32_bf16 v[28:31], v[224:227], v[204:207], v[28:31]
ds_read_b128 v[216:219], v241 offset:17408
ds_read_b128 v[220:223], v240 offset:17408
v_mfma_f32_16x16x32_bf16 v[28:31], v[228:231], v[192:195], v[28:31]
ds_read_b128 v[224:227], v240 offset:18432
ds_read_b128 v[228:231], v241 offset:18432
s_waitcnt lgkmcnt(5)
v_mfma_f32_16x16x32_bf16 v[48:51], v[232:235], v[192:195], v[48:51]
s_waitcnt lgkmcnt(4)
v_mfma_f32_16x16x32_bf16 v[48:51], v[236:239], v[204:207], v[48:51]
v_mfma_f32_16x16x32_bf16 v[56:59], v[236:239], v[208:211], v[56:59]
v_mfma_f32_16x16x32_bf16 v[56:59], v[232:235], v[196:199], v[56:59]
v_mfma_f32_16x16x32_bf16 v[64:67], v[232:235], v[200:203], v[64:67]
ds_read_b128 v[232:235], v241 offset:19456
v_mfma_f32_16x16x32_bf16 v[64:67], v[236:239], v[212:215], v[64:67]
ds_read_b128 v[236:239], v240 offset:19456
s_waitcnt lgkmcnt(5)
v_mfma_f32_16x16x32_bf16 v[68:71], v[216:219], v[212:215], v[68:71]
s_waitcnt lgkmcnt(4)
v_mfma_f32_16x16x32_bf16 v[68:71], v[220:223], v[200:203], v[68:71]
v_mfma_f32_16x16x32_bf16 v[60:63], v[220:223], v[196:199], v[60:63]
v_mfma_f32_16x16x32_bf16 v[60:63], v[216:219], v[208:211], v[60:63]
v_mfma_f32_16x16x32_bf16 v[52:55], v[216:219], v[204:207], v[52:55]
v_mfma_f32_16x16x32_bf16 v[52:55], v[220:223], v[192:195], v[52:55]
s_waitcnt lgkmcnt(3)
v_mfma_f32_16x16x32_bf16 v[72:75], v[224:227], v[192:195], v[72:75]
s_waitcnt lgkmcnt(2)
v_mfma_f32_16x16x32_bf16 v[72:75], v[228:231], v[204:207], v[72:75]
v_mfma_f32_16x16x32_bf16 v[80:83], v[228:231], v[208:211], v[80:83]
v_mfma_f32_16x16x32_bf16 v[80:83], v[224:227], v[196:199], v[80:83]
v_mfma_f32_16x16x32_bf16 v[88:91], v[224:227], v[200:203], v[88:91]
v_mfma_f32_16x16x32_bf16 v[88:91], v[228:231], v[212:215], v[88:91]
s_waitcnt lgkmcnt(1)
v_mfma_f32_16x16x32_bf16 v[92:95], v[232:235], v[212:215], v[92:95]
s_waitcnt lgkmcnt(0)
v_mfma_f32_16x16x32_bf16 v[92:95], v[236:239], v[200:203], v[92:95]
v_mfma_f32_16x16x32_bf16 v[84:87], v[236:239], v[196:199], v[84:87]
v_mfma_f32_16x16x32_bf16 v[84:87], v[232:235], v[208:211], v[84:87]
s_waitcnt vmcnt(3)
s_barrier
ds_read_b128 v[216:219], v240 offset:32768
ds_read_b128 v[220:223], v241 offset:32768
v_mfma_f32_16x16x32_bf16 v[76:79], v[232:235], v[204:207], v[76:79]
ds_read_b128 v[224:227], v241 offset:33792
ds_read_b128 v[228:231], v240 offset:33792
v_mfma_f32_16x16x32_bf16 v[76:79], v[236:239], v[192:195], v[76:79]
ds_read_b128 v[232:235], v240 offset:34816
ds_read_b128 v[236:239], v241 offset:34816
s_waitcnt lgkmcnt(5)
v_mfma_f32_16x16x32_bf16 v[96:99], v[216:219], v[192:195], v[96:99]
s_waitcnt lgkmcnt(4)
v_mfma_f32_16x16x32_bf16 v[96:99], v[220:223], v[204:207], v[96:99]
v_mfma_f32_16x16x32_bf16 v[104:107], v[220:223], v[208:211], v[104:107]
v_mfma_f32_16x16x32_bf16 v[104:107], v[216:219], v[196:199], v[104:107]
v_mfma_f32_16x16x32_bf16 v[112:115], v[216:219], v[200:203], v[112:115]
ds_read_b128 v[216:219], v241 offset:35840
v_mfma_f32_16x16x32_bf16 v[112:115], v[220:223], v[212:215], v[112:115]
ds_read_b128 v[220:223], v240 offset:35840
s_waitcnt lgkmcnt(5)
v_mfma_f32_16x16x32_bf16 v[116:119], v[224:227], v[212:215], v[116:119]
s_waitcnt lgkmcnt(4)
v_mfma_f32_16x16x32_bf16 v[116:119], v[228:231], v[200:203], v[116:119]
v_mfma_f32_16x16x32_bf16 v[108:111], v[228:231], v[196:199], v[108:111]
v_mfma_f32_16x16x32_bf16 v[108:111], v[224:227], v[208:211], v[108:111]
v_mfma_f32_16x16x32_bf16 v[100:103], v[224:227], v[204:207], v[100:103]
v_mfma_f32_16x16x32_bf16 v[100:103], v[228:231], v[192:195], v[100:103]
s_waitcnt lgkmcnt(3)
v_mfma_f32_16x16x32_bf16 v[120:123], v[232:235], v[192:195], v[120:123]
s_waitcnt lgkmcnt(2)
v_mfma_f32_16x16x32_bf16 v[120:123], v[236:239], v[204:207], v[120:123]
v_mfma_f32_16x16x32_bf16 v[128:131], v[236:239], v[208:211], v[128:131]
v_mfma_f32_16x16x32_bf16 v[128:131], v[232:235], v[196:199], v[128:131]
v_mfma_f32_16x16x32_bf16 v[136:139], v[232:235], v[200:203], v[136:139]
v_mfma_f32_16x16x32_bf16 v[136:139], v[236:239], v[212:215], v[136:139]
s_waitcnt lgkmcnt(1)
v_mfma_f32_16x16x32_bf16 v[140:143], v[216:219], v[212:215], v[140:143]
s_waitcnt lgkmcnt(0)
v_mfma_f32_16x16x32_bf16 v[140:143], v[220:223], v[200:203], v[140:143]
v_mfma_f32_16x16x32_bf16 v[132:135], v[220:223], v[196:199], v[132:135]
v_mfma_f32_16x16x32_bf16 v[132:135], v[216:219], v[208:211], v[132:135]
s_waitcnt vmcnt(0)
s_barrier
v_xor_b32 v240, 0x10000, v240
ds_read_b128 v[224:227], v240 offset:16384
v_mfma_f32_16x16x32_bf16 v[124:127], v[216:219], v[204:207], v[124:127]
v_xor_b32 v241, 0x10000, v241
ds_read_b128 v[228:231], v241 offset:16384
v_mfma_f32_16x16x32_bf16 v[124:127], v[220:223], v[192:195], v[124:127]
ds_read_b128 v[232:235], v241 offset:17408
ds_read_b128 v[236:239], v240 offset:17408
ds_read_b128 v[216:219], v240 offset:18432
ds_read_b128 v[220:223], v241 offset:18432
s_waitcnt lgkmcnt(5)
v_mfma_f32_16x16x32_bf16 v[144:147], v[224:227], v[192:195], v[144:147]
s_waitcnt lgkmcnt(4)
v_mfma_f32_16x16x32_bf16 v[144:147], v[228:231], v[204:207], v[144:147]
v_mfma_f32_16x16x32_bf16 v[152:155], v[228:231], v[208:211], v[152:155]
v_mfma_f32_16x16x32_bf16 v[152:155], v[224:227], v[196:199], v[152:155]
v_mfma_f32_16x16x32_bf16 v[160:163], v[224:227], v[200:203], v[160:163]
ds_read_b128 v[224:227], v241 offset:19456
v_mfma_f32_16x16x32_bf16 v[160:163], v[228:231], v[212:215], v[160:163]
ds_read_b128 v[228:231], v240 offset:19456
s_waitcnt lgkmcnt(5)
v_mfma_f32_16x16x32_bf16 v[164:167], v[232:235], v[212:215], v[164:167]
s_waitcnt lgkmcnt(4)
v_mfma_f32_16x16x32_bf16 v[164:167], v[236:239], v[200:203], v[164:167]
v_mfma_f32_16x16x32_bf16 v[156:159], v[236:239], v[196:199], v[156:159]
v_mfma_f32_16x16x32_bf16 v[156:159], v[232:235], v[208:211], v[156:159]
v_mfma_f32_16x16x32_bf16 v[148:151], v[232:235], v[204:207], v[148:151]
v_mfma_f32_16x16x32_bf16 v[148:151], v[236:239], v[192:195], v[148:151]
s_waitcnt lgkmcnt(3)
v_mfma_f32_16x16x32_bf16 v[168:171], v[216:219], v[192:195], v[168:171]
s_waitcnt lgkmcnt(2)
v_mfma_f32_16x16x32_bf16 v[168:171], v[220:223], v[204:207], v[168:171]
v_mfma_f32_16x16x32_bf16 v[176:179], v[220:223], v[208:211], v[176:179]
v_mfma_f32_16x16x32_bf16 v[176:179], v[216:219], v[196:199], v[176:179]
v_mfma_f32_16x16x32_bf16 v[184:187], v[216:219], v[200:203], v[184:187]
v_mfma_f32_16x16x32_bf16 v[184:187], v[220:223], v[212:215], v[184:187]
s_waitcnt lgkmcnt(1)
v_mfma_f32_16x16x32_bf16 v[188:191], v[224:227], v[212:215], v[188:191]
s_waitcnt lgkmcnt(0)
v_mfma_f32_16x16x32_bf16 v[188:191], v[228:231], v[200:203], v[188:191]
v_mfma_f32_16x16x32_bf16 v[180:183], v[228:231], v[196:199], v[180:183]
v_mfma_f32_16x16x32_bf16 v[180:183], v[224:227], v[208:211], v[180:183]
s_barrier
v_mfma_f32_16x16x32_bf16 v[172:175], v[224:227], v[204:207], v[172:175]
v_mfma_f32_16x16x32_bf16 v[172:175], v[228:231], v[192:195], v[172:175]
s_add_u32 m0, s42, 0
v_add_u32 v246, 0xffe80080, v246
buffer_load_dwordx4 v246, s[16:19], s35 offen offset:1024 lds
buffer_load_dwordx4 v246, s[16:19], s36 offen offset:2048 lds
buffer_load_dwordx4 v246, s[16:19], s37 offen offset:3072 lds
s_barrier
s_add_u32 m0, s42, 16384
v_add_u32 v246, 0x80000, v246
buffer_load_dwordx4 v246, s[16:19], 0 offen lds
buffer_load_dwordx4 v246, s[16:19], s35 offen offset:1024 lds
s_barrier
buffer_load_dwordx4 v246, s[16:19], s36 offen offset:2048 lds
buffer_load_dwordx4 v246, s[16:19], s37 offen offset:3072 lds
s_add_u32 m0, s42, 32768
v_add_u32 v246, 0x80000, v246
buffer_load_dwordx4 v246, s[16:19], 0 offen lds
buffer_load_dwordx4 v246, s[16:19], s35 offen offset:1024 lds
s_waitcnt vmcnt(6)
s_barrier
buffer_load_dwordx4 v246, s[16:19], s36 offen offset:2048 lds
buffer_load_dwordx4 v246, s[16:19], s37 offen offset:3072 lds
s_add_u32 m0, s42, 81920
v_add_u32 v246, 0x80000, v246
buffer_load_dwordx4 v246, s[16:19], 0 offen lds
buffer_load_dwordx4 v246, s[16:19], s35 offen offset:1024 lds
s_waitcnt vmcnt(6)
s_barrier
buffer_load_dwordx4 v246, s[16:19], s36 offen offset:2048 lds
buffer_load_dwordx4 v246, s[16:19], s37 offen offset:3072 lds
s_add_u32 m0, s42, 65536
v_add_u32 v245, 0xfffe0080, v245
buffer_load_dwordx4 v245, s[8:11], 0 offen nt lds
buffer_load_dwordx4 v245, s[8:11], s32 offen offset:1024 nt lds
buffer_load_dwordx4 v245, s[8:11], s33 offen offset:2048 nt lds
buffer_load_dwordx4 v245, s[8:11], s34 offen offset:3072 nt lds
s_waitcnt vmcnt(8)
s_barrier
s_add_u32 m0, s42, 98304
v_add_u32 v245, 0x10000, v245
buffer_load_dwordx4 v245, s[8:11], 0 offen nt lds
buffer_load_dwordx4 v245, s[8:11], s32 offen offset:1024 nt lds
buffer_load_dwordx4 v245, s[8:11], s33 offen offset:2048 nt lds
buffer_load_dwordx4 v245, s[8:11], s34 offen offset:3072 nt lds
s_add_u32 m0, s42, 114688
v_add_u32 v245, 0x10000, v245
buffer_load_dwordx4 v245, s[8:11], 0 offen nt lds
buffer_load_dwordx4 v245, s[8:11], s32 offen offset:1024 nt lds
buffer_load_dwordx4 v245, s[8:11], s33 offen offset:2048 nt lds
buffer_load_dwordx4 v245, s[8:11], s34 offen offset:3072 nt lds
s_waitcnt vmcnt(12)
s_barrier
s_barrier
v_xor_b32 v240, 0x10000, v240
ds_read_b128 v[232:235], v240 offset:49152
ds_read_b128 v[192:195], v242
v_xor_b32 v241, 0x10000, v241
ds_read_b128 v[236:239], v241 offset:49152
ds_read_b128 v[204:207], v242 offset:3072
ds_read_b128 v[208:211], v242 offset:4096
ds_read_b128 v[196:199], v242 offset:1024
ds_read_b128 v[200:203], v242 offset:2048
ds_read_b128 v[212:215], v242 offset:5120
ds_read_b128 v[216:219], v241 offset:50176
ds_read_b128 v[220:223], v240 offset:50176
ds_read_b128 v[224:227], v240 offset:51200
ds_read_b128 v[228:231], v241 offset:51200
s_waitcnt lgkmcnt(10)
v_mfma_f32_16x16x32_bf16 v[0:3], v[232:235], v[192:195], v[0:3]
s_waitcnt lgkmcnt(8)
v_mfma_f32_16x16x32_bf16 v[0:3], v[236:239], v[204:207], v[0:3]
s_waitcnt lgkmcnt(7)
v_mfma_f32_16x16x32_bf16 v[8:11], v[236:239], v[208:211], v[8:11]
s_waitcnt lgkmcnt(6)
v_mfma_f32_16x16x32_bf16 v[8:11], v[232:235], v[196:199], v[8:11]
s_waitcnt lgkmcnt(5)
v_mfma_f32_16x16x32_bf16 v[16:19], v[232:235], v[200:203], v[16:19]
ds_read_b128 v[232:235], v241 offset:52224
s_waitcnt lgkmcnt(5)
v_mfma_f32_16x16x32_bf16 v[16:19], v[236:239], v[212:215], v[16:19]
ds_read_b128 v[236:239], v240 offset:52224
s_waitcnt lgkmcnt(5)
v_mfma_f32_16x16x32_bf16 v[20:23], v[216:219], v[212:215], v[20:23]
s_waitcnt lgkmcnt(4)
v_mfma_f32_16x16x32_bf16 v[20:23], v[220:223], v[200:203], v[20:23]
v_mfma_f32_16x16x32_bf16 v[12:15], v[220:223], v[196:199], v[12:15]
v_mfma_f32_16x16x32_bf16 v[12:15], v[216:219], v[208:211], v[12:15]
v_mfma_f32_16x16x32_bf16 v[4:7], v[216:219], v[204:207], v[4:7]
v_mfma_f32_16x16x32_bf16 v[4:7], v[220:223], v[192:195], v[4:7]
s_waitcnt lgkmcnt(3)
v_mfma_f32_16x16x32_bf16 v[24:27], v[224:227], v[192:195], v[24:27]
s_waitcnt lgkmcnt(2)
v_mfma_f32_16x16x32_bf16 v[24:27], v[228:231], v[204:207], v[24:27]
v_mfma_f32_16x16x32_bf16 v[32:35], v[228:231], v[208:211], v[32:35]
v_mfma_f32_16x16x32_bf16 v[32:35], v[224:227], v[196:199], v[32:35]
v_mfma_f32_16x16x32_bf16 v[40:43], v[224:227], v[200:203], v[40:43]
v_mfma_f32_16x16x32_bf16 v[40:43], v[228:231], v[212:215], v[40:43]
s_waitcnt lgkmcnt(1)
v_mfma_f32_16x16x32_bf16 v[44:47], v[232:235], v[212:215], v[44:47]
s_waitcnt lgkmcnt(0)
v_mfma_f32_16x16x32_bf16 v[44:47], v[236:239], v[200:203], v[44:47]
v_mfma_f32_16x16x32_bf16 v[36:39], v[236:239], v[196:199], v[36:39]
v_mfma_f32_16x16x32_bf16 v[36:39], v[232:235], v[208:211], v[36:39]
s_barrier
v_mfma_f32_16x16x32_bf16 v[28:31], v[232:235], v[204:207], v[28:31]
v_mfma_f32_16x16x32_bf16 v[28:31], v[236:239], v[192:195], v[28:31]
s_waitcnt vmcnt(8)
s_barrier
v_xor_b32 v240, 0x10000, v240
ds_read_b128 v[216:219], v240
v_xor_b32 v241, 0x10000, v241
ds_read_b128 v[220:223], v241
ds_read_b128 v[224:227], v241 offset:1024
ds_read_b128 v[228:231], v240 offset:1024
ds_read_b128 v[232:235], v240 offset:2048
ds_read_b128 v[236:239], v241 offset:2048
s_waitcnt lgkmcnt(5)
v_mfma_f32_16x16x32_bf16 v[48:51], v[216:219], v[192:195], v[48:51]
s_waitcnt lgkmcnt(4)
v_mfma_f32_16x16x32_bf16 v[48:51], v[220:223], v[204:207], v[48:51]
v_mfma_f32_16x16x32_bf16 v[56:59], v[220:223], v[208:211], v[56:59]
v_mfma_f32_16x16x32_bf16 v[56:59], v[216:219], v[196:199], v[56:59]
v_mfma_f32_16x16x32_bf16 v[64:67], v[216:219], v[200:203], v[64:67]
ds_read_b128 v[216:219], v241 offset:3072
v_mfma_f32_16x16x32_bf16 v[64:67], v[220:223], v[212:215], v[64:67]
ds_read_b128 v[220:223], v240 offset:3072
s_waitcnt lgkmcnt(5)
v_mfma_f32_16x16x32_bf16 v[68:71], v[224:227], v[212:215], v[68:71]
s_waitcnt lgkmcnt(4)
v_mfma_f32_16x16x32_bf16 v[68:71], v[228:231], v[200:203], v[68:71]
v_mfma_f32_16x16x32_bf16 v[60:63], v[228:231], v[196:199], v[60:63]
v_mfma_f32_16x16x32_bf16 v[60:63], v[224:227], v[208:211], v[60:63]
v_mfma_f32_16x16x32_bf16 v[52:55], v[224:227], v[204:207], v[52:55]
v_mfma_f32_16x16x32_bf16 v[52:55], v[228:231], v[192:195], v[52:55]
s_waitcnt lgkmcnt(3)
v_mfma_f32_16x16x32_bf16 v[72:75], v[232:235], v[192:195], v[72:75]
s_waitcnt lgkmcnt(2)
v_mfma_f32_16x16x32_bf16 v[72:75], v[236:239], v[204:207], v[72:75]
v_mfma_f32_16x16x32_bf16 v[80:83], v[236:239], v[208:211], v[80:83]
v_mfma_f32_16x16x32_bf16 v[80:83], v[232:235], v[196:199], v[80:83]
v_mfma_f32_16x16x32_bf16 v[88:91], v[232:235], v[200:203], v[88:91]
v_mfma_f32_16x16x32_bf16 v[88:91], v[236:239], v[212:215], v[88:91]
s_waitcnt lgkmcnt(1)
v_mfma_f32_16x16x32_bf16 v[92:95], v[216:219], v[212:215], v[92:95]
s_waitcnt lgkmcnt(0)
v_mfma_f32_16x16x32_bf16 v[92:95], v[220:223], v[200:203], v[92:95]
v_mfma_f32_16x16x32_bf16 v[84:87], v[220:223], v[196:199], v[84:87]
v_mfma_f32_16x16x32_bf16 v[84:87], v[216:219], v[208:211], v[84:87]
s_waitcnt vmcnt(4)
s_barrier
ds_read_b128 v[224:227], v240 offset:32768
ds_read_b128 v[228:231], v241 offset:32768
v_mfma_f32_16x16x32_bf16 v[76:79], v[216:219], v[204:207], v[76:79]
ds_read_b128 v[232:235], v241 offset:33792
ds_read_b128 v[236:239], v240 offset:33792
v_mfma_f32_16x16x32_bf16 v[76:79], v[220:223], v[192:195], v[76:79]
ds_read_b128 v[216:219], v240 offset:34816
ds_read_b128 v[220:223], v241 offset:34816
s_waitcnt lgkmcnt(5)
v_mfma_f32_16x16x32_bf16 v[96:99], v[224:227], v[192:195], v[96:99]
s_waitcnt lgkmcnt(4)
v_mfma_f32_16x16x32_bf16 v[96:99], v[228:231], v[204:207], v[96:99]
v_mfma_f32_16x16x32_bf16 v[104:107], v[228:231], v[208:211], v[104:107]
v_mfma_f32_16x16x32_bf16 v[104:107], v[224:227], v[196:199], v[104:107]
v_mfma_f32_16x16x32_bf16 v[112:115], v[224:227], v[200:203], v[112:115]
ds_read_b128 v[224:227], v241 offset:35840
v_mfma_f32_16x16x32_bf16 v[112:115], v[228:231], v[212:215], v[112:115]
ds_read_b128 v[228:231], v240 offset:35840
s_waitcnt lgkmcnt(5)
v_mfma_f32_16x16x32_bf16 v[116:119], v[232:235], v[212:215], v[116:119]
s_waitcnt lgkmcnt(4)
v_mfma_f32_16x16x32_bf16 v[116:119], v[236:239], v[200:203], v[116:119]
v_mfma_f32_16x16x32_bf16 v[108:111], v[236:239], v[196:199], v[108:111]
v_mfma_f32_16x16x32_bf16 v[108:111], v[232:235], v[208:211], v[108:111]
v_mfma_f32_16x16x32_bf16 v[100:103], v[232:235], v[204:207], v[100:103]
v_mfma_f32_16x16x32_bf16 v[100:103], v[236:239], v[192:195], v[100:103]
s_waitcnt lgkmcnt(3)
v_mfma_f32_16x16x32_bf16 v[120:123], v[216:219], v[192:195], v[120:123]
s_waitcnt lgkmcnt(2)
v_mfma_f32_16x16x32_bf16 v[120:123], v[220:223], v[204:207], v[120:123]
v_mfma_f32_16x16x32_bf16 v[128:131], v[220:223], v[208:211], v[128:131]
v_mfma_f32_16x16x32_bf16 v[128:131], v[216:219], v[196:199], v[128:131]
v_mfma_f32_16x16x32_bf16 v[136:139], v[216:219], v[200:203], v[136:139]
v_mfma_f32_16x16x32_bf16 v[136:139], v[220:223], v[212:215], v[136:139]
s_waitcnt lgkmcnt(1)
v_mfma_f32_16x16x32_bf16 v[140:143], v[224:227], v[212:215], v[140:143]
s_waitcnt lgkmcnt(0)
v_mfma_f32_16x16x32_bf16 v[140:143], v[228:231], v[200:203], v[140:143]
v_mfma_f32_16x16x32_bf16 v[132:135], v[228:231], v[196:199], v[132:135]
v_mfma_f32_16x16x32_bf16 v[132:135], v[224:227], v[208:211], v[132:135]
s_waitcnt vmcnt(0)
s_barrier
ds_read_b128 v[232:235], v240 offset:49152
ds_read_b128 v[236:239], v241 offset:49152
v_mfma_f32_16x16x32_bf16 v[124:127], v[224:227], v[204:207], v[124:127]
ds_read_b128 v[216:219], v241 offset:50176
ds_read_b128 v[220:223], v240 offset:50176
v_mfma_f32_16x16x32_bf16 v[124:127], v[228:231], v[192:195], v[124:127]
ds_read_b128 v[224:227], v240 offset:51200
ds_read_b128 v[228:231], v241 offset:51200
s_waitcnt lgkmcnt(5)
v_mfma_f32_16x16x32_bf16 v[144:147], v[232:235], v[192:195], v[144:147]
s_waitcnt lgkmcnt(4)
v_mfma_f32_16x16x32_bf16 v[144:147], v[236:239], v[204:207], v[144:147]
v_mfma_f32_16x16x32_bf16 v[152:155], v[236:239], v[208:211], v[152:155]
v_mfma_f32_16x16x32_bf16 v[152:155], v[232:235], v[196:199], v[152:155]
v_mfma_f32_16x16x32_bf16 v[160:163], v[232:235], v[200:203], v[160:163]
ds_read_b128 v[232:235], v241 offset:52224
v_mfma_f32_16x16x32_bf16 v[160:163], v[236:239], v[212:215], v[160:163]
ds_read_b128 v[236:239], v240 offset:52224
s_waitcnt lgkmcnt(5)
v_mfma_f32_16x16x32_bf16 v[164:167], v[216:219], v[212:215], v[164:167]
s_waitcnt lgkmcnt(4)
v_mfma_f32_16x16x32_bf16 v[164:167], v[220:223], v[200:203], v[164:167]
v_mfma_f32_16x16x32_bf16 v[156:159], v[220:223], v[196:199], v[156:159]
v_mfma_f32_16x16x32_bf16 v[156:159], v[216:219], v[208:211], v[156:159]
v_mfma_f32_16x16x32_bf16 v[148:151], v[216:219], v[204:207], v[148:151]
v_mfma_f32_16x16x32_bf16 v[148:151], v[220:223], v[192:195], v[148:151]
s_waitcnt lgkmcnt(3)
v_mfma_f32_16x16x32_bf16 v[168:171], v[224:227], v[192:195], v[168:171]
s_waitcnt lgkmcnt(2)
v_mfma_f32_16x16x32_bf16 v[168:171], v[228:231], v[204:207], v[168:171]
v_mfma_f32_16x16x32_bf16 v[176:179], v[228:231], v[208:211], v[176:179]
v_mfma_f32_16x16x32_bf16 v[176:179], v[224:227], v[196:199], v[176:179]
v_mfma_f32_16x16x32_bf16 v[184:187], v[224:227], v[200:203], v[184:187]
v_mfma_f32_16x16x32_bf16 v[184:187], v[228:231], v[212:215], v[184:187]
s_waitcnt lgkmcnt(1)
v_mfma_f32_16x16x32_bf16 v[188:191], v[232:235], v[212:215], v[188:191]
s_waitcnt lgkmcnt(0)
v_mfma_f32_16x16x32_bf16 v[188:191], v[236:239], v[200:203], v[188:191]
v_mfma_f32_16x16x32_bf16 v[180:183], v[236:239], v[196:199], v[180:183]
v_mfma_f32_16x16x32_bf16 v[180:183], v[232:235], v[208:211], v[180:183]
s_barrier
v_mfma_f32_16x16x32_bf16 v[172:175], v[232:235], v[204:207], v[172:175]
v_mfma_f32_16x16x32_bf16 v[172:175], v[236:239], v[192:195], v[172:175]
s_add_u32 m0, s42, 65536
v_add_u32 v246, 0xfff00080, v246
buffer_load_dwordx4 v246, s[16:19], s37 offen offset:3072 lds
s_add_u32 m0, s42, 98304
v_add_u32 v246, 0x80000, v246
buffer_load_dwordx4 v246, s[16:19], 0 offen lds
buffer_load_dwordx4 v246, s[16:19], s35 offen offset:1024 lds
buffer_load_dwordx4 v246, s[16:19], s36 offen offset:2048 lds
buffer_load_dwordx4 v246, s[16:19], s37 offen offset:3072 lds
s_add_u32 m0, s42, 114688
v_add_u32 v246, 0x80000, v246
buffer_load_dwordx4 v246, s[16:19], 0 offen lds
buffer_load_dwordx4 v246, s[16:19], s35 offen offset:1024 lds
s_barrier
buffer_load_dwordx4 v246, s[16:19], s36 offen offset:2048 lds
buffer_load_dwordx4 v246, s[16:19], s37 offen offset:3072 lds
s_add_u32 m0, s42, 0
v_add_u32 v245, 0xfffd0080, v245
buffer_load_dwordx4 v245, s[8:11], s33 offen offset:2048 nt lds
buffer_load_dwordx4 v245, s[8:11], s34 offen offset:3072 nt lds
s_add_u32 m0, s42, 16384
v_add_u32 v245, 0x10000, v245
buffer_load_dwordx4 v245, s[8:11], 0 offen nt lds
buffer_load_dwordx4 v245, s[8:11], s32 offen offset:1024 nt lds
buffer_load_dwordx4 v245, s[8:11], s33 offen offset:2048 nt lds
s_waitcnt vmcnt(13)
s_barrier
s_waitcnt vmcnt(5)
s_barrier
s_waitcnt vmcnt(3)
s_barrier
v_xor_b32 v240, 0x10000, v240
ds_read_b128 v[216:219], v240
ds_read_b128 v[192:195], v242 offset:12288
v_xor_b32 v241, 0x10000, v241
ds_read_b128 v[220:223], v241
ds_read_b128 v[204:207], v242 offset:15360
ds_read_b128 v[208:211], v242 offset:16384
ds_read_b128 v[196:199], v242 offset:13312
ds_read_b128 v[200:203], v242 offset:14336
ds_read_b128 v[212:215], v242 offset:17408
ds_read_b128 v[224:227], v241 offset:1024
ds_read_b128 v[228:231], v240 offset:1024
ds_read_b128 v[232:235], v240 offset:2048
ds_read_b128 v[236:239], v241 offset:2048
s_waitcnt lgkmcnt(10)
v_mfma_f32_16x16x32_bf16 v[0:3], v[216:219], v[192:195], v[0:3]
s_waitcnt lgkmcnt(8)
v_mfma_f32_16x16x32_bf16 v[0:3], v[220:223], v[204:207], v[0:3]
s_waitcnt lgkmcnt(7)
v_mfma_f32_16x16x32_bf16 v[8:11], v[220:223], v[208:211], v[8:11]
s_waitcnt lgkmcnt(6)
v_mfma_f32_16x16x32_bf16 v[8:11], v[216:219], v[196:199], v[8:11]
s_waitcnt lgkmcnt(5)
v_mfma_f32_16x16x32_bf16 v[16:19], v[216:219], v[200:203], v[16:19]
ds_read_b128 v[216:219], v241 offset:3072
s_waitcnt lgkmcnt(5)
v_mfma_f32_16x16x32_bf16 v[16:19], v[220:223], v[212:215], v[16:19]
ds_read_b128 v[220:223], v240 offset:3072
s_waitcnt lgkmcnt(5)
v_mfma_f32_16x16x32_bf16 v[20:23], v[224:227], v[212:215], v[20:23]
s_waitcnt lgkmcnt(4)
v_mfma_f32_16x16x32_bf16 v[20:23], v[228:231], v[200:203], v[20:23]
v_mfma_f32_16x16x32_bf16 v[12:15], v[228:231], v[196:199], v[12:15]
v_mfma_f32_16x16x32_bf16 v[12:15], v[224:227], v[208:211], v[12:15]
v_mfma_f32_16x16x32_bf16 v[4:7], v[224:227], v[204:207], v[4:7]
v_mfma_f32_16x16x32_bf16 v[4:7], v[228:231], v[192:195], v[4:7]
s_waitcnt lgkmcnt(3)
v_mfma_f32_16x16x32_bf16 v[24:27], v[232:235], v[192:195], v[24:27]
s_waitcnt lgkmcnt(2)
v_mfma_f32_16x16x32_bf16 v[24:27], v[236:239], v[204:207], v[24:27]
v_mfma_f32_16x16x32_bf16 v[32:35], v[236:239], v[208:211], v[32:35]
v_max_f32 v249, v0, v1
v_max_f32 v250, v8, v9
v_mfma_f32_16x16x32_bf16 v[32:35], v[232:235], v[196:199], v[32:35]
v_max_f32 v251, v16, v17
v_max3_f32 v249, v249, v2, v3
v_mfma_f32_16x16x32_bf16 v[40:43], v[232:235], v[200:203], v[40:43]
v_max3_f32 v250, v250, v10, v11
v_max3_f32 v251, v251, v18, v19
v_mfma_f32_16x16x32_bf16 v[40:43], v[236:239], v[212:215], v[40:43]
v_max3_f32 v249, v249, v4, v5
v_max3_f32 v250, v250, v12, v13
s_waitcnt lgkmcnt(1)
v_mfma_f32_16x16x32_bf16 v[44:47], v[216:219], v[212:215], v[44:47]
v_max3_f32 v251, v251, v20, v21
v_max3_f32 v249, v249, v6, v7
s_waitcnt lgkmcnt(0)
v_mfma_f32_16x16x32_bf16 v[44:47], v[220:223], v[200:203], v[44:47]
v_max3_f32 v250, v250, v14, v15
v_max3_f32 v251, v251, v22, v23
v_mfma_f32_16x16x32_bf16 v[36:39], v[220:223], v[196:199], v[36:39]
v_mfma_f32_16x16x32_bf16 v[36:39], v[216:219], v[208:211], v[36:39]
v_mfma_f32_16x16x32_bf16 v[28:31], v[216:219], v[204:207], v[28:31]
v_mfma_f32_16x16x32_bf16 v[28:31], v[220:223], v[192:195], v[28:31]
v_max3_f32 v249, v249, v24, v25
v_max3_f32 v250, v250, v32, v33
v_max3_f32 v251, v251, v40, v41
v_max3_f32 v249, v249, v26, v27
v_max3_f32 v250, v250, v34, v35
v_max3_f32 v251, v251, v42, v43
s_nop 1
v_max3_f32 v249, v249, v28, v29
v_max3_f32 v250, v250, v36, v37
v_max3_f32 v251, v251, v44, v45
v_max3_f32 v249, v249, v30, v31
v_max3_f32 v250, v250, v38, v39
v_max3_f32 v251, v251, v46, v47
v_mul_f32 v249, s43, v249
v_mul_f32 v250, s43, v250
v_mul_f32 v251, s43, v251
v_fma_f32 v0, v0, s43, -v249
v_fma_f32 v1, v1, s43, -v249
v_fma_f32 v2, v2, s43, -v249
v_fma_f32 v3, v3, s43, -v249
v_fma_f32 v4, v4, s43, -v249
v_fma_f32 v5, v5, s43, -v249
v_fma_f32 v6, v6, s43, -v249
v_fma_f32 v7, v7, s43, -v249
v_exp_f32 v0, v0
v_exp_f32 v1, v1
v_exp_f32 v2, v2
v_exp_f32 v3, v3
v_exp_f32 v4, v4
v_exp_f32 v5, v5
v_exp_f32 v6, v6
v_exp_f32 v7, v7
v_fma_f32 v8, v8, s43, -v250
v_fma_f32 v9, v9, s43, -v250
v_fma_f32 v10, v10, s43, -v250
v_fma_f32 v11, v11, s43, -v250
v_fma_f32 v12, v12, s43, -v250
v_fma_f32 v13, v13, s43, -v250
v_fma_f32 v14, v14, s43, -v250
v_fma_f32 v15, v15, s43, -v250
v_exp_f32 v8, v8
v_exp_f32 v9, v9
v_exp_f32 v10, v10
v_exp_f32 v11, v11
v_exp_f32 v12, v12
v_exp_f32 v13, v13
v_exp_f32 v14, v14
v_exp_f32 v15, v15
v_fma_f32 v16, v16, s43, -v251
v_fma_f32 v17, v17, s43, -v251
v_fma_f32 v18, v18, s43, -v251
v_fma_f32 v19, v19, s43, -v251
v_fma_f32 v20, v20, s43, -v251
v_fma_f32 v21, v21, s43, -v251
v_fma_f32 v22, v22, s43, -v251
v_fma_f32 v23, v23, s43, -v251
v_exp_f32 v16, v16
v_exp_f32 v17, v17
v_exp_f32 v18, v18
v_exp_f32 v19, v19
v_exp_f32 v20, v20
v_exp_f32 v21, v21
v_exp_f32 v22, v22
v_exp_f32 v23, v23
v_fma_f32 v24, v24, s43, -v249
v_fma_f32 v25, v25, s43, -v249
v_fma_f32 v26, v26, s43, -v249
v_fma_f32 v27, v27, s43, -v249
v_fma_f32 v28, v28, s43, -v249
v_fma_f32 v29, v29, s43, -v249
v_fma_f32 v30, v30, s43, -v249
v_fma_f32 v31, v31, s43, -v249
v_exp_f32 v24, v24
v_exp_f32 v25, v25
v_exp_f32 v26, v26
v_exp_f32 v27, v27
v_exp_f32 v28, v28
v_exp_f32 v29, v29
v_exp_f32 v30, v30
v_exp_f32 v31, v31
v_fma_f32 v32, v32, s43, -v250
v_fma_f32 v33, v33, s43, -v250
v_fma_f32 v34, v34, s43, -v250
v_fma_f32 v35, v35, s43, -v250
v_fma_f32 v36, v36, s43, -v250
v_fma_f32 v37, v37, s43, -v250
v_fma_f32 v38, v38, s43, -v250
v_fma_f32 v39, v39, s43, -v250
v_exp_f32 v32, v32
v_exp_f32 v33, v33
v_exp_f32 v34, v34
v_exp_f32 v35, v35
v_exp_f32 v36, v36
s_waitcnt vmcnt(0)
s_barrier
ds_read_b128 v[224:227], v240 offset:16384
ds_read_b128 v[228:231], v241 offset:16384
ds_read_b128 v[232:235], v241 offset:17408
ds_read_b128 v[236:239], v240 offset:17408
ds_read_b128 v[216:219], v240 offset:18432
ds_read_b128 v[220:223], v241 offset:18432
v_exp_f32 v37, v37
v_exp_f32 v38, v38
v_exp_f32 v39, v39
v_fma_f32 v40, v40, s43, -v251
v_fma_f32 v41, v41, s43, -v251
v_fma_f32 v42, v42, s43, -v251
v_fma_f32 v43, v43, s43, -v251
v_fma_f32 v44, v44, s43, -v251
v_fma_f32 v45, v45, s43, -v251
v_fma_f32 v46, v46, s43, -v251
v_fma_f32 v47, v47, s43, -v251
v_exp_f32 v40, v40
s_waitcnt lgkmcnt(5)
v_mfma_f32_16x16x32_bf16 v[48:51], v[224:227], v[192:195], v[48:51]
v_exp_f32 v41, v41
s_waitcnt lgkmcnt(4)
v_mfma_f32_16x16x32_bf16 v[48:51], v[228:231], v[204:207], v[48:51]
v_exp_f32 v42, v42
v_mfma_f32_16x16x32_bf16 v[56:59], v[228:231], v[208:211], v[56:59]
v_exp_f32 v43, v43
v_mfma_f32_16x16x32_bf16 v[56:59], v[224:227], v[196:199], v[56:59]
v_exp_f32 v44, v44
v_mfma_f32_16x16x32_bf16 v[64:67], v[224:227], v[200:203], v[64:67]
ds_read_b128 v[224:227], v241 offset:19456
v_exp_f32 v45, v45
v_mfma_f32_16x16x32_bf16 v[64:67], v[228:231], v[212:215], v[64:67]
ds_read_b128 v[228:231], v240 offset:19456
v_exp_f32 v46, v46
s_waitcnt lgkmcnt(5)
v_mfma_f32_16x16x32_bf16 v[68:71], v[232:235], v[212:215], v[68:71]
v_exp_f32 v47, v47
s_waitcnt lgkmcnt(4)
v_mfma_f32_16x16x32_bf16 v[68:71], v[236:239], v[200:203], v[68:71]
v_mfma_f32_16x16x32_bf16 v[60:63], v[236:239], v[196:199], v[60:63]
v_mfma_f32_16x16x32_bf16 v[60:63], v[232:235], v[208:211], v[60:63]
v_mfma_f32_16x16x32_bf16 v[52:55], v[232:235], v[204:207], v[52:55]
v_mfma_f32_16x16x32_bf16 v[52:55], v[236:239], v[192:195], v[52:55]
s_waitcnt lgkmcnt(3)
v_mfma_f32_16x16x32_bf16 v[72:75], v[216:219], v[192:195], v[72:75]
s_waitcnt lgkmcnt(2)
v_mfma_f32_16x16x32_bf16 v[72:75], v[220:223], v[204:207], v[72:75]
v_mfma_f32_16x16x32_bf16 v[80:83], v[220:223], v[208:211], v[80:83]
v_max_f32 v252, v48, v49
v_max_f32 v253, v56, v57
v_mfma_f32_16x16x32_bf16 v[80:83], v[216:219], v[196:199], v[80:83]
v_max_f32 v254, v64, v65
v_max3_f32 v252, v252, v50, v51
v_mfma_f32_16x16x32_bf16 v[88:91], v[216:219], v[200:203], v[88:91]
v_max3_f32 v253, v253, v58, v59
v_max3_f32 v254, v254, v66, v67
v_mfma_f32_16x16x32_bf16 v[88:91], v[220:223], v[212:215], v[88:91]
v_max3_f32 v252, v252, v52, v53
v_max3_f32 v253, v253, v60, v61
s_waitcnt lgkmcnt(1)
v_mfma_f32_16x16x32_bf16 v[92:95], v[224:227], v[212:215], v[92:95]
v_max3_f32 v254, v254, v68, v69
v_max3_f32 v252, v252, v54, v55
s_waitcnt lgkmcnt(0)
v_mfma_f32_16x16x32_bf16 v[92:95], v[228:231], v[200:203], v[92:95]
v_max3_f32 v253, v253, v62, v63
v_max3_f32 v254, v254, v70, v71
v_mfma_f32_16x16x32_bf16 v[84:87], v[228:231], v[196:199], v[84:87]
v_mfma_f32_16x16x32_bf16 v[84:87], v[224:227], v[208:211], v[84:87]
v_mfma_f32_16x16x32_bf16 v[76:79], v[224:227], v[204:207], v[76:79]
v_mfma_f32_16x16x32_bf16 v[76:79], v[228:231], v[192:195], v[76:79]
v_max3_f32 v252, v252, v72, v73
v_max3_f32 v253, v253, v80, v81
v_max3_f32 v254, v254, v88, v89
v_max3_f32 v252, v252, v74, v75
v_max3_f32 v253, v253, v82, v83
v_max3_f32 v254, v254, v90, v91
s_nop 1
v_max3_f32 v252, v252, v76, v77
v_max3_f32 v253, v253, v84, v85
v_max3_f32 v254, v254, v92, v93
v_max3_f32 v252, v252, v78, v79
v_max3_f32 v253, v253, v86, v87
v_max3_f32 v254, v254, v94, v95
v_mul_f32 v252, s43, v252
v_mul_f32 v253, s43, v253
v_mul_f32 v254, s43, v254
v_fma_f32 v48, v48, s43, -v252
v_fma_f32 v49, v49, s43, -v252
v_fma_f32 v50, v50, s43, -v252
v_fma_f32 v51, v51, s43, -v252
v_fma_f32 v52, v52, s43, -v252
v_fma_f32 v53, v53, s43, -v252
v_fma_f32 v54, v54, s43, -v252
v_fma_f32 v55, v55, s43, -v252
v_exp_f32 v48, v48
v_exp_f32 v49, v49
v_exp_f32 v50, v50
v_exp_f32 v51, v51
v_exp_f32 v52, v52
v_exp_f32 v53, v53
v_exp_f32 v54, v54
v_exp_f32 v55, v55
v_fma_f32 v56, v56, s43, -v253
v_fma_f32 v57, v57, s43, -v253
v_fma_f32 v58, v58, s43, -v253
v_fma_f32 v59, v59, s43, -v253
v_fma_f32 v60, v60, s43, -v253
v_fma_f32 v61, v61, s43, -v253
v_fma_f32 v62, v62, s43, -v253
v_fma_f32 v63, v63, s43, -v253
v_exp_f32 v56, v56
v_exp_f32 v57, v57
v_exp_f32 v58, v58
v_exp_f32 v59, v59
v_exp_f32 v60, v60
v_exp_f32 v61, v61
v_exp_f32 v62, v62
v_exp_f32 v63, v63
v_fma_f32 v64, v64, s43, -v254
v_fma_f32 v65, v65, s43, -v254
v_fma_f32 v66, v66, s43, -v254
v_fma_f32 v67, v67, s43, -v254
v_fma_f32 v68, v68, s43, -v254
v_fma_f32 v69, v69, s43, -v254
v_fma_f32 v70, v70, s43, -v254
v_fma_f32 v71, v71, s43, -v254
v_exp_f32 v64, v64
v_exp_f32 v65, v65
v_exp_f32 v66, v66
v_exp_f32 v67, v67
v_exp_f32 v68, v68
v_exp_f32 v69, v69
v_exp_f32 v70, v70
v_exp_f32 v71, v71
v_fma_f32 v72, v72, s43, -v252
v_fma_f32 v73, v73, s43, -v252
v_fma_f32 v74, v74, s43, -v252
v_fma_f32 v75, v75, s43, -v252
v_fma_f32 v76, v76, s43, -v252
v_fma_f32 v77, v77, s43, -v252
v_fma_f32 v78, v78, s43, -v252
v_fma_f32 v79, v79, s43, -v252
v_exp_f32 v72, v72
v_exp_f32 v73, v73
v_exp_f32 v74, v74
v_exp_f32 v75, v75
v_exp_f32 v76, v76
v_exp_f32 v77, v77
v_exp_f32 v78, v78
v_exp_f32 v79, v79
v_fma_f32 v80, v80, s43, -v253
v_fma_f32 v81, v81, s43, -v253
v_fma_f32 v82, v82, s43, -v253
v_fma_f32 v83, v83, s43, -v253
v_fma_f32 v84, v84, s43, -v253
v_fma_f32 v85, v85, s43, -v253
v_fma_f32 v86, v86, s43, -v253
v_fma_f32 v87, v87, s43, -v253
v_exp_f32 v80, v80
v_exp_f32 v81, v81
v_exp_f32 v82, v82
v_exp_f32 v83, v83
v_exp_f32 v84, v84
s_barrier
s_barrier
ds_read_b128 v[232:235], v240 offset:32768
ds_read_b128 v[236:239], v241 offset:32768
ds_read_b128 v[216:219], v241 offset:33792
ds_read_b128 v[220:223], v240 offset:33792
ds_read_b128 v[224:227], v240 offset:34816
ds_read_b128 v[228:231], v241 offset:34816
v_exp_f32 v85, v85
v_exp_f32 v86, v86
v_exp_f32 v87, v87
v_fma_f32 v88, v88, s43, -v254
v_fma_f32 v89, v89, s43, -v254
v_fma_f32 v90, v90, s43, -v254
v_fma_f32 v91, v91, s43, -v254
v_fma_f32 v92, v92, s43, -v254
v_fma_f32 v93, v93, s43, -v254
v_fma_f32 v94, v94, s43, -v254
v_fma_f32 v95, v95, s43, -v254
v_exp_f32 v88, v88
s_waitcnt lgkmcnt(5)
v_mfma_f32_16x16x32_bf16 v[96:99], v[232:235], v[192:195], v[96:99]
v_exp_f32 v89, v89
s_waitcnt lgkmcnt(4)
v_mfma_f32_16x16x32_bf16 v[96:99], v[236:239], v[204:207], v[96:99]
v_exp_f32 v90, v90
v_mfma_f32_16x16x32_bf16 v[104:107], v[236:239], v[208:211], v[104:107]
v_exp_f32 v91, v91
v_mfma_f32_16x16x32_bf16 v[104:107], v[232:235], v[196:199], v[104:107]
v_exp_f32 v92, v92
v_mfma_f32_16x16x32_bf16 v[112:115], v[232:235], v[200:203], v[112:115]
ds_read_b128 v[232:235], v241 offset:35840
v_exp_f32 v93, v93
v_mfma_f32_16x16x32_bf16 v[112:115], v[236:239], v[212:215], v[112:115]
ds_read_b128 v[236:239], v240 offset:35840
v_exp_f32 v94, v94
s_waitcnt lgkmcnt(5)
v_mfma_f32_16x16x32_bf16 v[116:119], v[216:219], v[212:215], v[116:119]
v_exp_f32 v95, v95
s_waitcnt lgkmcnt(4)
v_mfma_f32_16x16x32_bf16 v[116:119], v[220:223], v[200:203], v[116:119]
v_mfma_f32_16x16x32_bf16 v[108:111], v[220:223], v[196:199], v[108:111]
v_mfma_f32_16x16x32_bf16 v[108:111], v[216:219], v[208:211], v[108:111]
v_mfma_f32_16x16x32_bf16 v[100:103], v[216:219], v[204:207], v[100:103]
v_mfma_f32_16x16x32_bf16 v[100:103], v[220:223], v[192:195], v[100:103]
s_waitcnt lgkmcnt(3)
v_mfma_f32_16x16x32_bf16 v[120:123], v[224:227], v[192:195], v[120:123]
s_waitcnt lgkmcnt(2)
v_mfma_f32_16x16x32_bf16 v[120:123], v[228:231], v[204:207], v[120:123]
v_mfma_f32_16x16x32_bf16 v[128:131], v[228:231], v[208:211], v[128:131]
v_max_f32 v245, v96, v97
v_max_f32 v246, v104, v105
v_mfma_f32_16x16x32_bf16 v[128:131], v[224:227], v[196:199], v[128:131]
v_max_f32 v247, v112, v113
v_max3_f32 v245, v245, v98, v99
v_mfma_f32_16x16x32_bf16 v[136:139], v[224:227], v[200:203], v[136:139]
v_max3_f32 v246, v246, v106, v107
v_max3_f32 v247, v247, v114, v115
v_mfma_f32_16x16x32_bf16 v[136:139], v[228:231], v[212:215], v[136:139]
v_max3_f32 v245, v245, v100, v101
v_max3_f32 v246, v246, v108, v109
s_waitcnt lgkmcnt(1)
v_mfma_f32_16x16x32_bf16 v[140:143], v[232:235], v[212:215], v[140:143]
v_max3_f32 v247, v247, v116, v117
v_max3_f32 v245, v245, v102, v103
s_waitcnt lgkmcnt(0)
v_mfma_f32_16x16x32_bf16 v[140:143], v[236:239], v[200:203], v[140:143]
v_max3_f32 v246, v246, v110, v111
v_max3_f32 v247, v247, v118, v119
v_mfma_f32_16x16x32_bf16 v[132:135], v[236:239], v[196:199], v[132:135]
v_mfma_f32_16x16x32_bf16 v[132:135], v[232:235], v[208:211], v[132:135]
s_barrier
v_xor_b32 v240, 0x10000, v240
ds_read_b128 v[216:219], v240 offset:16384
v_mfma_f32_16x16x32_bf16 v[124:127], v[232:235], v[204:207], v[124:127]
v_xor_b32 v241, 0x10000, v241
ds_read_b128 v[220:223], v241 offset:16384
v_mfma_f32_16x16x32_bf16 v[124:127], v[236:239], v[192:195], v[124:127]
ds_read_b128 v[224:227], v241 offset:17408
ds_read_b128 v[228:231], v240 offset:17408
ds_read_b128 v[232:235], v240 offset:18432
ds_read_b128 v[236:239], v241 offset:18432
s_waitcnt lgkmcnt(5)
v_mfma_f32_16x16x32_bf16 v[144:147], v[216:219], v[192:195], v[144:147]
v_max3_f32 v245, v245, v120, v121
v_max3_f32 v246, v246, v128, v129
s_waitcnt lgkmcnt(4)
v_mfma_f32_16x16x32_bf16 v[144:147], v[220:223], v[204:207], v[144:147]
v_max3_f32 v247, v247, v136, v137
v_max3_f32 v245, v245, v122, v123
v_mfma_f32_16x16x32_bf16 v[152:155], v[220:223], v[208:211], v[152:155]
v_max3_f32 v246, v246, v130, v131
v_max3_f32 v247, v247, v138, v139
v_mfma_f32_16x16x32_bf16 v[152:155], v[216:219], v[196:199], v[152:155]
v_max3_f32 v245, v245, v124, v125
v_max3_f32 v246, v246, v132, v133
v_mfma_f32_16x16x32_bf16 v[160:163], v[216:219], v[200:203], v[160:163]
ds_read_b128 v[216:219], v241 offset:19456
v_max3_f32 v247, v247, v140, v141
v_mfma_f32_16x16x32_bf16 v[160:163], v[220:223], v[212:215], v[160:163]
ds_read_b128 v[220:223], v240 offset:19456
v_max3_f32 v245, v245, v126, v127
s_waitcnt lgkmcnt(5)
v_mfma_f32_16x16x32_bf16 v[164:167], v[224:227], v[212:215], v[164:167]
v_max3_f32 v246, v246, v134, v135
v_max3_f32 v247, v247, v142, v143
s_waitcnt lgkmcnt(4)
v_mfma_f32_16x16x32_bf16 v[164:167], v[228:231], v[200:203], v[164:167]
v_mfma_f32_16x16x32_bf16 v[156:159], v[228:231], v[196:199], v[156:159]
v_mfma_f32_16x16x32_bf16 v[156:159], v[224:227], v[208:211], v[156:159]
v_mfma_f32_16x16x32_bf16 v[148:151], v[224:227], v[204:207], v[148:151]
v_mfma_f32_16x16x32_bf16 v[148:151], v[228:231], v[192:195], v[148:151]
s_waitcnt lgkmcnt(3)
v_mfma_f32_16x16x32_bf16 v[168:171], v[232:235], v[192:195], v[168:171]
s_waitcnt lgkmcnt(2)
v_mfma_f32_16x16x32_bf16 v[168:171], v[236:239], v[204:207], v[168:171]
v_mfma_f32_16x16x32_bf16 v[176:179], v[236:239], v[208:211], v[176:179]
v_max3_f32 v245, v245, v144, v145
v_max3_f32 v246, v246, v152, v153
v_mfma_f32_16x16x32_bf16 v[176:179], v[232:235], v[196:199], v[176:179]
v_max3_f32 v247, v247, v160, v161
v_max3_f32 v245, v245, v146, v147
v_mfma_f32_16x16x32_bf16 v[184:187], v[232:235], v[200:203], v[184:187]
v_max3_f32 v246, v246, v154, v155
v_max3_f32 v247, v247, v162, v163
v_mfma_f32_16x16x32_bf16 v[184:187], v[236:239], v[212:215], v[184:187]
v_max3_f32 v245, v245, v148, v149
v_max3_f32 v246, v246, v156, v157
s_waitcnt lgkmcnt(1)
v_mfma_f32_16x16x32_bf16 v[188:191], v[216:219], v[212:215], v[188:191]
v_max3_f32 v247, v247, v164, v165
v_max3_f32 v245, v245, v150, v151
s_waitcnt lgkmcnt(0)
v_mfma_f32_16x16x32_bf16 v[188:191], v[220:223], v[200:203], v[188:191]
v_max3_f32 v246, v246, v158, v159
v_max3_f32 v247, v247, v166, v167
v_mfma_f32_16x16x32_bf16 v[180:183], v[220:223], v[196:199], v[180:183]
v_mfma_f32_16x16x32_bf16 v[180:183], v[216:219], v[208:211], v[180:183]
v_mfma_f32_16x16x32_bf16 v[172:175], v[216:219], v[204:207], v[172:175]
v_mfma_f32_16x16x32_bf16 v[172:175], v[220:223], v[192:195], v[172:175]
v_max3_f32 v245, v245, v168, v169
v_max3_f32 v246, v246, v176, v177
v_max3_f32 v247, v247, v184, v185
v_max3_f32 v245, v245, v170, v171
v_max3_f32 v246, v246, v178, v179
v_max3_f32 v247, v247, v186, v187
s_nop 1
v_max3_f32 v245, v245, v172, v173
v_max3_f32 v246, v246, v180, v181
v_max3_f32 v247, v247, v188, v189
v_max3_f32 v245, v245, v174, v175
v_max3_f32 v246, v246, v182, v183
v_max3_f32 v247, v247, v190, v191
v_mul_f32 v240, s43, v245
v_mul_f32 v241, s43, v246
v_mul_f32 v242, s43, v247
v_max_f32 v240, v240, v249
v_max_f32 v241, v241, v250
v_max_f32 v242, v242, v251
v_max_f32 v240, v240, v252
v_max_f32 v241, v241, v253
v_max_f32 v242, v242, v254
v_mov_b32 v192, v240
v_mov_b32 v193, v241
v_mov_b32 v194, v242
v_permlane32_swap_b32 v192, v240
v_permlane32_swap_b32 v193, v241
v_permlane32_swap_b32 v194, v242
v_max_f32 v240, v240, v192
v_max_f32 v241, v241, v193
v_max_f32 v242, v242, v194
v_mov_b32 v192, v240
v_mov_b32 v193, v241
v_mov_b32 v194, v242
v_permlane16_swap_b32 v192, v240
v_permlane16_swap_b32 v193, v241
v_permlane16_swap_b32 v194, v242
v_max_f32 v240, v240, v192
v_max_f32 v241, v241, v193
v_max_f32 v242, v242, v194
ds_write_b128 v243, v[240:243] offset:6144
v_xor_b32 v245, 32, v244
v_xor_b32 v246, 8192, v244
v_xor_b32 v247, 8224, v244
s_waitcnt lgkmcnt(0)
s_barrier
ds_read_b128 v[192:195], v248 offset:6144
s_waitcnt lgkmcnt(0)
v_max_f32 v240, v240, v192
v_max_f32 v241, v241, v193
v_max_f32 v242, v242, v194
v_sub_f32 v249, v249, v240
v_sub_f32 v250, v250, v241
v_sub_f32 v251, v251, v242
v_exp_f32 v249, v249
v_exp_f32 v250, v250
v_exp_f32 v251, v251
v_sub_f32 v252, v252, v240
v_sub_f32 v253, v253, v241
v_sub_f32 v254, v254, v242
v_exp_f32 v252, v252
v_exp_f32 v253, v253
v_exp_f32 v254, v254
v_mul_f32 v0, v0, v249
v_mul_f32 v1, v1, v249
v_mul_f32 v2, v2, v249
v_mul_f32 v3, v3, v249
v_mul_f32 v4, v4, v249
v_mul_f32 v5, v5, v249
v_mul_f32 v6, v6, v249
v_mul_f32 v7, v7, v249
v_cvt_pk_bf16_f32 v0, v0, v1
v_cvt_pk_bf16_f32 v1, v2, v3
v_cvt_pk_bf16_f32 v2, v4, v5
v_cvt_pk_bf16_f32 v3, v6, v7
v_mul_f32 v8, v8, v250
v_mul_f32 v9, v9, v250
v_mul_f32 v10, v10, v250
v_mul_f32 v11, v11, v250
v_mul_f32 v12, v12, v250
v_mul_f32 v13, v13, v250
v_mul_f32 v14, v14, v250
v_mul_f32 v15, v15, v250
v_cvt_pk_bf16_f32 v8, v8, v9
v_cvt_pk_bf16_f32 v9, v10, v11
v_cvt_pk_bf16_f32 v10, v12, v13
v_cvt_pk_bf16_f32 v11, v14, v15
ds_write_b128 v243, v[0:3]
v_mul_f32 v16, v16, v251
v_mul_f32 v17, v17, v251
v_mul_f32 v18, v18, v251
v_mul_f32 v19, v19, v251
v_mul_f32 v20, v20, v251
v_mul_f32 v21, v21, v251
v_mul_f32 v22, v22, v251
v_mul_f32 v23, v23, v251
v_cvt_pk_bf16_f32 v16, v16, v17
v_cvt_pk_bf16_f32 v17, v18, v19
v_cvt_pk_bf16_f32 v18, v20, v21
v_cvt_pk_bf16_f32 v19, v22, v23
ds_write_b128 v243, v[8:11] offset:1024
v_mul_f32 v24, v24, v249
v_mul_f32 v25, v25, v249
v_mul_f32 v26, v26, v249
v_mul_f32 v27, v27, v249
v_mul_f32 v28, v28, v249
v_mul_f32 v29, v29, v249
v_mul_f32 v30, v30, v249
v_mul_f32 v31, v31, v249
v_cvt_pk_bf16_f32 v24, v24, v25
v_cvt_pk_bf16_f32 v25, v26, v27
v_cvt_pk_bf16_f32 v26, v28, v29
v_cvt_pk_bf16_f32 v27, v30, v31
ds_write_b128 v243, v[16:19] offset:2048
v_mul_f32 v32, v32, v250
v_mul_f32 v33, v33, v250
v_mul_f32 v34, v34, v250
v_mul_f32 v35, v35, v250
v_mul_f32 v36, v36, v250
v_mul_f32 v37, v37, v250
v_mul_f32 v38, v38, v250
v_mul_f32 v39, v39, v250
v_cvt_pk_bf16_f32 v32, v32, v33
v_cvt_pk_bf16_f32 v33, v34, v35
v_cvt_pk_bf16_f32 v34, v36, v37
v_cvt_pk_bf16_f32 v35, v38, v39
s_waitcnt lgkmcnt(0)
s_barrier
ds_read_b128 v[4:7], v248
ds_read_b128 v[12:15], v248 offset:1024
v_mul_f32 v40, v40, v251
v_mul_f32 v41, v41, v251
v_mul_f32 v42, v42, v251
ds_read_b128 v[20:23], v248 offset:2048
v_mul_f32 v43, v43, v251
v_mul_f32 v44, v44, v251
v_mul_f32 v45, v45, v251
ds_write_b128 v243, v[24:27] offset:3072
v_mul_f32 v46, v46, v251
v_mul_f32 v47, v47, v251
v_cvt_pk_bf16_f32 v40, v40, v41
v_cvt_pk_bf16_f32 v41, v42, v43
v_cvt_pk_bf16_f32 v42, v44, v45
v_cvt_pk_bf16_f32 v43, v46, v47
ds_write_b128 v243, v[32:35] offset:4096
v_mul_f32 v48, v48, v252
v_mul_f32 v49, v49, v252
v_mul_f32 v50, v50, v252
v_mul_f32 v51, v51, v252
v_mul_f32 v52, v52, v252
v_mul_f32 v53, v53, v252
v_mul_f32 v54, v54, v252
v_mul_f32 v55, v55, v252
v_cvt_pk_bf16_f32 v48, v48, v49
v_cvt_pk_bf16_f32 v49, v50, v51
v_cvt_pk_bf16_f32 v50, v52, v53
v_cvt_pk_bf16_f32 v51, v54, v55
ds_write_b128 v243, v[40:43] offset:5120
v_mul_f32 v56, v56, v253
v_mul_f32 v57, v57, v253
v_mul_f32 v58, v58, v253
v_mul_f32 v59, v59, v253
v_mul_f32 v60, v60, v253
v_mul_f32 v61, v61, v253
v_mul_f32 v62, v62, v253
v_mul_f32 v63, v63, v253
v_cvt_pk_bf16_f32 v56, v56, v57
v_cvt_pk_bf16_f32 v57, v58, v59
v_cvt_pk_bf16_f32 v58, v60, v61
v_cvt_pk_bf16_f32 v59, v62, v63
s_waitcnt lgkmcnt(0)
s_barrier
ds_read_b128 v[28:31], v248 offset:3072
ds_read_b128 v[36:39], v248 offset:4096
v_mul_f32 v64, v64, v254
v_mul_f32 v65, v65, v254
v_mul_f32 v66, v66, v254
ds_read_b128 v[44:47], v248 offset:5120
v_mul_f32 v67, v67, v254
v_mul_f32 v68, v68, v254
v_mul_f32 v69, v69, v254
ds_write_b128 v243, v[48:51]
v_mul_f32 v70, v70, v254
v_mul_f32 v71, v71, v254
v_cvt_pk_bf16_f32 v64, v64, v65
v_cvt_pk_bf16_f32 v65, v66, v67
v_cvt_pk_bf16_f32 v66, v68, v69
v_cvt_pk_bf16_f32 v67, v70, v71
ds_write_b128 v243, v[56:59] offset:1024
v_mul_f32 v72, v72, v252
v_mul_f32 v73, v73, v252
v_mul_f32 v74, v74, v252
v_mul_f32 v75, v75, v252
v_mul_f32 v76, v76, v252
v_mul_f32 v77, v77, v252
v_mul_f32 v78, v78, v252
v_mul_f32 v79, v79, v252
v_cvt_pk_bf16_f32 v72, v72, v73
v_cvt_pk_bf16_f32 v73, v74, v75
v_cvt_pk_bf16_f32 v74, v76, v77
v_cvt_pk_bf16_f32 v75, v78, v79
ds_write_b128 v243, v[64:67] offset:2048
v_mul_f32 v80, v80, v253
v_mul_f32 v81, v81, v253
v_mul_f32 v82, v82, v253
v_mul_f32 v83, v83, v253
v_mul_f32 v84, v84, v253
v_mul_f32 v85, v85, v253
v_mul_f32 v86, v86, v253
v_mul_f32 v87, v87, v253
v_cvt_pk_bf16_f32 v80, v80, v81
v_cvt_pk_bf16_f32 v81, v82, v83
v_cvt_pk_bf16_f32 v82, v84, v85
v_cvt_pk_bf16_f32 v83, v86, v87
s_waitcnt lgkmcnt(0)
s_barrier
ds_read_b128 v[52:55], v248
ds_read_b128 v[60:63], v248 offset:1024
v_mul_f32 v88, v88, v254
v_mul_f32 v89, v89, v254
v_mul_f32 v90, v90, v254
ds_read_b128 v[68:71], v248 offset:2048
v_mul_f32 v91, v91, v254
v_mul_f32 v92, v92, v254
v_mul_f32 v93, v93, v254
ds_write_b128 v243, v[72:75] offset:3072
v_mul_f32 v94, v94, v254
v_mul_f32 v95, v95, v254
v_cvt_pk_bf16_f32 v88, v88, v89
v_cvt_pk_bf16_f32 v89, v90, v91
v_cvt_pk_bf16_f32 v90, v92, v93
v_cvt_pk_bf16_f32 v91, v94, v95
ds_write_b128 v243, v[80:83] offset:4096
v_fma_f32 v96, v96, s43, -v240
v_fma_f32 v97, v97, s43, -v240
v_fma_f32 v98, v98, s43, -v240
v_fma_f32 v99, v99, s43, -v240
v_fma_f32 v100, v100, s43, -v240
v_fma_f32 v101, v101, s43, -v240
v_fma_f32 v102, v102, s43, -v240
v_fma_f32 v103, v103, s43, -v240
v_exp_f32 v96, v96
v_exp_f32 v97, v97
v_exp_f32 v98, v98
v_exp_f32 v99, v99
v_exp_f32 v100, v100
v_exp_f32 v101, v101
v_exp_f32 v102, v102
v_exp_f32 v103, v103
v_cvt_pk_bf16_f32 v96, v96, v97
v_cvt_pk_bf16_f32 v97, v98, v99
v_cvt_pk_bf16_f32 v98, v100, v101
v_cvt_pk_bf16_f32 v99, v102, v103
ds_write_b128 v243, v[88:91] offset:5120
v_fma_f32 v104, v104, s43, -v241
v_fma_f32 v105, v105, s43, -v241
v_fma_f32 v106, v106, s43, -v241
v_fma_f32 v107, v107, s43, -v241
v_fma_f32 v108, v108, s43, -v241
v_fma_f32 v109, v109, s43, -v241
v_fma_f32 v110, v110, s43, -v241
v_fma_f32 v111, v111, s43, -v241
v_exp_f32 v104, v104
v_exp_f32 v105, v105
v_exp_f32 v106, v106
v_exp_f32 v107, v107
v_exp_f32 v108, v108
v_exp_f32 v109, v109
v_exp_f32 v110, v110
v_exp_f32 v111, v111
v_cvt_pk_bf16_f32 v104, v104, v105
v_cvt_pk_bf16_f32 v105, v106, v107
v_cvt_pk_bf16_f32 v106, v108, v109
v_cvt_pk_bf16_f32 v107, v110, v111
s_waitcnt lgkmcnt(0)
s_barrier
ds_read_b128 v[76:79], v248 offset:3072
ds_read_b128 v[84:87], v248 offset:4096
v_fma_f32 v112, v112, s43, -v242
v_fma_f32 v113, v113, s43, -v242
v_fma_f32 v114, v114, s43, -v242
ds_read_b128 v[92:95], v248 offset:5120
v_fma_f32 v115, v115, s43, -v242
v_fma_f32 v116, v116, s43, -v242
v_fma_f32 v117, v117, s43, -v242
v_fma_f32 v118, v118, s43, -v242
v_fma_f32 v119, v119, s43, -v242
v_exp_f32 v112, v112
v_exp_f32 v113, v113
ds_write_b128 v243, v[96:99]
v_exp_f32 v114, v114
v_exp_f32 v115, v115
v_exp_f32 v116, v116
v_exp_f32 v117, v117
v_exp_f32 v118, v118
v_exp_f32 v119, v119
v_cvt_pk_bf16_f32 v112, v112, v113
v_cvt_pk_bf16_f32 v113, v114, v115
v_cvt_pk_bf16_f32 v114, v116, v117
v_cvt_pk_bf16_f32 v115, v118, v119
ds_write_b128 v243, v[104:107] offset:1024
v_fma_f32 v120, v120, s43, -v240
v_fma_f32 v121, v121, s43, -v240
v_fma_f32 v122, v122, s43, -v240
v_fma_f32 v123, v123, s43, -v240
v_fma_f32 v124, v124, s43, -v240
v_fma_f32 v125, v125, s43, -v240
v_fma_f32 v126, v126, s43, -v240
v_fma_f32 v127, v127, s43, -v240
v_exp_f32 v120, v120
v_exp_f32 v121, v121
v_exp_f32 v122, v122
v_exp_f32 v123, v123
v_exp_f32 v124, v124
v_exp_f32 v125, v125
v_exp_f32 v126, v126
v_exp_f32 v127, v127
v_cvt_pk_bf16_f32 v120, v120, v121
v_cvt_pk_bf16_f32 v121, v122, v123
v_cvt_pk_bf16_f32 v122, v124, v125
v_cvt_pk_bf16_f32 v123, v126, v127
ds_write_b128 v243, v[112:115] offset:2048
v_fma_f32 v128, v128, s43, -v241
v_fma_f32 v129, v129, s43, -v241
v_fma_f32 v130, v130, s43, -v241
v_fma_f32 v131, v131, s43, -v241
v_fma_f32 v132, v132, s43, -v241
v_fma_f32 v133, v133, s43, -v241
v_fma_f32 v134, v134, s43, -v241
v_fma_f32 v135, v135, s43, -v241
v_exp_f32 v128, v128
v_exp_f32 v129, v129
v_exp_f32 v130, v130
v_exp_f32 v131, v131
v_exp_f32 v132, v132
v_exp_f32 v133, v133
v_exp_f32 v134, v134
v_exp_f32 v135, v135
v_cvt_pk_bf16_f32 v128, v128, v129
v_cvt_pk_bf16_f32 v129, v130, v131
v_cvt_pk_bf16_f32 v130, v132, v133
v_cvt_pk_bf16_f32 v131, v134, v135
s_waitcnt lgkmcnt(0)
s_barrier
ds_read_b128 v[100:103], v248
ds_read_b128 v[108:111], v248 offset:1024
v_fma_f32 v136, v136, s43, -v242
v_fma_f32 v137, v137, s43, -v242
v_fma_f32 v138, v138, s43, -v242
ds_read_b128 v[116:119], v248 offset:2048
v_fma_f32 v139, v139, s43, -v242
v_fma_f32 v140, v140, s43, -v242
v_fma_f32 v141, v141, s43, -v242
v_fma_f32 v142, v142, s43, -v242
v_fma_f32 v143, v143, s43, -v242
v_exp_f32 v136, v136
v_exp_f32 v137, v137
ds_write_b128 v243, v[120:123] offset:3072
v_exp_f32 v138, v138
v_exp_f32 v139, v139
v_exp_f32 v140, v140
v_exp_f32 v141, v141
v_exp_f32 v142, v142
v_exp_f32 v143, v143
v_cvt_pk_bf16_f32 v136, v136, v137
v_cvt_pk_bf16_f32 v137, v138, v139
v_cvt_pk_bf16_f32 v138, v140, v141
v_cvt_pk_bf16_f32 v139, v142, v143
ds_write_b128 v243, v[128:131] offset:4096
v_fma_f32 v144, v144, s43, -v240
v_fma_f32 v145, v145, s43, -v240
v_fma_f32 v146, v146, s43, -v240
v_fma_f32 v147, v147, s43, -v240
v_fma_f32 v148, v148, s43, -v240
v_fma_f32 v149, v149, s43, -v240
v_fma_f32 v150, v150, s43, -v240
v_fma_f32 v151, v151, s43, -v240
v_exp_f32 v144, v144
v_exp_f32 v145, v145
v_exp_f32 v146, v146
v_exp_f32 v147, v147
v_exp_f32 v148, v148
v_exp_f32 v149, v149
v_exp_f32 v150, v150
v_exp_f32 v151, v151
v_cvt_pk_bf16_f32 v144, v144, v145
v_cvt_pk_bf16_f32 v145, v146, v147
v_cvt_pk_bf16_f32 v146, v148, v149
v_cvt_pk_bf16_f32 v147, v150, v151
ds_write_b128 v243, v[136:139] offset:5120
v_fma_f32 v152, v152, s43, -v241
v_fma_f32 v153, v153, s43, -v241
v_fma_f32 v154, v154, s43, -v241
v_fma_f32 v155, v155, s43, -v241
v_fma_f32 v156, v156, s43, -v241
v_fma_f32 v157, v157, s43, -v241
v_fma_f32 v158, v158, s43, -v241
v_fma_f32 v159, v159, s43, -v241
v_exp_f32 v152, v152
v_exp_f32 v153, v153
v_exp_f32 v154, v154
v_exp_f32 v155, v155
v_exp_f32 v156, v156
v_exp_f32 v157, v157
v_exp_f32 v158, v158
v_exp_f32 v159, v159
v_cvt_pk_bf16_f32 v152, v152, v153
v_cvt_pk_bf16_f32 v153, v154, v155
v_cvt_pk_bf16_f32 v154, v156, v157
v_cvt_pk_bf16_f32 v155, v158, v159
s_waitcnt lgkmcnt(0)
s_barrier
ds_read_b128 v[124:127], v248 offset:3072
ds_read_b128 v[132:135], v248 offset:4096
v_fma_f32 v160, v160, s43, -v242
v_fma_f32 v161, v161, s43, -v242
v_fma_f32 v162, v162, s43, -v242
ds_read_b128 v[140:143], v248 offset:5120
v_fma_f32 v163, v163, s43, -v242
v_fma_f32 v164, v164, s43, -v242
v_fma_f32 v165, v165, s43, -v242
v_fma_f32 v166, v166, s43, -v242
v_fma_f32 v167, v167, s43, -v242
v_exp_f32 v160, v160
v_exp_f32 v161, v161
ds_write_b128 v243, v[144:147]
v_exp_f32 v162, v162
v_exp_f32 v163, v163
v_exp_f32 v164, v164
v_exp_f32 v165, v165
v_exp_f32 v166, v166
v_exp_f32 v167, v167
v_cvt_pk_bf16_f32 v160, v160, v161
v_cvt_pk_bf16_f32 v161, v162, v163
v_cvt_pk_bf16_f32 v162, v164, v165
v_cvt_pk_bf16_f32 v163, v166, v167
ds_write_b128 v243, v[152:155] offset:1024
v_fma_f32 v168, v168, s43, -v240
v_fma_f32 v169, v169, s43, -v240
v_fma_f32 v170, v170, s43, -v240
v_fma_f32 v171, v171, s43, -v240
v_fma_f32 v172, v172, s43, -v240
v_fma_f32 v173, v173, s43, -v240
v_fma_f32 v174, v174, s43, -v240
v_fma_f32 v175, v175, s43, -v240
v_exp_f32 v168, v168
v_exp_f32 v169, v169
v_exp_f32 v170, v170
v_exp_f32 v171, v171
v_exp_f32 v172, v172
v_exp_f32 v173, v173
v_exp_f32 v174, v174
v_exp_f32 v175, v175
v_cvt_pk_bf16_f32 v168, v168, v169
v_cvt_pk_bf16_f32 v169, v170, v171
v_cvt_pk_bf16_f32 v170, v172, v173
v_cvt_pk_bf16_f32 v171, v174, v175
ds_write_b128 v243, v[160:163] offset:2048
v_fma_f32 v176, v176, s43, -v241
v_fma_f32 v177, v177, s43, -v241
v_fma_f32 v178, v178, s43, -v241
v_fma_f32 v179, v179, s43, -v241
v_fma_f32 v180, v180, s43, -v241
v_fma_f32 v181, v181, s43, -v241
v_fma_f32 v182, v182, s43, -v241
v_fma_f32 v183, v183, s43, -v241
v_exp_f32 v176, v176
v_exp_f32 v177, v177
v_exp_f32 v178, v178
v_exp_f32 v179, v179
v_exp_f32 v180, v180
v_exp_f32 v181, v181
v_exp_f32 v182, v182
v_exp_f32 v183, v183
v_cvt_pk_bf16_f32 v176, v176, v177
v_cvt_pk_bf16_f32 v177, v178, v179
v_cvt_pk_bf16_f32 v178, v180, v181
v_cvt_pk_bf16_f32 v179, v182, v183
s_waitcnt lgkmcnt(0)
s_barrier
ds_read_b128 v[148:151], v248
ds_read_b128 v[156:159], v248 offset:1024
v_fma_f32 v184, v184, s43, -v242
v_fma_f32 v185, v185, s43, -v242
v_fma_f32 v186, v186, s43, -v242
ds_read_b128 v[164:167], v248 offset:2048
v_fma_f32 v187, v187, s43, -v242
v_fma_f32 v188, v188, s43, -v242
v_fma_f32 v189, v189, s43, -v242
v_fma_f32 v190, v190, s43, -v242
v_fma_f32 v191, v191, s43, -v242
v_exp_f32 v184, v184
v_exp_f32 v185, v185
ds_write_b128 v243, v[168:171] offset:3072
v_exp_f32 v186, v186
v_exp_f32 v187, v187
v_exp_f32 v188, v188
v_exp_f32 v189, v189
v_exp_f32 v190, v190
v_exp_f32 v191, v191
v_cvt_pk_bf16_f32 v184, v184, v185
v_cvt_pk_bf16_f32 v185, v186, v187
v_cvt_pk_bf16_f32 v186, v188, v189
v_cvt_pk_bf16_f32 v187, v190, v191
ds_write_b128 v243, v[176:179] offset:4096
ds_write_b128 v243, v[184:187] offset:5120
s_waitcnt lgkmcnt(0)
s_barrier
ds_read_b128 v[172:175], v248 offset:3072
ds_read_b128 v[180:183], v248 offset:4096
ds_read_b128 v[188:191], v248 offset:5120
v_mbcnt_lo_u32_b32 v254, -1, 0
v_mbcnt_hi_u32_b32 v254, -1, v254
v_lshrrev_b32 v251, 3, v254
v_and_b32 v250, 6, v251
v_xor_b32 v254, v254, v250
v_and_b32 v254, 7, v254
s_lshl_b32 s44, s41, 5
v_add_u32 v250, s44, v251
v_lshlrev_b32 v250, 9, v250
v_lshl_add_u32 v250, v254, 4, v250
s_and_b32 s44, s41, 1
s_lshl_b32 s44, s44, 5
v_add_u32 v251, s44, v251
s_lshr_b32 s44, s41, 1
s_lshl_b32 s44, s44, 8
v_add_u32 v251, s44, v251
v_mul_u32_u24 v251, 896, v251
v_lshl_add_u32 v251, v254, 4, v251
s_waitcnt lgkmcnt(0)
s_barrier
s_barrier
ds_read_b64_tr_b16 v[224:225], v244 offset:16384
ds_read_b64_tr_b16 v[226:227], v244 offset:17408
ds_read_b64_tr_b16 v[228:229], v244 offset:18432
ds_read_b64_tr_b16 v[230:231], v244 offset:19456
ds_read_b64_tr_b16 v[232:233], v245 offset:18432
ds_read_b64_tr_b16 v[234:235], v245 offset:19456
ds_read_b64_tr_b16 v[236:237], v245 offset:16384
ds_read_b64_tr_b16 v[238:239], v245 offset:17408
ds_read_b64_tr_b16 v[216:217], v247 offset:16384
ds_read_b64_tr_b16 v[218:219], v247 offset:17408
ds_read_b64_tr_b16 v[220:221], v247 offset:18432
ds_read_b64_tr_b16 v[222:223], v247 offset:19456
s_waitcnt lgkmcnt(10)
v_mfma_f32_16x16x32_bf16 v[192:195], v[224:227], v[0:3], 0
s_waitcnt lgkmcnt(8)
v_mfma_f32_16x16x32_bf16 v[192:195], v[228:231], v[24:27], v[192:195]
v_mfma_f32_16x16x32_bf16 v[196:199], v[228:231], v[32:35], 0
v_mfma_f32_16x16x32_bf16 v[196:199], v[224:227], v[8:11], v[196:199]
v_mfma_f32_16x16x32_bf16 v[200:203], v[224:227], v[16:19], 0
ds_read_b64_tr_b16 v[224:225], v246 offset:18432
ds_read_b64_tr_b16 v[226:227], v246 offset:19456
v_mfma_f32_16x16x32_bf16 v[200:203], v[228:231], v[40:43], v[200:203]
ds_read_b64_tr_b16 v[228:229], v246 offset:16384
ds_read_b64_tr_b16 v[230:231], v246 offset:17408
s_waitcnt lgkmcnt(10)
v_mfma_f32_16x16x32_bf16 v[212:215], v[232:235], v[40:43], 0
s_waitcnt lgkmcnt(8)
v_mfma_f32_16x16x32_bf16 v[212:215], v[236:239], v[16:19], v[212:215]
v_mfma_f32_16x16x32_bf16 v[208:211], v[236:239], v[8:11], 0
v_mfma_f32_16x16x32_bf16 v[208:211], v[232:235], v[32:35], v[208:211]
v_mfma_f32_16x16x32_bf16 v[204:207], v[232:235], v[24:27], 0
v_mfma_f32_16x16x32_bf16 v[204:207], v[236:239], v[0:3], v[204:207]
s_waitcnt lgkmcnt(6)
v_mfma_f32_16x16x32_bf16 v[204:207], v[216:219], v[4:7], v[204:207]
s_waitcnt lgkmcnt(4)
v_mfma_f32_16x16x32_bf16 v[204:207], v[220:223], v[28:31], v[204:207]
v_mfma_f32_16x16x32_bf16 v[208:211], v[220:223], v[36:39], v[208:211]
v_mfma_f32_16x16x32_bf16 v[208:211], v[216:219], v[12:15], v[208:211]
v_mfma_f32_16x16x32_bf16 v[212:215], v[216:219], v[20:23], v[212:215]
v_mfma_f32_16x16x32_bf16 v[212:215], v[220:223], v[44:47], v[212:215]
s_waitcnt lgkmcnt(2)
v_mfma_f32_16x16x32_bf16 v[200:203], v[224:227], v[44:47], v[200:203]
s_waitcnt lgkmcnt(0)
v_mfma_f32_16x16x32_bf16 v[200:203], v[228:231], v[20:23], v[200:203]
v_mfma_f32_16x16x32_bf16 v[196:199], v[228:231], v[12:15], v[196:199]
v_mfma_f32_16x16x32_bf16 v[196:199], v[224:227], v[36:39], v[196:199]
s_barrier
ds_read_b64_tr_b16 v[232:233], v244 offset:32768
ds_read_b64_tr_b16 v[234:235], v244 offset:33792
v_mfma_f32_16x16x32_bf16 v[192:195], v[224:227], v[28:31], v[192:195]
ds_read_b64_tr_b16 v[236:237], v244 offset:34816
ds_read_b64_tr_b16 v[238:239], v244 offset:35840
v_mfma_f32_16x16x32_bf16 v[192:195], v[228:231], v[4:7], v[192:195]
ds_read_b64_tr_b16 v[216:217], v245 offset:34816
ds_read_b64_tr_b16 v[218:219], v245 offset:35840
ds_read_b64_tr_b16 v[220:221], v245 offset:32768
ds_read_b64_tr_b16 v[222:223], v245 offset:33792
ds_read_b64_tr_b16 v[224:225], v247 offset:32768
ds_read_b64_tr_b16 v[226:227], v247 offset:33792
ds_read_b64_tr_b16 v[228:229], v247 offset:34816
ds_read_b64_tr_b16 v[230:231], v247 offset:35840
s_waitcnt lgkmcnt(10)
v_mfma_f32_16x16x32_bf16 v[192:195], v[232:235], v[48:51], v[192:195]
s_waitcnt lgkmcnt(8)
v_mfma_f32_16x16x32_bf16 v[192:195], v[236:239], v[72:75], v[192:195]
v_mfma_f32_16x16x32_bf16 v[196:199], v[236:239], v[80:83], v[196:199]
v_mfma_f32_16x16x32_bf16 v[196:199], v[232:235], v[56:59], v[196:199]
v_mfma_f32_16x16x32_bf16 v[200:203], v[232:235], v[64:67], v[200:203]
ds_read_b64_tr_b16 v[232:233], v246 offset:34816
ds_read_b64_tr_b16 v[234:235], v246 offset:35840
v_mfma_f32_16x16x32_bf16 v[200:203], v[236:239], v[88:91], v[200:203]
ds_read_b64_tr_b16 v[236:237], v246 offset:32768
ds_read_b64_tr_b16 v[238:239], v246 offset:33792
s_waitcnt lgkmcnt(10)
v_mfma_f32_16x16x32_bf16 v[212:215], v[216:219], v[88:91], v[212:215]
s_waitcnt lgkmcnt(8)
v_mfma_f32_16x16x32_bf16 v[212:215], v[220:223], v[64:67], v[212:215]
v_mfma_f32_16x16x32_bf16 v[208:211], v[220:223], v[56:59], v[208:211]
v_mfma_f32_16x16x32_bf16 v[208:211], v[216:219], v[80:83], v[208:211]
v_mfma_f32_16x16x32_bf16 v[204:207], v[216:219], v[72:75], v[204:207]
v_mfma_f32_16x16x32_bf16 v[204:207], v[220:223], v[48:51], v[204:207]
s_waitcnt lgkmcnt(6)
v_mfma_f32_16x16x32_bf16 v[204:207], v[224:227], v[52:55], v[204:207]
s_waitcnt lgkmcnt(4)
v_mfma_f32_16x16x32_bf16 v[204:207], v[228:231], v[76:79], v[204:207]
v_mfma_f32_16x16x32_bf16 v[208:211], v[228:231], v[84:87], v[208:211]
v_mfma_f32_16x16x32_bf16 v[208:211], v[224:227], v[60:63], v[208:211]
v_mfma_f32_16x16x32_bf16 v[212:215], v[224:227], v[68:71], v[212:215]
v_mfma_f32_16x16x32_bf16 v[212:215], v[228:231], v[92:95], v[212:215]
s_waitcnt lgkmcnt(2)
v_mfma_f32_16x16x32_bf16 v[200:203], v[232:235], v[92:95], v[200:203]
s_waitcnt lgkmcnt(0)
v_mfma_f32_16x16x32_bf16 v[200:203], v[236:239], v[68:71], v[200:203]
v_mfma_f32_16x16x32_bf16 v[196:199], v[236:239], v[60:63], v[196:199]
v_mfma_f32_16x16x32_bf16 v[196:199], v[232:235], v[84:87], v[196:199]
s_barrier
v_xor_b32 v244, 0x10000, v244
ds_read_b64_tr_b16 v[216:217], v244
v_mfma_f32_16x16x32_bf16 v[192:195], v[232:235], v[76:79], v[192:195]
ds_read_b64_tr_b16 v[218:219], v244 offset:1024
ds_read_b64_tr_b16 v[220:221], v244 offset:2048
v_mfma_f32_16x16x32_bf16 v[192:195], v[236:239], v[52:55], v[192:195]
ds_read_b64_tr_b16 v[222:223], v244 offset:3072
v_xor_b32 v245, 0x10000, v245
ds_read_b64_tr_b16 v[224:225], v245 offset:2048
ds_read_b64_tr_b16 v[226:227], v245 offset:3072
ds_read_b64_tr_b16 v[228:229], v245
ds_read_b64_tr_b16 v[230:231], v245 offset:1024
v_xor_b32 v247, 0x10000, v247
ds_read_b64_tr_b16 v[232:233], v247
ds_read_b64_tr_b16 v[234:235], v247 offset:1024
ds_read_b64_tr_b16 v[236:237], v247 offset:2048
ds_read_b64_tr_b16 v[238:239], v247 offset:3072
v_xor_b32 v246, 0x10000, v246
s_waitcnt lgkmcnt(10)
v_mfma_f32_16x16x32_bf16 v[192:195], v[216:219], v[96:99], v[192:195]
v_mbcnt_lo_u32_b32 v249, -1, 0
v_mbcnt_hi_u32_b32 v249, -1, v249
s_waitcnt lgkmcnt(8)
v_mfma_f32_16x16x32_bf16 v[192:195], v[220:223], v[120:123], v[192:195]
s_mul_i32 s44, s41, 7168
s_add_u32 s44, s44, 137216
v_mfma_f32_16x16x32_bf16 v[196:199], v[220:223], v[128:131], v[196:199]
v_lshl_add_u32 v249, v249, 2, s44
ds_read_b32 v240, v249
v_mfma_f32_16x16x32_bf16 v[196:199], v[216:219], v[104:107], v[196:199]
ds_read_b32 v241, v249 offset:256
ds_read_b32 v242, v249 offset:512
v_mfma_f32_16x16x32_bf16 v[200:203], v[216:219], v[112:115], v[200:203]
ds_read_b64_tr_b16 v[216:217], v246 offset:2048
ds_read_b64_tr_b16 v[218:219], v246 offset:3072
v_mfma_f32_16x16x32_bf16 v[200:203], v[220:223], v[136:139], v[200:203]
ds_read_b64_tr_b16 v[220:221], v246
ds_read_b64_tr_b16 v[222:223], v246 offset:1024
s_waitcnt lgkmcnt(13)
v_mfma_f32_16x16x32_bf16 v[212:215], v[224:227], v[136:139], v[212:215]
s_waitcnt lgkmcnt(11)
v_mfma_f32_16x16x32_bf16 v[212:215], v[228:231], v[112:115], v[212:215]
v_mfma_f32_16x16x32_bf16 v[208:211], v[228:231], v[104:107], v[208:211]
v_mfma_f32_16x16x32_bf16 v[208:211], v[224:227], v[128:131], v[208:211]
v_mfma_f32_16x16x32_bf16 v[204:207], v[224:227], v[120:123], v[204:207]
v_mfma_f32_16x16x32_bf16 v[204:207], v[228:231], v[96:99], v[204:207]
s_waitcnt lgkmcnt(9)
v_mfma_f32_16x16x32_bf16 v[204:207], v[232:235], v[100:103], v[204:207]
s_waitcnt lgkmcnt(7)
v_mfma_f32_16x16x32_bf16 v[204:207], v[236:239], v[124:127], v[204:207]
v_mfma_f32_16x16x32_bf16 v[208:211], v[236:239], v[132:135], v[208:211]
v_mfma_f32_16x16x32_bf16 v[208:211], v[232:235], v[108:111], v[208:211]
v_mfma_f32_16x16x32_bf16 v[212:215], v[232:235], v[116:119], v[212:215]
v_mfma_f32_16x16x32_bf16 v[212:215], v[236:239], v[140:143], v[212:215]
s_waitcnt lgkmcnt(0)
s_barrier
ds_read_b64_tr_b16 v[224:225], v244 offset:16384
ds_read_b64_tr_b16 v[226:227], v244 offset:17408
v_mfma_f32_16x16x32_bf16 v[200:203], v[216:219], v[140:143], v[200:203]
ds_read_b64_tr_b16 v[228:229], v244 offset:18432
ds_read_b64_tr_b16 v[230:231], v244 offset:19456
v_mfma_f32_16x16x32_bf16 v[200:203], v[220:223], v[116:119], v[200:203]
ds_read_b64_tr_b16 v[232:233], v246 offset:16384
ds_read_b64_tr_b16 v[234:235], v246 offset:17408
v_mfma_f32_16x16x32_bf16 v[196:199], v[220:223], v[108:111], v[196:199]
ds_read_b64_tr_b16 v[236:237], v246 offset:18432
ds_read_b64_tr_b16 v[238:239], v246 offset:19456
v_mfma_f32_16x16x32_bf16 v[196:199], v[216:219], v[132:135], v[196:199]
v_mfma_f32_16x16x32_bf16 v[192:195], v[216:219], v[124:127], v[192:195]
ds_read_b64_tr_b16 v[216:217], v247 offset:18432
ds_read_b64_tr_b16 v[218:219], v247 offset:19456
v_mfma_f32_16x16x32_bf16 v[192:195], v[220:223], v[100:103], v[192:195]
ds_read_b64_tr_b16 v[220:221], v247 offset:16384
ds_read_b64_tr_b16 v[222:223], v247 offset:17408
s_waitcnt lgkmcnt(10)
v_mfma_f32_16x16x32_bf16 v[192:195], v[224:227], v[144:147], v[192:195]
s_waitcnt lgkmcnt(8)
v_mfma_f32_16x16x32_bf16 v[192:195], v[228:231], v[168:171], v[192:195]
s_waitcnt lgkmcnt(6)
v_mfma_f32_16x16x32_bf16 v[192:195], v[232:235], v[148:151], v[192:195]
s_waitcnt lgkmcnt(4)
v_mfma_f32_16x16x32_bf16 v[192:195], v[236:239], v[172:175], v[192:195]
v_mfma_f32_16x16x32_bf16 v[196:199], v[236:239], v[180:183], v[196:199]
v_mfma_f32_16x16x32_bf16 v[196:199], v[232:235], v[156:159], v[196:199]
v_mfma_f32_16x16x32_bf16 v[196:199], v[228:231], v[176:179], v[196:199]
s_nop 4
v_mul_f32 v192, v192, v240
v_mul_f32 v193, v193, v240
v_mfma_f32_16x16x32_bf16 v[196:199], v[224:227], v[152:155], v[196:199]
v_mul_f32 v194, v194, v240
v_mul_f32 v195, v195, v240
v_mfma_f32_16x16x32_bf16 v[200:203], v[224:227], v[160:163], v[200:203]
ds_read_b64_tr_b16 v[224:225], v245 offset:18432
ds_read_b64_tr_b16 v[226:227], v245 offset:19456
v_mfma_f32_16x16x32_bf16 v[200:203], v[228:231], v[184:187], v[200:203]
ds_read_b64_tr_b16 v[228:229], v245 offset:16384
ds_read_b64_tr_b16 v[230:231], v245 offset:17408
v_mfma_f32_16x16x32_bf16 v[200:203], v[232:235], v[164:167], v[200:203]
v_cvt_pk_bf16_f32 v192, v192, v193
v_cvt_pk_bf16_f32 v193, v194, v195
v_mfma_f32_16x16x32_bf16 v[200:203], v[236:239], v[188:191], v[200:203]
v_mul_f32 v196, v196, v241
v_mul_f32 v197, v197, v241
s_waitcnt lgkmcnt(6)
v_mfma_f32_16x16x32_bf16 v[212:215], v[216:219], v[188:191], v[212:215]
v_mul_f32 v198, v198, v241
v_mul_f32 v199, v199, v241
s_waitcnt lgkmcnt(4)
v_mfma_f32_16x16x32_bf16 v[212:215], v[220:223], v[164:167], v[212:215]
v_cvt_pk_bf16_f32 v196, v196, v197
v_cvt_pk_bf16_f32 v197, v198, v199
s_waitcnt lgkmcnt(2)
v_mfma_f32_16x16x32_bf16 v[212:215], v[224:227], v[184:187], v[212:215]
v_mul_f32 v200, v200, v242
v_mul_f32 v201, v201, v242
s_waitcnt lgkmcnt(0)
v_mfma_f32_16x16x32_bf16 v[212:215], v[228:231], v[160:163], v[212:215]
v_mul_f32 v202, v202, v242
v_mul_f32 v203, v203, v242
v_mfma_f32_16x16x32_bf16 v[208:211], v[228:231], v[152:155], v[208:211]
v_cvt_pk_bf16_f32 v200, v200, v201
v_cvt_pk_bf16_f32 v201, v202, v203
v_mfma_f32_16x16x32_bf16 v[208:211], v[224:227], v[176:179], v[208:211]
v_mfma_f32_16x16x32_bf16 v[208:211], v[220:223], v[156:159], v[208:211]
s_nop 0
v_mul_f32 v212, v212, v242
v_mul_f32 v213, v213, v242
v_mfma_f32_16x16x32_bf16 v[208:211], v[216:219], v[180:183], v[208:211]
v_mul_f32 v214, v214, v242
v_mul_f32 v215, v215, v242
v_mfma_f32_16x16x32_bf16 v[204:207], v[216:219], v[172:175], v[204:207]
v_cvt_pk_bf16_f32 v202, v212, v213
v_cvt_pk_bf16_f32 v203, v214, v215
v_mfma_f32_16x16x32_bf16 v[204:207], v[220:223], v[148:151], v[204:207]
ds_write_b128 v243, v[200:203] offset:2048
v_mfma_f32_16x16x32_bf16 v[204:207], v[224:227], v[168:171], v[204:207]
v_mul_f32 v208, v208, v241
v_mul_f32 v209, v209, v241
v_mfma_f32_16x16x32_bf16 v[204:207], v[228:231], v[144:147], v[204:207]
v_mul_f32 v210, v210, v241
v_mul_f32 v211, v211, v241
v_cvt_pk_bf16_f32 v198, v208, v209
v_cvt_pk_bf16_f32 v199, v210, v211
ds_write_b128 v243, v[196:199] offset:1024
s_nop 2
v_mul_f32 v204, v204, v240
v_mul_f32 v205, v205, v240
v_mul_f32 v206, v206, v240
v_mul_f32 v207, v207, v240
v_cvt_pk_bf16_f32 v194, v204, v205
v_cvt_pk_bf16_f32 v195, v206, v207
ds_write_b128 v243, v[192:195]
s_waitcnt lgkmcnt(0)
s_barrier
ds_read_b64_tr_b16 v[232:233], v244 offset:49152
ds_read_b64_tr_b16 v[234:235], v244 offset:50176
ds_read_b64_tr_b16 v[236:237], v244 offset:51200
ds_read_b64_tr_b16 v[238:239], v244 offset:52224
ds_read_b64_tr_b16 v[216:217], v245 offset:51200
ds_read_b64_tr_b16 v[218:219], v245 offset:52224
ds_read_b64_tr_b16 v[220:221], v245 offset:49152
ds_read_b64_tr_b16 v[222:223], v245 offset:50176
ds_read_b64_tr_b16 v[224:225], v247 offset:49152
ds_read_b64_tr_b16 v[226:227], v247 offset:50176
ds_read_b64_tr_b16 v[228:229], v247 offset:51200
ds_read_b64_tr_b16 v[230:231], v247 offset:52224
s_waitcnt lgkmcnt(10)
v_mfma_f32_16x16x32_bf16 v[192:195], v[232:235], v[0:3], 0
s_waitcnt lgkmcnt(8)
v_mfma_f32_16x16x32_bf16 v[192:195], v[236:239], v[24:27], v[192:195]
v_mfma_f32_16x16x32_bf16 v[196:199], v[236:239], v[32:35], 0
v_mfma_f32_16x16x32_bf16 v[196:199], v[232:235], v[8:11], v[196:199]
v_mfma_f32_16x16x32_bf16 v[200:203], v[232:235], v[16:19], 0
ds_read_b64_tr_b16 v[232:233], v246 offset:51200
ds_read_b64_tr_b16 v[234:235], v246 offset:52224
v_mfma_f32_16x16x32_bf16 v[200:203], v[236:239], v[40:43], v[200:203]
ds_read_b64_tr_b16 v[236:237], v246 offset:49152
ds_read_b64_tr_b16 v[238:239], v246 offset:50176
s_waitcnt lgkmcnt(10)
v_mfma_f32_16x16x32_bf16 v[212:215], v[216:219], v[40:43], 0
s_waitcnt lgkmcnt(8)
v_mfma_f32_16x16x32_bf16 v[212:215], v[220:223], v[16:19], v[212:215]
v_mfma_f32_16x16x32_bf16 v[208:211], v[220:223], v[8:11], 0
v_mfma_f32_16x16x32_bf16 v[208:211], v[216:219], v[32:35], v[208:211]
v_mfma_f32_16x16x32_bf16 v[204:207], v[216:219], v[24:27], 0
v_mfma_f32_16x16x32_bf16 v[204:207], v[220:223], v[0:3], v[204:207]
s_waitcnt lgkmcnt(6)
v_mfma_f32_16x16x32_bf16 v[204:207], v[224:227], v[4:7], v[204:207]
s_waitcnt lgkmcnt(4)
v_mfma_f32_16x16x32_bf16 v[204:207], v[228:231], v[28:31], v[204:207]
v_mfma_f32_16x16x32_bf16 v[208:211], v[228:231], v[36:39], v[208:211]
v_mfma_f32_16x16x32_bf16 v[208:211], v[224:227], v[12:15], v[208:211]
v_mfma_f32_16x16x32_bf16 v[212:215], v[224:227], v[20:23], v[212:215]
v_mfma_f32_16x16x32_bf16 v[212:215], v[228:231], v[44:47], v[212:215]
s_waitcnt lgkmcnt(2)
v_mfma_f32_16x16x32_bf16 v[200:203], v[232:235], v[44:47], v[200:203]
s_waitcnt lgkmcnt(0)
v_mfma_f32_16x16x32_bf16 v[200:203], v[236:239], v[20:23], v[200:203]
v_mfma_f32_16x16x32_bf16 v[196:199], v[236:239], v[12:15], v[196:199]
v_mfma_f32_16x16x32_bf16 v[196:199], v[232:235], v[36:39], v[196:199]
s_barrier
v_xor_b32 v244, 0x10000, v244
ds_read_b64_tr_b16 v[216:217], v244 offset:49152
v_mfma_f32_16x16x32_bf16 v[192:195], v[232:235], v[28:31], v[192:195]
ds_read_b64_tr_b16 v[218:219], v244 offset:50176
ds_read_b64_tr_b16 v[220:221], v244 offset:51200
v_mfma_f32_16x16x32_bf16 v[192:195], v[236:239], v[4:7], v[192:195]
ds_read_b64_tr_b16 v[222:223], v244 offset:52224
v_xor_b32 v245, 0x10000, v245
ds_read_b64_tr_b16 v[224:225], v245 offset:51200
ds_read_b64_tr_b16 v[226:227], v245 offset:52224
ds_read_b64_tr_b16 v[228:229], v245 offset:49152
ds_read_b64_tr_b16 v[230:231], v245 offset:50176
v_xor_b32 v247, 0x10000, v247
ds_read_b64_tr_b16 v[232:233], v247 offset:49152
ds_read_b64_tr_b16 v[234:235], v247 offset:50176
ds_read_b64_tr_b16 v[236:237], v247 offset:51200
ds_read_b64_tr_b16 v[238:239], v247 offset:52224
v_xor_b32 v246, 0x10000, v246
s_waitcnt lgkmcnt(10)
v_mfma_f32_16x16x32_bf16 v[192:195], v[216:219], v[48:51], v[192:195]
s_waitcnt lgkmcnt(8)
v_mfma_f32_16x16x32_bf16 v[192:195], v[220:223], v[72:75], v[192:195]
v_mfma_f32_16x16x32_bf16 v[196:199], v[220:223], v[80:83], v[196:199]
v_mfma_f32_16x16x32_bf16 v[196:199], v[216:219], v[56:59], v[196:199]
v_mfma_f32_16x16x32_bf16 v[200:203], v[216:219], v[64:67], v[200:203]
ds_read_b64_tr_b16 v[216:217], v246 offset:51200
ds_read_b64_tr_b16 v[218:219], v246 offset:52224
v_mfma_f32_16x16x32_bf16 v[200:203], v[220:223], v[88:91], v[200:203]
ds_read_b64_tr_b16 v[220:221], v246 offset:49152
ds_read_b64_tr_b16 v[222:223], v246 offset:50176
s_waitcnt lgkmcnt(10)
v_mfma_f32_16x16x32_bf16 v[212:215], v[224:227], v[88:91], v[212:215]
s_waitcnt lgkmcnt(8)
v_mfma_f32_16x16x32_bf16 v[212:215], v[228:231], v[64:67], v[212:215]
v_mfma_f32_16x16x32_bf16 v[208:211], v[228:231], v[56:59], v[208:211]
v_mfma_f32_16x16x32_bf16 v[208:211], v[224:227], v[80:83], v[208:211]
v_mfma_f32_16x16x32_bf16 v[204:207], v[224:227], v[72:75], v[204:207]
v_mfma_f32_16x16x32_bf16 v[204:207], v[228:231], v[48:51], v[204:207]
s_waitcnt lgkmcnt(6)
v_mfma_f32_16x16x32_bf16 v[204:207], v[232:235], v[52:55], v[204:207]
s_waitcnt lgkmcnt(4)
v_mfma_f32_16x16x32_bf16 v[204:207], v[236:239], v[76:79], v[204:207]
v_mfma_f32_16x16x32_bf16 v[208:211], v[236:239], v[84:87], v[208:211]
v_mfma_f32_16x16x32_bf16 v[208:211], v[232:235], v[60:63], v[208:211]
v_mfma_f32_16x16x32_bf16 v[212:215], v[232:235], v[68:71], v[212:215]
v_mfma_f32_16x16x32_bf16 v[212:215], v[236:239], v[92:95], v[212:215]
s_waitcnt lgkmcnt(2)
v_mfma_f32_16x16x32_bf16 v[200:203], v[216:219], v[92:95], v[200:203]
s_waitcnt lgkmcnt(0)
v_mfma_f32_16x16x32_bf16 v[200:203], v[220:223], v[68:71], v[200:203]
v_mfma_f32_16x16x32_bf16 v[196:199], v[220:223], v[60:63], v[196:199]
v_mfma_f32_16x16x32_bf16 v[196:199], v[216:219], v[84:87], v[196:199]
s_barrier
v_mfma_f32_16x16x32_bf16 v[192:195], v[216:219], v[76:79], v[192:195]
v_mfma_f32_16x16x32_bf16 v[192:195], v[220:223], v[52:55], v[192:195]
s_barrier
v_xor_b32 v244, 0x10000, v244
ds_read_b64_tr_b16 v[224:225], v244 offset:32768
ds_read_b64_tr_b16 v[226:227], v244 offset:33792
ds_read_b64_tr_b16 v[228:229], v244 offset:34816
ds_read_b64_tr_b16 v[230:231], v244 offset:35840
v_xor_b32 v245, 0x10000, v245
ds_read_b64_tr_b16 v[232:233], v245 offset:34816
ds_read_b64_tr_b16 v[234:235], v245 offset:35840
ds_read_b64_tr_b16 v[236:237], v245 offset:32768
ds_read_b64_tr_b16 v[238:239], v245 offset:33792
v_xor_b32 v247, 0x10000, v247
ds_read_b64_tr_b16 v[216:217], v247 offset:32768
ds_read_b64_tr_b16 v[218:219], v247 offset:33792
ds_read_b64_tr_b16 v[220:221], v247 offset:34816
ds_read_b64_tr_b16 v[222:223], v247 offset:35840
v_xor_b32 v246, 0x10000, v246
s_waitcnt lgkmcnt(10)
v_mfma_f32_16x16x32_bf16 v[192:195], v[224:227], v[96:99], v[192:195]
s_waitcnt lgkmcnt(8)
v_mfma_f32_16x16x32_bf16 v[192:195], v[228:231], v[120:123], v[192:195]
v_mfma_f32_16x16x32_bf16 v[196:199], v[228:231], v[128:131], v[196:199]
v_mfma_f32_16x16x32_bf16 v[196:199], v[224:227], v[104:107], v[196:199]
v_mfma_f32_16x16x32_bf16 v[200:203], v[224:227], v[112:115], v[200:203]
ds_read_b64_tr_b16 v[224:225], v246 offset:34816
ds_read_b64_tr_b16 v[226:227], v246 offset:35840
v_mfma_f32_16x16x32_bf16 v[200:203], v[228:231], v[136:139], v[200:203]
ds_read_b64_tr_b16 v[228:229], v246 offset:32768
ds_read_b64_tr_b16 v[230:231], v246 offset:33792
s_waitcnt lgkmcnt(10)
v_mfma_f32_16x16x32_bf16 v[212:215], v[232:235], v[136:139], v[212:215]
s_waitcnt lgkmcnt(8)
v_mfma_f32_16x16x32_bf16 v[212:215], v[236:239], v[112:115], v[212:215]
v_mfma_f32_16x16x32_bf16 v[208:211], v[236:239], v[104:107], v[208:211]
v_mfma_f32_16x16x32_bf16 v[208:211], v[232:235], v[128:131], v[208:211]
v_mfma_f32_16x16x32_bf16 v[204:207], v[232:235], v[120:123], v[204:207]
v_mfma_f32_16x16x32_bf16 v[204:207], v[236:239], v[96:99], v[204:207]
s_waitcnt lgkmcnt(6)
v_mfma_f32_16x16x32_bf16 v[204:207], v[216:219], v[100:103], v[204:207]
s_waitcnt lgkmcnt(4)
v_mfma_f32_16x16x32_bf16 v[204:207], v[220:223], v[124:127], v[204:207]
v_mfma_f32_16x16x32_bf16 v[208:211], v[220:223], v[132:135], v[208:211]
v_mfma_f32_16x16x32_bf16 v[208:211], v[216:219], v[108:111], v[208:211]
v_mfma_f32_16x16x32_bf16 v[212:215], v[216:219], v[116:119], v[212:215]
v_mfma_f32_16x16x32_bf16 v[212:215], v[220:223], v[140:143], v[212:215]
s_waitcnt lgkmcnt(2)
v_mfma_f32_16x16x32_bf16 v[200:203], v[224:227], v[140:143], v[200:203]
s_waitcnt lgkmcnt(0)
v_mfma_f32_16x16x32_bf16 v[200:203], v[228:231], v[116:119], v[200:203]
v_mfma_f32_16x16x32_bf16 v[196:199], v[228:231], v[108:111], v[196:199]
v_mfma_f32_16x16x32_bf16 v[196:199], v[224:227], v[132:135], v[196:199]
s_barrier
v_mfma_f32_16x16x32_bf16 v[192:195], v[224:227], v[124:127], v[192:195]
v_mfma_f32_16x16x32_bf16 v[192:195], v[228:231], v[100:103], v[192:195]
s_barrier
s_barrier
s_barrier
v_xor_b32 v244, 0x10000, v244
ds_read_b64_tr_b16 v[232:233], v244 offset:32768
ds_read_b64_tr_b16 v[234:235], v244 offset:33792
ds_read_b64_tr_b16 v[236:237], v244 offset:34816
ds_read_b64_tr_b16 v[238:239], v244 offset:35840
v_xor_b32 v246, 0x10000, v246
ds_read_b64_tr_b16 v[216:217], v246 offset:32768
ds_read_b64_tr_b16 v[218:219], v246 offset:33792
ds_read_b64_tr_b16 v[220:221], v246 offset:34816
ds_read_b64_tr_b16 v[222:223], v246 offset:35840
v_xor_b32 v247, 0x10000, v247
ds_read_b64_tr_b16 v[224:225], v247 offset:34816
ds_read_b64_tr_b16 v[226:227], v247 offset:35840
ds_read_b64_tr_b16 v[228:229], v247 offset:32768
ds_read_b64_tr_b16 v[230:231], v247 offset:33792
v_xor_b32 v245, 0x10000, v245
s_waitcnt lgkmcnt(10)
v_mfma_f32_16x16x32_bf16 v[192:195], v[232:235], v[144:147], v[192:195]
s_waitcnt lgkmcnt(8)
v_mfma_f32_16x16x32_bf16 v[192:195], v[236:239], v[168:171], v[192:195]
s_waitcnt lgkmcnt(6)
v_mfma_f32_16x16x32_bf16 v[192:195], v[216:219], v[148:151], v[192:195]
s_waitcnt lgkmcnt(4)
v_mfma_f32_16x16x32_bf16 v[192:195], v[220:223], v[172:175], v[192:195]
v_mfma_f32_16x16x32_bf16 v[196:199], v[220:223], v[180:183], v[196:199]
v_mfma_f32_16x16x32_bf16 v[196:199], v[216:219], v[156:159], v[196:199]
v_mfma_f32_16x16x32_bf16 v[196:199], v[236:239], v[176:179], v[196:199]
s_nop 4
v_mul_f32 v192, v192, v240
v_mul_f32 v193, v193, v240
v_mfma_f32_16x16x32_bf16 v[196:199], v[232:235], v[152:155], v[196:199]
v_mul_f32 v194, v194, v240
v_mul_f32 v195, v195, v240
v_mfma_f32_16x16x32_bf16 v[200:203], v[232:235], v[160:163], v[200:203]
ds_read_b64_tr_b16 v[232:233], v245 offset:34816
ds_read_b64_tr_b16 v[234:235], v245 offset:35840
v_mfma_f32_16x16x32_bf16 v[200:203], v[236:239], v[184:187], v[200:203]
ds_read_b64_tr_b16 v[236:237], v245 offset:32768
ds_read_b64_tr_b16 v[238:239], v245 offset:33792
v_mfma_f32_16x16x32_bf16 v[200:203], v[216:219], v[164:167], v[200:203]
v_cvt_pk_bf16_f32 v192, v192, v193
v_cvt_pk_bf16_f32 v193, v194, v195
v_mfma_f32_16x16x32_bf16 v[200:203], v[220:223], v[188:191], v[200:203]
v_mul_f32 v196, v196, v241
v_mul_f32 v197, v197, v241
s_waitcnt lgkmcnt(6)
v_mfma_f32_16x16x32_bf16 v[212:215], v[224:227], v[188:191], v[212:215]
v_mul_f32 v198, v198, v241
v_mul_f32 v199, v199, v241
s_waitcnt lgkmcnt(4)
v_mfma_f32_16x16x32_bf16 v[212:215], v[228:231], v[164:167], v[212:215]
v_cvt_pk_bf16_f32 v196, v196, v197
v_cvt_pk_bf16_f32 v197, v198, v199
s_waitcnt lgkmcnt(2)
v_mfma_f32_16x16x32_bf16 v[212:215], v[232:235], v[184:187], v[212:215]
v_mul_f32 v200, v200, v242
v_mul_f32 v201, v201, v242
s_waitcnt lgkmcnt(0)
v_mfma_f32_16x16x32_bf16 v[212:215], v[236:239], v[160:163], v[212:215]
v_mul_f32 v202, v202, v242
v_mul_f32 v203, v203, v242
v_mfma_f32_16x16x32_bf16 v[208:211], v[236:239], v[152:155], v[208:211]
v_cvt_pk_bf16_f32 v200, v200, v201
v_cvt_pk_bf16_f32 v201, v202, v203
v_mfma_f32_16x16x32_bf16 v[208:211], v[232:235], v[176:179], v[208:211]
v_mfma_f32_16x16x32_bf16 v[208:211], v[228:231], v[156:159], v[208:211]
s_nop 0
v_mul_f32 v212, v212, v242
v_mul_f32 v213, v213, v242
v_mfma_f32_16x16x32_bf16 v[208:211], v[224:227], v[180:183], v[208:211]
v_mul_f32 v214, v214, v242
v_mul_f32 v215, v215, v242
v_mfma_f32_16x16x32_bf16 v[204:207], v[224:227], v[172:175], v[204:207]
v_cvt_pk_bf16_f32 v202, v212, v213
v_cvt_pk_bf16_f32 v203, v214, v215
v_mfma_f32_16x16x32_bf16 v[204:207], v[228:231], v[148:151], v[204:207]
ds_write_b128 v243, v[200:203] offset:2048
v_mfma_f32_16x16x32_bf16 v[204:207], v[232:235], v[168:171], v[204:207]
v_mul_f32 v208, v208, v241
v_mul_f32 v209, v209, v241
v_mfma_f32_16x16x32_bf16 v[204:207], v[236:239], v[144:147], v[204:207]
v_mul_f32 v210, v210, v241
v_mul_f32 v211, v211, v241
v_cvt_pk_bf16_f32 v198, v208, v209
v_cvt_pk_bf16_f32 v199, v210, v211
ds_write_b128 v243, v[196:199] offset:1024
s_nop 2
v_mul_f32 v204, v204, v240
v_mul_f32 v205, v205, v240
v_mul_f32 v206, v206, v240
v_mul_f32 v207, v207, v240
v_cvt_pk_bf16_f32 v194, v204, v205
v_cvt_pk_bf16_f32 v195, v206, v207
ds_write_b128 v243, v[192:195]
s_waitcnt lgkmcnt(0)
s_barrier
s_barrier
s_barrier
v_xor_b32 v244, 0x10000, v244
ds_read_b64_tr_b16 v[216:217], v244 offset:49152
ds_read_b64_tr_b16 v[218:219], v244 offset:50176
ds_read_b64_tr_b16 v[220:221], v244 offset:51200
ds_read_b64_tr_b16 v[222:223], v244 offset:52224
v_xor_b32 v245, 0x10000, v245
ds_read_b64_tr_b16 v[224:225], v245 offset:51200
ds_read_b64_tr_b16 v[226:227], v245 offset:52224
ds_read_b64_tr_b16 v[228:229], v245 offset:49152
ds_read_b64_tr_b16 v[230:231], v245 offset:50176
v_xor_b32 v247, 0x10000, v247
ds_read_b64_tr_b16 v[232:233], v247 offset:49152
ds_read_b64_tr_b16 v[234:235], v247 offset:50176
ds_read_b64_tr_b16 v[236:237], v247 offset:51200
ds_read_b64_tr_b16 v[238:239], v247 offset:52224
v_xor_b32 v246, 0x10000, v246
s_waitcnt lgkmcnt(10)
v_mfma_f32_16x16x32_bf16 v[192:195], v[216:219], v[0:3], 0
s_waitcnt lgkmcnt(8)
v_mfma_f32_16x16x32_bf16 v[192:195], v[220:223], v[24:27], v[192:195]
v_mfma_f32_16x16x32_bf16 v[196:199], v[220:223], v[32:35], 0
v_mfma_f32_16x16x32_bf16 v[196:199], v[216:219], v[8:11], v[196:199]
v_mfma_f32_16x16x32_bf16 v[200:203], v[216:219], v[16:19], 0
ds_read_b64_tr_b16 v[216:217], v246 offset:51200
ds_read_b64_tr_b16 v[218:219], v246 offset:52224
v_mfma_f32_16x16x32_bf16 v[200:203], v[220:223], v[40:43], v[200:203]
ds_read_b64_tr_b16 v[220:221], v246 offset:49152
ds_read_b64_tr_b16 v[222:223], v246 offset:50176
s_waitcnt lgkmcnt(10)
v_mfma_f32_16x16x32_bf16 v[212:215], v[224:227], v[40:43], 0
s_waitcnt lgkmcnt(8)
v_mfma_f32_16x16x32_bf16 v[212:215], v[228:231], v[16:19], v[212:215]
v_mfma_f32_16x16x32_bf16 v[208:211], v[228:231], v[8:11], 0
v_mfma_f32_16x16x32_bf16 v[208:211], v[224:227], v[32:35], v[208:211]
v_mfma_f32_16x16x32_bf16 v[204:207], v[224:227], v[24:27], 0
v_mfma_f32_16x16x32_bf16 v[204:207], v[228:231], v[0:3], v[204:207]
s_waitcnt lgkmcnt(6)
v_mfma_f32_16x16x32_bf16 v[204:207], v[232:235], v[4:7], v[204:207]
s_waitcnt lgkmcnt(4)
v_mfma_f32_16x16x32_bf16 v[204:207], v[236:239], v[28:31], v[204:207]
v_mfma_f32_16x16x32_bf16 v[208:211], v[236:239], v[36:39], v[208:211]
v_mfma_f32_16x16x32_bf16 v[208:211], v[232:235], v[12:15], v[208:211]
v_mfma_f32_16x16x32_bf16 v[212:215], v[232:235], v[20:23], v[212:215]
v_mfma_f32_16x16x32_bf16 v[212:215], v[236:239], v[44:47], v[212:215]
s_waitcnt lgkmcnt(2)
v_mfma_f32_16x16x32_bf16 v[200:203], v[216:219], v[44:47], v[200:203]
s_waitcnt lgkmcnt(0)
v_mfma_f32_16x16x32_bf16 v[200:203], v[220:223], v[20:23], v[200:203]
v_mfma_f32_16x16x32_bf16 v[196:199], v[220:223], v[12:15], v[196:199]
v_mfma_f32_16x16x32_bf16 v[196:199], v[216:219], v[36:39], v[196:199]
s_barrier
v_xor_b32 v244, 0x10000, v244
ds_read_b64_tr_b16 v[224:225], v244 offset:16384
v_mfma_f32_16x16x32_bf16 v[192:195], v[216:219], v[28:31], v[192:195]
ds_read_b64_tr_b16 v[226:227], v244 offset:17408
ds_read_b64_tr_b16 v[228:229], v244 offset:18432
v_mfma_f32_16x16x32_bf16 v[192:195], v[220:223], v[4:7], v[192:195]
ds_read_b64_tr_b16 v[230:231], v244 offset:19456
v_xor_b32 v245, 0x10000, v245
ds_read_b64_tr_b16 v[232:233], v245 offset:18432
ds_read_b64_tr_b16 v[234:235], v245 offset:19456
ds_read_b64_tr_b16 v[236:237], v245 offset:16384
ds_read_b64_tr_b16 v[238:239], v245 offset:17408
v_xor_b32 v247, 0x10000, v247
ds_read_b64_tr_b16 v[216:217], v247 offset:16384
ds_read_b64_tr_b16 v[218:219], v247 offset:17408
ds_read_b64_tr_b16 v[220:221], v247 offset:18432
ds_read_b64_tr_b16 v[222:223], v247 offset:19456
v_xor_b32 v246, 0x10000, v246
s_waitcnt lgkmcnt(10)
v_mfma_f32_16x16x32_bf16 v[192:195], v[224:227], v[48:51], v[192:195]
s_waitcnt lgkmcnt(8)
v_mfma_f32_16x16x32_bf16 v[192:195], v[228:231], v[72:75], v[192:195]
v_mfma_f32_16x16x32_bf16 v[196:199], v[228:231], v[80:83], v[196:199]
v_mfma_f32_16x16x32_bf16 v[196:199], v[224:227], v[56:59], v[196:199]
v_mfma_f32_16x16x32_bf16 v[200:203], v[224:227], v[64:67], v[200:203]
ds_read_b64_tr_b16 v[224:225], v246 offset:18432
ds_read_b64_tr_b16 v[226:227], v246 offset:19456
v_mfma_f32_16x16x32_bf16 v[200:203], v[228:231], v[88:91], v[200:203]
ds_read_b64_tr_b16 v[228:229], v246 offset:16384
ds_read_b64_tr_b16 v[230:231], v246 offset:17408
s_waitcnt lgkmcnt(10)
v_mfma_f32_16x16x32_bf16 v[212:215], v[232:235], v[88:91], v[212:215]
s_waitcnt lgkmcnt(8)
v_mfma_f32_16x16x32_bf16 v[212:215], v[236:239], v[64:67], v[212:215]
v_mfma_f32_16x16x32_bf16 v[208:211], v[236:239], v[56:59], v[208:211]
v_mfma_f32_16x16x32_bf16 v[208:211], v[232:235], v[80:83], v[208:211]
v_mfma_f32_16x16x32_bf16 v[204:207], v[232:235], v[72:75], v[204:207]
v_mfma_f32_16x16x32_bf16 v[204:207], v[236:239], v[48:51], v[204:207]
s_waitcnt lgkmcnt(6)
v_mfma_f32_16x16x32_bf16 v[204:207], v[216:219], v[52:55], v[204:207]
s_waitcnt lgkmcnt(4)
v_mfma_f32_16x16x32_bf16 v[204:207], v[220:223], v[76:79], v[204:207]
v_mfma_f32_16x16x32_bf16 v[208:211], v[220:223], v[84:87], v[208:211]
v_mfma_f32_16x16x32_bf16 v[208:211], v[216:219], v[60:63], v[208:211]
v_mfma_f32_16x16x32_bf16 v[212:215], v[216:219], v[68:71], v[212:215]
v_mfma_f32_16x16x32_bf16 v[212:215], v[220:223], v[92:95], v[212:215]
s_waitcnt lgkmcnt(2)
v_mfma_f32_16x16x32_bf16 v[200:203], v[224:227], v[92:95], v[200:203]
s_waitcnt lgkmcnt(0)
v_mfma_f32_16x16x32_bf16 v[200:203], v[228:231], v[68:71], v[200:203]
v_mfma_f32_16x16x32_bf16 v[196:199], v[228:231], v[60:63], v[196:199]
v_mfma_f32_16x16x32_bf16 v[196:199], v[224:227], v[84:87], v[196:199]
s_barrier
v_xor_b32 v244, 0x10000, v244
ds_read_b64_tr_b16 v[232:233], v244
v_mfma_f32_16x16x32_bf16 v[192:195], v[224:227], v[76:79], v[192:195]
ds_read_b64_tr_b16 v[234:235], v244 offset:1024
ds_read_b64_tr_b16 v[236:237], v244 offset:2048
v_mfma_f32_16x16x32_bf16 v[192:195], v[228:231], v[52:55], v[192:195]
ds_read_b64_tr_b16 v[238:239], v244 offset:3072
v_xor_b32 v245, 0x10000, v245
ds_read_b64_tr_b16 v[216:217], v245 offset:2048
ds_read_b64_tr_b16 v[218:219], v245 offset:3072
ds_read_b64_tr_b16 v[220:221], v245
ds_read_b64_tr_b16 v[222:223], v245 offset:1024
v_xor_b32 v247, 0x10000, v247
ds_read_b64_tr_b16 v[224:225], v247
ds_read_b64_tr_b16 v[226:227], v247 offset:1024
ds_read_b64_tr_b16 v[228:229], v247 offset:2048
ds_read_b64_tr_b16 v[230:231], v247 offset:3072
v_xor_b32 v246, 0x10000, v246
s_waitcnt lgkmcnt(10)
v_mfma_f32_16x16x32_bf16 v[192:195], v[232:235], v[96:99], v[192:195]
s_waitcnt lgkmcnt(8)
v_mfma_f32_16x16x32_bf16 v[192:195], v[236:239], v[120:123], v[192:195]
v_mfma_f32_16x16x32_bf16 v[196:199], v[236:239], v[128:131], v[196:199]
v_mfma_f32_16x16x32_bf16 v[196:199], v[232:235], v[104:107], v[196:199]
v_mfma_f32_16x16x32_bf16 v[200:203], v[232:235], v[112:115], v[200:203]
ds_read_b64_tr_b16 v[232:233], v246 offset:2048
ds_read_b64_tr_b16 v[234:235], v246 offset:3072
v_mfma_f32_16x16x32_bf16 v[200:203], v[236:239], v[136:139], v[200:203]
ds_read_b64_tr_b16 v[236:237], v246
ds_read_b64_tr_b16 v[238:239], v246 offset:1024
s_waitcnt lgkmcnt(10)
v_mfma_f32_16x16x32_bf16 v[212:215], v[216:219], v[136:139], v[212:215]
s_waitcnt lgkmcnt(8)
v_mfma_f32_16x16x32_bf16 v[212:215], v[220:223], v[112:115], v[212:215]
v_mfma_f32_16x16x32_bf16 v[208:211], v[220:223], v[104:107], v[208:211]
v_mfma_f32_16x16x32_bf16 v[208:211], v[216:219], v[128:131], v[208:211]
v_mfma_f32_16x16x32_bf16 v[204:207], v[216:219], v[120:123], v[204:207]
v_mfma_f32_16x16x32_bf16 v[204:207], v[220:223], v[96:99], v[204:207]
s_waitcnt lgkmcnt(6)
v_mfma_f32_16x16x32_bf16 v[204:207], v[224:227], v[100:103], v[204:207]
s_waitcnt lgkmcnt(4)
v_mfma_f32_16x16x32_bf16 v[204:207], v[228:231], v[124:127], v[204:207]
v_mfma_f32_16x16x32_bf16 v[208:211], v[228:231], v[132:135], v[208:211]
v_mfma_f32_16x16x32_bf16 v[208:211], v[224:227], v[108:111], v[208:211]
v_mfma_f32_16x16x32_bf16 v[212:215], v[224:227], v[116:119], v[212:215]
v_mfma_f32_16x16x32_bf16 v[212:215], v[228:231], v[140:143], v[212:215]
s_waitcnt lgkmcnt(2)
v_mfma_f32_16x16x32_bf16 v[200:203], v[232:235], v[140:143], v[200:203]
s_waitcnt lgkmcnt(0)
v_mfma_f32_16x16x32_bf16 v[200:203], v[236:239], v[116:119], v[200:203]
v_mfma_f32_16x16x32_bf16 v[196:199], v[236:239], v[108:111], v[196:199]
v_mfma_f32_16x16x32_bf16 v[196:199], v[232:235], v[132:135], v[196:199]
s_barrier
v_mfma_f32_16x16x32_bf16 v[192:195], v[232:235], v[124:127], v[192:195]
v_mfma_f32_16x16x32_bf16 v[192:195], v[236:239], v[100:103], v[192:195]
s_barrier
ds_read_b64_tr_b16 v[216:217], v244 offset:16384
ds_read_b64_tr_b16 v[218:219], v244 offset:17408
ds_read_b64_tr_b16 v[220:221], v244 offset:18432
ds_read_b64_tr_b16 v[222:223], v244 offset:19456
ds_read_b64_tr_b16 v[224:225], v246 offset:16384
ds_read_b64_tr_b16 v[226:227], v246 offset:17408
ds_read_b64_tr_b16 v[228:229], v246 offset:18432
ds_read_b64_tr_b16 v[230:231], v246 offset:19456
ds_read_b64_tr_b16 v[232:233], v247 offset:18432
ds_read_b64_tr_b16 v[234:235], v247 offset:19456
ds_read_b64_tr_b16 v[236:237], v247 offset:16384
ds_read_b64_tr_b16 v[238:239], v247 offset:17408
s_waitcnt lgkmcnt(10)
v_mfma_f32_16x16x32_bf16 v[192:195], v[216:219], v[144:147], v[192:195]
s_waitcnt lgkmcnt(8)
v_mfma_f32_16x16x32_bf16 v[192:195], v[220:223], v[168:171], v[192:195]
s_waitcnt lgkmcnt(6)
v_mfma_f32_16x16x32_bf16 v[192:195], v[224:227], v[148:151], v[192:195]
s_waitcnt lgkmcnt(4)
v_mfma_f32_16x16x32_bf16 v[192:195], v[228:231], v[172:175], v[192:195]
v_mfma_f32_16x16x32_bf16 v[196:199], v[228:231], v[180:183], v[196:199]
v_mfma_f32_16x16x32_bf16 v[196:199], v[224:227], v[156:159], v[196:199]
v_mfma_f32_16x16x32_bf16 v[196:199], v[220:223], v[176:179], v[196:199]
s_nop 4
v_mul_f32 v192, v192, v240
v_mul_f32 v193, v193, v240
v_mfma_f32_16x16x32_bf16 v[196:199], v[216:219], v[152:155], v[196:199]
v_mul_f32 v194, v194, v240
v_mul_f32 v195, v195, v240
v_mfma_f32_16x16x32_bf16 v[200:203], v[216:219], v[160:163], v[200:203]
ds_read_b64_tr_b16 v[216:217], v245 offset:18432
ds_read_b64_tr_b16 v[218:219], v245 offset:19456
v_mfma_f32_16x16x32_bf16 v[200:203], v[220:223], v[184:187], v[200:203]
ds_read_b64_tr_b16 v[220:221], v245 offset:16384
ds_read_b64_tr_b16 v[222:223], v245 offset:17408
v_mfma_f32_16x16x32_bf16 v[200:203], v[224:227], v[164:167], v[200:203]
v_cvt_pk_bf16_f32 v192, v192, v193
v_cvt_pk_bf16_f32 v193, v194, v195
v_mfma_f32_16x16x32_bf16 v[200:203], v[228:231], v[188:191], v[200:203]
v_mul_f32 v196, v196, v241
v_mul_f32 v197, v197, v241
s_waitcnt lgkmcnt(6)
v_mfma_f32_16x16x32_bf16 v[212:215], v[232:235], v[188:191], v[212:215]
v_mul_f32 v198, v198, v241
v_mul_f32 v199, v199, v241
s_waitcnt lgkmcnt(4)
v_mfma_f32_16x16x32_bf16 v[212:215], v[236:239], v[164:167], v[212:215]
v_cvt_pk_bf16_f32 v196, v196, v197
v_cvt_pk_bf16_f32 v197, v198, v199
s_waitcnt lgkmcnt(2)
v_mfma_f32_16x16x32_bf16 v[212:215], v[216:219], v[184:187], v[212:215]
v_mul_f32 v200, v200, v242
v_mul_f32 v201, v201, v242
s_waitcnt lgkmcnt(0)
v_mfma_f32_16x16x32_bf16 v[212:215], v[220:223], v[160:163], v[212:215]
v_mul_f32 v202, v202, v242
v_mul_f32 v203, v203, v242
v_mfma_f32_16x16x32_bf16 v[208:211], v[220:223], v[152:155], v[208:211]
v_cvt_pk_bf16_f32 v200, v200, v201
v_cvt_pk_bf16_f32 v201, v202, v203
v_mfma_f32_16x16x32_bf16 v[208:211], v[216:219], v[176:179], v[208:211]
v_mfma_f32_16x16x32_bf16 v[208:211], v[236:239], v[156:159], v[208:211]
s_nop 0
v_mul_f32 v212, v212, v242
v_mul_f32 v213, v213, v242
v_mfma_f32_16x16x32_bf16 v[208:211], v[232:235], v[180:183], v[208:211]
v_mul_f32 v214, v214, v242
v_mul_f32 v215, v215, v242
v_mfma_f32_16x16x32_bf16 v[204:207], v[232:235], v[172:175], v[204:207]
v_cvt_pk_bf16_f32 v202, v212, v213
v_cvt_pk_bf16_f32 v203, v214, v215
v_mfma_f32_16x16x32_bf16 v[204:207], v[236:239], v[148:151], v[204:207]
ds_write_b128 v243, v[200:203] offset:2048
v_mfma_f32_16x16x32_bf16 v[204:207], v[216:219], v[168:171], v[204:207]
v_mul_f32 v208, v208, v241
v_mul_f32 v209, v209, v241
v_mfma_f32_16x16x32_bf16 v[204:207], v[220:223], v[144:147], v[204:207]
v_mul_f32 v210, v210, v241
v_mul_f32 v211, v211, v241
v_cvt_pk_bf16_f32 v198, v208, v209
v_cvt_pk_bf16_f32 v199, v210, v211
ds_write_b128 v243, v[196:199] offset:1024
s_nop 2
v_mul_f32 v204, v204, v240
v_mul_f32 v205, v205, v240
v_mul_f32 v206, v206, v240
v_mul_f32 v207, v207, v240
v_cvt_pk_bf16_f32 v194, v204, v205
v_cvt_pk_bf16_f32 v195, v206, v207
ds_write_b128 v243, v[192:195]
s_waitcnt lgkmcnt(0)
s_barrier
v_mbcnt_lo_u32_b32 v224, -1, 0
v_mbcnt_hi_u32_b32 v224, -1, v224
v_lshlrev_b32 v226, 4, v224
v_lshlrev_b32 v227, 3, v224
v_and_b32 v229, 7, v224
v_lshlrev_b32 v229, 2, v229
s_lshl_b32 s44, s49, 9
s_lshl_b32 s45, s41, 7
s_add_u32 s44, s44, s45
v_add_u32 v229, s44, v229
v_and_b32 v228, 15, v224
v_mul_u32_u24 v228, 896, v228
v_lshrrev_b32 v225, 4, v224
v_lshl_add_u32 v228, v225, 3, v228
s_mul_i32 s44, s48, 344064
s_mul_i32 s45, s49, 6144
s_add_u32 s44, s44, s45
s_mul_i32 s45, s41, 1536
s_add_u32 s44, s44, s45
s_add_u32 s4, s78, s44
s_addc_u32 s5, s79, 0
s_mov_b32 s6, 302592
s_mov_b32 s7, 0x20000
s_mul_i32 s44, s48, 43008
s_add_u32 s28, s74, s44
s_addc_u32 s29, s75, 0
s_mov_b32 s30, 43008
s_mov_b32 s31, 0x20000
s_lshl_b32 s90, s41, 5
s_lshl_b32 s45, s49, 7
s_add_u32 s90, s90, s45
s_add_u32 s91, s90, 14336
s_add_u32 s92, s90, 28672
s_mov_b32 s93, 1
s_mov_b32 s94, 0
v_bfe_u32 v231, v224, 2, 2
v_cmp_eq_u32 vcc, v231, v225
v_and_b32 v231, 1, v224
v_lshlrev_b32 v231, 4, v231
v_mov_b32 v232, 0x3f80
v_lshlrev_b32 v231, v231, v232
v_cndmask_b32 v231, 0, v231, vcc
v_and_b32 v233, 2, v224
v_cmp_eq_u32 vcc, 0, v233
v_mov_b32 v234, 0
s_nop 0
v_cndmask_b32 v232, v234, v231, vcc
v_cndmask_b32 v233, v231, v234, vcc
v_mov_b32 v234, v232
v_mov_b32 v235, v233
v_mov_b32 v0, 0
v_mov_b32 v1, 0
v_mov_b32 v16, 0
v_mov_b32 v17, 0
v_mov_b32 v32, 0
v_mov_b32 v33, 0
s_add_u32 s44, s49, 1
s_and_b32 s44, s44, 7
s_mul_i32 s65, s44, 43008
s_add_u32 s44, s49, 2
s_and_b32 s44, s44, 7
s_mul_i32 s66, s44, 43008
s_add_u32 s44, s49, 3
s_and_b32 s44, s44, 7
s_mul_i32 s67, s44, 43008
s_add_u32 s44, s49, 4
s_and_b32 s44, s44, 7
s_mul_i32 s68, s44, 43008
s_add_u32 s44, s49, 5
s_and_b32 s44, s44, 7
s_mul_i32 s69, s44, 43008
s_add_u32 s44, s49, 6
s_and_b32 s44, s44, 7
s_mul_i32 s70, s44, 43008
s_add_u32 s44, s49, 7
s_and_b32 s44, s44, 7
s_mul_i32 s71, s44, 43008
s_barrier
s_barrier
s_barrier
s_cmp_eq_u32 s49, 7
s_cbranch_scc1 L_rend_c1
s_barrier
ds_read_b128 v[96:99], v243 offset:3072
ds_read_b128 v[100:103], v243 offset:4096
ds_read_b128 v[104:107], v243 offset:5120
buffer_load_dword v230, v229, s[24:27], 0 offen sc1
L_rl_c1:
s_waitcnt vmcnt(0)
L_rl2_c1:
v_cmp_ne_u32 vcc, 0, v230
s_add_u32 s94, s94, 1
s_cmp_gt_u32 s94, 0x80000
s_cbranch_scc1 L_rsum_c1
s_and_b32 s95, vcc_lo, 0xff
s_andn2_b32 s95, s95, s93
s_cbranch_scc0 L_rp_c1
s_and_b32 s44, s95, 14
s_cbranch_scc0 L_rx_c1
s_bitcmp0_b32 s95, 1
s_cbranch_scc1 L_ra1_c1
buffer_load_dwordx2 v[2:3], v226, s[4:7], s65 offen sc1
buffer_load_dwordx2 v[18:19], v226, s[4:7], s65 offen offset:8 sc1
buffer_load_dwordx2 v[34:35], v227, s[4:7], s65 offen offset:1024 sc1
L_ra1_c1:
s_bitcmp0_b32 s95, 2
s_cbranch_scc1 L_ra2_c1
buffer_load_dwordx2 v[4:5], v226, s[4:7], s66 offen sc1
buffer_load_dwordx2 v[20:21], v226, s[4:7], s66 offen offset:8 sc1
buffer_load_dwordx2 v[36:37], v227, s[4:7], s66 offen offset:1024 sc1
L_ra2_c1:
s_bitcmp0_b32 s95, 3
s_cbranch_scc1 L_ra3_c1
buffer_load_dwordx2 v[6:7], v226, s[4:7], s67 offen sc1
buffer_load_dwordx2 v[22:23], v226, s[4:7], s67 offen offset:8 sc1
buffer_load_dwordx2 v[38:39], v227, s[4:7], s67 offen offset:1024 sc1
L_ra3_c1:
L_rx_c1:
s_and_b32 s44, s95, 48
s_cbranch_scc0 L_ry_c1
s_bitcmp0_b32 s95, 4
s_cbranch_scc1 L_ra4_c1
buffer_load_dwordx2 v[8:9], v226, s[4:7], s68 offen sc1
buffer_load_dwordx2 v[24:25], v226, s[4:7], s68 offen offset:8 sc1
buffer_load_dwordx2 v[40:41], v227, s[4:7], s68 offen offset:1024 sc1
L_ra4_c1:
s_bitcmp0_b32 s95, 5
s_cbranch_scc1 L_ra5_c1
buffer_load_dwordx2 v[10:11], v226, s[4:7], s69 offen sc1
buffer_load_dwordx2 v[26:27], v226, s[4:7], s69 offen offset:8 sc1
buffer_load_dwordx2 v[42:43], v227, s[4:7], s69 offen offset:1024 sc1
L_ra5_c1:
L_ry_c1:
s_and_b32 s44, s95, 192
s_cbranch_scc0 L_rz_c1
s_bitcmp0_b32 s95, 6
s_cbranch_scc1 L_ra6_c1
buffer_load_dwordx2 v[12:13], v226, s[4:7], s70 offen sc1
buffer_load_dwordx2 v[28:29], v226, s[4:7], s70 offen offset:8 sc1
buffer_load_dwordx2 v[44:45], v227, s[4:7], s70 offen offset:1024 sc1
L_ra6_c1:
s_bitcmp0_b32 s95, 7
s_cbranch_scc1 L_ra7_c1
buffer_load_dwordx2 v[14:15], v226, s[4:7], s71 offen sc1
buffer_load_dwordx2 v[30:31], v226, s[4:7], s71 offen offset:8 sc1
buffer_load_dwordx2 v[46:47], v227, s[4:7], s71 offen offset:1024 sc1
L_ra7_c1:
L_rz_c1:
s_or_b32 s93, s93, s95
s_cmp_eq_u32 s93, 0xff
s_cbranch_scc1 L_rsum_c1
L_rp_c1:
buffer_load_dword v230, v229, s[24:27], 0 offen sc1
s_branch L_rl_c1
L_rsum_c1:
s_waitcnt vmcnt(0) lgkmcnt(0)
v_mfma_f32_16x16x32_bf16 v[96:99], v[232:235], v[0:3], v[96:99]
v_mfma_f32_16x16x32_bf16 v[96:99], v[232:235], v[4:7], v[96:99]
v_mfma_f32_16x16x32_bf16 v[96:99], v[232:235], v[8:11], v[96:99]
v_mfma_f32_16x16x32_bf16 v[96:99], v[232:235], v[12:15], v[96:99]
v_mfma_f32_16x16x32_bf16 v[100:103], v[232:235], v[16:19], v[100:103]
v_mfma_f32_16x16x32_bf16 v[100:103], v[232:235], v[20:23], v[100:103]
v_mfma_f32_16x16x32_bf16 v[100:103], v[232:235], v[24:27], v[100:103]
v_mfma_f32_16x16x32_bf16 v[100:103], v[232:235], v[28:31], v[100:103]
v_mfma_f32_16x16x32_bf16 v[104:107], v[232:235], v[32:35], v[104:107]
v_mfma_f32_16x16x32_bf16 v[104:107], v[232:235], v[36:39], v[104:107]
v_mfma_f32_16x16x32_bf16 v[104:107], v[232:235], v[40:43], v[104:107]
v_mfma_f32_16x16x32_bf16 v[104:107], v[232:235], v[44:47], v[104:107]
v_cvt_pk_bf16_f32 v96, v96, v97
v_cvt_pk_bf16_f32 v97, v98, v99
buffer_store_dwordx2 v[96:97], v228, s[28:31], s90 offen
s_nop 0
v_cvt_pk_bf16_f32 v100, v100, v101
v_cvt_pk_bf16_f32 v101, v102, v103
buffer_store_dwordx2 v[100:101], v228, s[28:31], s91 offen
s_nop 0
v_cvt_pk_bf16_f32 v104, v104, v105
v_cvt_pk_bf16_f32 v105, v106, v107
buffer_store_dwordx2 v[104:105], v228, s[28:31], s92 offen
L_rend_c1:
L_last_c1:
s_endpgm
.section .rodata,"a"
.p2align 6
.amdhsa_kernel standalone__gqa_block_cached__near_ridge_kernel
  .amdhsa_next_free_vgpr 256
  .amdhsa_next_free_sgpr 102
  .amdhsa_accum_offset 256
  .amdhsa_group_segment_fixed_size 0
  .amdhsa_kernarg_size 64
  .amdhsa_user_sgpr_count 2
  .amdhsa_user_sgpr_kernarg_segment_ptr 1
  .amdhsa_system_sgpr_workgroup_id_x 1
  .amdhsa_float_denorm_mode_32 3
.end_amdhsa_kernel
```
